```python
import torch

def _softmax(x, axis=-1):
    return torch.softmax(x, dim=axis)

def _gelu(x):
    return torch.nn.functional.gelu(x, approximate='tanh')

def _silu(x):
    return torch.nn.functional.silu(x)

def _sigmoid(x):
    return torch.sigmoid(x)

def _layernorm(x, axis=-1, eps=1e-05):
    m = x.mean(dim=axis, keepdim=True)
    v = x.var(dim=axis, keepdim=True, unbiased=False)
    return (x - m) / torch.sqrt(v + eps)

def _scatter_add(tgt, idx, src, axis=0):
    return tgt.clone().index_add_(axis, idx, src)

def _segment_sum(src, seg, n):
    out = torch.zeros((n,) + src.shape[1:], dtype=src.dtype)
    return out.index_add_(0, seg, src)

def _pad(x, pw):
    flat = tuple((v for pair in reversed(pw) for v in pair))
    return torch.nn.functional.pad(x, flat)
kernel_name = 'adaLN_cond__gqa_block_cached__glu_gated_geglu__prompt'

def setup_inputs():

    _w = lambda a: (lambda t: t.to(torch.bfloat16) if t.is_floating_point() else t)(torch.as_tensor(a))

    def _A_setup():
        B, Sq, D = (1, 2048, 576)
        Hq, Hkv, Sk, Dh = (32, 16, 2048, 128)
        assert Hq % Hkv == 0, (Hq, Hkv)
        return {'x': _w((lambda *s: torch.randn(*s, dtype=torch.bfloat16) * 0.05)(B, Sq, D)), 'k_cache': _w((lambda *s: torch.randn(*s, dtype=torch.bfloat16) * 0.8)(B, Hkv, Sk, Dh)), 'v_cache': _w((lambda *s: torch.randn(*s, dtype=torch.bfloat16) * 3.2)(B, Hkv, Sk, Dh)), 'wq': _w((lambda *s: torch.randn(*s, dtype=torch.bfloat16) * 0.8)(D, Hq * Dh) * D ** (-0.5)), 'wo': _w((lambda *s: torch.randn(*s, dtype=torch.bfloat16) * 3.2)(Hq * Dh, D) * (Hq * Dh) ** (-0.5))}
    _A_in = _A_setup()

    def _B_setup():
        B, S, Dm, Df = (1, 2048, 576, 4608)
        return {'x': _w((lambda *s: torch.randn(*s, dtype=torch.bfloat16) * 0.05)(B, S, Dm)), 'w_gate': _w((lambda *s: torch.randn(*s, dtype=torch.bfloat16) * 3.2)(Dm, Df) * Dm ** (-0.5)), 'w_up': _w((lambda *s: torch.randn(*s, dtype=torch.bfloat16) * 3.2)(Dm, Df) * Dm ** (-0.5)), 'w_down': _w((lambda *s: torch.randn(*s, dtype=torch.bfloat16) * 3.2)(Df, Dm) * Df ** (-0.5))}
    _B_in = _B_setup()
    return {'A_x': _A_in['x'], 'A_k_cache': _A_in['k_cache'], 'A_v_cache': _A_in['v_cache'], 'A_wq': _A_in['wq'], 'A_wo': _A_in['wo'], 'B_x': _B_in['x'], 'B_w_gate': _B_in['w_gate'], 'B_w_up': _B_in['w_up'], 'B_w_down': _B_in['w_down'], 'c': _w((lambda *s: torch.randn(*s, dtype=torch.bfloat16) * 0.4)(1, 576) * 8.0), 'w_mod': _w((lambda *s: torch.randn(*s, dtype=torch.bfloat16) * 0.4)(576, 6 * 576) * 576 ** (-0.5) * 8.0)}

def reference(A_x, A_k_cache, A_v_cache, A_wq, A_wo, B_x, B_w_gate, B_w_up, B_w_down, c, w_mod):

    def _A_ref(x, k_cache, v_cache, wq, wo):
        B, Sq, D = x.shape
        Hq, Dh = (32, 128)
        Hkv = k_cache.shape[1]
        rep = Hq // Hkv
        q = (lambda x, *d: x.permute(*d))((x @ wq).reshape(B, Sq, Hq, Dh), 0, 2, 1, 3)
        k = (lambda x, n, axis: torch.repeat_interleave(x, n, dim=axis))(k_cache, rep, axis=1)
        v = (lambda x, n, axis: torch.repeat_interleave(x, n, dim=axis))(v_cache, rep, axis=1)
        scores = torch.einsum('bhqd,bhkd->bhqk', q, k) * Dh ** (-0.5)
        p = _softmax(scores, axis=-1)
        o = torch.einsum('bhqk,bhkd->bhqd', p, v)
        return (lambda x, *d: x.permute(*d))(o, 0, 2, 1, 3).reshape(B, Sq, Hq * Dh) @ wo

    def _B_ref(x, w_gate, w_up, w_down):
        g = torch.einsum('bsd,df->bsf', x, w_gate)
        u = torch.einsum('bsd,df->bsf', x, w_up)
        h = _gelu(g) * u
        return torch.einsum('bsf,fd->bsd', h, w_down)
    x = A_x
    mod = (_silu(c) @ w_mod).reshape(c.shape[0], 6, 1, -1)
    sa, ca, ga, sb, cb, gb = (mod[:, 0].clone(), mod[:, 1].clone(), mod[:, 2].clone(), mod[:, 3].clone(), mod[:, 4].clone(), mod[:, 5].clone())
    h = _layernorm(x, axis=-1) * (1 + ca) + sa
    x = x + ga * _A_ref(h, A_k_cache, A_v_cache, A_wq, A_wo)
    h = _layernorm(x, axis=-1) * (1 + cb) + sb
    x = x + gb * _B_ref(h, B_w_gate, B_w_up, B_w_down)
    return x
```

```asm
; @launch kernel=k1_kernel grid=(256,1,1) block=(256,1,1) lds=1024
; @launch kernel=adaLN_cond__gqa_block_cached__glu_gated_geglu__prompt_kernel grid=(256,1,1) block=(256,1,1) lds=147456
; @launch kernel=k45_kernel grid=(256,1,1) block=(256,1,1) lds=139264
.amdgcn_target "amdgcn-amd-amdhsa--gfx950"
.text
.globl k1_kernel
.p2align 8
.type k1_kernel,@function
k1_kernel:
    s_cmp_ge_u32 s2, 256
    s_cbranch_scc1 END_k1_kernel
    s_load_dwordx2 s[40:41], s[0:1], 0
    s_load_dwordx4 s[44:47], s[0:1], 72
    s_load_dwordx2 s[42:43], s[0:1], 104
    s_load_dwordx4 s[48:51], s[0:1], 8
    s_load_dwordx2 s[52:53], s[0:1], 24
    v_lshrrev_b32 v1, 6, v0
    v_and_b32 v0, 63, v0
    v_min_u32 v123, 27, v0
    v_lshlrev_b32 v123, 7, v123
    s_getpc_b64 s[34:35]
PS_k1_kernel:
    s_sub_u32 s34, s34, PS_k1_kernel-k1_kernel
    s_subb_u32 s35, s35, 0
    global_load_dword v124, v123, s[34:35]
    v_readfirstlane_b32 s24, v1
    v_lshrrev_b32 v2, 3, v0
    v_and_b32 v3, 7, v0
    s_cmp_eq_u32 s24, 3
    s_cbranch_scc1 LN_k1_kernel
    s_and_b32 s25, s2, 3
    s_lshr_b32 s26, s2, 2
    s_mul_i32 s27, s25, 144
    s_mul_i32 s28, s24, 48
    s_add_u32 s27, s27, s28
    s_lshl_b32 s28, s27, 1
    s_mul_i32 s27, s27, 6912
    s_lshl_b32 s29, s26, 7
    s_add_u32 s27, s27, s29
    v_mul_u32_u24 v4, 6912, v2
    v_lshl_add_u32 v4, v3, 4, v4
    v_lshlrev_b32 v5, 1, v2
    s_waitcnt lgkmcnt(0)
    s_mov_b32 s8, s44
    s_and_b32 s9, s45, 0xffff
    s_mov_b32 s10, 1152
    s_mov_b32 s11, 0x00020000
    s_mov_b32 s12, s46
    s_and_b32 s13, s47, 0xffff
    s_mov_b32 s14, 3981312
    s_mov_b32 s15, 0x00020000
    s_mov_b32 s16, s42
    s_and_b32 s17, s43, 0xffff
    s_mov_b32 s18, 268435456
    s_mov_b32 s19, 0x00020000
    s_cmp_lt_u32 s2, 216
    s_cbranch_scc1 GV_k1_kernel
    s_endpgm
GV_k1_kernel:
    buffer_load_ushort v8, v5, s[8:11], s28 offen offset:0
    buffer_load_ushort v9, v5, s[8:11], s28 offen offset:16
    buffer_load_ushort v10, v5, s[8:11], s28 offen offset:32
    buffer_load_ushort v11, v5, s[8:11], s28 offen offset:48
    buffer_load_ushort v12, v5, s[8:11], s28 offen offset:64
    buffer_load_ushort v13, v5, s[8:11], s28 offen offset:80
    buffer_load_dwordx4 v[32:35], v4, s[12:15], s27 offen
    s_add_u32 s27, s27, 55296
    buffer_load_dwordx4 v[36:39], v4, s[12:15], s27 offen
    s_add_u32 s27, s27, 55296
    buffer_load_dwordx4 v[40:43], v4, s[12:15], s27 offen
    s_add_u32 s27, s27, 55296
    buffer_load_dwordx4 v[44:47], v4, s[12:15], s27 offen
    s_add_u32 s27, s27, 55296
    buffer_load_dwordx4 v[48:51], v4, s[12:15], s27 offen
    s_add_u32 s27, s27, 55296
    buffer_load_dwordx4 v[52:55], v4, s[12:15], s27 offen
    s_mul_i32 s27, s25, 13824
    s_lshl_b32 s29, s26, 8
    s_add_u32 s27, s27, s29
    s_add_u32 s27, s27, 2359296
    v_lshrrev_b32 v6, 4, v0
    v_lshlrev_b32 v6, 3, v6
    v_lshl_add_u32 v6, v3, 5, v6
    v_lshl_add_u32 v6, v1, 8, v6
    v_lshlrev_b32 v7, 2, v0
    v_mov_b32 v20, 0
    v_mov_b32 v21, 0
    v_mov_b32 v22, 0
    v_mov_b32 v23, 0
    v_mov_b32 v24, 0
    v_mov_b32 v25, 0
    v_mov_b32 v26, 0
    v_mov_b32 v27, 0
    s_waitcnt vmcnt(6)
    v_lshlrev_b32 v8, 16, v8
    v_lshlrev_b32 v9, 16, v9
    v_lshlrev_b32 v10, 16, v10
    v_lshlrev_b32 v11, 16, v11
    v_lshlrev_b32 v12, 16, v12
    v_lshlrev_b32 v13, 16, v13
    v_mul_f32 v14, 3216550459, v8
    v_mul_f32 v15, 3216550459, v9
    v_mul_f32 v16, 3216550459, v10
    v_mul_f32 v17, 3216550459, v11
    v_mul_f32 v18, 3216550459, v12
    v_mul_f32 v19, 3216550459, v13
    v_exp_f32 v14, v14
    v_exp_f32 v15, v15
    v_exp_f32 v16, v16
    v_exp_f32 v17, v17
    v_exp_f32 v18, v18
    v_exp_f32 v19, v19
    v_add_f32 v14, 1.0, v14
    v_add_f32 v15, 1.0, v15
    v_add_f32 v16, 1.0, v16
    v_add_f32 v17, 1.0, v17
    v_add_f32 v18, 1.0, v18
    v_add_f32 v19, 1.0, v19
    v_rcp_f32 v14, v14
    v_rcp_f32 v15, v15
    v_rcp_f32 v16, v16
    v_rcp_f32 v17, v17
    v_rcp_f32 v18, v18
    v_rcp_f32 v19, v19
    v_mul_f32 v8, v8, v14
    v_mul_f32 v9, v9, v15
    v_mul_f32 v10, v10, v16
    v_mul_f32 v11, v11, v17
    v_mul_f32 v12, v12, v18
    v_mul_f32 v13, v13, v19
    v_cvt_pk_bf16_f32 v8, v8, 0
    v_cvt_pk_bf16_f32 v9, v9, 0
    v_cvt_pk_bf16_f32 v10, v10, 0
    v_cvt_pk_bf16_f32 v11, v11, 0
    v_cvt_pk_bf16_f32 v12, v12, 0
    v_cvt_pk_bf16_f32 v13, v13, 0
    v_lshlrev_b32 v14, 16, v8
    v_lshlrev_b32 v15, 16, v9
    v_lshlrev_b32 v16, 16, v10
    v_lshlrev_b32 v17, 16, v11
    v_lshlrev_b32 v18, 16, v12
    v_lshlrev_b32 v19, 16, v13
    s_waitcnt vmcnt(5)
    v_dot2c_f32_bf16 v20, v32, v8
    v_dot2c_f32_bf16 v21, v32, v14
    v_dot2c_f32_bf16 v22, v33, v8
    v_dot2c_f32_bf16 v23, v33, v14
    v_dot2c_f32_bf16 v24, v34, v8
    v_dot2c_f32_bf16 v25, v34, v14
    v_dot2c_f32_bf16 v26, v35, v8
    v_dot2c_f32_bf16 v27, v35, v14
    s_waitcnt vmcnt(4)
    v_dot2c_f32_bf16 v20, v36, v9
    v_dot2c_f32_bf16 v21, v36, v15
    v_dot2c_f32_bf16 v22, v37, v9
    v_dot2c_f32_bf16 v23, v37, v15
    v_dot2c_f32_bf16 v24, v38, v9
    v_dot2c_f32_bf16 v25, v38, v15
    v_dot2c_f32_bf16 v26, v39, v9
    v_dot2c_f32_bf16 v27, v39, v15
    s_waitcnt vmcnt(3)
    v_dot2c_f32_bf16 v20, v40, v10
    v_dot2c_f32_bf16 v21, v40, v16
    v_dot2c_f32_bf16 v22, v41, v10
    v_dot2c_f32_bf16 v23, v41, v16
    v_dot2c_f32_bf16 v24, v42, v10
    v_dot2c_f32_bf16 v25, v42, v16
    v_dot2c_f32_bf16 v26, v43, v10
    v_dot2c_f32_bf16 v27, v43, v16
    s_waitcnt vmcnt(2)
    v_dot2c_f32_bf16 v20, v44, v11
    v_dot2c_f32_bf16 v21, v44, v17
    v_dot2c_f32_bf16 v22, v45, v11
    v_dot2c_f32_bf16 v23, v45, v17
    v_dot2c_f32_bf16 v24, v46, v11
    v_dot2c_f32_bf16 v25, v46, v17
    v_dot2c_f32_bf16 v26, v47, v11
    v_dot2c_f32_bf16 v27, v47, v17
    s_waitcnt vmcnt(1)
    v_dot2c_f32_bf16 v20, v48, v12
    v_dot2c_f32_bf16 v21, v48, v18
    v_dot2c_f32_bf16 v22, v49, v12
    v_dot2c_f32_bf16 v23, v49, v18
    v_dot2c_f32_bf16 v24, v50, v12
    v_dot2c_f32_bf16 v25, v50, v18
    v_dot2c_f32_bf16 v26, v51, v12
    v_dot2c_f32_bf16 v27, v51, v18
    s_waitcnt vmcnt(0)
    v_dot2c_f32_bf16 v20, v52, v13
    v_dot2c_f32_bf16 v21, v52, v19
    v_dot2c_f32_bf16 v22, v53, v13
    v_dot2c_f32_bf16 v23, v53, v19
    v_dot2c_f32_bf16 v24, v54, v13
    v_dot2c_f32_bf16 v25, v54, v19
    v_dot2c_f32_bf16 v26, v55, v13
    v_dot2c_f32_bf16 v27, v55, v19
    s_nop 3
    v_permlane32_swap_b32 v20, v24
    v_permlane32_swap_b32 v21, v25
    v_permlane32_swap_b32 v22, v26
    v_permlane32_swap_b32 v23, v27
    v_add_f32 v20, v20, v24
    v_add_f32 v21, v21, v25
    v_add_f32 v22, v22, v26
    v_add_f32 v23, v23, v27
    s_nop 0
    v_permlane16_swap_b32 v20, v22
    v_permlane16_swap_b32 v21, v23
    v_add_f32 v20, v20, v22
    v_add_f32 v21, v21, v23
    s_nop 0
    v_add_f32_dpp v20, v20, v20 row_ror:8 row_mask:0xf bank_mask:0xf
    v_add_f32_dpp v21, v21, v21 row_ror:8 row_mask:0xf bank_mask:0xf
    ds_write_b64 v6, v[20:21]
    s_waitcnt lgkmcnt(0)
    s_barrier
    s_cmp_lg_u32 s24, 0
    s_cbranch_scc1 END_k1_kernel
    ds_read_b32 v20, v7 offset:0
    ds_read_b32 v21, v7 offset:256
    ds_read_b32 v22, v7 offset:512
    s_waitcnt lgkmcnt(0)
    v_add_f32 v20, v20, v21
    v_add_f32 v20, v20, v22
    buffer_store_dword v20, v7, s[16:19], s27 offen
END_k1_kernel:
    s_endpgm
LN_k1_kernel:
    v_mul_u32_u24 v4, 1152, v3
    v_lshl_add_u32 v4, v2, 4, v4
    s_mul_i32 s27, s2, 9216
    s_waitcnt lgkmcnt(0)
    s_mov_b32 s8, s40
    s_and_b32 s9, s41, 0xffff
    s_mov_b32 s10, 2359296
    s_mov_b32 s11, 0x00020000
    s_mov_b32 s16, s42
    s_and_b32 s17, s43, 0xffff
    s_mov_b32 s18, 268435456
    s_mov_b32 s19, 0x00020000
    buffer_load_dwordx4 v[8:11], v4, s[8:11], s27 offen offset:0
    buffer_load_dwordx4 v[12:15], v4, s[8:11], s27 offen offset:128
    buffer_load_dwordx4 v[16:19], v4, s[8:11], s27 offen offset:256
    buffer_load_dwordx4 v[20:23], v4, s[8:11], s27 offen offset:384
    buffer_load_dwordx4 v[24:27], v4, s[8:11], s27 offen offset:512
    buffer_load_dwordx4 v[28:31], v4, s[8:11], s27 offen offset:640
    buffer_load_dwordx4 v[32:35], v4, s[8:11], s27 offen offset:768
    buffer_load_dwordx4 v[36:39], v4, s[8:11], s27 offen offset:896
    buffer_load_dwordx4 v[40:43], v4, s[8:11], s27 offen offset:1024
    s_lshr_b32 s28, s2, 1
    s_mul_i32 s28, s28, 18432
    s_and_b32 s29, s2, 1
    s_lshl_b32 s29, s29, 7
    s_add_u32 s28, s28, s29
    v_lshlrev_b32 v5, 4, v3
    v_lshl_add_u32 v5, v2, 8, v5
    v_lshlrev_b32 v120, 7, v0
    s_lshr_b32 s30, s2, 3
    s_min_u32 s30, s30, 9
    s_lshl_b32 s30, s30, 13
    v_add_u32 v120, s30, v120
    v_min_u32 v120, END_k45_kernel-adaLN_cond__gqa_block_cached__glu_gated_geglu__prompt_kernel, v120
    s_getpc_b64 s[32:33]
PC_k1_kernel:
    s_add_u32 s32, s32, adaLN_cond__gqa_block_cached__glu_gated_geglu__prompt_kernel-PC_k1_kernel
    s_addc_u32 s33, s33, 0
    global_load_dword v122, v120, s[32:33]
    s_waitcnt vmcnt(9)
    v_lshlrev_b32 v48, 16, v8
    v_and_b32 v49, 0xffff0000, v8
    v_lshlrev_b32 v50, 16, v9
    v_and_b32 v51, 0xffff0000, v9
    v_lshlrev_b32 v52, 16, v10
    v_and_b32 v53, 0xffff0000, v10
    v_lshlrev_b32 v54, 16, v11
    v_and_b32 v55, 0xffff0000, v11
    v_pk_add_f32 v[44:45], v[48:49], v[50:51]
    v_pk_add_f32 v[46:47], v[52:53], v[54:55]
    s_waitcnt vmcnt(8)
    v_lshlrev_b32 v56, 16, v12
    v_and_b32 v57, 0xffff0000, v12
    v_lshlrev_b32 v58, 16, v13
    v_and_b32 v59, 0xffff0000, v13
    v_lshlrev_b32 v60, 16, v14
    v_and_b32 v61, 0xffff0000, v14
    v_lshlrev_b32 v62, 16, v15
    v_and_b32 v63, 0xffff0000, v15
    v_pk_add_f32 v[44:45], v[44:45], v[56:57]
    v_pk_add_f32 v[46:47], v[46:47], v[58:59]
    v_pk_add_f32 v[44:45], v[44:45], v[60:61]
    v_pk_add_f32 v[46:47], v[46:47], v[62:63]
    s_waitcnt vmcnt(7)
    v_lshlrev_b32 v64, 16, v16
    v_and_b32 v65, 0xffff0000, v16
    v_lshlrev_b32 v66, 16, v17
    v_and_b32 v67, 0xffff0000, v17
    v_lshlrev_b32 v68, 16, v18
    v_and_b32 v69, 0xffff0000, v18
    v_lshlrev_b32 v70, 16, v19
    v_and_b32 v71, 0xffff0000, v19
    v_pk_add_f32 v[44:45], v[44:45], v[64:65]
    v_pk_add_f32 v[46:47], v[46:47], v[66:67]
    v_pk_add_f32 v[44:45], v[44:45], v[68:69]
    v_pk_add_f32 v[46:47], v[46:47], v[70:71]
    s_waitcnt vmcnt(6)
    v_lshlrev_b32 v72, 16, v20
    v_and_b32 v73, 0xffff0000, v20
    v_lshlrev_b32 v74, 16, v21
    v_and_b32 v75, 0xffff0000, v21
    v_lshlrev_b32 v76, 16, v22
    v_and_b32 v77, 0xffff0000, v22
    v_lshlrev_b32 v78, 16, v23
    v_and_b32 v79, 0xffff0000, v23
    v_pk_add_f32 v[44:45], v[44:45], v[72:73]
    v_pk_add_f32 v[46:47], v[46:47], v[74:75]
    v_pk_add_f32 v[44:45], v[44:45], v[76:77]
    v_pk_add_f32 v[46:47], v[46:47], v[78:79]
    s_waitcnt vmcnt(5)
    v_lshlrev_b32 v80, 16, v24
    v_and_b32 v81, 0xffff0000, v24
    v_lshlrev_b32 v82, 16, v25
    v_and_b32 v83, 0xffff0000, v25
    v_lshlrev_b32 v84, 16, v26
    v_and_b32 v85, 0xffff0000, v26
    v_lshlrev_b32 v86, 16, v27
    v_and_b32 v87, 0xffff0000, v27
    v_pk_add_f32 v[44:45], v[44:45], v[80:81]
    v_pk_add_f32 v[46:47], v[46:47], v[82:83]
    v_pk_add_f32 v[44:45], v[44:45], v[84:85]
    v_pk_add_f32 v[46:47], v[46:47], v[86:87]
    s_waitcnt vmcnt(4)
    v_lshlrev_b32 v88, 16, v28
    v_and_b32 v89, 0xffff0000, v28
    v_lshlrev_b32 v90, 16, v29
    v_and_b32 v91, 0xffff0000, v29
    v_lshlrev_b32 v92, 16, v30
    v_and_b32 v93, 0xffff0000, v30
    v_lshlrev_b32 v94, 16, v31
    v_and_b32 v95, 0xffff0000, v31
    v_pk_add_f32 v[44:45], v[44:45], v[88:89]
    v_pk_add_f32 v[46:47], v[46:47], v[90:91]
    v_pk_add_f32 v[44:45], v[44:45], v[92:93]
    v_pk_add_f32 v[46:47], v[46:47], v[94:95]
    s_waitcnt vmcnt(3)
    v_lshlrev_b32 v96, 16, v32
    v_and_b32 v97, 0xffff0000, v32
    v_lshlrev_b32 v98, 16, v33
    v_and_b32 v99, 0xffff0000, v33
    v_lshlrev_b32 v100, 16, v34
    v_and_b32 v101, 0xffff0000, v34
    v_lshlrev_b32 v102, 16, v35
    v_and_b32 v103, 0xffff0000, v35
    v_pk_add_f32 v[44:45], v[44:45], v[96:97]
    v_pk_add_f32 v[46:47], v[46:47], v[98:99]
    v_pk_add_f32 v[44:45], v[44:45], v[100:101]
    v_pk_add_f32 v[46:47], v[46:47], v[102:103]
    s_waitcnt vmcnt(2)
    v_lshlrev_b32 v104, 16, v36
    v_and_b32 v105, 0xffff0000, v36
    v_lshlrev_b32 v106, 16, v37
    v_and_b32 v107, 0xffff0000, v37
    v_lshlrev_b32 v108, 16, v38
    v_and_b32 v109, 0xffff0000, v38
    v_lshlrev_b32 v110, 16, v39
    v_and_b32 v111, 0xffff0000, v39
    v_pk_add_f32 v[44:45], v[44:45], v[104:105]
    v_pk_add_f32 v[46:47], v[46:47], v[106:107]
    v_pk_add_f32 v[44:45], v[44:45], v[108:109]
    v_pk_add_f32 v[46:47], v[46:47], v[110:111]
    s_waitcnt vmcnt(1)
    v_lshlrev_b32 v112, 16, v40
    v_and_b32 v113, 0xffff0000, v40
    v_lshlrev_b32 v114, 16, v41
    v_and_b32 v115, 0xffff0000, v41
    v_lshlrev_b32 v116, 16, v42
    v_and_b32 v117, 0xffff0000, v42
    v_lshlrev_b32 v118, 16, v43
    v_and_b32 v119, 0xffff0000, v43
    v_pk_add_f32 v[44:45], v[44:45], v[112:113]
    v_pk_add_f32 v[46:47], v[46:47], v[114:115]
    v_pk_add_f32 v[44:45], v[44:45], v[116:117]
    v_pk_add_f32 v[46:47], v[46:47], v[118:119]
    v_pk_add_f32 v[44:45], v[44:45], v[46:47]
    v_add_f32 v44, v44, v45
    s_nop 1
    v_add_f32_dpp v44, v44, v44 row_ror:8 row_mask:0xf bank_mask:0xf
    v_mov_b32 v45, v44
    s_nop 1
    v_permlane16_swap_b32 v44, v45
    v_add_f32 v44, v44, v45
    v_mov_b32 v45, v44
    s_nop 1
    v_permlane32_swap_b32 v44, v45
    v_add_f32 v44, v44, v45
    v_mul_f32 v6, 3135475257, v44
    v_pk_add_f32 v[48:49], v[48:49], v[6:7] op_sel_hi:[1,0]
    v_pk_add_f32 v[50:51], v[50:51], v[6:7] op_sel_hi:[1,0]
    v_pk_mul_f32 v[46:47], v[48:49], v[48:49]
    v_pk_add_f32 v[52:53], v[52:53], v[6:7] op_sel_hi:[1,0]
    v_pk_mul_f32 v[44:45], v[50:51], v[50:51]
    v_pk_add_f32 v[54:55], v[54:55], v[6:7] op_sel_hi:[1,0]
    v_pk_fma_f32 v[46:47], v[52:53], v[52:53], v[46:47]
    v_pk_add_f32 v[56:57], v[56:57], v[6:7] op_sel_hi:[1,0]
    v_pk_fma_f32 v[44:45], v[54:55], v[54:55], v[44:45]
    v_pk_add_f32 v[58:59], v[58:59], v[6:7] op_sel_hi:[1,0]
    v_pk_fma_f32 v[46:47], v[56:57], v[56:57], v[46:47]
    v_pk_add_f32 v[60:61], v[60:61], v[6:7] op_sel_hi:[1,0]
    v_pk_fma_f32 v[44:45], v[58:59], v[58:59], v[44:45]
    v_pk_add_f32 v[62:63], v[62:63], v[6:7] op_sel_hi:[1,0]
    v_pk_fma_f32 v[46:47], v[60:61], v[60:61], v[46:47]
    v_pk_add_f32 v[64:65], v[64:65], v[6:7] op_sel_hi:[1,0]
    v_pk_fma_f32 v[44:45], v[62:63], v[62:63], v[44:45]
    v_pk_add_f32 v[66:67], v[66:67], v[6:7] op_sel_hi:[1,0]
    v_pk_fma_f32 v[46:47], v[64:65], v[64:65], v[46:47]
    v_pk_add_f32 v[68:69], v[68:69], v[6:7] op_sel_hi:[1,0]
    v_pk_fma_f32 v[44:45], v[66:67], v[66:67], v[44:45]
    v_pk_add_f32 v[70:71], v[70:71], v[6:7] op_sel_hi:[1,0]
    v_pk_fma_f32 v[46:47], v[68:69], v[68:69], v[46:47]
    v_pk_add_f32 v[72:73], v[72:73], v[6:7] op_sel_hi:[1,0]
    v_pk_fma_f32 v[44:45], v[70:71], v[70:71], v[44:45]
    v_pk_add_f32 v[74:75], v[74:75], v[6:7] op_sel_hi:[1,0]
    v_pk_fma_f32 v[46:47], v[72:73], v[72:73], v[46:47]
    v_pk_add_f32 v[76:77], v[76:77], v[6:7] op_sel_hi:[1,0]
    v_pk_fma_f32 v[44:45], v[74:75], v[74:75], v[44:45]
    v_pk_add_f32 v[78:79], v[78:79], v[6:7] op_sel_hi:[1,0]
    v_pk_fma_f32 v[46:47], v[76:77], v[76:77], v[46:47]
    v_pk_add_f32 v[80:81], v[80:81], v[6:7] op_sel_hi:[1,0]
    v_pk_fma_f32 v[44:45], v[78:79], v[78:79], v[44:45]
    v_pk_add_f32 v[82:83], v[82:83], v[6:7] op_sel_hi:[1,0]
    v_pk_fma_f32 v[46:47], v[80:81], v[80:81], v[46:47]
    v_pk_add_f32 v[84:85], v[84:85], v[6:7] op_sel_hi:[1,0]
    v_pk_fma_f32 v[44:45], v[82:83], v[82:83], v[44:45]
    v_pk_add_f32 v[86:87], v[86:87], v[6:7] op_sel_hi:[1,0]
    v_pk_fma_f32 v[46:47], v[84:85], v[84:85], v[46:47]
    v_pk_add_f32 v[88:89], v[88:89], v[6:7] op_sel_hi:[1,0]
    v_pk_fma_f32 v[44:45], v[86:87], v[86:87], v[44:45]
    v_pk_add_f32 v[90:91], v[90:91], v[6:7] op_sel_hi:[1,0]
    v_pk_fma_f32 v[46:47], v[88:89], v[88:89], v[46:47]
    v_pk_add_f32 v[92:93], v[92:93], v[6:7] op_sel_hi:[1,0]
    v_pk_fma_f32 v[44:45], v[90:91], v[90:91], v[44:45]
    v_pk_add_f32 v[94:95], v[94:95], v[6:7] op_sel_hi:[1,0]
    v_pk_fma_f32 v[46:47], v[92:93], v[92:93], v[46:47]
    v_pk_add_f32 v[96:97], v[96:97], v[6:7] op_sel_hi:[1,0]
    v_pk_fma_f32 v[44:45], v[94:95], v[94:95], v[44:45]
    v_pk_add_f32 v[98:99], v[98:99], v[6:7] op_sel_hi:[1,0]
    v_pk_fma_f32 v[46:47], v[96:97], v[96:97], v[46:47]
    v_pk_add_f32 v[100:101], v[100:101], v[6:7] op_sel_hi:[1,0]
    v_pk_fma_f32 v[44:45], v[98:99], v[98:99], v[44:45]
    v_pk_add_f32 v[102:103], v[102:103], v[6:7] op_sel_hi:[1,0]
    v_pk_fma_f32 v[46:47], v[100:101], v[100:101], v[46:47]
    v_pk_add_f32 v[104:105], v[104:105], v[6:7] op_sel_hi:[1,0]
    v_pk_fma_f32 v[44:45], v[102:103], v[102:103], v[44:45]
    v_pk_add_f32 v[106:107], v[106:107], v[6:7] op_sel_hi:[1,0]
    v_pk_fma_f32 v[46:47], v[104:105], v[104:105], v[46:47]
    v_pk_add_f32 v[108:109], v[108:109], v[6:7] op_sel_hi:[1,0]
    v_pk_fma_f32 v[44:45], v[106:107], v[106:107], v[44:45]
    v_pk_add_f32 v[110:111], v[110:111], v[6:7] op_sel_hi:[1,0]
    v_pk_fma_f32 v[46:47], v[108:109], v[108:109], v[46:47]
    v_pk_add_f32 v[112:113], v[112:113], v[6:7] op_sel_hi:[1,0]
    v_pk_fma_f32 v[44:45], v[110:111], v[110:111], v[44:45]
    v_pk_add_f32 v[114:115], v[114:115], v[6:7] op_sel_hi:[1,0]
    v_pk_fma_f32 v[46:47], v[112:113], v[112:113], v[46:47]
    v_pk_add_f32 v[116:117], v[116:117], v[6:7] op_sel_hi:[1,0]
    v_pk_fma_f32 v[44:45], v[114:115], v[114:115], v[44:45]
    v_pk_add_f32 v[118:119], v[118:119], v[6:7] op_sel_hi:[1,0]
    v_pk_fma_f32 v[46:47], v[116:117], v[116:117], v[46:47]
    v_pk_fma_f32 v[44:45], v[118:119], v[118:119], v[44:45]
    v_pk_add_f32 v[44:45], v[44:45], v[46:47]
    v_add_f32 v44, v44, v45
    s_nop 1
    v_add_f32_dpp v44, v44, v44 row_ror:8 row_mask:0xf bank_mask:0xf
    v_mov_b32 v45, v44
    s_nop 1
    v_permlane16_swap_b32 v44, v45
    v_add_f32 v44, v44, v45
    v_mov_b32 v45, v44
    s_nop 1
    v_permlane32_swap_b32 v44, v45
    v_add_f32 v44, v44, v45
    v_mov_b32 v45, 925353388
    v_fmac_f32 v45, 987991609, v44
    v_rsq_f32 v6, v45
    s_barrier
    v_pk_mul_f32 v[48:49], v[48:49], v[6:7] op_sel_hi:[1,0]
    v_pk_mul_f32 v[50:51], v[50:51], v[6:7] op_sel_hi:[1,0]
    v_pk_mul_f32 v[52:53], v[52:53], v[6:7] op_sel_hi:[1,0]
    v_pk_mul_f32 v[54:55], v[54:55], v[6:7] op_sel_hi:[1,0]
    v_cvt_pk_f16_f32 v8, v48, v49
    v_cvt_pk_f16_f32 v9, v50, v51
    v_cvt_pk_f16_f32 v10, v52, v53
    v_cvt_pk_f16_f32 v11, v54, v55
    buffer_store_dwordx4 v[8:11], v5, s[16:19], s28 offen offset:0
    v_pk_mul_f32 v[56:57], v[56:57], v[6:7] op_sel_hi:[1,0]
    v_pk_mul_f32 v[58:59], v[58:59], v[6:7] op_sel_hi:[1,0]
    v_pk_mul_f32 v[60:61], v[60:61], v[6:7] op_sel_hi:[1,0]
    v_pk_mul_f32 v[62:63], v[62:63], v[6:7] op_sel_hi:[1,0]
    v_cvt_pk_f16_f32 v12, v56, v57
    v_cvt_pk_f16_f32 v13, v58, v59
    v_cvt_pk_f16_f32 v14, v60, v61
    v_cvt_pk_f16_f32 v15, v62, v63
    buffer_store_dwordx4 v[12:15], v5, s[16:19], s28 offen offset:2048
    s_add_u32 s28, s28, 4096
    v_pk_mul_f32 v[64:65], v[64:65], v[6:7] op_sel_hi:[1,0]
    v_pk_mul_f32 v[66:67], v[66:67], v[6:7] op_sel_hi:[1,0]
    v_pk_mul_f32 v[68:69], v[68:69], v[6:7] op_sel_hi:[1,0]
    v_pk_mul_f32 v[70:71], v[70:71], v[6:7] op_sel_hi:[1,0]
    v_cvt_pk_f16_f32 v16, v64, v65
    v_cvt_pk_f16_f32 v17, v66, v67
    v_cvt_pk_f16_f32 v18, v68, v69
    v_cvt_pk_f16_f32 v19, v70, v71
    buffer_store_dwordx4 v[16:19], v5, s[16:19], s28 offen offset:0
    v_pk_mul_f32 v[72:73], v[72:73], v[6:7] op_sel_hi:[1,0]
    v_pk_mul_f32 v[74:75], v[74:75], v[6:7] op_sel_hi:[1,0]
    v_pk_mul_f32 v[76:77], v[76:77], v[6:7] op_sel_hi:[1,0]
    v_pk_mul_f32 v[78:79], v[78:79], v[6:7] op_sel_hi:[1,0]
    v_cvt_pk_f16_f32 v20, v72, v73
    v_cvt_pk_f16_f32 v21, v74, v75
    v_cvt_pk_f16_f32 v22, v76, v77
    v_cvt_pk_f16_f32 v23, v78, v79
    buffer_store_dwordx4 v[20:23], v5, s[16:19], s28 offen offset:2048
    s_add_u32 s28, s28, 4096
    v_pk_mul_f32 v[80:81], v[80:81], v[6:7] op_sel_hi:[1,0]
    v_pk_mul_f32 v[82:83], v[82:83], v[6:7] op_sel_hi:[1,0]
    v_pk_mul_f32 v[84:85], v[84:85], v[6:7] op_sel_hi:[1,0]
    v_pk_mul_f32 v[86:87], v[86:87], v[6:7] op_sel_hi:[1,0]
    v_cvt_pk_f16_f32 v24, v80, v81
    v_cvt_pk_f16_f32 v25, v82, v83
    v_cvt_pk_f16_f32 v26, v84, v85
    v_cvt_pk_f16_f32 v27, v86, v87
    buffer_store_dwordx4 v[24:27], v5, s[16:19], s28 offen offset:0
    v_pk_mul_f32 v[88:89], v[88:89], v[6:7] op_sel_hi:[1,0]
    v_pk_mul_f32 v[90:91], v[90:91], v[6:7] op_sel_hi:[1,0]
    v_pk_mul_f32 v[92:93], v[92:93], v[6:7] op_sel_hi:[1,0]
    v_pk_mul_f32 v[94:95], v[94:95], v[6:7] op_sel_hi:[1,0]
    v_cvt_pk_f16_f32 v28, v88, v89
    v_cvt_pk_f16_f32 v29, v90, v91
    v_cvt_pk_f16_f32 v30, v92, v93
    v_cvt_pk_f16_f32 v31, v94, v95
    buffer_store_dwordx4 v[28:31], v5, s[16:19], s28 offen offset:2048
    s_add_u32 s28, s28, 4096
    v_pk_mul_f32 v[96:97], v[96:97], v[6:7] op_sel_hi:[1,0]
    v_pk_mul_f32 v[98:99], v[98:99], v[6:7] op_sel_hi:[1,0]
    v_pk_mul_f32 v[100:101], v[100:101], v[6:7] op_sel_hi:[1,0]
    v_pk_mul_f32 v[102:103], v[102:103], v[6:7] op_sel_hi:[1,0]
    v_cvt_pk_f16_f32 v32, v96, v97
    v_cvt_pk_f16_f32 v33, v98, v99
    v_cvt_pk_f16_f32 v34, v100, v101
    v_cvt_pk_f16_f32 v35, v102, v103
    buffer_store_dwordx4 v[32:35], v5, s[16:19], s28 offen offset:0
    v_pk_mul_f32 v[104:105], v[104:105], v[6:7] op_sel_hi:[1,0]
    v_pk_mul_f32 v[106:107], v[106:107], v[6:7] op_sel_hi:[1,0]
    v_pk_mul_f32 v[108:109], v[108:109], v[6:7] op_sel_hi:[1,0]
    v_pk_mul_f32 v[110:111], v[110:111], v[6:7] op_sel_hi:[1,0]
    v_cvt_pk_f16_f32 v36, v104, v105
    v_cvt_pk_f16_f32 v37, v106, v107
    v_cvt_pk_f16_f32 v38, v108, v109
    v_cvt_pk_f16_f32 v39, v110, v111
    buffer_store_dwordx4 v[36:39], v5, s[16:19], s28 offen offset:2048
    s_add_u32 s28, s28, 4096
    v_pk_mul_f32 v[112:113], v[112:113], v[6:7] op_sel_hi:[1,0]
    v_pk_mul_f32 v[114:115], v[114:115], v[6:7] op_sel_hi:[1,0]
    v_pk_mul_f32 v[116:117], v[116:117], v[6:7] op_sel_hi:[1,0]
    v_pk_mul_f32 v[118:119], v[118:119], v[6:7] op_sel_hi:[1,0]
    v_cvt_pk_f16_f32 v40, v112, v113
    v_cvt_pk_f16_f32 v41, v114, v115
    v_cvt_pk_f16_f32 v42, v116, v117
    v_cvt_pk_f16_f32 v43, v118, v119
    buffer_store_dwordx4 v[40:43], v5, s[16:19], s28 offen offset:0
    s_cmp_ge_u32 s2, 64
    s_cbranch_scc1 NZ_k1_kernel
    v_mbcnt_lo_u32_b32 v2, -1, 0
    v_mov_b32 v3, 0
    v_mbcnt_hi_u32_b32 v2, -1, v2
    s_lshl_b32 s28, s2, 8
    v_lshlrev_b32 v2, 2, v2
    s_add_u32 s28, s28, 3145728
    buffer_store_dword v3, v2, s[16:19], s28 offen
NZ_k1_kernel:
    s_endpgm

.globl adaLN_cond__gqa_block_cached__glu_gated_geglu__prompt_kernel
.p2align 8
.type adaLN_cond__gqa_block_cached__glu_gated_geglu__prompt_kernel,@function
adaLN_cond__gqa_block_cached__glu_gated_geglu__prompt_kernel:
    s_cmp_ge_u32 s2, 256
    s_cbranch_scc1 END_adaLN_cond__gqa_block_cached__glu_gated_geglu__prompt_kernel
    s_load_dwordx4 s[40:43], s[0:1], 8
    s_load_dwordx2 s[44:45], s[0:1], 24
    s_load_dwordx2 s[46:47], s[0:1], 104
    s_load_dwordx2 s[4:5], s[0:1], 32
    s_load_dwordx4 s[76:79], s[0:1], 48
    s_load_dwordx2 s[80:81], s[0:1], 64
    v_lshrrev_b32 v15, 6, v0
    s_and_b32 s29, s2, 7
    v_readfirstlane_b32 s24, v15
    s_lshr_b32 s30, s2, 3
    s_lshl_b32 s25, s29, 1
    s_and_b32 s29, s30, 1
    s_or_b32 s25, s25, s29
    s_lshr_b32 s26, s30, 1
    v_and_b32 v0, 63, v0
    v_lshlrev_b32 v14, 4, v0
    s_mul_i32 s29, s24, 576
    v_add_u32 v16, s29, v14
    s_lshl_b32 s37, s24, 12
    v_lshrrev_b32 v17, 5, v0
    v_and_b32 v18, 31, v0
    v_lshlrev_b32 v18, 4, v18
    v_lshlrev_b32 v19, 5, v17
    v_xor_b32 v18, v18, v19
    v_lshl_add_u32 v18, v17, 13, v18
    s_lshr_b32 s29, s24, 1
    s_lshl_b32 s29, s29, 18
    s_and_b32 s30, s24, 1
    s_lshl_b32 s30, s30, 15
    s_add_u32 s29, s29, s30
    v_add_u32 v10, s29, v18
    v_xor_b32 v18, 64, v10
    v_add_u32 v11, 15360, v18
    v_xor_b32 v18, 128, v10
    v_add_u32 v12, 63488, v18
    v_xor_b32 v18, 192, v10
    v_add_u32 v13, 78848, v18
    s_lshl_b32 s28, s24, 13
    s_lshl_b32 s29, s26, 2
    s_add_u32 s29, s29, s24
    s_mul_i32 s34, s29, 36864
    s_add_u32 s35, s34, 18432
    v_lshl_add_u32 v19, v0, 6, s29
    v_cmp_gt_u32 vcc, 32, v0
    v_lshrrev_b32 v52, 2, v19
    v_and_b32 v19, 3, v19
    v_lshlrev_b32 v19, 7, v19
    v_lshl_add_u32 v19, v52, 13, v19
    v_add_u32 v19, 524288, v19
    v_mov_b32 v52, 0x40000000
    v_cndmask_b32 v54, v52, v19, vcc
    v_lshrrev_b32 v17, 4, v0
    v_and_b32 v18, 15, v0
    s_lshl_b32 s29, s24, 3
    v_add_u32 v19, s29, v17
    v_lshlrev_b32 v52, 8, v19
    v_and_b32 v19, 15, v19
    v_xor_b32 v19, v19, v18
    v_lshl_add_u32 v19, v19, 4, v52
    v_accvgpr_write_b32 a160, v19
    v_xor_b32 v19, 64, v19
    v_accvgpr_write_b32 a161, v19
    v_lshlrev_b32 v19, 1, v17
    v_xor_b32 v19, v19, v18
    v_lshl_add_u32 v19, v19, 4, v52
    v_accvgpr_write_b32 a162, v19
    v_xor_b32 v19, 0x80, v19
    v_accvgpr_write_b32 a163, v19
    v_lshrrev_b32 v18, 2, v0
    v_and_b32 v19, 7, v18
    v_and_b32 v52, 3, v0
    v_lshlrev_b32 v52, 3, v52
    v_lshl_add_u32 v52, v19, 5, v52
    v_lshl_add_u32 v53, v18, 9, v52
    v_add_u32 v1, 0x10000, v53
    v_xor_b32 v2, 32, v1
    v_xor_b32 v3, 64, v1
    v_xor_b32 v4, 96, v1
    v_xor_b32 v5, 128, v1
    v_xor_b32 v6, 160, v1
    v_xor_b32 v7, 192, v1
    v_xor_b32 v8, 224, v1
    v_lshl_add_u32 v53, v19, 8, v52
    v_lshrrev_b32 v19, 5, v0
    v_lshl_add_u32 v53, v19, 12, v53
    v_add_u32 v53, 0x800, v53
    v_accvgpr_write_b32 a164, v53
    v_lshlrev_b32 v9, 6, v17
    v_add_u32 v9, 131072, v9
    v_and_b32 v52, 1, v17
    v_lshl_or_b32 v52, v52, 1, v19
    v_and_b32 v18, 15, v0
    v_xor_b32 v52, v52, v18
    v_lshlrev_b32 v52, 4, v52
    v_and_b32 v19, 7, v0
    v_lshl_add_u32 v52, v19, 8, v52
    v_bfe_u32 v19, v0, 3, 1
    v_lshl_add_u32 v52, v19, 12, v52
    v_add_u32 v52, 0x10000, v52
    v_accvgpr_write_b32 a165, v52
    v_lshrrev_b32 v19, 2, v0
    v_and_b32 v19, 8, v19
    v_xor_b32 v19, v19, v0
    v_and_b32 v19, 11, v19
    v_cmp_eq_u32 vcc, 0, v19
    v_mov_b32 v19, 0x3f803f80
    v_lshrrev_b32 v17, 5, v16
    v_cndmask_b32 v19, 0, v19, vcc
    v_accvgpr_write_b32 a166, v19
    v_and_b32 v18, 0x10, v16
    v_lshl_add_u32 v17, v17, 6, v18
    v_add_u32 v17, 131072, v17
    s_mul_i32 s95, s2, 405
    s_lshr_b32 s95, s95, 15
    s_mul_i32 s96, s95, 81
    s_sub_u32 s96, s2, s96
    s_mul_i32 s97, s96, 57
    s_lshr_b32 s97, s97, 9
    s_mul_i32 s98, s97, 9
    s_sub_u32 s98, s96, s98
    s_mul_i32 s99, s98, 11
    s_lshr_b32 s99, s99, 5
    s_mul_i32 s50, s99, 3
    s_sub_u32 s50, s98, s50
    s_mul_i32 s29, s24, 3
    s_add_u32 s50, s50, s29
    s_lshl_b32 s50, s50, 10
    s_mul_i32 s29, s97, 6
    s_add_u32 s99, s99, s29
    s_lshl_b32 s29, s99, 1
    s_add_u32 s29, s29, s95
    s_add_u32 s99, s99, 108
    s_movk_i32 s30, 1152
    s_cmp_lt_u32 s95, 2
    s_cselect_b32 s99, s29, s99
    s_cselect_b32 s30, 9216, s30
    s_cselect_b32 s51, 6, 3
    s_cselect_b64 vcc, -1, 0
    s_cselect_b32 s58, 4294902912, 0
    s_mul_i32 s99, s99, 12288
    s_add_u32 s50, s50, s99
    s_add_u32 s50, s50, 134217728
    s_mul_i32 s51, s51, 12288
    s_sub_u32 s59, 1990656, s51
    s_xor_b32 s59, s59, s51
    s_mul_i32 s57, s30, 288
    s_mul_i32 s56, s98, s30
    s_lshl_b32 s56, s56, 5
    s_lshl_b32 s97, s97, 7
    s_add_u32 s56, s56, s97
    v_lshrrev_b32 v18, 3, v0
    v_and_b32 v19, 3, v18
    v_lshrrev_b32 v52, 5, v0
    v_lshl_add_u32 v19, v52, 3, v19
    s_and_b32 s97, s24, 1
    s_lshl_b32 s97, s97, 4
    s_lshr_b32 s98, s24, 1
    s_lshl_b32 s98, s98, 2
    s_add_u32 s97, s97, s98
    v_add_u32 v19, s97, v19
    s_lshl_b32 s97, s24, 3
    v_add_u32 v18, s97, v18
    v_cndmask_b32 v18, v18, v19, vcc
    v_mul_u32_u24 v18, s30, v18
    v_lshrrev_b32 v19, 4, v0
    v_lshlrev_b32 v19, 1, v19
    v_and_b32 v53, 7, v0
    v_xor_b32 v19, v19, v53
    v_lshl_add_u32 v18, v19, 4, v18
    s_lshl_b32 s97, s24, 13
    v_lshl_add_u32 v19, v0, 7, s97
    s_lshl_b32 s96, s96, 15
    s_lshl_b32 s97, s24, 10
    s_add_u32 s39, s97, 139264
    s_add_u32 s97, s97, s96
    s_add_u32 s97, s97, 150994944
    s_cmp_eq_u32 s95, 3
    s_cselect_b64 vcc, -1, 0
    s_cselect_b32 s56, s96, s56
    s_cselect_b32 s57, 425984, s57
    s_cselect_b32 s50, s97, s50
    s_cselect_b32 s51, 0, s51
    s_cselect_b32 s59, 0, s59
    v_cndmask_b32 v18, v18, v19, vcc
    v_accvgpr_write_b32 a167, v18
    v_bfe_u32 v18, v0, 2, 3
    v_lshrrev_b32 v19, 1, v18
    v_xor_b32 v19, s24, v19
    v_lshlrev_b32 v19, 5, v19
    v_lshl_add_u32 v19, v18, 7, v19
    v_and_b32 v18, 3, v0
    v_lshl_add_u32 v19, v18, 3, v19
    v_lshl_add_u32 v19, v52, 10, v19
    v_add_u32 v19, 139264, v19
    v_accvgpr_write_b32 a168, v19
    s_lshl_b32 s29, s25, 9
    s_sub_u32 s18, 4718592, s29
    s_mov_b32 s19, 0x00020000
    s_waitcnt lgkmcnt(0)
    s_add_u32 s16, s44, s29
    s_addc_u32 s17, s45, 0
    s_and_b32 s17, s17, 0xffff
    s_add_u32 m0, s28, 65536
    s_mov_b32 s36, 0
    buffer_load_dwordx4 v10, s[16:19], s36 offen offset:0 lds
    s_mov_b32 s20, s46
    s_and_b32 s21, s47, 0xffff
    s_mov_b32 s22, 268435456
    s_mov_b32 s23, 0x00020000
    s_lshl_b32 s30, s25, 19
    s_add_u32 s8, s40, s30
    s_addc_u32 s9, s41, 0
    s_and_b32 s9, s9, 0xffff
    s_mov_b32 s10, 524288
    s_mov_b32 s11, 0x00020000
    v_accvgpr_write_b32 a0, 0
    v_accvgpr_write_b32 a1, 0
    v_accvgpr_write_b32 a2, 0
    buffer_load_dwordx4 v11, s[16:19], s36 offen offset:1024 lds
    v_accvgpr_write_b32 a3, 0
    v_accvgpr_write_b32 a4, 0
    v_accvgpr_write_b32 a5, 0
    v_accvgpr_write_b32 a6, 0
    v_accvgpr_write_b32 a7, 0
    v_accvgpr_write_b32 a8, 0
    v_accvgpr_write_b32 a9, 0
    v_accvgpr_write_b32 a10, 0
    v_accvgpr_write_b32 a11, 0
    v_accvgpr_write_b32 a12, 0
    v_accvgpr_write_b32 a13, 0
    v_accvgpr_write_b32 a14, 0
    v_accvgpr_write_b32 a15, 0
    buffer_load_dwordx4 v12, s[16:19], s36 offen offset:2048 lds
    v_accvgpr_write_b32 a16, 0
    v_accvgpr_write_b32 a17, 0
    v_accvgpr_write_b32 a18, 0
    v_accvgpr_write_b32 a19, 0
    v_accvgpr_write_b32 a20, 0
    v_accvgpr_write_b32 a21, 0
    v_accvgpr_write_b32 a22, 0
    v_accvgpr_write_b32 a23, 0
    v_accvgpr_write_b32 a24, 0
    v_accvgpr_write_b32 a25, 0
    v_accvgpr_write_b32 a26, 0
    v_accvgpr_write_b32 a27, 0
    v_accvgpr_write_b32 a28, 0
    buffer_load_dwordx4 v13, s[16:19], s36 offen offset:3072 lds
    v_accvgpr_write_b32 a29, 0
    v_accvgpr_write_b32 a30, 0
    v_accvgpr_write_b32 a31, 0
    v_accvgpr_write_b32 a32, 0
    v_accvgpr_write_b32 a33, 0
    v_accvgpr_write_b32 a34, 0
    v_accvgpr_write_b32 a35, 0
    v_accvgpr_write_b32 a36, 0
    v_accvgpr_write_b32 a37, 0
    v_accvgpr_write_b32 a38, 0
    v_accvgpr_write_b32 a39, 0
    v_accvgpr_write_b32 a40, 0
    v_accvgpr_write_b32 a41, 0
    s_add_u32 m0, s28, 69632
    s_mov_b32 s36, 131072
    buffer_load_dwordx4 v10, s[16:19], s36 offen offset:0 lds
    v_accvgpr_write_b32 a42, 0
    v_accvgpr_write_b32 a43, 0
    v_accvgpr_write_b32 a44, 0
    v_accvgpr_write_b32 a45, 0
    v_accvgpr_write_b32 a46, 0
    v_accvgpr_write_b32 a47, 0
    v_accvgpr_write_b32 a48, 0
    v_accvgpr_write_b32 a49, 0
    v_accvgpr_write_b32 a50, 0
    v_accvgpr_write_b32 a51, 0
    buffer_load_dwordx4 v11, s[16:19], s36 offen offset:1024 lds
    v_accvgpr_write_b32 a52, 0
    v_accvgpr_write_b32 a53, 0
    v_accvgpr_write_b32 a54, 0
    v_accvgpr_write_b32 a55, 0
    v_accvgpr_write_b32 a56, 0
    v_accvgpr_write_b32 a57, 0
    v_accvgpr_write_b32 a58, 0
    v_accvgpr_write_b32 a59, 0
    v_accvgpr_write_b32 a60, 0
    v_accvgpr_write_b32 a61, 0
    v_accvgpr_write_b32 a62, 0
    buffer_load_dwordx4 v12, s[16:19], s36 offen offset:2048 lds
    v_accvgpr_write_b32 a63, 0
    v_accvgpr_write_b32 a64, 0
    v_accvgpr_write_b32 a65, 0
    v_accvgpr_write_b32 a66, 0
    v_accvgpr_write_b32 a67, 0
    v_accvgpr_write_b32 a68, 0
    v_accvgpr_write_b32 a69, 0
    v_accvgpr_write_b32 a70, 0
    v_accvgpr_write_b32 a71, 0
    v_accvgpr_write_b32 a72, 0
    buffer_load_dwordx4 v13, s[16:19], s36 offen offset:3072 lds
    v_accvgpr_write_b32 a73, 0
    v_accvgpr_write_b32 a74, 0
    v_accvgpr_write_b32 a75, 0
    v_accvgpr_write_b32 a76, 0
    v_accvgpr_write_b32 a77, 0
    v_accvgpr_write_b32 a78, 0
    v_accvgpr_write_b32 a79, 0
    v_accvgpr_write_b32 a80, 0
    v_accvgpr_write_b32 a81, 0
    v_accvgpr_write_b32 a82, 0
    v_accvgpr_write_b32 a83, 0
    s_mov_b32 exec_hi, 15
    s_mov_b32 s29, 2359296
    buffer_load_dwordx4 v[20:23], v16, s[20:23], s29 offen
    s_add_u32 s12, s42, s30
    s_addc_u32 s13, s43, 0
    s_sub_u32 s12, s12, 26624
    s_subb_u32 s13, s13, 0
    s_and_b32 s13, s13, 0xffff
    s_mov_b32 s14, 550912
    s_mov_b32 s15, 0x00020000
    s_mov_b32 s31, 847249408
    s_mov_b32 s38, 1117257728
    buffer_load_dwordx4 v[24:27], v16, s[20:23], s29 offen offset:2304
    s_mov_b32 s52, s4
    s_mov_b32 s53, s5
    s_mov_b32 s54, 4718592
    s_mov_b32 s29, 2373120
    buffer_load_dwordx4 v[28:31], v16, s[20:23], s29 offen
    s_cmp_eq_u32 s95, 0
    s_cselect_b32 s52, s76, s52
    s_cselect_b32 s53, s77, s53
    s_cselect_b32 s54, 5308416, s54
    buffer_load_dwordx4 v[32:35], v16, s[20:23], s29 offen offset:2304
    s_cmp_eq_u32 s95, 1
    s_cselect_b32 s52, s78, s52
    s_cselect_b32 s53, s79, s53
    s_cselect_b32 s54, 5308416, s54
    s_mov_b32 s29, 2386944
    buffer_load_dwordx4 v[36:39], v16, s[20:23], s29 offen
    s_cmp_eq_u32 s95, 2
    s_cselect_b32 s52, s80, s52
    s_cselect_b32 s53, s81, s53
    s_cselect_b32 s54, 5308416, s54
    buffer_load_dwordx4 v[40:43], v16, s[20:23], s29 offen offset:2304
    s_and_b32 s53, s53, 0xffff
    s_mov_b32 s55, 0x00020000
    s_mov_b32 s29, 2400768
    buffer_load_dwordx4 v[44:47], v16, s[20:23], s29 offen
    buffer_load_dwordx4 v[48:51], v16, s[20:23], s29 offen offset:2304
    s_mov_b32 exec_hi, -1
    buffer_load_dwordx4 v[160:163], v14, s[20:23], s34 offen offset:0
    v_accvgpr_write_b32 a84, 0
    v_accvgpr_write_b32 a85, 0
    v_accvgpr_write_b32 a86, 0
    v_accvgpr_write_b32 a87, 0
    v_accvgpr_write_b32 a88, 0
    v_accvgpr_write_b32 a89, 0
    v_accvgpr_write_b32 a90, 0
    v_accvgpr_write_b32 a91, 0
    v_accvgpr_write_b32 a92, 0
    v_accvgpr_write_b32 a93, 0
    v_accvgpr_write_b32 a94, 0
    buffer_load_dwordx4 v[164:167], v14, s[20:23], s35 offen offset:0
    v_accvgpr_write_b32 a95, 0
    v_accvgpr_write_b32 a96, 0
    v_accvgpr_write_b32 a97, 0
    v_accvgpr_write_b32 a98, 0
    v_accvgpr_write_b32 a99, 0
    v_accvgpr_write_b32 a100, 0
    v_accvgpr_write_b32 a101, 0
    v_accvgpr_write_b32 a102, 0
    v_accvgpr_write_b32 a103, 0
    v_accvgpr_write_b32 a104, 0
    v_accvgpr_write_b32 a105, 0
    buffer_load_dwordx4 v[168:171], v14, s[20:23], s34 offen offset:1024
    v_accvgpr_write_b32 a106, 0
    v_accvgpr_write_b32 a107, 0
    v_accvgpr_write_b32 a108, 0
    v_accvgpr_write_b32 a109, 0
    v_accvgpr_write_b32 a110, 0
    v_accvgpr_write_b32 a111, 0
    v_accvgpr_write_b32 a112, 0
    v_accvgpr_write_b32 a113, 0
    v_accvgpr_write_b32 a114, 0
    v_accvgpr_write_b32 a115, 0
    v_accvgpr_write_b32 a116, 0
    buffer_load_dwordx4 v[172:175], v14, s[20:23], s35 offen offset:1024
    v_accvgpr_write_b32 a117, 0
    v_accvgpr_write_b32 a118, 0
    v_accvgpr_write_b32 a119, 0
    v_accvgpr_write_b32 a120, 0
    v_accvgpr_write_b32 a121, 0
    v_accvgpr_write_b32 a122, 0
    v_accvgpr_write_b32 a123, 0
    v_accvgpr_write_b32 a124, 0
    v_accvgpr_write_b32 a125, 0
    v_accvgpr_write_b32 a126, 0
    v_accvgpr_write_b32 a127, 0
    buffer_load_dword a170, v54, s[16:19], 0 offen
    s_mov_b32 s29, 1040356334
    s_add_u32 m0, s28, 98304
    s_mov_b32 s36, 524288
    buffer_load_dwordx4 v10, s[16:19], s36 offen offset:0 lds
    buffer_load_dwordx4 v11, s[16:19], s36 offen offset:1024 lds
    buffer_load_dwordx4 v12, s[16:19], s36 offen offset:2048 lds
    buffer_load_dwordx4 v13, s[16:19], s36 offen offset:3072 lds
    s_waitcnt vmcnt(9)
    s_add_u32 m0, s28, 102400
    s_mov_b32 s36, 655360
    buffer_load_dwordx4 v10, s[16:19], s36 offen offset:0 lds
    v_add_f32 v20, v20, v28
    v_add_f32 v36, v36, v44
    v_add_f32 v21, v21, v29
    v_add_f32 v37, v37, v45
    v_add_f32 v22, v22, v30
    v_add_f32 v38, v38, v46
    v_add_f32 v23, v23, v31
    v_add_f32 v39, v39, v47
    v_add_f32 v24, v24, v32
    v_add_f32 v40, v40, v48
    v_add_f32 v25, v25, v33
    v_add_f32 v41, v41, v49
    v_add_f32 v26, v26, v34
    buffer_load_dwordx4 v11, s[16:19], s36 offen offset:1024 lds
    v_add_f32 v42, v42, v50
    v_add_f32 v27, v27, v35
    v_add_f32 v43, v43, v51
    v_add_f32 v20, v20, v36
    v_add_f32 v21, v21, v37
    v_add_f32 v22, v22, v38
    v_add_f32 v23, v23, v39
    v_add_f32 v24, v24, v40
    v_add_f32 v25, v25, v41
    v_add_f32 v26, v26, v42
    v_add_f32 v27, v27, v43
    v_cvt_pk_bf16_f32 v28, v20, v21
    v_cvt_pk_bf16_f32 v29, v22, v23
    v_cvt_pk_bf16_f32 v30, v24, v25
    buffer_load_dwordx4 v12, s[16:19], s36 offen offset:2048 lds
    v_cvt_pk_bf16_f32 v31, v26, v27
    v_lshlrev_b32 v20, 16, v28
    v_and_b32 v21, 0xffff0000, v28
    v_lshlrev_b32 v22, 16, v29
    v_and_b32 v23, 0xffff0000, v29
    v_lshlrev_b32 v24, 16, v30
    v_and_b32 v25, 0xffff0000, v30
    v_lshlrev_b32 v26, 16, v31
    v_and_b32 v27, 0xffff0000, v31
    v_add_f32 v24, 1.0, v24
    v_add_f32 v25, 1.0, v25
    v_add_f32 v26, 1.0, v26
    v_add_f32 v27, 1.0, v27
    buffer_load_dwordx4 v13, s[16:19], s36 offen offset:3072 lds
    v_cvt_pk_bf16_f32 v28, v24, v25
    v_cvt_pk_bf16_f32 v29, v26, v27
    v_lshlrev_b32 v24, 16, v28
    v_and_b32 v25, 0xffff0000, v28
    v_lshlrev_b32 v26, 16, v29
    v_and_b32 v27, 0xffff0000, v29
    v_mul_f32 v20, s29, v20
    v_mul_f32 v21, s29, v21
    v_mul_f32 v22, s29, v22
    v_mul_f32 v23, s29, v23
    v_mul_f32 v24, s29, v24
    v_mul_f32 v25, s29, v25
    v_mul_f32 v26, s29, v26
    v_mul_f32 v27, s29, v27
    s_mov_b32 exec_hi, 15
    ds_write_b128 v17, v[24:27]
    ds_write_b128 v17, v[20:23] offset:32
    s_mov_b32 exec_hi, -1
    s_waitcnt lgkmcnt(0)
    s_barrier
    ds_read_b128 v[224:227], v9 offset:0
    ds_read_b128 v[232:235], v9 offset:32
    ds_read_b128 v[228:231], v9 offset:16
    ds_read_b128 v[236:239], v9 offset:48
    ds_read_b128 v[240:243], v9 offset:256
    ds_read_b128 v[248:251], v9 offset:288
    ds_read_b128 v[244:247], v9 offset:272
    ds_read_b128 v[252:255], v9 offset:304
    ds_read_b64_tr_b16 a[192:193], v1 offset:0
    ds_read_b64_tr_b16 a[194:195], v1 offset:8192
    ds_read_b64_tr_b16 a[196:197], v2 offset:0
    ds_read_b64_tr_b16 a[198:199], v2 offset:8192
    ds_read_b64_tr_b16 a[200:201], v3 offset:0
    ds_read_b64_tr_b16 a[202:203], v3 offset:8192
    ds_read_b64_tr_b16 a[204:205], v4 offset:0
    ds_read_b64_tr_b16 a[206:207], v4 offset:8192
    ds_read_b64_tr_b16 a[208:209], v5 offset:0
    ds_read_b64_tr_b16 a[210:211], v5 offset:8192
    ds_read_b64_tr_b16 a[212:213], v6 offset:0
    ds_read_b64_tr_b16 a[214:215], v6 offset:8192
    buffer_load_dwordx4 v[176:179], v14, s[20:23], s34 offen offset:2048
    s_waitcnt vmcnt(12) lgkmcnt(15)
    v_fma_mix_f32 v15, v160, v224, v232 op_sel:[0,0,0] op_sel_hi:[1,0,0]
    v_fma_mix_f32 v144, v160, v225, v233 op_sel:[1,0,0] op_sel_hi:[1,0,0]
    v_fma_mix_f32 v232, v164, v224, v232 op_sel:[0,0,0] op_sel_hi:[1,0,0]
    v_cvt_pk_bf16_f32 v144, v15, v144
    v_fma_mix_f32 v233, v164, v225, v233 op_sel:[1,0,0] op_sel_hi:[1,0,0]
    buffer_load_dwordx4 v[180:183], v14, s[20:23], s35 offen offset:2048
    v_cvt_pk_bf16_f32 v148, v232, v233
    v_fma_mix_f32 v15, v161, v226, v234 op_sel:[0,0,0] op_sel_hi:[1,0,0]
    v_fma_mix_f32 v145, v161, v227, v235 op_sel:[1,0,0] op_sel_hi:[1,0,0]
    v_fma_mix_f32 v234, v165, v226, v234 op_sel:[0,0,0] op_sel_hi:[1,0,0]
    v_cvt_pk_bf16_f32 v145, v15, v145
    v_fma_mix_f32 v235, v165, v227, v235 op_sel:[1,0,0] op_sel_hi:[1,0,0]
    buffer_load_dwordx4 v[184:187], v14, s[20:23], s34 offen offset:3072
    v_cvt_pk_bf16_f32 v149, v234, v235
    v_fma_mix_f32 v15, v162, v228, v236 op_sel:[0,0,0] op_sel_hi:[1,0,0]
    v_fma_mix_f32 v146, v162, v229, v237 op_sel:[1,0,0] op_sel_hi:[1,0,0]
    v_fma_mix_f32 v236, v166, v228, v236 op_sel:[0,0,0] op_sel_hi:[1,0,0]
    v_cvt_pk_bf16_f32 v146, v15, v146
    v_fma_mix_f32 v237, v166, v229, v237 op_sel:[1,0,0] op_sel_hi:[1,0,0]
    buffer_load_dwordx4 v[188:191], v14, s[20:23], s35 offen offset:3072
    v_cvt_pk_bf16_f32 v150, v236, v237
    v_fma_mix_f32 v15, v163, v230, v238 op_sel:[0,0,0] op_sel_hi:[1,0,0]
    v_fma_mix_f32 v147, v163, v231, v239 op_sel:[1,0,0] op_sel_hi:[1,0,0]
    v_fma_mix_f32 v238, v167, v230, v238 op_sel:[0,0,0] op_sel_hi:[1,0,0]
    v_cvt_pk_bf16_f32 v147, v15, v147
    v_fma_mix_f32 v239, v167, v231, v239 op_sel:[1,0,0] op_sel_hi:[1,0,0]
    v_cvt_pk_bf16_f32 v151, v238, v239
    s_waitcnt lgkmcnt(8)
    s_nop 0
    v_mfma_f32_16x16x32_bf16 v[16:19], a[192:195], v[144:147], 0
    s_waitcnt vmcnt(13)
    ds_read_b64_tr_b16 a[216:217], v7 offset:0
    ds_read_b64_tr_b16 a[218:219], v7 offset:8192
    v_fma_mix_f32 v15, v168, v240, v248 op_sel:[0,0,0] op_sel_hi:[1,0,0]
    v_mfma_f32_16x16x32_bf16 v[20:23], a[192:195], v[148:151], 0
    ds_read_b64_tr_b16 a[220:221], v8 offset:0
    ds_read_b64_tr_b16 a[222:223], v8 offset:8192
    v_mfma_f32_16x16x32_bf16 v[28:31], a[196:199], v[148:151], 0
    s_add_u32 s34, s34, 4096
    buffer_load_dwordx4 v[192:195], v14, s[20:23], s34 offen offset:0
    v_fma_mix_f32 v152, v168, v241, v249 op_sel:[1,0,0] op_sel_hi:[1,0,0]
    v_mfma_f32_16x16x32_bf16 v[24:27], a[196:199], v[144:147], 0
    s_waitcnt lgkmcnt(8)
    ds_read_b128 v[224:227], v9 offset:512
    v_fma_mix_f32 v248, v172, v240, v248 op_sel:[0,0,0] op_sel_hi:[1,0,0]
    v_cvt_pk_bf16_f32 v152, v15, v152
    v_mfma_f32_16x16x32_bf16 v[32:35], a[200:203], v[144:147], 0
    ds_read_b128 v[232:235], v9 offset:544
    ds_read_b128 v[228:231], v9 offset:528
    v_mfma_f32_16x16x32_bf16 v[36:39], a[200:203], v[148:151], 0
    s_add_u32 s35, s35, 4096
    buffer_load_dwordx4 v[196:199], v14, s[20:23], s35 offen offset:0
    v_fma_mix_f32 v249, v172, v241, v249 op_sel:[1,0,0] op_sel_hi:[1,0,0]
    v_mfma_f32_16x16x32_bf16 v[44:47], a[204:207], v[148:151], 0
    ds_read_b128 v[236:239], v9 offset:560
    ds_read_b64_tr_b16 a[224:225], v1 offset:256
    v_cvt_pk_bf16_f32 v156, v248, v249
    v_mfma_f32_16x16x32_bf16 v[40:43], a[204:207], v[144:147], 0
    s_waitcnt lgkmcnt(9)
    ds_read_b64_tr_b16 a[226:227], v1 offset:8448
    ds_read_b64_tr_b16 a[228:229], v2 offset:256
    v_mfma_f32_16x16x32_bf16 v[48:51], a[208:211], v[144:147], 0
    ds_read_b64_tr_b16 a[230:231], v2 offset:8448
    ds_read_b64_tr_b16 a[232:233], v3 offset:256
    v_fma_mix_f32 v15, v169, v242, v250 op_sel:[0,0,0] op_sel_hi:[1,0,0]
    v_mfma_f32_16x16x32_bf16 v[52:55], a[208:211], v[148:151], 0
    buffer_load_dwordx4 v[200:203], v14, s[20:23], s34 offen offset:1024
    v_fma_mix_f32 v153, v169, v243, v251 op_sel:[1,0,0] op_sel_hi:[1,0,0]
    v_mfma_f32_16x16x32_bf16 v[60:63], a[212:215], v[148:151], 0
    ds_read_b64_tr_b16 a[234:235], v3 offset:8448
    ds_read_b64_tr_b16 a[236:237], v4 offset:256
    v_mfma_f32_16x16x32_bf16 v[56:59], a[212:215], v[144:147], 0
    s_waitcnt lgkmcnt(11)
    ds_read_b64_tr_b16 a[238:239], v4 offset:8448
    v_fma_mix_f32 v250, v173, v242, v250 op_sel:[0,0,0] op_sel_hi:[1,0,0]
    v_cvt_pk_bf16_f32 v153, v15, v153
    v_mfma_f32_16x16x32_bf16 v[64:67], a[216:219], v[144:147], 0
    buffer_load_dwordx4 v[204:207], v14, s[20:23], s35 offen offset:1024
    v_fma_mix_f32 v251, v173, v243, v251 op_sel:[1,0,0] op_sel_hi:[1,0,0]
    v_mfma_f32_16x16x32_bf16 v[68:71], a[216:219], v[148:151], 0
    ds_read_b64_tr_b16 a[240:241], v5 offset:256
    ds_read_b64_tr_b16 a[242:243], v5 offset:8448
    v_mfma_f32_16x16x32_bf16 v[76:79], a[220:223], v[148:151], 0
    ds_read_b64_tr_b16 a[244:245], v6 offset:256
    ds_read_b64_tr_b16 a[246:247], v6 offset:8448
    v_cvt_pk_bf16_f32 v157, v250, v251
    v_mfma_f32_16x16x32_bf16 v[72:75], a[220:223], v[144:147], 0
    s_waitcnt lgkmcnt(8)
    ds_read_b64_tr_b16 a[248:249], v7 offset:256
    ds_read_b64_tr_b16 a[250:251], v7 offset:8448
    v_fma_mix_f32 v15, v170, v244, v252 op_sel:[0,0,0] op_sel_hi:[1,0,0]
    v_mfma_f32_16x16x32_bf16 v[80:83], a[224:227], v[144:147], 0
    buffer_load_dwordx4 v[208:211], v14, s[20:23], s34 offen offset:2048
    v_mfma_f32_16x16x32_bf16 v[84:87], a[224:227], v[148:151], 0
    ds_read_b64_tr_b16 a[252:253], v8 offset:256
    ds_read_b64_tr_b16 a[254:255], v8 offset:8448
    v_fma_mix_f32 v154, v170, v245, v253 op_sel:[1,0,0] op_sel_hi:[1,0,0]
    v_mfma_f32_16x16x32_bf16 v[92:95], a[228:231], v[148:151], 0
    ds_read_b64_tr_b16 a[192:193], v1 offset:16384
    v_fma_mix_f32 v252, v174, v244, v252 op_sel:[0,0,0] op_sel_hi:[1,0,0]
    v_cvt_pk_bf16_f32 v154, v15, v154
    v_mfma_f32_16x16x32_bf16 v[88:91], a[228:231], v[144:147], 0
    s_waitcnt lgkmcnt(9)
    ds_read_b64_tr_b16 a[194:195], v1 offset:24576
    ds_read_b64_tr_b16 a[196:197], v2 offset:16384
    v_mfma_f32_16x16x32_bf16 v[96:99], a[232:235], v[144:147], 0
    buffer_load_dwordx4 v[212:215], v14, s[20:23], s35 offen offset:2048
    v_fma_mix_f32 v253, v174, v245, v253 op_sel:[1,0,0] op_sel_hi:[1,0,0]
    v_mfma_f32_16x16x32_bf16 v[100:103], a[232:235], v[148:151], 0
    ds_read_b64_tr_b16 a[198:199], v2 offset:24576
    ds_read_b64_tr_b16 a[200:201], v3 offset:16384
    v_cvt_pk_bf16_f32 v158, v252, v253
    v_mfma_f32_16x16x32_bf16 v[108:111], a[236:239], v[148:151], 0
    s_add_u32 m0, s28, 0
    ds_read_b64_tr_b16 a[202:203], v3 offset:24576
    ds_read_b64_tr_b16 a[204:205], v4 offset:16384
    v_mfma_f32_16x16x32_bf16 v[104:107], a[236:239], v[144:147], 0
    s_mov_b32 s36, 1048576
    s_waitcnt lgkmcnt(11)
    buffer_load_dwordx4 v10, s[16:19], s36 offen offset:0 lds
    v_fma_mix_f32 v15, v171, v246, v254 op_sel:[0,0,0] op_sel_hi:[1,0,0]
    v_mfma_f32_16x16x32_bf16 v[112:115], a[240:243], v[144:147], 0
    ds_read_b64_tr_b16 a[206:207], v4 offset:24576
    ds_read_b64_tr_b16 a[208:209], v5 offset:16384
    v_fma_mix_f32 v155, v171, v247, v255 op_sel:[1,0,0] op_sel_hi:[1,0,0]
    v_mfma_f32_16x16x32_bf16 v[116:119], a[240:243], v[148:151], 0
    ds_read_b64_tr_b16 a[210:211], v5 offset:24576
    ds_read_b64_tr_b16 a[212:213], v6 offset:16384
    v_mfma_f32_16x16x32_bf16 v[124:127], a[244:247], v[148:151], 0
    ds_read_b64_tr_b16 a[214:215], v6 offset:24576
    v_fma_mix_f32 v254, v175, v246, v254 op_sel:[0,0,0] op_sel_hi:[1,0,0]
    v_cvt_pk_bf16_f32 v155, v15, v155
    v_mfma_f32_16x16x32_bf16 v[120:123], a[244:247], v[144:147], 0
    s_waitcnt lgkmcnt(12)
    buffer_load_dwordx4 v11, s[16:19], s36 offen offset:1024 lds
    v_fma_mix_f32 v255, v175, v247, v255 op_sel:[1,0,0] op_sel_hi:[1,0,0]
    v_mfma_f32_16x16x32_bf16 v[128:131], a[248:251], v[144:147], 0
    ds_read_b64_tr_b16 a[216:217], v7 offset:16384
    ds_read_b64_tr_b16 a[218:219], v7 offset:24576
    v_mfma_f32_16x16x32_bf16 v[132:135], a[248:251], v[148:151], 0
    ds_read_b64_tr_b16 a[220:221], v8 offset:16384
    ds_read_b64_tr_b16 a[222:223], v8 offset:24576
    v_cvt_pk_bf16_f32 v159, v254, v255
    v_mfma_f32_16x16x32_bf16 v[140:143], a[252:255], v[148:151], 0
    ds_read_b128 v[240:243], v9 offset:768
    ds_read_b128 v[248:251], v9 offset:800
    v_mfma_f32_16x16x32_bf16 v[136:139], a[252:255], v[144:147], 0
    s_waitcnt lgkmcnt(14)
    buffer_load_dwordx4 v12, s[16:19], s36 offen offset:2048 lds
    v_mfma_f32_16x16x32_bf16 v[16:19], a[192:195], v[152:155], v[16:19]
    ds_read_b128 v[244:247], v9 offset:784
    ds_read_b128 v[252:255], v9 offset:816
    v_mfma_f32_16x16x32_bf16 v[20:23], a[192:195], v[156:159], v[20:23]
    s_waitcnt vmcnt(11)
    ds_read_b64_tr_b16 a[224:225], v1 offset:16640
    v_fma_mix_f32 v15, v176, v224, v232 op_sel:[0,0,0] op_sel_hi:[1,0,0]
    v_fma_mix_f32 v144, v176, v225, v233 op_sel:[1,0,0] op_sel_hi:[1,0,0]
    v_mfma_f32_16x16x32_bf16 v[28:31], a[196:199], v[156:159], v[28:31]
    buffer_load_dwordx4 v13, s[16:19], s36 offen offset:3072 lds
    v_mfma_f32_16x16x32_bf16 v[24:27], a[196:199], v[152:155], v[24:27]
    s_waitcnt lgkmcnt(13)
    ds_read_b64_tr_b16 a[226:227], v1 offset:24832
    ds_read_b64_tr_b16 a[228:229], v2 offset:16640
    v_mfma_f32_16x16x32_bf16 v[32:35], a[200:203], v[152:155], v[32:35]
    ds_read_b64_tr_b16 a[230:231], v2 offset:24832
    ds_read_b64_tr_b16 a[232:233], v3 offset:16640
    v_fma_mix_f32 v232, v180, v224, v232 op_sel:[0,0,0] op_sel_hi:[1,0,0]
    v_mfma_f32_16x16x32_bf16 v[36:39], a[200:203], v[156:159], v[36:39]
    s_add_u32 m0, s28, 4096
    ds_read_b64_tr_b16 a[234:235], v3 offset:24832
    ds_read_b64_tr_b16 a[236:237], v4 offset:16640
    v_mfma_f32_16x16x32_bf16 v[44:47], a[204:207], v[156:159], v[44:47]
    s_mov_b32 s36, 1179648
    buffer_load_dwordx4 v10, s[16:19], s36 offen offset:0 lds
    v_mfma_f32_16x16x32_bf16 v[40:43], a[204:207], v[152:155], v[40:43]
    s_waitcnt lgkmcnt(15)
    ds_read_b64_tr_b16 a[238:239], v4 offset:24832
    ds_read_b64_tr_b16 a[240:241], v5 offset:16640
    v_mfma_f32_16x16x32_bf16 v[48:51], a[208:211], v[152:155], v[48:51]
    ds_read_b64_tr_b16 a[242:243], v5 offset:24832
    ds_read_b64_tr_b16 a[244:245], v6 offset:16640
    v_cvt_pk_bf16_f32 v144, v15, v144
    v_mfma_f32_16x16x32_bf16 v[52:55], a[208:211], v[156:159], v[52:55]
    ds_read_b64_tr_b16 a[246:247], v6 offset:24832
    v_fma_mix_f32 v233, v180, v225, v233 op_sel:[1,0,0] op_sel_hi:[1,0,0]
    v_mfma_f32_16x16x32_bf16 v[60:63], a[212:215], v[156:159], v[60:63]
    buffer_load_dwordx4 v11, s[16:19], s36 offen offset:1024 lds
    v_mfma_f32_16x16x32_bf16 v[56:59], a[212:215], v[152:155], v[56:59]
    s_waitcnt lgkmcnt(15)
    ds_read_b64_tr_b16 a[248:249], v7 offset:16640
    ds_read_b64_tr_b16 a[250:251], v7 offset:24832
    v_cvt_pk_bf16_f32 v148, v232, v233
    v_mfma_f32_16x16x32_bf16 v[64:67], a[216:219], v[152:155], v[64:67]
    ds_read_b64_tr_b16 a[252:253], v8 offset:16640
    ds_read_b64_tr_b16 a[254:255], v8 offset:24832
    v_mfma_f32_16x16x32_bf16 v[68:71], a[216:219], v[156:159], v[68:71]
    buffer_load_dwordx4 v12, s[16:19], s36 offen offset:2048 lds
    v_mfma_f32_16x16x32_bf16 v[76:79], a[220:223], v[156:159], v[76:79]
    v_fma_mix_f32 v15, v177, v226, v234 op_sel:[0,0,0] op_sel_hi:[1,0,0]
    v_fma_mix_f32 v145, v177, v227, v235 op_sel:[1,0,0] op_sel_hi:[1,0,0]
    v_fma_mix_f32 v234, v181, v226, v234 op_sel:[0,0,0] op_sel_hi:[1,0,0]
    v_mfma_f32_16x16x32_bf16 v[72:75], a[220:223], v[152:155], v[72:75]
    s_waitcnt lgkmcnt(12)
    v_cvt_pk_bf16_f32 v145, v15, v145
    v_fma_mix_f32 v235, v181, v227, v235 op_sel:[1,0,0] op_sel_hi:[1,0,0]
    v_mfma_f32_16x16x32_bf16 v[80:83], a[224:227], v[152:155], v[80:83]
    v_cvt_pk_bf16_f32 v149, v234, v235
    v_fma_mix_f32 v15, v178, v228, v236 op_sel:[0,0,0] op_sel_hi:[1,0,0]
    v_mfma_f32_16x16x32_bf16 v[84:87], a[224:227], v[156:159], v[84:87]
    buffer_load_dwordx4 v13, s[16:19], s36 offen offset:3072 lds
    v_mfma_f32_16x16x32_bf16 v[92:95], a[228:231], v[156:159], v[92:95]
    s_waitcnt lgkmcnt(0)
    v_fma_mix_f32 v146, v178, v229, v237 op_sel:[1,0,0] op_sel_hi:[1,0,0]
    v_fma_mix_f32 v236, v182, v228, v236 op_sel:[0,0,0] op_sel_hi:[1,0,0]
    v_cvt_pk_bf16_f32 v146, v15, v146
    v_mfma_f32_16x16x32_bf16 v[88:91], a[228:231], v[152:155], v[88:91]
    s_barrier
    v_fma_mix_f32 v237, v182, v229, v237 op_sel:[1,0,0] op_sel_hi:[1,0,0]
    v_cvt_pk_bf16_f32 v150, v236, v237
    v_mfma_f32_16x16x32_bf16 v[96:99], a[232:235], v[152:155], v[96:99]
    ds_read_b64_tr_b16 a[192:193], v1 offset:32768
    ds_read_b64_tr_b16 a[194:195], v1 offset:40960
    v_mfma_f32_16x16x32_bf16 v[100:103], a[232:235], v[156:159], v[100:103]
    ds_read_b64_tr_b16 a[196:197], v2 offset:32768
    v_fma_mix_f32 v15, v179, v230, v238 op_sel:[0,0,0] op_sel_hi:[1,0,0]
    v_fma_mix_f32 v147, v179, v231, v239 op_sel:[1,0,0] op_sel_hi:[1,0,0]
    v_mfma_f32_16x16x32_bf16 v[108:111], a[236:239], v[156:159], v[108:111]
    buffer_load_dwordx4 v[216:219], v14, s[20:23], s34 offen offset:3072
    v_mfma_f32_16x16x32_bf16 v[104:107], a[236:239], v[152:155], v[104:107]
    ds_read_b64_tr_b16 a[198:199], v2 offset:40960
    ds_read_b64_tr_b16 a[200:201], v3 offset:32768
    v_mfma_f32_16x16x32_bf16 v[112:115], a[240:243], v[152:155], v[112:115]
    ds_read_b64_tr_b16 a[202:203], v3 offset:40960
    v_fma_mix_f32 v238, v183, v230, v238 op_sel:[0,0,0] op_sel_hi:[1,0,0]
    v_cvt_pk_bf16_f32 v147, v15, v147
    v_mfma_f32_16x16x32_bf16 v[116:119], a[240:243], v[156:159], v[116:119]
    ds_read_b64_tr_b16 a[204:205], v4 offset:32768
    ds_read_b64_tr_b16 a[206:207], v4 offset:40960
    v_mfma_f32_16x16x32_bf16 v[124:127], a[244:247], v[156:159], v[124:127]
    buffer_load_dwordx4 v[220:223], v14, s[20:23], s35 offen offset:3072
    v_mfma_f32_16x16x32_bf16 v[120:123], a[244:247], v[152:155], v[120:123]
    ds_read_b64_tr_b16 a[208:209], v5 offset:32768
    ds_read_b64_tr_b16 a[210:211], v5 offset:40960
    v_mfma_f32_16x16x32_bf16 v[128:131], a[248:251], v[152:155], v[128:131]
    ds_read_b64_tr_b16 a[212:213], v6 offset:32768
    v_fma_mix_f32 v239, v183, v231, v239 op_sel:[1,0,0] op_sel_hi:[1,0,0]
    v_cvt_pk_bf16_f32 v151, v238, v239
    v_mfma_f32_16x16x32_bf16 v[132:135], a[248:251], v[156:159], v[132:135]
    ds_read_b64_tr_b16 a[214:215], v6 offset:40960
    ds_read_b64_tr_b16 a[216:217], v7 offset:32768
    v_mfma_f32_16x16x32_bf16 v[140:143], a[252:255], v[156:159], v[140:143]
    ds_read_b64_tr_b16 a[218:219], v7 offset:40960
    v_mfma_f32_16x16x32_bf16 v[136:139], a[252:255], v[152:155], v[136:139]
    s_add_u32 s34, s34, 4096
    s_waitcnt lgkmcnt(10)
    buffer_load_dwordx4 v[160:163], v14, s[20:23], s34 offen offset:0
    v_mfma_f32_16x16x32_bf16 v[16:19], a[192:195], v[144:147], v[16:19]
    s_waitcnt vmcnt(17)
    ds_read_b64_tr_b16 a[220:221], v8 offset:32768
    ds_read_b64_tr_b16 a[222:223], v8 offset:40960
    v_fma_mix_f32 v15, v184, v240, v248 op_sel:[0,0,0] op_sel_hi:[1,0,0]
    v_mfma_f32_16x16x32_bf16 v[20:23], a[192:195], v[148:151], v[20:23]
    ds_read_b128 v[224:227], v9 offset:1024
    ds_read_b128 v[232:235], v9 offset:1056
    v_mfma_f32_16x16x32_bf16 v[28:31], a[196:199], v[148:151], v[28:31]
    ds_read_b128 v[228:231], v9 offset:1040
    v_fma_mix_f32 v152, v184, v241, v249 op_sel:[1,0,0] op_sel_hi:[1,0,0]
    v_fma_mix_f32 v248, v188, v240, v248 op_sel:[0,0,0] op_sel_hi:[1,0,0]
    v_mfma_f32_16x16x32_bf16 v[24:27], a[196:199], v[144:147], v[24:27]
    s_add_u32 s35, s35, 4096
    s_waitcnt lgkmcnt(11)
    buffer_load_dwordx4 v[164:167], v14, s[20:23], s35 offen offset:0
    v_mfma_f32_16x16x32_bf16 v[32:35], a[200:203], v[144:147], v[32:35]
    ds_read_b128 v[236:239], v9 offset:1072
    ds_read_b64_tr_b16 a[224:225], v1 offset:33024
    v_cvt_pk_bf16_f32 v152, v15, v152
    v_mfma_f32_16x16x32_bf16 v[36:39], a[200:203], v[148:151], v[36:39]
    ds_read_b64_tr_b16 a[226:227], v1 offset:41216
    v_fma_mix_f32 v249, v188, v241, v249 op_sel:[1,0,0] op_sel_hi:[1,0,0]
    v_mfma_f32_16x16x32_bf16 v[44:47], a[204:207], v[148:151], v[44:47]
    ds_read_b64_tr_b16 a[228:229], v2 offset:33024
    ds_read_b64_tr_b16 a[230:231], v2 offset:41216
    v_cvt_pk_bf16_f32 v156, v248, v249
    v_mfma_f32_16x16x32_bf16 v[40:43], a[204:207], v[144:147], v[40:43]
    s_waitcnt lgkmcnt(12)
    ds_read_b64_tr_b16 a[232:233], v3 offset:33024
    ds_read_b64_tr_b16 a[234:235], v3 offset:41216
    v_mfma_f32_16x16x32_bf16 v[48:51], a[208:211], v[144:147], v[48:51]
    buffer_load_dwordx4 v[168:171], v14, s[20:23], s34 offen offset:1024
    v_fma_mix_f32 v15, v185, v242, v250 op_sel:[0,0,0] op_sel_hi:[1,0,0]
    v_mfma_f32_16x16x32_bf16 v[52:55], a[208:211], v[148:151], v[52:55]
    ds_read_b64_tr_b16 a[236:237], v4 offset:33024
    v_fma_mix_f32 v153, v185, v243, v251 op_sel:[1,0,0] op_sel_hi:[1,0,0]
    v_mfma_f32_16x16x32_bf16 v[60:63], a[212:215], v[148:151], v[60:63]
    ds_read_b64_tr_b16 a[238:239], v4 offset:41216
    ds_read_b64_tr_b16 a[240:241], v5 offset:33024
    v_fma_mix_f32 v250, v189, v242, v250 op_sel:[0,0,0] op_sel_hi:[1,0,0]
    v_mfma_f32_16x16x32_bf16 v[56:59], a[212:215], v[144:147], v[56:59]
    s_waitcnt lgkmcnt(13)
    ds_read_b64_tr_b16 a[242:243], v5 offset:41216
    v_cvt_pk_bf16_f32 v153, v15, v153
    v_mfma_f32_16x16x32_bf16 v[64:67], a[216:219], v[144:147], v[64:67]
    buffer_load_dwordx4 v[172:175], v14, s[20:23], s35 offen offset:1024
    v_fma_mix_f32 v251, v189, v243, v251 op_sel:[1,0,0] op_sel_hi:[1,0,0]
    v_mfma_f32_16x16x32_bf16 v[68:71], a[216:219], v[148:151], v[68:71]
    ds_read_b64_tr_b16 a[244:245], v6 offset:33024
    ds_read_b64_tr_b16 a[246:247], v6 offset:41216
    v_mfma_f32_16x16x32_bf16 v[76:79], a[220:223], v[148:151], v[76:79]
    ds_read_b64_tr_b16 a[248:249], v7 offset:33024
    ds_read_b64_tr_b16 a[250:251], v7 offset:41216
    v_cvt_pk_bf16_f32 v157, v250, v251
    v_mfma_f32_16x16x32_bf16 v[72:75], a[220:223], v[144:147], v[72:75]
    s_waitcnt lgkmcnt(10)
    ds_read_b64_tr_b16 a[252:253], v8 offset:33024
    v_fma_mix_f32 v15, v186, v244, v252 op_sel:[0,0,0] op_sel_hi:[1,0,0]
    v_mfma_f32_16x16x32_bf16 v[80:83], a[224:227], v[144:147], v[80:83]
    s_add_u32 m0, s28, 32768
    ds_read_b64_tr_b16 a[254:255], v8 offset:41216
    ds_read_b64_tr_b16 a[192:193], v1 offset:49152
    v_fma_mix_f32 v154, v186, v245, v253 op_sel:[1,0,0] op_sel_hi:[1,0,0]
    v_mfma_f32_16x16x32_bf16 v[84:87], a[224:227], v[148:151], v[84:87]
    s_mov_b32 s36, 1572864
    buffer_load_dwordx4 v10, s[16:19], s36 offen offset:0 lds
    v_mfma_f32_16x16x32_bf16 v[92:95], a[228:231], v[148:151], v[92:95]
    ds_read_b64_tr_b16 a[194:195], v1 offset:57344
    v_fma_mix_f32 v252, v190, v244, v252 op_sel:[0,0,0] op_sel_hi:[1,0,0]
    v_cvt_pk_bf16_f32 v154, v15, v154
    v_mfma_f32_16x16x32_bf16 v[88:91], a[228:231], v[144:147], v[88:91]
    s_waitcnt lgkmcnt(10)
    ds_read_b64_tr_b16 a[196:197], v2 offset:49152
    ds_read_b64_tr_b16 a[198:199], v2 offset:57344
    v_mfma_f32_16x16x32_bf16 v[96:99], a[232:235], v[144:147], v[96:99]
    ds_read_b64_tr_b16 a[200:201], v3 offset:49152
    ds_read_b64_tr_b16 a[202:203], v3 offset:57344
    v_fma_mix_f32 v253, v190, v245, v253 op_sel:[1,0,0] op_sel_hi:[1,0,0]
    v_mfma_f32_16x16x32_bf16 v[100:103], a[232:235], v[148:151], v[100:103]
    buffer_load_dwordx4 v11, s[16:19], s36 offen offset:1024 lds
    v_mfma_f32_16x16x32_bf16 v[108:111], a[236:239], v[148:151], v[108:111]
    ds_read_b64_tr_b16 a[204:205], v4 offset:49152
    v_cvt_pk_bf16_f32 v158, v252, v253
    v_fma_mix_f32 v15, v187, v246, v254 op_sel:[0,0,0] op_sel_hi:[1,0,0]
    v_mfma_f32_16x16x32_bf16 v[104:107], a[236:239], v[144:147], v[104:107]
    s_waitcnt lgkmcnt(11)
    ds_read_b64_tr_b16 a[206:207], v4 offset:57344
    ds_read_b64_tr_b16 a[208:209], v5 offset:49152
    v_mfma_f32_16x16x32_bf16 v[112:115], a[240:243], v[144:147], v[112:115]
    ds_read_b64_tr_b16 a[210:211], v5 offset:57344
    v_fma_mix_f32 v155, v187, v247, v255 op_sel:[1,0,0] op_sel_hi:[1,0,0]
    v_fma_mix_f32 v254, v191, v246, v254 op_sel:[0,0,0] op_sel_hi:[1,0,0]
    v_mfma_f32_16x16x32_bf16 v[116:119], a[240:243], v[148:151], v[116:119]
    ds_read_b64_tr_b16 a[212:213], v6 offset:49152
    ds_read_b64_tr_b16 a[214:215], v6 offset:57344
    v_mfma_f32_16x16x32_bf16 v[124:127], a[244:247], v[148:151], v[124:127]
    buffer_load_dwordx4 v12, s[16:19], s36 offen offset:2048 lds
    v_cvt_pk_bf16_f32 v155, v15, v155
    v_mfma_f32_16x16x32_bf16 v[120:123], a[244:247], v[144:147], v[120:123]
    s_waitcnt lgkmcnt(12)
    ds_read_b64_tr_b16 a[216:217], v7 offset:49152
    ds_read_b64_tr_b16 a[218:219], v7 offset:57344
    v_mfma_f32_16x16x32_bf16 v[128:131], a[248:251], v[144:147], v[128:131]
    ds_read_b64_tr_b16 a[220:221], v8 offset:49152
    v_fma_mix_f32 v255, v191, v247, v255 op_sel:[1,0,0] op_sel_hi:[1,0,0]
    v_cvt_pk_bf16_f32 v159, v254, v255
    v_mfma_f32_16x16x32_bf16 v[132:135], a[248:251], v[148:151], v[132:135]
    ds_read_b64_tr_b16 a[222:223], v8 offset:57344
    ds_read_b128 v[240:243], v9 offset:1280
    v_mfma_f32_16x16x32_bf16 v[140:143], a[252:255], v[148:151], v[140:143]
    buffer_load_dwordx4 v13, s[16:19], s36 offen offset:3072 lds
    v_mfma_f32_16x16x32_bf16 v[136:139], a[252:255], v[144:147], v[136:139]
    s_waitcnt lgkmcnt(13)
    ds_read_b128 v[248:251], v9 offset:1312
    v_mfma_f32_16x16x32_bf16 v[16:19], a[192:195], v[152:155], v[16:19]
    ds_read_b128 v[244:247], v9 offset:1296
    ds_read_b128 v[252:255], v9 offset:1328
    v_mfma_f32_16x16x32_bf16 v[20:23], a[192:195], v[156:159], v[20:23]
    s_waitcnt vmcnt(22)
    ds_read_b64_tr_b16 a[224:225], v1 offset:49408
    ds_read_b64_tr_b16 a[226:227], v1 offset:57600
    v_fma_mix_f32 v15, v192, v224, v232 op_sel:[0,0,0] op_sel_hi:[1,0,0]
    v_mfma_f32_16x16x32_bf16 v[28:31], a[196:199], v[156:159], v[28:31]
    s_add_u32 m0, s28, 36864
    ds_read_b64_tr_b16 a[228:229], v2 offset:49408
    v_fma_mix_f32 v144, v192, v225, v233 op_sel:[1,0,0] op_sel_hi:[1,0,0]
    v_mfma_f32_16x16x32_bf16 v[24:27], a[196:199], v[152:155], v[24:27]
    s_mov_b32 s36, 1703936
    s_waitcnt lgkmcnt(15)
    buffer_load_dwordx4 v10, s[16:19], s36 offen offset:0 lds
    v_fma_mix_f32 v232, v196, v224, v232 op_sel:[0,0,0] op_sel_hi:[1,0,0]
    v_mfma_f32_16x16x32_bf16 v[32:35], a[200:203], v[152:155], v[32:35]
    ds_read_b64_tr_b16 a[230:231], v2 offset:57600
    ds_read_b64_tr_b16 a[232:233], v3 offset:49408
    v_mfma_f32_16x16x32_bf16 v[36:39], a[200:203], v[156:159], v[36:39]
    ds_read_b64_tr_b16 a[234:235], v3 offset:57600
    v_cvt_pk_bf16_f32 v144, v15, v144
    v_mfma_f32_16x16x32_bf16 v[44:47], a[204:207], v[156:159], v[44:47]
    ds_read_b64_tr_b16 a[236:237], v4 offset:49408
    ds_read_b64_tr_b16 a[238:239], v4 offset:57600
    v_fma_mix_f32 v233, v196, v225, v233 op_sel:[1,0,0] op_sel_hi:[1,0,0]
    v_mfma_f32_16x16x32_bf16 v[40:43], a[204:207], v[152:155], v[40:43]
    s_waitcnt lgkmcnt(15)
    buffer_load_dwordx4 v11, s[16:19], s36 offen offset:1024 lds
    v_mfma_f32_16x16x32_bf16 v[48:51], a[208:211], v[152:155], v[48:51]
    ds_read_b64_tr_b16 a[240:241], v5 offset:49408
    ds_read_b64_tr_b16 a[242:243], v5 offset:57600
    v_cvt_pk_bf16_f32 v148, v232, v233
    v_mfma_f32_16x16x32_bf16 v[52:55], a[208:211], v[156:159], v[52:55]
    ds_read_b64_tr_b16 a[244:245], v6 offset:49408
    v_fma_mix_f32 v15, v193, v226, v234 op_sel:[0,0,0] op_sel_hi:[1,0,0]
    v_mfma_f32_16x16x32_bf16 v[60:63], a[212:215], v[156:159], v[60:63]
    ds_read_b64_tr_b16 a[246:247], v6 offset:57600
    ds_read_b64_tr_b16 a[248:249], v7 offset:49408
    v_fma_mix_f32 v145, v193, v227, v235 op_sel:[1,0,0] op_sel_hi:[1,0,0]
    v_mfma_f32_16x16x32_bf16 v[56:59], a[212:215], v[152:155], v[56:59]
    s_waitcnt lgkmcnt(15)
    ds_read_b64_tr_b16 a[250:251], v7 offset:57600
    v_fma_mix_f32 v234, v197, v226, v234 op_sel:[0,0,0] op_sel_hi:[1,0,0]
    v_mfma_f32_16x16x32_bf16 v[64:67], a[216:219], v[152:155], v[64:67]
    buffer_load_dwordx4 v12, s[16:19], s36 offen offset:2048 lds
    v_mfma_f32_16x16x32_bf16 v[68:71], a[216:219], v[156:159], v[68:71]
    ds_read_b64_tr_b16 a[252:253], v8 offset:49408
    ds_read_b64_tr_b16 a[254:255], v8 offset:57600
    v_cvt_pk_bf16_f32 v145, v15, v145
    v_mfma_f32_16x16x32_bf16 v[76:79], a[220:223], v[156:159], v[76:79]
    v_fma_mix_f32 v235, v197, v227, v235 op_sel:[1,0,0] op_sel_hi:[1,0,0]
    v_cvt_pk_bf16_f32 v149, v234, v235
    v_mfma_f32_16x16x32_bf16 v[72:75], a[220:223], v[152:155], v[72:75]
    s_waitcnt lgkmcnt(12)
    v_xor_b32 v1, 0x10000, v1
    v_xor_b32 v2, 0x10000, v2
    v_fma_mix_f32 v15, v194, v228, v236 op_sel:[0,0,0] op_sel_hi:[1,0,0]
    v_mfma_f32_16x16x32_bf16 v[80:83], a[224:227], v[152:155], v[80:83]
    buffer_load_dwordx4 v13, s[16:19], s36 offen offset:3072 lds
    v_xor_b32 v3, 0x10000, v3
    v_xor_b32 v4, 0x10000, v4
    v_mfma_f32_16x16x32_bf16 v[84:87], a[224:227], v[156:159], v[84:87]
    v_xor_b32 v5, 0x10000, v5
    v_xor_b32 v6, 0x10000, v6
    v_mfma_f32_16x16x32_bf16 v[92:95], a[228:231], v[156:159], v[92:95]
    s_waitcnt vmcnt(14) lgkmcnt(0)
    v_xor_b32 v7, 0x10000, v7
    v_xor_b32 v8, 0x10000, v8
    v_mfma_f32_16x16x32_bf16 v[88:91], a[228:231], v[152:155], v[88:91]
    s_barrier
    v_fma_mix_f32 v146, v194, v229, v237 op_sel:[1,0,0] op_sel_hi:[1,0,0]
    v_fma_mix_f32 v236, v198, v228, v236 op_sel:[0,0,0] op_sel_hi:[1,0,0]
    v_cvt_pk_bf16_f32 v146, v15, v146
    v_mfma_f32_16x16x32_bf16 v[96:99], a[232:235], v[152:155], v[96:99]
    ds_read_b64_tr_b16 a[192:193], v1 offset:0
    ds_read_b64_tr_b16 a[194:195], v1 offset:8192
    v_mfma_f32_16x16x32_bf16 v[100:103], a[232:235], v[156:159], v[100:103]
    ds_read_b64_tr_b16 a[196:197], v2 offset:0
    v_fma_mix_f32 v237, v198, v229, v237 op_sel:[1,0,0] op_sel_hi:[1,0,0]
    v_cvt_pk_bf16_f32 v150, v236, v237
    v_mfma_f32_16x16x32_bf16 v[108:111], a[236:239], v[156:159], v[108:111]
    buffer_load_dwordx4 v[176:179], v14, s[20:23], s34 offen offset:2048
    v_mfma_f32_16x16x32_bf16 v[104:107], a[236:239], v[152:155], v[104:107]
    ds_read_b64_tr_b16 a[198:199], v2 offset:8192
    ds_read_b64_tr_b16 a[200:201], v3 offset:0
    v_fma_mix_f32 v15, v195, v230, v238 op_sel:[0,0,0] op_sel_hi:[1,0,0]
    v_mfma_f32_16x16x32_bf16 v[112:115], a[240:243], v[152:155], v[112:115]
    ds_read_b64_tr_b16 a[202:203], v3 offset:8192
    v_fma_mix_f32 v147, v195, v231, v239 op_sel:[1,0,0] op_sel_hi:[1,0,0]
    v_mfma_f32_16x16x32_bf16 v[116:119], a[240:243], v[156:159], v[116:119]
    ds_read_b64_tr_b16 a[204:205], v4 offset:0
    ds_read_b64_tr_b16 a[206:207], v4 offset:8192
    v_mfma_f32_16x16x32_bf16 v[124:127], a[244:247], v[156:159], v[124:127]
    ds_read_b64_tr_b16 a[208:209], v5 offset:0
    v_fma_mix_f32 v238, v199, v230, v238 op_sel:[0,0,0] op_sel_hi:[1,0,0]
    v_cvt_pk_bf16_f32 v147, v15, v147
    v_mfma_f32_16x16x32_bf16 v[120:123], a[244:247], v[152:155], v[120:123]
    buffer_load_dwordx4 v[180:183], v14, s[20:23], s35 offen offset:2048
    v_mfma_f32_16x16x32_bf16 v[128:131], a[248:251], v[152:155], v[128:131]
    ds_read_b64_tr_b16 a[210:211], v5 offset:8192
    ds_read_b64_tr_b16 a[212:213], v6 offset:0
    v_fma_mix_f32 v239, v199, v231, v239 op_sel:[1,0,0] op_sel_hi:[1,0,0]
    v_mfma_f32_16x16x32_bf16 v[132:135], a[248:251], v[156:159], v[132:135]
    ds_read_b64_tr_b16 a[214:215], v6 offset:8192
    v_cvt_pk_bf16_f32 v151, v238, v239
    v_mfma_f32_16x16x32_bf16 v[140:143], a[252:255], v[156:159], v[140:143]
    ds_read_b64_tr_b16 a[216:217], v7 offset:0
    ds_read_b64_tr_b16 a[218:219], v7 offset:8192
    v_mfma_f32_16x16x32_bf16 v[136:139], a[252:255], v[152:155], v[136:139]
    s_waitcnt lgkmcnt(10)
    ds_read_b64_tr_b16 a[220:221], v8 offset:0
    v_mfma_f32_16x16x32_bf16 v[16:19], a[192:195], v[144:147], v[16:19]
    buffer_load_dwordx4 v[184:187], v14, s[20:23], s34 offen offset:3072
    v_mfma_f32_16x16x32_bf16 v[20:23], a[192:195], v[148:151], v[20:23]
    ds_read_b64_tr_b16 a[222:223], v8 offset:8192
    ds_read_b128 v[224:227], v9 offset:1536
    v_fma_mix_f32 v15, v200, v240, v248 op_sel:[0,0,0] op_sel_hi:[1,0,0]
    v_mfma_f32_16x16x32_bf16 v[28:31], a[196:199], v[148:151], v[28:31]
    ds_read_b128 v[232:235], v9 offset:1568
    v_fma_mix_f32 v152, v200, v241, v249 op_sel:[1,0,0] op_sel_hi:[1,0,0]
    v_mfma_f32_16x16x32_bf16 v[24:27], a[196:199], v[144:147], v[24:27]
    s_waitcnt lgkmcnt(10)
    ds_read_b128 v[228:231], v9 offset:1552
    ds_read_b128 v[236:239], v9 offset:1584
    v_fma_mix_f32 v248, v204, v240, v248 op_sel:[0,0,0] op_sel_hi:[1,0,0]
    v_mfma_f32_16x16x32_bf16 v[32:35], a[200:203], v[144:147], v[32:35]
    ds_read_b64_tr_b16 a[224:225], v1 offset:256
    v_cvt_pk_bf16_f32 v152, v15, v152
    v_mfma_f32_16x16x32_bf16 v[36:39], a[200:203], v[148:151], v[36:39]
    buffer_load_dwordx4 v[188:191], v14, s[20:23], s35 offen offset:3072
    v_fma_mix_f32 v249, v204, v241, v249 op_sel:[1,0,0] op_sel_hi:[1,0,0]
    v_mfma_f32_16x16x32_bf16 v[44:47], a[204:207], v[148:151], v[44:47]
    ds_read_b64_tr_b16 a[226:227], v1 offset:8448
    ds_read_b64_tr_b16 a[228:229], v2 offset:256
    v_mfma_f32_16x16x32_bf16 v[40:43], a[204:207], v[144:147], v[40:43]
    s_waitcnt lgkmcnt(11)
    ds_read_b64_tr_b16 a[230:231], v2 offset:8448
    ds_read_b64_tr_b16 a[232:233], v3 offset:256
    v_mfma_f32_16x16x32_bf16 v[48:51], a[208:211], v[144:147], v[48:51]
    ds_read_b64_tr_b16 a[234:235], v3 offset:8448
    v_cvt_pk_bf16_f32 v156, v248, v249
    v_fma_mix_f32 v15, v201, v242, v250 op_sel:[0,0,0] op_sel_hi:[1,0,0]
    v_mfma_f32_16x16x32_bf16 v[52:55], a[208:211], v[148:151], v[52:55]
    ds_read_b64_tr_b16 a[236:237], v4 offset:256
    ds_read_b64_tr_b16 a[238:239], v4 offset:8448
    v_mfma_f32_16x16x32_bf16 v[60:63], a[212:215], v[148:151], v[60:63]
    s_add_u32 m0, s28, 65536
    ds_read_b64_tr_b16 a[240:241], v5 offset:256
    v_fma_mix_f32 v153, v201, v243, v251 op_sel:[1,0,0] op_sel_hi:[1,0,0]
    v_fma_mix_f32 v250, v205, v242, v250 op_sel:[0,0,0] op_sel_hi:[1,0,0]
    v_mfma_f32_16x16x32_bf16 v[56:59], a[212:215], v[144:147], v[56:59]
    s_mov_b32 s36, 2097152
    s_waitcnt lgkmcnt(13)
    buffer_load_dwordx4 v10, s[16:19], s36 offen offset:0 lds
    v_mfma_f32_16x16x32_bf16 v[64:67], a[216:219], v[144:147], v[64:67]
    ds_read_b64_tr_b16 a[242:243], v5 offset:8448
    ds_read_b64_tr_b16 a[244:245], v6 offset:256
    v_cvt_pk_bf16_f32 v153, v15, v153
    v_mfma_f32_16x16x32_bf16 v[68:71], a[216:219], v[148:151], v[68:71]
    ds_read_b64_tr_b16 a[246:247], v6 offset:8448
    v_fma_mix_f32 v251, v205, v243, v251 op_sel:[1,0,0] op_sel_hi:[1,0,0]
    v_mfma_f32_16x16x32_bf16 v[76:79], a[220:223], v[148:151], v[76:79]
    ds_read_b64_tr_b16 a[248:249], v7 offset:256
    ds_read_b64_tr_b16 a[250:251], v7 offset:8448
    v_cvt_pk_bf16_f32 v157, v250, v251
    v_mfma_f32_16x16x32_bf16 v[72:75], a[220:223], v[144:147], v[72:75]
    s_waitcnt lgkmcnt(10)
    ds_read_b64_tr_b16 a[252:253], v8 offset:256
    v_fma_mix_f32 v15, v202, v244, v252 op_sel:[0,0,0] op_sel_hi:[1,0,0]
    v_mfma_f32_16x16x32_bf16 v[80:83], a[224:227], v[144:147], v[80:83]
    buffer_load_dwordx4 v11, s[16:19], s36 offen offset:1024 lds
    v_mfma_f32_16x16x32_bf16 v[84:87], a[224:227], v[148:151], v[84:87]
    ds_read_b64_tr_b16 a[254:255], v8 offset:8448
    ds_read_b64_tr_b16 a[192:193], v1 offset:16384
    v_fma_mix_f32 v154, v202, v245, v253 op_sel:[1,0,0] op_sel_hi:[1,0,0]
    v_mfma_f32_16x16x32_bf16 v[92:95], a[228:231], v[148:151], v[92:95]
    ds_read_b64_tr_b16 a[194:195], v1 offset:24576
    v_fma_mix_f32 v252, v206, v244, v252 op_sel:[0,0,0] op_sel_hi:[1,0,0]
    v_mfma_f32_16x16x32_bf16 v[88:91], a[228:231], v[144:147], v[88:91]
    s_waitcnt lgkmcnt(10)
    ds_read_b64_tr_b16 a[196:197], v2 offset:16384
    ds_read_b64_tr_b16 a[198:199], v2 offset:24576
    v_cvt_pk_bf16_f32 v154, v15, v154
    v_mfma_f32_16x16x32_bf16 v[96:99], a[232:235], v[144:147], v[96:99]
    ds_read_b64_tr_b16 a[200:201], v3 offset:16384
    v_fma_mix_f32 v253, v206, v245, v253 op_sel:[1,0,0] op_sel_hi:[1,0,0]
    v_mfma_f32_16x16x32_bf16 v[100:103], a[232:235], v[148:151], v[100:103]
    buffer_load_dwordx4 v12, s[16:19], s36 offen offset:2048 lds
    v_cvt_pk_bf16_f32 v158, v252, v253
    v_mfma_f32_16x16x32_bf16 v[108:111], a[236:239], v[148:151], v[108:111]
    ds_read_b64_tr_b16 a[202:203], v3 offset:24576
    ds_read_b64_tr_b16 a[204:205], v4 offset:16384
    v_mfma_f32_16x16x32_bf16 v[104:107], a[236:239], v[144:147], v[104:107]
    s_waitcnt lgkmcnt(11)
    ds_read_b64_tr_b16 a[206:207], v4 offset:24576
    v_fma_mix_f32 v15, v203, v246, v254 op_sel:[0,0,0] op_sel_hi:[1,0,0]
    v_mfma_f32_16x16x32_bf16 v[112:115], a[240:243], v[144:147], v[112:115]
    ds_read_b64_tr_b16 a[208:209], v5 offset:16384
    ds_read_b64_tr_b16 a[210:211], v5 offset:24576
    v_fma_mix_f32 v155, v203, v247, v255 op_sel:[1,0,0] op_sel_hi:[1,0,0]
    v_mfma_f32_16x16x32_bf16 v[116:119], a[240:243], v[148:151], v[116:119]
    ds_read_b64_tr_b16 a[212:213], v6 offset:16384
    v_fma_mix_f32 v254, v207, v246, v254 op_sel:[0,0,0] op_sel_hi:[1,0,0]
    v_mfma_f32_16x16x32_bf16 v[124:127], a[244:247], v[148:151], v[124:127]
    buffer_load_dwordx4 v13, s[16:19], s36 offen offset:3072 lds
    v_cvt_pk_bf16_f32 v155, v15, v155
    v_mfma_f32_16x16x32_bf16 v[120:123], a[244:247], v[144:147], v[120:123]
    s_waitcnt lgkmcnt(11)
    ds_read_b64_tr_b16 a[214:215], v6 offset:24576
    ds_read_b64_tr_b16 a[216:217], v7 offset:16384
    v_mfma_f32_16x16x32_bf16 v[128:131], a[248:251], v[144:147], v[128:131]
    ds_read_b64_tr_b16 a[218:219], v7 offset:24576
    ds_read_b64_tr_b16 a[220:221], v8 offset:16384
    v_fma_mix_f32 v255, v207, v247, v255 op_sel:[1,0,0] op_sel_hi:[1,0,0]
    v_mfma_f32_16x16x32_bf16 v[132:135], a[248:251], v[148:151], v[132:135]
    ds_read_b64_tr_b16 a[222:223], v8 offset:24576
    v_cvt_pk_bf16_f32 v159, v254, v255
    v_mfma_f32_16x16x32_bf16 v[140:143], a[252:255], v[148:151], v[140:143]
    ds_read_b128 v[240:243], v9 offset:1792
    ds_read_b128 v[248:251], v9 offset:1824
    v_mfma_f32_16x16x32_bf16 v[136:139], a[252:255], v[144:147], v[136:139]
    s_add_u32 m0, s28, 69632
    s_waitcnt lgkmcnt(14)
    ds_read_b128 v[244:247], v9 offset:1808
    v_mfma_f32_16x16x32_bf16 v[16:19], a[192:195], v[152:155], v[16:19]
    s_mov_b32 s36, 2228224
    buffer_load_dwordx4 v10, s[16:19], s36 offen offset:0 lds
    v_mfma_f32_16x16x32_bf16 v[20:23], a[192:195], v[156:159], v[20:23]
    ds_read_b128 v[252:255], v9 offset:1840
    ds_read_b64_tr_b16 a[224:225], v1 offset:16640
    v_mfma_f32_16x16x32_bf16 v[28:31], a[196:199], v[156:159], v[28:31]
    ds_read_b64_tr_b16 a[226:227], v1 offset:24832
    v_fma_mix_f32 v15, v208, v224, v232 op_sel:[0,0,0] op_sel_hi:[1,0,0]
    v_fma_mix_f32 v144, v208, v225, v233 op_sel:[1,0,0] op_sel_hi:[1,0,0]
    v_mfma_f32_16x16x32_bf16 v[24:27], a[196:199], v[152:155], v[24:27]
    s_waitcnt lgkmcnt(14)
    ds_read_b64_tr_b16 a[228:229], v2 offset:16640
    ds_read_b64_tr_b16 a[230:231], v2 offset:24832
    v_mfma_f32_16x16x32_bf16 v[32:35], a[200:203], v[152:155], v[32:35]
    ds_read_b64_tr_b16 a[232:233], v3 offset:16640
    v_fma_mix_f32 v232, v212, v224, v232 op_sel:[0,0,0] op_sel_hi:[1,0,0]
    v_mfma_f32_16x16x32_bf16 v[36:39], a[200:203], v[156:159], v[36:39]
    buffer_load_dwordx4 v11, s[16:19], s36 offen offset:1024 lds
    v_mfma_f32_16x16x32_bf16 v[44:47], a[204:207], v[156:159], v[44:47]
    ds_read_b64_tr_b16 a[234:235], v3 offset:24832
    ds_read_b64_tr_b16 a[236:237], v4 offset:16640
    v_mfma_f32_16x16x32_bf16 v[40:43], a[204:207], v[152:155], v[40:43]
    s_waitcnt lgkmcnt(15)
    ds_read_b64_tr_b16 a[238:239], v4 offset:24832
    v_cvt_pk_bf16_f32 v144, v15, v144
    v_mfma_f32_16x16x32_bf16 v[48:51], a[208:211], v[152:155], v[48:51]
    ds_read_b64_tr_b16 a[240:241], v5 offset:16640
    ds_read_b64_tr_b16 a[242:243], v5 offset:24832
    v_fma_mix_f32 v233, v212, v225, v233 op_sel:[1,0,0] op_sel_hi:[1,0,0]
    v_mfma_f32_16x16x32_bf16 v[52:55], a[208:211], v[156:159], v[52:55]
    ds_read_b64_tr_b16 a[244:245], v6 offset:16640
    v_cvt_pk_bf16_f32 v148, v232, v233
    v_mfma_f32_16x16x32_bf16 v[60:63], a[212:215], v[156:159], v[60:63]
    buffer_load_dwordx4 v12, s[16:19], s36 offen offset:2048 lds
    v_mfma_f32_16x16x32_bf16 v[56:59], a[212:215], v[152:155], v[56:59]
    s_waitcnt lgkmcnt(15)
    ds_read_b64_tr_b16 a[246:247], v6 offset:24832
    ds_read_b64_tr_b16 a[248:249], v7 offset:16640
    v_mfma_f32_16x16x32_bf16 v[64:67], a[216:219], v[152:155], v[64:67]
    ds_read_b64_tr_b16 a[250:251], v7 offset:24832
    v_fma_mix_f32 v15, v209, v226, v234 op_sel:[0,0,0] op_sel_hi:[1,0,0]
    v_mfma_f32_16x16x32_bf16 v[68:71], a[216:219], v[156:159], v[68:71]
    ds_read_b64_tr_b16 a[252:253], v8 offset:16640
    ds_read_b64_tr_b16 a[254:255], v8 offset:24832
    v_mfma_f32_16x16x32_bf16 v[76:79], a[220:223], v[156:159], v[76:79]
    v_fma_mix_f32 v145, v209, v227, v235 op_sel:[1,0,0] op_sel_hi:[1,0,0]
    v_fma_mix_f32 v234, v213, v226, v234 op_sel:[0,0,0] op_sel_hi:[1,0,0]
    v_cvt_pk_bf16_f32 v145, v15, v145
    v_mfma_f32_16x16x32_bf16 v[72:75], a[220:223], v[152:155], v[72:75]
    s_waitcnt lgkmcnt(12)
    buffer_load_dwordx4 v13, s[16:19], s36 offen offset:3072 lds
    v_mfma_f32_16x16x32_bf16 v[80:83], a[224:227], v[152:155], v[80:83]
    v_fma_mix_f32 v235, v213, v227, v235 op_sel:[1,0,0] op_sel_hi:[1,0,0]
    v_cvt_pk_bf16_f32 v149, v234, v235
    v_mfma_f32_16x16x32_bf16 v[84:87], a[224:227], v[156:159], v[84:87]
    v_fma_mix_f32 v15, v210, v228, v236 op_sel:[0,0,0] op_sel_hi:[1,0,0]
    v_fma_mix_f32 v146, v210, v229, v237 op_sel:[1,0,0] op_sel_hi:[1,0,0]
    v_mfma_f32_16x16x32_bf16 v[92:95], a[228:231], v[156:159], v[92:95]
    s_waitcnt vmcnt(12) lgkmcnt(0)
    v_fma_mix_f32 v236, v214, v228, v236 op_sel:[0,0,0] op_sel_hi:[1,0,0]
    v_cvt_pk_bf16_f32 v146, v15, v146
    v_mfma_f32_16x16x32_bf16 v[88:91], a[228:231], v[152:155], v[88:91]
    s_barrier
    v_fma_mix_f32 v237, v214, v229, v237 op_sel:[1,0,0] op_sel_hi:[1,0,0]
    v_cvt_pk_bf16_f32 v150, v236, v237
    v_mfma_f32_16x16x32_bf16 v[96:99], a[232:235], v[152:155], v[96:99]
    ds_read_b64_tr_b16 a[192:193], v1 offset:32768
    ds_read_b64_tr_b16 a[194:195], v1 offset:40960
    v_fma_mix_f32 v15, v211, v230, v238 op_sel:[0,0,0] op_sel_hi:[1,0,0]
    v_mfma_f32_16x16x32_bf16 v[100:103], a[232:235], v[156:159], v[100:103]
    ds_read_b64_tr_b16 a[196:197], v2 offset:32768
    v_fma_mix_f32 v147, v211, v231, v239 op_sel:[1,0,0] op_sel_hi:[1,0,0]
    v_mfma_f32_16x16x32_bf16 v[108:111], a[236:239], v[156:159], v[108:111]
    s_add_u32 s34, s34, 4096
    buffer_load_dwordx4 v[192:195], v14, s[20:23], s34 offen offset:0
    v_mfma_f32_16x16x32_bf16 v[104:107], a[236:239], v[152:155], v[104:107]
    ds_read_b64_tr_b16 a[198:199], v2 offset:40960
    ds_read_b64_tr_b16 a[200:201], v3 offset:32768
    v_mfma_f32_16x16x32_bf16 v[112:115], a[240:243], v[152:155], v[112:115]
    ds_read_b64_tr_b16 a[202:203], v3 offset:40960
    v_fma_mix_f32 v238, v215, v230, v238 op_sel:[0,0,0] op_sel_hi:[1,0,0]
    v_mfma_f32_16x16x32_bf16 v[116:119], a[240:243], v[156:159], v[116:119]
    ds_read_b64_tr_b16 a[204:205], v4 offset:32768
    ds_read_b64_tr_b16 a[206:207], v4 offset:40960
    v_mfma_f32_16x16x32_bf16 v[124:127], a[244:247], v[156:159], v[124:127]
    ds_read_b64_tr_b16 a[208:209], v5 offset:32768
    v_cvt_pk_bf16_f32 v147, v15, v147
    v_fma_mix_f32 v239, v215, v231, v239 op_sel:[1,0,0] op_sel_hi:[1,0,0]
    v_mfma_f32_16x16x32_bf16 v[120:123], a[244:247], v[152:155], v[120:123]
    s_add_u32 s35, s35, 4096
    buffer_load_dwordx4 v[196:199], v14, s[20:23], s35 offen offset:0
    v_mfma_f32_16x16x32_bf16 v[128:131], a[248:251], v[152:155], v[128:131]
    ds_read_b64_tr_b16 a[210:211], v5 offset:40960
    ds_read_b64_tr_b16 a[212:213], v6 offset:32768
    v_mfma_f32_16x16x32_bf16 v[132:135], a[248:251], v[156:159], v[132:135]
    ds_read_b64_tr_b16 a[214:215], v6 offset:40960
    v_cvt_pk_bf16_f32 v151, v238, v239
    v_mfma_f32_16x16x32_bf16 v[140:143], a[252:255], v[156:159], v[140:143]
    ds_read_b64_tr_b16 a[216:217], v7 offset:32768
    ds_read_b64_tr_b16 a[218:219], v7 offset:40960
    v_mfma_f32_16x16x32_bf16 v[136:139], a[252:255], v[152:155], v[136:139]
    s_waitcnt lgkmcnt(10)
    ds_read_b64_tr_b16 a[220:221], v8 offset:32768
    v_mfma_f32_16x16x32_bf16 v[16:19], a[192:195], v[144:147], v[16:19]
    buffer_load_dwordx4 v[200:203], v14, s[20:23], s34 offen offset:1024
    v_mfma_f32_16x16x32_bf16 v[20:23], a[192:195], v[148:151], v[20:23]
    ds_read_b64_tr_b16 a[222:223], v8 offset:40960
    ds_read_b128 v[224:227], v9 offset:2048
    v_fma_mix_f32 v15, v216, v240, v248 op_sel:[0,0,0] op_sel_hi:[1,0,0]
    v_mfma_f32_16x16x32_bf16 v[28:31], a[196:199], v[148:151], v[28:31]
    ds_read_b128 v[232:235], v9 offset:2080
    v_fma_mix_f32 v152, v216, v241, v249 op_sel:[1,0,0] op_sel_hi:[1,0,0]
    v_mfma_f32_16x16x32_bf16 v[24:27], a[196:199], v[144:147], v[24:27]
    s_waitcnt lgkmcnt(10)
    ds_read_b128 v[228:231], v9 offset:2064
    ds_read_b128 v[236:239], v9 offset:2096
    v_fma_mix_f32 v248, v220, v240, v248 op_sel:[0,0,0] op_sel_hi:[1,0,0]
    v_mfma_f32_16x16x32_bf16 v[32:35], a[200:203], v[144:147], v[32:35]
    ds_read_b64_tr_b16 a[224:225], v1 offset:33024
    v_cvt_pk_bf16_f32 v152, v15, v152
    v_mfma_f32_16x16x32_bf16 v[36:39], a[200:203], v[148:151], v[36:39]
    buffer_load_dwordx4 v[204:207], v14, s[20:23], s35 offen offset:1024
    v_fma_mix_f32 v249, v220, v241, v249 op_sel:[1,0,0] op_sel_hi:[1,0,0]
    v_mfma_f32_16x16x32_bf16 v[44:47], a[204:207], v[148:151], v[44:47]
    ds_read_b64_tr_b16 a[226:227], v1 offset:41216
    ds_read_b64_tr_b16 a[228:229], v2 offset:33024
    v_mfma_f32_16x16x32_bf16 v[40:43], a[204:207], v[144:147], v[40:43]
    s_waitcnt lgkmcnt(11)
    ds_read_b64_tr_b16 a[230:231], v2 offset:41216
    ds_read_b64_tr_b16 a[232:233], v3 offset:33024
    v_mfma_f32_16x16x32_bf16 v[48:51], a[208:211], v[144:147], v[48:51]
    ds_read_b64_tr_b16 a[234:235], v3 offset:41216
    v_cvt_pk_bf16_f32 v156, v248, v249
    v_fma_mix_f32 v15, v217, v242, v250 op_sel:[0,0,0] op_sel_hi:[1,0,0]
    v_mfma_f32_16x16x32_bf16 v[52:55], a[208:211], v[148:151], v[52:55]
    ds_read_b64_tr_b16 a[236:237], v4 offset:33024
    ds_read_b64_tr_b16 a[238:239], v4 offset:41216
    v_mfma_f32_16x16x32_bf16 v[60:63], a[212:215], v[148:151], v[60:63]
    s_add_u32 m0, s28, 98304
    ds_read_b64_tr_b16 a[240:241], v5 offset:33024
    v_fma_mix_f32 v153, v217, v243, v251 op_sel:[1,0,0] op_sel_hi:[1,0,0]
    v_fma_mix_f32 v250, v221, v242, v250 op_sel:[0,0,0] op_sel_hi:[1,0,0]
    v_mfma_f32_16x16x32_bf16 v[56:59], a[212:215], v[144:147], v[56:59]
    s_mov_b32 s36, 2621440
    s_waitcnt lgkmcnt(13)
    buffer_load_dwordx4 v10, s[16:19], s36 offen offset:0 lds
    v_mfma_f32_16x16x32_bf16 v[64:67], a[216:219], v[144:147], v[64:67]
    ds_read_b64_tr_b16 a[242:243], v5 offset:41216
    ds_read_b64_tr_b16 a[244:245], v6 offset:33024
    v_cvt_pk_bf16_f32 v153, v15, v153
    v_mfma_f32_16x16x32_bf16 v[68:71], a[216:219], v[148:151], v[68:71]
    ds_read_b64_tr_b16 a[246:247], v6 offset:41216
    v_fma_mix_f32 v251, v221, v243, v251 op_sel:[1,0,0] op_sel_hi:[1,0,0]
    v_mfma_f32_16x16x32_bf16 v[76:79], a[220:223], v[148:151], v[76:79]
    ds_read_b64_tr_b16 a[248:249], v7 offset:33024
    ds_read_b64_tr_b16 a[250:251], v7 offset:41216
    v_cvt_pk_bf16_f32 v157, v250, v251
    v_mfma_f32_16x16x32_bf16 v[72:75], a[220:223], v[144:147], v[72:75]
    s_waitcnt lgkmcnt(10)
    ds_read_b64_tr_b16 a[252:253], v8 offset:33024
    v_fma_mix_f32 v15, v218, v244, v252 op_sel:[0,0,0] op_sel_hi:[1,0,0]
    v_mfma_f32_16x16x32_bf16 v[80:83], a[224:227], v[144:147], v[80:83]
    buffer_load_dwordx4 v11, s[16:19], s36 offen offset:1024 lds
    v_mfma_f32_16x16x32_bf16 v[84:87], a[224:227], v[148:151], v[84:87]
    ds_read_b64_tr_b16 a[254:255], v8 offset:41216
    ds_read_b64_tr_b16 a[192:193], v1 offset:49152
    v_fma_mix_f32 v154, v218, v245, v253 op_sel:[1,0,0] op_sel_hi:[1,0,0]
    v_mfma_f32_16x16x32_bf16 v[92:95], a[228:231], v[148:151], v[92:95]
    ds_read_b64_tr_b16 a[194:195], v1 offset:57344
    v_fma_mix_f32 v252, v222, v244, v252 op_sel:[0,0,0] op_sel_hi:[1,0,0]
    v_mfma_f32_16x16x32_bf16 v[88:91], a[228:231], v[144:147], v[88:91]
    s_waitcnt lgkmcnt(10)
    ds_read_b64_tr_b16 a[196:197], v2 offset:49152
    ds_read_b64_tr_b16 a[198:199], v2 offset:57344
    v_cvt_pk_bf16_f32 v154, v15, v154
    v_mfma_f32_16x16x32_bf16 v[96:99], a[232:235], v[144:147], v[96:99]
    ds_read_b64_tr_b16 a[200:201], v3 offset:49152
    v_fma_mix_f32 v253, v222, v245, v253 op_sel:[1,0,0] op_sel_hi:[1,0,0]
    v_mfma_f32_16x16x32_bf16 v[100:103], a[232:235], v[148:151], v[100:103]
    buffer_load_dwordx4 v12, s[16:19], s36 offen offset:2048 lds
    v_cvt_pk_bf16_f32 v158, v252, v253
    v_mfma_f32_16x16x32_bf16 v[108:111], a[236:239], v[148:151], v[108:111]
    ds_read_b64_tr_b16 a[202:203], v3 offset:57344
    ds_read_b64_tr_b16 a[204:205], v4 offset:49152
    v_mfma_f32_16x16x32_bf16 v[104:107], a[236:239], v[144:147], v[104:107]
    s_waitcnt lgkmcnt(11)
    ds_read_b64_tr_b16 a[206:207], v4 offset:57344
    v_fma_mix_f32 v15, v219, v246, v254 op_sel:[0,0,0] op_sel_hi:[1,0,0]
    v_mfma_f32_16x16x32_bf16 v[112:115], a[240:243], v[144:147], v[112:115]
    ds_read_b64_tr_b16 a[208:209], v5 offset:49152
    ds_read_b64_tr_b16 a[210:211], v5 offset:57344
    v_fma_mix_f32 v155, v219, v247, v255 op_sel:[1,0,0] op_sel_hi:[1,0,0]
    v_mfma_f32_16x16x32_bf16 v[116:119], a[240:243], v[148:151], v[116:119]
    ds_read_b64_tr_b16 a[212:213], v6 offset:49152
    v_fma_mix_f32 v254, v223, v246, v254 op_sel:[0,0,0] op_sel_hi:[1,0,0]
    v_mfma_f32_16x16x32_bf16 v[124:127], a[244:247], v[148:151], v[124:127]
    buffer_load_dwordx4 v13, s[16:19], s36 offen offset:3072 lds
    v_cvt_pk_bf16_f32 v155, v15, v155
    v_mfma_f32_16x16x32_bf16 v[120:123], a[244:247], v[144:147], v[120:123]
    s_waitcnt lgkmcnt(11)
    ds_read_b64_tr_b16 a[214:215], v6 offset:57344
    ds_read_b64_tr_b16 a[216:217], v7 offset:49152
    v_mfma_f32_16x16x32_bf16 v[128:131], a[248:251], v[144:147], v[128:131]
    ds_read_b64_tr_b16 a[218:219], v7 offset:57344
    ds_read_b64_tr_b16 a[220:221], v8 offset:49152
    v_fma_mix_f32 v255, v223, v247, v255 op_sel:[1,0,0] op_sel_hi:[1,0,0]
    v_mfma_f32_16x16x32_bf16 v[132:135], a[248:251], v[148:151], v[132:135]
    ds_read_b64_tr_b16 a[222:223], v8 offset:57344
    v_cvt_pk_bf16_f32 v159, v254, v255
    v_mfma_f32_16x16x32_bf16 v[140:143], a[252:255], v[148:151], v[140:143]
    ds_read_b128 v[240:243], v9 offset:2304
    ds_read_b128 v[248:251], v9 offset:2336
    v_mfma_f32_16x16x32_bf16 v[136:139], a[252:255], v[144:147], v[136:139]
    s_add_u32 m0, s28, 102400
    s_waitcnt lgkmcnt(14)
    ds_read_b128 v[244:247], v9 offset:2320
    v_mfma_f32_16x16x32_bf16 v[16:19], a[192:195], v[152:155], v[16:19]
    s_mov_b32 s36, 2752512
    buffer_load_dwordx4 v10, s[16:19], s36 offen offset:0 lds
    v_mfma_f32_16x16x32_bf16 v[20:23], a[192:195], v[156:159], v[20:23]
    ds_read_b128 v[252:255], v9 offset:2352
    ds_read_b64_tr_b16 a[224:225], v1 offset:49408
    v_fma_mix_f32 v15, v160, v224, v232 op_sel:[0,0,0] op_sel_hi:[1,0,0]
    v_mfma_f32_16x16x32_bf16 v[28:31], a[196:199], v[156:159], v[28:31]
    ds_read_b64_tr_b16 a[226:227], v1 offset:57600
    v_fma_mix_f32 v144, v160, v225, v233 op_sel:[1,0,0] op_sel_hi:[1,0,0]
    v_mfma_f32_16x16x32_bf16 v[24:27], a[196:199], v[152:155], v[24:27]
    s_waitcnt lgkmcnt(14)
    ds_read_b64_tr_b16 a[228:229], v2 offset:49408
    ds_read_b64_tr_b16 a[230:231], v2 offset:57600
    v_fma_mix_f32 v232, v164, v224, v232 op_sel:[0,0,0] op_sel_hi:[1,0,0]
    v_mfma_f32_16x16x32_bf16 v[32:35], a[200:203], v[152:155], v[32:35]
    ds_read_b64_tr_b16 a[232:233], v3 offset:49408
    v_cvt_pk_bf16_f32 v144, v15, v144
    v_mfma_f32_16x16x32_bf16 v[36:39], a[200:203], v[156:159], v[36:39]
    buffer_load_dwordx4 v11, s[16:19], s36 offen offset:1024 lds
    v_mfma_f32_16x16x32_bf16 v[44:47], a[204:207], v[156:159], v[44:47]
    ds_read_b64_tr_b16 a[234:235], v3 offset:57600
    ds_read_b64_tr_b16 a[236:237], v4 offset:49408
    v_fma_mix_f32 v233, v164, v225, v233 op_sel:[1,0,0] op_sel_hi:[1,0,0]
    v_mfma_f32_16x16x32_bf16 v[40:43], a[204:207], v[152:155], v[40:43]
    s_waitcnt lgkmcnt(15)
    ds_read_b64_tr_b16 a[238:239], v4 offset:57600
    v_cvt_pk_bf16_f32 v148, v232, v233
    v_mfma_f32_16x16x32_bf16 v[48:51], a[208:211], v[152:155], v[48:51]
    ds_read_b64_tr_b16 a[240:241], v5 offset:49408
    ds_read_b64_tr_b16 a[242:243], v5 offset:57600
    v_mfma_f32_16x16x32_bf16 v[52:55], a[208:211], v[156:159], v[52:55]
    ds_read_b64_tr_b16 a[244:245], v6 offset:49408
    v_fma_mix_f32 v15, v161, v226, v234 op_sel:[0,0,0] op_sel_hi:[1,0,0]
    v_fma_mix_f32 v145, v161, v227, v235 op_sel:[1,0,0] op_sel_hi:[1,0,0]
    v_mfma_f32_16x16x32_bf16 v[60:63], a[212:215], v[156:159], v[60:63]
    buffer_load_dwordx4 v12, s[16:19], s36 offen offset:2048 lds
    v_mfma_f32_16x16x32_bf16 v[56:59], a[212:215], v[152:155], v[56:59]
    s_waitcnt lgkmcnt(15)
    ds_read_b64_tr_b16 a[246:247], v6 offset:57600
    ds_read_b64_tr_b16 a[248:249], v7 offset:49408
    v_fma_mix_f32 v234, v165, v226, v234 op_sel:[0,0,0] op_sel_hi:[1,0,0]
    v_mfma_f32_16x16x32_bf16 v[64:67], a[216:219], v[152:155], v[64:67]
    ds_read_b64_tr_b16 a[250:251], v7 offset:57600
    v_cvt_pk_bf16_f32 v145, v15, v145
    v_mfma_f32_16x16x32_bf16 v[68:71], a[216:219], v[156:159], v[68:71]
    ds_read_b64_tr_b16 a[252:253], v8 offset:49408
    ds_read_b64_tr_b16 a[254:255], v8 offset:57600
    v_mfma_f32_16x16x32_bf16 v[76:79], a[220:223], v[156:159], v[76:79]
    v_fma_mix_f32 v235, v165, v227, v235 op_sel:[1,0,0] op_sel_hi:[1,0,0]
    v_cvt_pk_bf16_f32 v149, v234, v235
    v_fma_mix_f32 v15, v162, v228, v236 op_sel:[0,0,0] op_sel_hi:[1,0,0]
    v_mfma_f32_16x16x32_bf16 v[72:75], a[220:223], v[152:155], v[72:75]
    s_waitcnt lgkmcnt(12)
    buffer_load_dwordx4 v13, s[16:19], s36 offen offset:3072 lds
    v_xor_b32 v1, 0x10000, v1
    v_xor_b32 v2, 0x10000, v2
    v_mfma_f32_16x16x32_bf16 v[80:83], a[224:227], v[152:155], v[80:83]
    v_xor_b32 v3, 0x10000, v3
    v_xor_b32 v4, 0x10000, v4
    v_mfma_f32_16x16x32_bf16 v[84:87], a[224:227], v[156:159], v[84:87]
    v_xor_b32 v5, 0x10000, v5
    v_xor_b32 v6, 0x10000, v6
    v_mfma_f32_16x16x32_bf16 v[92:95], a[228:231], v[156:159], v[92:95]
    s_waitcnt vmcnt(12) lgkmcnt(0)
    v_xor_b32 v7, 0x10000, v7
    v_xor_b32 v8, 0x10000, v8
    v_fma_mix_f32 v146, v162, v229, v237 op_sel:[1,0,0] op_sel_hi:[1,0,0]
    v_mfma_f32_16x16x32_bf16 v[88:91], a[228:231], v[152:155], v[88:91]
    s_barrier
    v_fma_mix_f32 v236, v166, v228, v236 op_sel:[0,0,0] op_sel_hi:[1,0,0]
    v_cvt_pk_bf16_f32 v146, v15, v146
    v_mfma_f32_16x16x32_bf16 v[96:99], a[232:235], v[152:155], v[96:99]
    ds_read_b64_tr_b16 a[192:193], v1 offset:0
    ds_read_b64_tr_b16 a[194:195], v1 offset:8192
    v_fma_mix_f32 v237, v166, v229, v237 op_sel:[1,0,0] op_sel_hi:[1,0,0]
    v_mfma_f32_16x16x32_bf16 v[100:103], a[232:235], v[156:159], v[100:103]
    ds_read_b64_tr_b16 a[196:197], v2 offset:0
    v_cvt_pk_bf16_f32 v150, v236, v237
    v_mfma_f32_16x16x32_bf16 v[108:111], a[236:239], v[156:159], v[108:111]
    buffer_load_dwordx4 v[208:211], v14, s[20:23], s34 offen offset:2048
    v_mfma_f32_16x16x32_bf16 v[104:107], a[236:239], v[152:155], v[104:107]
    ds_read_b64_tr_b16 a[198:199], v2 offset:8192
    ds_read_b64_tr_b16 a[200:201], v3 offset:0
    v_fma_mix_f32 v15, v163, v230, v238 op_sel:[0,0,0] op_sel_hi:[1,0,0]
    v_mfma_f32_16x16x32_bf16 v[112:115], a[240:243], v[152:155], v[112:115]
    ds_read_b64_tr_b16 a[202:203], v3 offset:8192
    v_fma_mix_f32 v147, v163, v231, v239 op_sel:[1,0,0] op_sel_hi:[1,0,0]
    v_mfma_f32_16x16x32_bf16 v[116:119], a[240:243], v[156:159], v[116:119]
    ds_read_b64_tr_b16 a[204:205], v4 offset:0
    ds_read_b64_tr_b16 a[206:207], v4 offset:8192
    v_mfma_f32_16x16x32_bf16 v[124:127], a[244:247], v[156:159], v[124:127]
    ds_read_b64_tr_b16 a[208:209], v5 offset:0
    v_fma_mix_f32 v238, v167, v230, v238 op_sel:[0,0,0] op_sel_hi:[1,0,0]
    v_cvt_pk_bf16_f32 v147, v15, v147
    v_mfma_f32_16x16x32_bf16 v[120:123], a[244:247], v[152:155], v[120:123]
    buffer_load_dwordx4 v[212:215], v14, s[20:23], s35 offen offset:2048
    v_mfma_f32_16x16x32_bf16 v[128:131], a[248:251], v[152:155], v[128:131]
    ds_read_b64_tr_b16 a[210:211], v5 offset:8192
    ds_read_b64_tr_b16 a[212:213], v6 offset:0
    v_fma_mix_f32 v239, v167, v231, v239 op_sel:[1,0,0] op_sel_hi:[1,0,0]
    v_mfma_f32_16x16x32_bf16 v[132:135], a[248:251], v[156:159], v[132:135]
    ds_read_b64_tr_b16 a[214:215], v6 offset:8192
    v_cvt_pk_bf16_f32 v151, v238, v239
    v_mfma_f32_16x16x32_bf16 v[140:143], a[252:255], v[156:159], v[140:143]
    ds_read_b64_tr_b16 a[216:217], v7 offset:0
    ds_read_b64_tr_b16 a[218:219], v7 offset:8192
    v_mfma_f32_16x16x32_bf16 v[136:139], a[252:255], v[152:155], v[136:139]
    s_waitcnt lgkmcnt(10)
    ds_read_b64_tr_b16 a[220:221], v8 offset:0
    v_mfma_f32_16x16x32_bf16 v[16:19], a[192:195], v[144:147], v[16:19]
    buffer_load_dwordx4 v[216:219], v14, s[20:23], s34 offen offset:3072
    v_mfma_f32_16x16x32_bf16 v[20:23], a[192:195], v[148:151], v[20:23]
    ds_read_b64_tr_b16 a[222:223], v8 offset:8192
    ds_read_b128 v[224:227], v9 offset:2560
    v_fma_mix_f32 v15, v168, v240, v248 op_sel:[0,0,0] op_sel_hi:[1,0,0]
    v_mfma_f32_16x16x32_bf16 v[28:31], a[196:199], v[148:151], v[28:31]
    ds_read_b128 v[232:235], v9 offset:2592
    v_fma_mix_f32 v152, v168, v241, v249 op_sel:[1,0,0] op_sel_hi:[1,0,0]
    v_mfma_f32_16x16x32_bf16 v[24:27], a[196:199], v[144:147], v[24:27]
    s_waitcnt lgkmcnt(10)
    ds_read_b128 v[228:231], v9 offset:2576
    ds_read_b128 v[236:239], v9 offset:2608
    v_fma_mix_f32 v248, v172, v240, v248 op_sel:[0,0,0] op_sel_hi:[1,0,0]
    v_mfma_f32_16x16x32_bf16 v[32:35], a[200:203], v[144:147], v[32:35]
    ds_read_b64_tr_b16 a[224:225], v1 offset:256
    v_cvt_pk_bf16_f32 v152, v15, v152
    v_mfma_f32_16x16x32_bf16 v[36:39], a[200:203], v[148:151], v[36:39]
    buffer_load_dwordx4 v[220:223], v14, s[20:23], s35 offen offset:3072
    v_fma_mix_f32 v249, v172, v241, v249 op_sel:[1,0,0] op_sel_hi:[1,0,0]
    v_mfma_f32_16x16x32_bf16 v[44:47], a[204:207], v[148:151], v[44:47]
    ds_read_b64_tr_b16 a[226:227], v1 offset:8448
    ds_read_b64_tr_b16 a[228:229], v2 offset:256
    v_mfma_f32_16x16x32_bf16 v[40:43], a[204:207], v[144:147], v[40:43]
    s_waitcnt lgkmcnt(11)
    ds_read_b64_tr_b16 a[230:231], v2 offset:8448
    ds_read_b64_tr_b16 a[232:233], v3 offset:256
    v_mfma_f32_16x16x32_bf16 v[48:51], a[208:211], v[144:147], v[48:51]
    ds_read_b64_tr_b16 a[234:235], v3 offset:8448
    v_cvt_pk_bf16_f32 v156, v248, v249
    v_fma_mix_f32 v15, v169, v242, v250 op_sel:[0,0,0] op_sel_hi:[1,0,0]
    v_mfma_f32_16x16x32_bf16 v[52:55], a[208:211], v[148:151], v[52:55]
    ds_read_b64_tr_b16 a[236:237], v4 offset:256
    ds_read_b64_tr_b16 a[238:239], v4 offset:8448
    v_mfma_f32_16x16x32_bf16 v[60:63], a[212:215], v[148:151], v[60:63]
    s_add_u32 m0, s28, 0
    ds_read_b64_tr_b16 a[240:241], v5 offset:256
    v_fma_mix_f32 v153, v169, v243, v251 op_sel:[1,0,0] op_sel_hi:[1,0,0]
    v_fma_mix_f32 v250, v173, v242, v250 op_sel:[0,0,0] op_sel_hi:[1,0,0]
    v_mfma_f32_16x16x32_bf16 v[56:59], a[212:215], v[144:147], v[56:59]
    s_mov_b32 s36, 3145728
    s_waitcnt lgkmcnt(13)
    buffer_load_dwordx4 v10, s[16:19], s36 offen offset:0 lds
    v_mfma_f32_16x16x32_bf16 v[64:67], a[216:219], v[144:147], v[64:67]
    ds_read_b64_tr_b16 a[242:243], v5 offset:8448
    ds_read_b64_tr_b16 a[244:245], v6 offset:256
    v_cvt_pk_bf16_f32 v153, v15, v153
    v_mfma_f32_16x16x32_bf16 v[68:71], a[216:219], v[148:151], v[68:71]
    ds_read_b64_tr_b16 a[246:247], v6 offset:8448
    v_fma_mix_f32 v251, v173, v243, v251 op_sel:[1,0,0] op_sel_hi:[1,0,0]
    v_mfma_f32_16x16x32_bf16 v[76:79], a[220:223], v[148:151], v[76:79]
    ds_read_b64_tr_b16 a[248:249], v7 offset:256
    ds_read_b64_tr_b16 a[250:251], v7 offset:8448
    v_cvt_pk_bf16_f32 v157, v250, v251
    v_mfma_f32_16x16x32_bf16 v[72:75], a[220:223], v[144:147], v[72:75]
    s_waitcnt lgkmcnt(10)
    ds_read_b64_tr_b16 a[252:253], v8 offset:256
    v_fma_mix_f32 v15, v170, v244, v252 op_sel:[0,0,0] op_sel_hi:[1,0,0]
    v_mfma_f32_16x16x32_bf16 v[80:83], a[224:227], v[144:147], v[80:83]
    buffer_load_dwordx4 v11, s[16:19], s36 offen offset:1024 lds
    v_mfma_f32_16x16x32_bf16 v[84:87], a[224:227], v[148:151], v[84:87]
    ds_read_b64_tr_b16 a[254:255], v8 offset:8448
    ds_read_b64_tr_b16 a[192:193], v1 offset:16384
    v_fma_mix_f32 v154, v170, v245, v253 op_sel:[1,0,0] op_sel_hi:[1,0,0]
    v_mfma_f32_16x16x32_bf16 v[92:95], a[228:231], v[148:151], v[92:95]
    ds_read_b64_tr_b16 a[194:195], v1 offset:24576
    v_fma_mix_f32 v252, v174, v244, v252 op_sel:[0,0,0] op_sel_hi:[1,0,0]
    v_mfma_f32_16x16x32_bf16 v[88:91], a[228:231], v[144:147], v[88:91]
    s_waitcnt lgkmcnt(10)
    ds_read_b64_tr_b16 a[196:197], v2 offset:16384
    ds_read_b64_tr_b16 a[198:199], v2 offset:24576
    v_cvt_pk_bf16_f32 v154, v15, v154
    v_mfma_f32_16x16x32_bf16 v[96:99], a[232:235], v[144:147], v[96:99]
    ds_read_b64_tr_b16 a[200:201], v3 offset:16384
    v_fma_mix_f32 v253, v174, v245, v253 op_sel:[1,0,0] op_sel_hi:[1,0,0]
    v_mfma_f32_16x16x32_bf16 v[100:103], a[232:235], v[148:151], v[100:103]
    buffer_load_dwordx4 v12, s[16:19], s36 offen offset:2048 lds
    v_cvt_pk_bf16_f32 v158, v252, v253
    v_mfma_f32_16x16x32_bf16 v[108:111], a[236:239], v[148:151], v[108:111]
    ds_read_b64_tr_b16 a[202:203], v3 offset:24576
    ds_read_b64_tr_b16 a[204:205], v4 offset:16384
    v_mfma_f32_16x16x32_bf16 v[104:107], a[236:239], v[144:147], v[104:107]
    s_waitcnt lgkmcnt(11)
    ds_read_b64_tr_b16 a[206:207], v4 offset:24576
    v_fma_mix_f32 v15, v171, v246, v254 op_sel:[0,0,0] op_sel_hi:[1,0,0]
    v_mfma_f32_16x16x32_bf16 v[112:115], a[240:243], v[144:147], v[112:115]
    ds_read_b64_tr_b16 a[208:209], v5 offset:16384
    ds_read_b64_tr_b16 a[210:211], v5 offset:24576
    v_fma_mix_f32 v155, v171, v247, v255 op_sel:[1,0,0] op_sel_hi:[1,0,0]
    v_mfma_f32_16x16x32_bf16 v[116:119], a[240:243], v[148:151], v[116:119]
    ds_read_b64_tr_b16 a[212:213], v6 offset:16384
    v_fma_mix_f32 v254, v175, v246, v254 op_sel:[0,0,0] op_sel_hi:[1,0,0]
    v_mfma_f32_16x16x32_bf16 v[124:127], a[244:247], v[148:151], v[124:127]
    buffer_load_dwordx4 v13, s[16:19], s36 offen offset:3072 lds
    v_cvt_pk_bf16_f32 v155, v15, v155
    v_mfma_f32_16x16x32_bf16 v[120:123], a[244:247], v[144:147], v[120:123]
    s_waitcnt lgkmcnt(11)
    ds_read_b64_tr_b16 a[214:215], v6 offset:24576
    ds_read_b64_tr_b16 a[216:217], v7 offset:16384
    v_mfma_f32_16x16x32_bf16 v[128:131], a[248:251], v[144:147], v[128:131]
    ds_read_b64_tr_b16 a[218:219], v7 offset:24576
    ds_read_b64_tr_b16 a[220:221], v8 offset:16384
    v_fma_mix_f32 v255, v175, v247, v255 op_sel:[1,0,0] op_sel_hi:[1,0,0]
    v_mfma_f32_16x16x32_bf16 v[132:135], a[248:251], v[148:151], v[132:135]
    ds_read_b64_tr_b16 a[222:223], v8 offset:24576
    v_cvt_pk_bf16_f32 v159, v254, v255
    v_mfma_f32_16x16x32_bf16 v[140:143], a[252:255], v[148:151], v[140:143]
    ds_read_b128 v[240:243], v9 offset:2816
    ds_read_b128 v[248:251], v9 offset:2848
    v_mfma_f32_16x16x32_bf16 v[136:139], a[252:255], v[144:147], v[136:139]
    s_add_u32 m0, s28, 4096
    s_waitcnt lgkmcnt(14)
    ds_read_b128 v[244:247], v9 offset:2832
    v_mfma_f32_16x16x32_bf16 v[16:19], a[192:195], v[152:155], v[16:19]
    s_mov_b32 s36, 3276800
    buffer_load_dwordx4 v10, s[16:19], s36 offen offset:0 lds
    v_mfma_f32_16x16x32_bf16 v[20:23], a[192:195], v[156:159], v[20:23]
    ds_read_b128 v[252:255], v9 offset:2864
    ds_read_b64_tr_b16 a[224:225], v1 offset:16640
    v_mfma_f32_16x16x32_bf16 v[28:31], a[196:199], v[156:159], v[28:31]
    ds_read_b64_tr_b16 a[226:227], v1 offset:24832
    v_fma_mix_f32 v15, v176, v224, v232 op_sel:[0,0,0] op_sel_hi:[1,0,0]
    v_fma_mix_f32 v144, v176, v225, v233 op_sel:[1,0,0] op_sel_hi:[1,0,0]
    v_mfma_f32_16x16x32_bf16 v[24:27], a[196:199], v[152:155], v[24:27]
    s_waitcnt lgkmcnt(14)
    ds_read_b64_tr_b16 a[228:229], v2 offset:16640
    ds_read_b64_tr_b16 a[230:231], v2 offset:24832
    v_mfma_f32_16x16x32_bf16 v[32:35], a[200:203], v[152:155], v[32:35]
    ds_read_b64_tr_b16 a[232:233], v3 offset:16640
    v_fma_mix_f32 v232, v180, v224, v232 op_sel:[0,0,0] op_sel_hi:[1,0,0]
    v_mfma_f32_16x16x32_bf16 v[36:39], a[200:203], v[156:159], v[36:39]
    buffer_load_dwordx4 v11, s[16:19], s36 offen offset:1024 lds
    v_mfma_f32_16x16x32_bf16 v[44:47], a[204:207], v[156:159], v[44:47]
    ds_read_b64_tr_b16 a[234:235], v3 offset:24832
    ds_read_b64_tr_b16 a[236:237], v4 offset:16640
    v_mfma_f32_16x16x32_bf16 v[40:43], a[204:207], v[152:155], v[40:43]
    s_waitcnt lgkmcnt(15)
    ds_read_b64_tr_b16 a[238:239], v4 offset:24832
    v_cvt_pk_bf16_f32 v144, v15, v144
    v_mfma_f32_16x16x32_bf16 v[48:51], a[208:211], v[152:155], v[48:51]
    ds_read_b64_tr_b16 a[240:241], v5 offset:16640
    ds_read_b64_tr_b16 a[242:243], v5 offset:24832
    v_fma_mix_f32 v233, v180, v225, v233 op_sel:[1,0,0] op_sel_hi:[1,0,0]
    v_mfma_f32_16x16x32_bf16 v[52:55], a[208:211], v[156:159], v[52:55]
    ds_read_b64_tr_b16 a[244:245], v6 offset:16640
    v_cvt_pk_bf16_f32 v148, v232, v233
    v_mfma_f32_16x16x32_bf16 v[60:63], a[212:215], v[156:159], v[60:63]
    buffer_load_dwordx4 v12, s[16:19], s36 offen offset:2048 lds
    v_mfma_f32_16x16x32_bf16 v[56:59], a[212:215], v[152:155], v[56:59]
    s_waitcnt lgkmcnt(15)
    ds_read_b64_tr_b16 a[246:247], v6 offset:24832
    ds_read_b64_tr_b16 a[248:249], v7 offset:16640
    v_mfma_f32_16x16x32_bf16 v[64:67], a[216:219], v[152:155], v[64:67]
    ds_read_b64_tr_b16 a[250:251], v7 offset:24832
    v_fma_mix_f32 v15, v177, v226, v234 op_sel:[0,0,0] op_sel_hi:[1,0,0]
    v_mfma_f32_16x16x32_bf16 v[68:71], a[216:219], v[156:159], v[68:71]
    ds_read_b64_tr_b16 a[252:253], v8 offset:16640
    ds_read_b64_tr_b16 a[254:255], v8 offset:24832
    v_mfma_f32_16x16x32_bf16 v[76:79], a[220:223], v[156:159], v[76:79]
    v_fma_mix_f32 v145, v177, v227, v235 op_sel:[1,0,0] op_sel_hi:[1,0,0]
    v_fma_mix_f32 v234, v181, v226, v234 op_sel:[0,0,0] op_sel_hi:[1,0,0]
    v_cvt_pk_bf16_f32 v145, v15, v145
    v_mfma_f32_16x16x32_bf16 v[72:75], a[220:223], v[152:155], v[72:75]
    s_waitcnt lgkmcnt(12)
    buffer_load_dwordx4 v13, s[16:19], s36 offen offset:3072 lds
    v_mfma_f32_16x16x32_bf16 v[80:83], a[224:227], v[152:155], v[80:83]
    v_fma_mix_f32 v235, v181, v227, v235 op_sel:[1,0,0] op_sel_hi:[1,0,0]
    v_cvt_pk_bf16_f32 v149, v234, v235
    v_mfma_f32_16x16x32_bf16 v[84:87], a[224:227], v[156:159], v[84:87]
    v_fma_mix_f32 v15, v178, v228, v236 op_sel:[0,0,0] op_sel_hi:[1,0,0]
    v_fma_mix_f32 v146, v178, v229, v237 op_sel:[1,0,0] op_sel_hi:[1,0,0]
    v_mfma_f32_16x16x32_bf16 v[92:95], a[228:231], v[156:159], v[92:95]
    s_waitcnt vmcnt(12) lgkmcnt(0)
    v_fma_mix_f32 v236, v182, v228, v236 op_sel:[0,0,0] op_sel_hi:[1,0,0]
    v_cvt_pk_bf16_f32 v146, v15, v146
    v_mfma_f32_16x16x32_bf16 v[88:91], a[228:231], v[152:155], v[88:91]
    s_barrier
    v_fma_mix_f32 v237, v182, v229, v237 op_sel:[1,0,0] op_sel_hi:[1,0,0]
    v_cvt_pk_bf16_f32 v150, v236, v237
    v_mfma_f32_16x16x32_bf16 v[96:99], a[232:235], v[152:155], v[96:99]
    ds_read_b64_tr_b16 a[192:193], v1 offset:32768
    ds_read_b64_tr_b16 a[194:195], v1 offset:40960
    v_fma_mix_f32 v15, v179, v230, v238 op_sel:[0,0,0] op_sel_hi:[1,0,0]
    v_mfma_f32_16x16x32_bf16 v[100:103], a[232:235], v[156:159], v[100:103]
    ds_read_b64_tr_b16 a[196:197], v2 offset:32768
    v_fma_mix_f32 v147, v179, v231, v239 op_sel:[1,0,0] op_sel_hi:[1,0,0]
    v_mfma_f32_16x16x32_bf16 v[108:111], a[236:239], v[156:159], v[108:111]
    s_add_u32 s34, s34, 4096
    buffer_load_dwordx4 v[160:163], v14, s[20:23], s34 offen offset:0
    v_mfma_f32_16x16x32_bf16 v[104:107], a[236:239], v[152:155], v[104:107]
    ds_read_b64_tr_b16 a[198:199], v2 offset:40960
    ds_read_b64_tr_b16 a[200:201], v3 offset:32768
    v_mfma_f32_16x16x32_bf16 v[112:115], a[240:243], v[152:155], v[112:115]
    ds_read_b64_tr_b16 a[202:203], v3 offset:40960
    v_fma_mix_f32 v238, v183, v230, v238 op_sel:[0,0,0] op_sel_hi:[1,0,0]
    v_mfma_f32_16x16x32_bf16 v[116:119], a[240:243], v[156:159], v[116:119]
    ds_read_b64_tr_b16 a[204:205], v4 offset:32768
    ds_read_b64_tr_b16 a[206:207], v4 offset:40960
    v_mfma_f32_16x16x32_bf16 v[124:127], a[244:247], v[156:159], v[124:127]
    ds_read_b64_tr_b16 a[208:209], v5 offset:32768
    v_cvt_pk_bf16_f32 v147, v15, v147
    v_fma_mix_f32 v239, v183, v231, v239 op_sel:[1,0,0] op_sel_hi:[1,0,0]
    v_mfma_f32_16x16x32_bf16 v[120:123], a[244:247], v[152:155], v[120:123]
    s_add_u32 s35, s35, 4096
    buffer_load_dwordx4 v[164:167], v14, s[20:23], s35 offen offset:0
    v_mfma_f32_16x16x32_bf16 v[128:131], a[248:251], v[152:155], v[128:131]
    ds_read_b64_tr_b16 a[210:211], v5 offset:40960
    ds_read_b64_tr_b16 a[212:213], v6 offset:32768
    v_mfma_f32_16x16x32_bf16 v[132:135], a[248:251], v[156:159], v[132:135]
    ds_read_b64_tr_b16 a[214:215], v6 offset:40960
    v_cvt_pk_bf16_f32 v151, v238, v239
    v_mfma_f32_16x16x32_bf16 v[140:143], a[252:255], v[156:159], v[140:143]
    ds_read_b64_tr_b16 a[216:217], v7 offset:32768
    ds_read_b64_tr_b16 a[218:219], v7 offset:40960
    v_mfma_f32_16x16x32_bf16 v[136:139], a[252:255], v[152:155], v[136:139]
    s_waitcnt lgkmcnt(10)
    ds_read_b64_tr_b16 a[220:221], v8 offset:32768
    v_mfma_f32_16x16x32_bf16 v[16:19], a[192:195], v[144:147], v[16:19]
    buffer_load_dwordx4 v[168:171], v14, s[20:23], s34 offen offset:1024
    v_mfma_f32_16x16x32_bf16 v[20:23], a[192:195], v[148:151], v[20:23]
    ds_read_b64_tr_b16 a[222:223], v8 offset:40960
    ds_read_b128 v[224:227], v9 offset:3072
    v_fma_mix_f32 v15, v184, v240, v248 op_sel:[0,0,0] op_sel_hi:[1,0,0]
    v_mfma_f32_16x16x32_bf16 v[28:31], a[196:199], v[148:151], v[28:31]
    ds_read_b128 v[232:235], v9 offset:3104
    v_fma_mix_f32 v152, v184, v241, v249 op_sel:[1,0,0] op_sel_hi:[1,0,0]
    v_mfma_f32_16x16x32_bf16 v[24:27], a[196:199], v[144:147], v[24:27]
    s_waitcnt lgkmcnt(10)
    ds_read_b128 v[228:231], v9 offset:3088
    ds_read_b128 v[236:239], v9 offset:3120
    v_fma_mix_f32 v248, v188, v240, v248 op_sel:[0,0,0] op_sel_hi:[1,0,0]
    v_mfma_f32_16x16x32_bf16 v[32:35], a[200:203], v[144:147], v[32:35]
    ds_read_b64_tr_b16 a[224:225], v1 offset:33024
    v_cvt_pk_bf16_f32 v152, v15, v152
    v_mfma_f32_16x16x32_bf16 v[36:39], a[200:203], v[148:151], v[36:39]
    buffer_load_dwordx4 v[172:175], v14, s[20:23], s35 offen offset:1024
    v_fma_mix_f32 v249, v188, v241, v249 op_sel:[1,0,0] op_sel_hi:[1,0,0]
    v_mfma_f32_16x16x32_bf16 v[44:47], a[204:207], v[148:151], v[44:47]
    ds_read_b64_tr_b16 a[226:227], v1 offset:41216
    ds_read_b64_tr_b16 a[228:229], v2 offset:33024
    v_mfma_f32_16x16x32_bf16 v[40:43], a[204:207], v[144:147], v[40:43]
    s_waitcnt lgkmcnt(11)
    ds_read_b64_tr_b16 a[230:231], v2 offset:41216
    ds_read_b64_tr_b16 a[232:233], v3 offset:33024
    v_mfma_f32_16x16x32_bf16 v[48:51], a[208:211], v[144:147], v[48:51]
    ds_read_b64_tr_b16 a[234:235], v3 offset:41216
    v_cvt_pk_bf16_f32 v156, v248, v249
    v_fma_mix_f32 v15, v185, v242, v250 op_sel:[0,0,0] op_sel_hi:[1,0,0]
    v_mfma_f32_16x16x32_bf16 v[52:55], a[208:211], v[148:151], v[52:55]
    ds_read_b64_tr_b16 a[236:237], v4 offset:33024
    ds_read_b64_tr_b16 a[238:239], v4 offset:41216
    v_mfma_f32_16x16x32_bf16 v[60:63], a[212:215], v[148:151], v[60:63]
    s_add_u32 m0, s28, 32768
    ds_read_b64_tr_b16 a[240:241], v5 offset:33024
    v_fma_mix_f32 v153, v185, v243, v251 op_sel:[1,0,0] op_sel_hi:[1,0,0]
    v_fma_mix_f32 v250, v189, v242, v250 op_sel:[0,0,0] op_sel_hi:[1,0,0]
    v_mfma_f32_16x16x32_bf16 v[56:59], a[212:215], v[144:147], v[56:59]
    s_mov_b32 s36, 3670016
    s_waitcnt lgkmcnt(13)
    buffer_load_dwordx4 v10, s[16:19], s36 offen offset:0 lds
    v_mfma_f32_16x16x32_bf16 v[64:67], a[216:219], v[144:147], v[64:67]
    ds_read_b64_tr_b16 a[242:243], v5 offset:41216
    ds_read_b64_tr_b16 a[244:245], v6 offset:33024
    v_cvt_pk_bf16_f32 v153, v15, v153
    v_mfma_f32_16x16x32_bf16 v[68:71], a[216:219], v[148:151], v[68:71]
    ds_read_b64_tr_b16 a[246:247], v6 offset:41216
    v_fma_mix_f32 v251, v189, v243, v251 op_sel:[1,0,0] op_sel_hi:[1,0,0]
    v_mfma_f32_16x16x32_bf16 v[76:79], a[220:223], v[148:151], v[76:79]
    ds_read_b64_tr_b16 a[248:249], v7 offset:33024
    ds_read_b64_tr_b16 a[250:251], v7 offset:41216
    v_cvt_pk_bf16_f32 v157, v250, v251
    v_mfma_f32_16x16x32_bf16 v[72:75], a[220:223], v[144:147], v[72:75]
    s_waitcnt lgkmcnt(10)
    ds_read_b64_tr_b16 a[252:253], v8 offset:33024
    v_fma_mix_f32 v15, v186, v244, v252 op_sel:[0,0,0] op_sel_hi:[1,0,0]
    v_mfma_f32_16x16x32_bf16 v[80:83], a[224:227], v[144:147], v[80:83]
    buffer_load_dwordx4 v11, s[16:19], s36 offen offset:1024 lds
    v_mfma_f32_16x16x32_bf16 v[84:87], a[224:227], v[148:151], v[84:87]
    ds_read_b64_tr_b16 a[254:255], v8 offset:41216
    ds_read_b64_tr_b16 a[192:193], v1 offset:49152
    v_fma_mix_f32 v154, v186, v245, v253 op_sel:[1,0,0] op_sel_hi:[1,0,0]
    v_mfma_f32_16x16x32_bf16 v[92:95], a[228:231], v[148:151], v[92:95]
    ds_read_b64_tr_b16 a[194:195], v1 offset:57344
    v_fma_mix_f32 v252, v190, v244, v252 op_sel:[0,0,0] op_sel_hi:[1,0,0]
    v_mfma_f32_16x16x32_bf16 v[88:91], a[228:231], v[144:147], v[88:91]
    s_waitcnt lgkmcnt(10)
    ds_read_b64_tr_b16 a[196:197], v2 offset:49152
    ds_read_b64_tr_b16 a[198:199], v2 offset:57344
    v_cvt_pk_bf16_f32 v154, v15, v154
    v_mfma_f32_16x16x32_bf16 v[96:99], a[232:235], v[144:147], v[96:99]
    ds_read_b64_tr_b16 a[200:201], v3 offset:49152
    v_fma_mix_f32 v253, v190, v245, v253 op_sel:[1,0,0] op_sel_hi:[1,0,0]
    v_mfma_f32_16x16x32_bf16 v[100:103], a[232:235], v[148:151], v[100:103]
    buffer_load_dwordx4 v12, s[16:19], s36 offen offset:2048 lds
    v_cvt_pk_bf16_f32 v158, v252, v253
    v_mfma_f32_16x16x32_bf16 v[108:111], a[236:239], v[148:151], v[108:111]
    ds_read_b64_tr_b16 a[202:203], v3 offset:57344
    ds_read_b64_tr_b16 a[204:205], v4 offset:49152
    v_mfma_f32_16x16x32_bf16 v[104:107], a[236:239], v[144:147], v[104:107]
    s_waitcnt lgkmcnt(11)
    ds_read_b64_tr_b16 a[206:207], v4 offset:57344
    v_fma_mix_f32 v15, v187, v246, v254 op_sel:[0,0,0] op_sel_hi:[1,0,0]
    v_mfma_f32_16x16x32_bf16 v[112:115], a[240:243], v[144:147], v[112:115]
    ds_read_b64_tr_b16 a[208:209], v5 offset:49152
    ds_read_b64_tr_b16 a[210:211], v5 offset:57344
    v_fma_mix_f32 v155, v187, v247, v255 op_sel:[1,0,0] op_sel_hi:[1,0,0]
    v_mfma_f32_16x16x32_bf16 v[116:119], a[240:243], v[148:151], v[116:119]
    ds_read_b64_tr_b16 a[212:213], v6 offset:49152
    v_fma_mix_f32 v254, v191, v246, v254 op_sel:[0,0,0] op_sel_hi:[1,0,0]
    v_mfma_f32_16x16x32_bf16 v[124:127], a[244:247], v[148:151], v[124:127]
    buffer_load_dwordx4 v13, s[16:19], s36 offen offset:3072 lds
    v_cvt_pk_bf16_f32 v155, v15, v155
    v_mfma_f32_16x16x32_bf16 v[120:123], a[244:247], v[144:147], v[120:123]
    s_waitcnt lgkmcnt(11)
    ds_read_b64_tr_b16 a[214:215], v6 offset:57344
    ds_read_b64_tr_b16 a[216:217], v7 offset:49152
    v_mfma_f32_16x16x32_bf16 v[128:131], a[248:251], v[144:147], v[128:131]
    ds_read_b64_tr_b16 a[218:219], v7 offset:57344
    ds_read_b64_tr_b16 a[220:221], v8 offset:49152
    v_fma_mix_f32 v255, v191, v247, v255 op_sel:[1,0,0] op_sel_hi:[1,0,0]
    v_mfma_f32_16x16x32_bf16 v[132:135], a[248:251], v[148:151], v[132:135]
    ds_read_b64_tr_b16 a[222:223], v8 offset:57344
    v_cvt_pk_bf16_f32 v159, v254, v255
    v_mfma_f32_16x16x32_bf16 v[140:143], a[252:255], v[148:151], v[140:143]
    ds_read_b128 v[240:243], v9 offset:3328
    ds_read_b128 v[248:251], v9 offset:3360
    v_mfma_f32_16x16x32_bf16 v[136:139], a[252:255], v[144:147], v[136:139]
    s_add_u32 m0, s28, 36864
    s_waitcnt lgkmcnt(14)
    ds_read_b128 v[244:247], v9 offset:3344
    v_mfma_f32_16x16x32_bf16 v[16:19], a[192:195], v[152:155], v[16:19]
    s_mov_b32 s36, 3801088
    buffer_load_dwordx4 v10, s[16:19], s36 offen offset:0 lds
    v_mfma_f32_16x16x32_bf16 v[20:23], a[192:195], v[156:159], v[20:23]
    ds_read_b128 v[252:255], v9 offset:3376
    ds_read_b64_tr_b16 a[224:225], v1 offset:49408
    v_fma_mix_f32 v15, v192, v224, v232 op_sel:[0,0,0] op_sel_hi:[1,0,0]
    v_mfma_f32_16x16x32_bf16 v[28:31], a[196:199], v[156:159], v[28:31]
    ds_read_b64_tr_b16 a[226:227], v1 offset:57600
    v_fma_mix_f32 v144, v192, v225, v233 op_sel:[1,0,0] op_sel_hi:[1,0,0]
    v_mfma_f32_16x16x32_bf16 v[24:27], a[196:199], v[152:155], v[24:27]
    s_waitcnt lgkmcnt(14)
    ds_read_b64_tr_b16 a[228:229], v2 offset:49408
    ds_read_b64_tr_b16 a[230:231], v2 offset:57600
    v_fma_mix_f32 v232, v196, v224, v232 op_sel:[0,0,0] op_sel_hi:[1,0,0]
    v_mfma_f32_16x16x32_bf16 v[32:35], a[200:203], v[152:155], v[32:35]
    ds_read_b64_tr_b16 a[232:233], v3 offset:49408
    v_cvt_pk_bf16_f32 v144, v15, v144
    v_mfma_f32_16x16x32_bf16 v[36:39], a[200:203], v[156:159], v[36:39]
    buffer_load_dwordx4 v11, s[16:19], s36 offen offset:1024 lds
    v_mfma_f32_16x16x32_bf16 v[44:47], a[204:207], v[156:159], v[44:47]
    ds_read_b64_tr_b16 a[234:235], v3 offset:57600
    ds_read_b64_tr_b16 a[236:237], v4 offset:49408
    v_fma_mix_f32 v233, v196, v225, v233 op_sel:[1,0,0] op_sel_hi:[1,0,0]
    v_mfma_f32_16x16x32_bf16 v[40:43], a[204:207], v[152:155], v[40:43]
    s_waitcnt lgkmcnt(15)
    ds_read_b64_tr_b16 a[238:239], v4 offset:57600
    v_cvt_pk_bf16_f32 v148, v232, v233
    v_mfma_f32_16x16x32_bf16 v[48:51], a[208:211], v[152:155], v[48:51]
    ds_read_b64_tr_b16 a[240:241], v5 offset:49408
    ds_read_b64_tr_b16 a[242:243], v5 offset:57600
    v_fma_mix_f32 v15, v193, v226, v234 op_sel:[0,0,0] op_sel_hi:[1,0,0]
    v_mfma_f32_16x16x32_bf16 v[52:55], a[208:211], v[156:159], v[52:55]
    ds_read_b64_tr_b16 a[244:245], v6 offset:49408
    v_fma_mix_f32 v145, v193, v227, v235 op_sel:[1,0,0] op_sel_hi:[1,0,0]
    v_mfma_f32_16x16x32_bf16 v[60:63], a[212:215], v[156:159], v[60:63]
    buffer_load_dwordx4 v12, s[16:19], s36 offen offset:2048 lds
    v_fma_mix_f32 v234, v197, v226, v234 op_sel:[0,0,0] op_sel_hi:[1,0,0]
    v_mfma_f32_16x16x32_bf16 v[56:59], a[212:215], v[152:155], v[56:59]
    s_waitcnt lgkmcnt(15)
    ds_read_b64_tr_b16 a[246:247], v6 offset:57600
    ds_read_b64_tr_b16 a[248:249], v7 offset:49408
    v_mfma_f32_16x16x32_bf16 v[64:67], a[216:219], v[152:155], v[64:67]
    ds_read_b64_tr_b16 a[250:251], v7 offset:57600
    v_cvt_pk_bf16_f32 v145, v15, v145
    v_mfma_f32_16x16x32_bf16 v[68:71], a[216:219], v[156:159], v[68:71]
    ds_read_b64_tr_b16 a[252:253], v8 offset:49408
    ds_read_b64_tr_b16 a[254:255], v8 offset:57600
    v_fma_mix_f32 v235, v197, v227, v235 op_sel:[1,0,0] op_sel_hi:[1,0,0]
    v_mfma_f32_16x16x32_bf16 v[76:79], a[220:223], v[156:159], v[76:79]
    v_cvt_pk_bf16_f32 v149, v234, v235
    v_fma_mix_f32 v15, v194, v228, v236 op_sel:[0,0,0] op_sel_hi:[1,0,0]
    v_mfma_f32_16x16x32_bf16 v[72:75], a[220:223], v[152:155], v[72:75]
    s_waitcnt lgkmcnt(12)
    buffer_load_dwordx4 v13, s[16:19], s36 offen offset:3072 lds
    v_xor_b32 v1, 0x10000, v1
    v_xor_b32 v2, 0x10000, v2
    v_mfma_f32_16x16x32_bf16 v[80:83], a[224:227], v[152:155], v[80:83]
    v_xor_b32 v3, 0x10000, v3
    v_xor_b32 v4, 0x10000, v4
    v_fma_mix_f32 v146, v194, v229, v237 op_sel:[1,0,0] op_sel_hi:[1,0,0]
    v_mfma_f32_16x16x32_bf16 v[84:87], a[224:227], v[156:159], v[84:87]
    v_xor_b32 v5, 0x10000, v5
    v_xor_b32 v6, 0x10000, v6
    v_mfma_f32_16x16x32_bf16 v[92:95], a[228:231], v[156:159], v[92:95]
    s_waitcnt vmcnt(12) lgkmcnt(0)
    v_xor_b32 v7, 0x10000, v7
    v_xor_b32 v8, 0x10000, v8
    v_mfma_f32_16x16x32_bf16 v[88:91], a[228:231], v[152:155], v[88:91]
    s_barrier
    v_fma_mix_f32 v236, v198, v228, v236 op_sel:[0,0,0] op_sel_hi:[1,0,0]
    v_cvt_pk_bf16_f32 v146, v15, v146
    v_fma_mix_f32 v237, v198, v229, v237 op_sel:[1,0,0] op_sel_hi:[1,0,0]
    v_mfma_f32_16x16x32_bf16 v[96:99], a[232:235], v[152:155], v[96:99]
    ds_read_b64_tr_b16 a[192:193], v1 offset:0
    ds_read_b64_tr_b16 a[194:195], v1 offset:8192
    v_mfma_f32_16x16x32_bf16 v[100:103], a[232:235], v[156:159], v[100:103]
    s_add_u32 m0, s28, 65536
    ds_read_b64_tr_b16 a[196:197], v2 offset:0
    v_cvt_pk_bf16_f32 v150, v236, v237
    v_fma_mix_f32 v15, v195, v230, v238 op_sel:[0,0,0] op_sel_hi:[1,0,0]
    v_mfma_f32_16x16x32_bf16 v[108:111], a[236:239], v[156:159], v[108:111]
    s_mov_b32 s36, 4194304
    buffer_load_dwordx4 v10, s[16:19], s36 offen offset:0 lds
    v_mfma_f32_16x16x32_bf16 v[104:107], a[236:239], v[152:155], v[104:107]
    ds_read_b64_tr_b16 a[198:199], v2 offset:8192
    ds_read_b64_tr_b16 a[200:201], v3 offset:0
    v_fma_mix_f32 v147, v195, v231, v239 op_sel:[1,0,0] op_sel_hi:[1,0,0]
    v_mfma_f32_16x16x32_bf16 v[112:115], a[240:243], v[152:155], v[112:115]
    ds_read_b64_tr_b16 a[202:203], v3 offset:8192
    v_fma_mix_f32 v238, v199, v230, v238 op_sel:[0,0,0] op_sel_hi:[1,0,0]
    v_mfma_f32_16x16x32_bf16 v[116:119], a[240:243], v[156:159], v[116:119]
    ds_read_b64_tr_b16 a[204:205], v4 offset:0
    ds_read_b64_tr_b16 a[206:207], v4 offset:8192
    v_mfma_f32_16x16x32_bf16 v[124:127], a[244:247], v[156:159], v[124:127]
    ds_read_b64_tr_b16 a[208:209], v5 offset:0
    ds_read_b64_tr_b16 a[210:211], v5 offset:8192
    v_cvt_pk_bf16_f32 v147, v15, v147
    v_mfma_f32_16x16x32_bf16 v[120:123], a[244:247], v[152:155], v[120:123]
    buffer_load_dwordx4 v11, s[16:19], s36 offen offset:1024 lds
    v_mfma_f32_16x16x32_bf16 v[128:131], a[248:251], v[152:155], v[128:131]
    ds_read_b64_tr_b16 a[212:213], v6 offset:0
    v_fma_mix_f32 v239, v199, v231, v239 op_sel:[1,0,0] op_sel_hi:[1,0,0]
    v_cvt_pk_bf16_f32 v151, v238, v239
    v_mfma_f32_16x16x32_bf16 v[132:135], a[248:251], v[156:159], v[132:135]
    ds_read_b64_tr_b16 a[214:215], v6 offset:8192
    ds_read_b64_tr_b16 a[216:217], v7 offset:0
    v_mfma_f32_16x16x32_bf16 v[140:143], a[252:255], v[156:159], v[140:143]
    ds_read_b64_tr_b16 a[218:219], v7 offset:8192
    v_mfma_f32_16x16x32_bf16 v[136:139], a[252:255], v[152:155], v[136:139]
    s_waitcnt lgkmcnt(10)
    ds_read_b64_tr_b16 a[220:221], v8 offset:0
    ds_read_b64_tr_b16 a[222:223], v8 offset:8192
    v_mfma_f32_16x16x32_bf16 v[16:19], a[192:195], v[144:147], v[16:19]
    buffer_load_dwordx4 v12, s[16:19], s36 offen offset:2048 lds
    v_fma_mix_f32 v15, v200, v240, v248 op_sel:[0,0,0] op_sel_hi:[1,0,0]
    v_mfma_f32_16x16x32_bf16 v[20:23], a[192:195], v[148:151], v[20:23]
    ds_read_b128 v[224:227], v9 offset:3584
    ds_read_b128 v[232:235], v9 offset:3616
    v_mfma_f32_16x16x32_bf16 v[28:31], a[196:199], v[148:151], v[28:31]
    ds_read_b128 v[228:231], v9 offset:3600
    v_fma_mix_f32 v152, v200, v241, v249 op_sel:[1,0,0] op_sel_hi:[1,0,0]
    v_fma_mix_f32 v248, v204, v240, v248 op_sel:[0,0,0] op_sel_hi:[1,0,0]
    v_mfma_f32_16x16x32_bf16 v[24:27], a[196:199], v[144:147], v[24:27]
    s_waitcnt lgkmcnt(11)
    ds_read_b128 v[236:239], v9 offset:3632
    ds_read_b64_tr_b16 a[224:225], v1 offset:256
    v_mfma_f32_16x16x32_bf16 v[32:35], a[200:203], v[144:147], v[32:35]
    ds_read_b64_tr_b16 a[226:227], v1 offset:8448
    v_cvt_pk_bf16_f32 v152, v15, v152
    v_fma_mix_f32 v249, v204, v241, v249 op_sel:[1,0,0] op_sel_hi:[1,0,0]
    v_mfma_f32_16x16x32_bf16 v[36:39], a[200:203], v[148:151], v[36:39]
    buffer_load_dwordx4 v13, s[16:19], s36 offen offset:3072 lds
    v_mfma_f32_16x16x32_bf16 v[44:47], a[204:207], v[148:151], v[44:47]
    ds_read_b64_tr_b16 a[228:229], v2 offset:256
    ds_read_b64_tr_b16 a[230:231], v2 offset:8448
    v_cvt_pk_bf16_f32 v156, v248, v249
    v_mfma_f32_16x16x32_bf16 v[40:43], a[204:207], v[144:147], v[40:43]
    s_waitcnt lgkmcnt(12)
    ds_read_b64_tr_b16 a[232:233], v3 offset:256
    ds_read_b64_tr_b16 a[234:235], v3 offset:8448
    v_mfma_f32_16x16x32_bf16 v[48:51], a[208:211], v[144:147], v[48:51]
    ds_read_b64_tr_b16 a[236:237], v4 offset:256
    v_fma_mix_f32 v15, v201, v242, v250 op_sel:[0,0,0] op_sel_hi:[1,0,0]
    v_fma_mix_f32 v153, v201, v243, v251 op_sel:[1,0,0] op_sel_hi:[1,0,0]
    v_mfma_f32_16x16x32_bf16 v[52:55], a[208:211], v[148:151], v[52:55]
    ds_read_b64_tr_b16 a[238:239], v4 offset:8448
    ds_read_b64_tr_b16 a[240:241], v5 offset:256
    v_mfma_f32_16x16x32_bf16 v[60:63], a[212:215], v[148:151], v[60:63]
    s_add_u32 m0, s28, 69632
    ds_read_b64_tr_b16 a[242:243], v5 offset:8448
    v_fma_mix_f32 v250, v205, v242, v250 op_sel:[0,0,0] op_sel_hi:[1,0,0]
    v_cvt_pk_bf16_f32 v153, v15, v153
    v_mfma_f32_16x16x32_bf16 v[56:59], a[212:215], v[144:147], v[56:59]
    s_mov_b32 s36, 4325376
    s_waitcnt lgkmcnt(14)
    buffer_load_dwordx4 v10, s[16:19], s36 offen offset:0 lds
    v_mfma_f32_16x16x32_bf16 v[64:67], a[216:219], v[144:147], v[64:67]
    ds_read_b64_tr_b16 a[244:245], v6 offset:256
    ds_read_b64_tr_b16 a[246:247], v6 offset:8448
    v_fma_mix_f32 v251, v205, v243, v251 op_sel:[1,0,0] op_sel_hi:[1,0,0]
    v_mfma_f32_16x16x32_bf16 v[68:71], a[216:219], v[148:151], v[68:71]
    ds_read_b64_tr_b16 a[248:249], v7 offset:256
    ds_read_b64_tr_b16 a[250:251], v7 offset:8448
    v_mfma_f32_16x16x32_bf16 v[76:79], a[220:223], v[148:151], v[76:79]
    ds_read_b64_tr_b16 a[252:253], v8 offset:256
    v_cvt_pk_bf16_f32 v157, v250, v251
    v_fma_mix_f32 v15, v202, v244, v252 op_sel:[0,0,0] op_sel_hi:[1,0,0]
    v_mfma_f32_16x16x32_bf16 v[72:75], a[220:223], v[144:147], v[72:75]
    s_waitcnt lgkmcnt(11)
    ds_read_b64_tr_b16 a[254:255], v8 offset:8448
    ds_read_b64_tr_b16 a[192:193], v1 offset:16384
    v_mfma_f32_16x16x32_bf16 v[80:83], a[224:227], v[144:147], v[80:83]
    buffer_load_dwordx4 v11, s[16:19], s36 offen offset:1024 lds
    v_fma_mix_f32 v154, v202, v245, v253 op_sel:[1,0,0] op_sel_hi:[1,0,0]
    v_mfma_f32_16x16x32_bf16 v[84:87], a[224:227], v[148:151], v[84:87]
    ds_read_b64_tr_b16 a[194:195], v1 offset:24576
    v_fma_mix_f32 v252, v206, v244, v252 op_sel:[0,0,0] op_sel_hi:[1,0,0]
    v_mfma_f32_16x16x32_bf16 v[92:95], a[228:231], v[148:151], v[92:95]
    ds_read_b64_tr_b16 a[196:197], v2 offset:16384
    ds_read_b64_tr_b16 a[198:199], v2 offset:24576
    v_cvt_pk_bf16_f32 v154, v15, v154
    v_mfma_f32_16x16x32_bf16 v[88:91], a[228:231], v[144:147], v[88:91]
    s_waitcnt lgkmcnt(12)
    ds_read_b64_tr_b16 a[200:201], v3 offset:16384
    ds_read_b64_tr_b16 a[202:203], v3 offset:24576
    v_mfma_f32_16x16x32_bf16 v[96:99], a[232:235], v[144:147], v[96:99]
    ds_read_b64_tr_b16 a[204:205], v4 offset:16384
    v_fma_mix_f32 v253, v206, v245, v253 op_sel:[1,0,0] op_sel_hi:[1,0,0]
    v_cvt_pk_bf16_f32 v158, v252, v253
    v_mfma_f32_16x16x32_bf16 v[100:103], a[232:235], v[148:151], v[100:103]
    buffer_load_dwordx4 v12, s[16:19], s36 offen offset:2048 lds
    v_mfma_f32_16x16x32_bf16 v[108:111], a[236:239], v[148:151], v[108:111]
    ds_read_b64_tr_b16 a[206:207], v4 offset:24576
    ds_read_b64_tr_b16 a[208:209], v5 offset:16384
    v_fma_mix_f32 v15, v203, v246, v254 op_sel:[0,0,0] op_sel_hi:[1,0,0]
    v_mfma_f32_16x16x32_bf16 v[104:107], a[236:239], v[144:147], v[104:107]
    s_waitcnt lgkmcnt(13)
    ds_read_b64_tr_b16 a[210:211], v5 offset:24576
    v_fma_mix_f32 v155, v203, v247, v255 op_sel:[1,0,0] op_sel_hi:[1,0,0]
    v_mfma_f32_16x16x32_bf16 v[112:115], a[240:243], v[144:147], v[112:115]
    ds_read_b64_tr_b16 a[212:213], v6 offset:16384
    ds_read_b64_tr_b16 a[214:215], v6 offset:24576
    v_fma_mix_f32 v254, v207, v246, v254 op_sel:[0,0,0] op_sel_hi:[1,0,0]
    v_mfma_f32_16x16x32_bf16 v[116:119], a[240:243], v[148:151], v[116:119]
    ds_read_b64_tr_b16 a[216:217], v7 offset:16384
    ds_read_b64_tr_b16 a[218:219], v7 offset:24576
    v_mfma_f32_16x16x32_bf16 v[124:127], a[244:247], v[148:151], v[124:127]
    buffer_load_dwordx4 v13, s[16:19], s36 offen offset:3072 lds
    v_cvt_pk_bf16_f32 v155, v15, v155
    v_mfma_f32_16x16x32_bf16 v[120:123], a[244:247], v[144:147], v[120:123]
    s_waitcnt lgkmcnt(14)
    v_accvgpr_read_b32 v10, a160
    v_accvgpr_read_b32 v11, a161
    v_mfma_f32_16x16x32_bf16 v[128:131], a[248:251], v[144:147], v[128:131]
    v_accvgpr_read_b32 v12, a162
    v_accvgpr_read_b32 v13, a163
    v_fma_mix_f32 v255, v207, v247, v255 op_sel:[1,0,0] op_sel_hi:[1,0,0]
    v_mfma_f32_16x16x32_bf16 v[132:135], a[248:251], v[148:151], v[132:135]
    ds_read_b64_tr_b16 a[220:221], v8 offset:16384
    v_cvt_pk_bf16_f32 v159, v254, v255
    v_mfma_f32_16x16x32_bf16 v[140:143], a[252:255], v[148:151], v[140:143]
    ds_read_b64_tr_b16 a[222:223], v8 offset:24576
    ds_read_b128 v[240:243], v9 offset:3840
    v_mfma_f32_16x16x32_bf16 v[136:139], a[252:255], v[144:147], v[136:139]
    s_add_u32 m0, s37, 98304
    s_waitcnt lgkmcnt(13)
    ds_read_b128 v[248:251], v9 offset:3872
    v_mfma_f32_16x16x32_bf16 v[16:19], a[192:195], v[152:155], v[16:19]
    s_mov_b32 s27, 0
    buffer_load_dwordx4 v10, s[8:11], s27 offen lds
    v_mfma_f32_16x16x32_bf16 v[20:23], a[192:195], v[156:159], v[20:23]
    ds_read_b128 v[244:247], v9 offset:3856
    ds_read_b128 v[252:255], v9 offset:3888
    v_mfma_f32_16x16x32_bf16 v[28:31], a[196:199], v[156:159], v[28:31]
    ds_read_b64_tr_b16 a[224:225], v1 offset:16640
    ds_read_b64_tr_b16 a[226:227], v1 offset:24832
    v_fma_mix_f32 v15, v208, v224, v232 op_sel:[0,0,0] op_sel_hi:[1,0,0]
    v_mfma_f32_16x16x32_bf16 v[24:27], a[196:199], v[152:155], v[24:27]
    s_waitcnt lgkmcnt(14)
    ds_read_b64_tr_b16 a[228:229], v2 offset:16640
    v_fma_mix_f32 v144, v208, v225, v233 op_sel:[1,0,0] op_sel_hi:[1,0,0]
    v_mfma_f32_16x16x32_bf16 v[32:35], a[200:203], v[152:155], v[32:35]
    ds_read_b64_tr_b16 a[230:231], v2 offset:24832
    ds_read_b64_tr_b16 a[232:233], v3 offset:16640
    v_mfma_f32_16x16x32_bf16 v[36:39], a[200:203], v[156:159], v[36:39]
    buffer_load_dwordx4 v11, s[8:11], s27 offen offset:1024 lds
    v_mfma_f32_16x16x32_bf16 v[44:47], a[204:207], v[156:159], v[44:47]
    ds_read_b64_tr_b16 a[234:235], v3 offset:24832
    v_fma_mix_f32 v232, v212, v224, v232 op_sel:[0,0,0] op_sel_hi:[1,0,0]
    v_mfma_f32_16x16x32_bf16 v[40:43], a[204:207], v[152:155], v[40:43]
    s_waitcnt lgkmcnt(14)
    ds_read_b64_tr_b16 a[236:237], v4 offset:16640
    ds_read_b64_tr_b16 a[238:239], v4 offset:24832
    v_cvt_pk_bf16_f32 v144, v15, v144
    v_mfma_f32_16x16x32_bf16 v[48:51], a[208:211], v[152:155], v[48:51]
    ds_read_b64_tr_b16 a[240:241], v5 offset:16640
    ds_read_b64_tr_b16 a[242:243], v5 offset:24832
    v_mfma_f32_16x16x32_bf16 v[52:55], a[208:211], v[156:159], v[52:55]
    s_add_u32 m0, s37, 114688
    ds_read_b64_tr_b16 a[244:245], v6 offset:16640
    v_fma_mix_f32 v233, v212, v225, v233 op_sel:[1,0,0] op_sel_hi:[1,0,0]
    v_mfma_f32_16x16x32_bf16 v[60:63], a[212:215], v[156:159], v[60:63]
    s_mov_b32 s27, 8192
    buffer_load_dwordx4 v10, s[8:11], s27 offen lds
    v_mfma_f32_16x16x32_bf16 v[56:59], a[212:215], v[152:155], v[56:59]
    s_waitcnt lgkmcnt(15)
    ds_read_b64_tr_b16 a[246:247], v6 offset:24832
    ds_read_b64_tr_b16 a[248:249], v7 offset:16640
    v_mfma_f32_16x16x32_bf16 v[64:67], a[216:219], v[152:155], v[64:67]
    ds_read_b64_tr_b16 a[250:251], v7 offset:24832
    v_cvt_pk_bf16_f32 v148, v232, v233
    v_fma_mix_f32 v15, v209, v226, v234 op_sel:[0,0,0] op_sel_hi:[1,0,0]
    v_mfma_f32_16x16x32_bf16 v[68:71], a[216:219], v[156:159], v[68:71]
    ds_read_b64_tr_b16 a[252:253], v8 offset:16640
    ds_read_b64_tr_b16 a[254:255], v8 offset:24832
    v_mfma_f32_16x16x32_bf16 v[76:79], a[220:223], v[156:159], v[76:79]
    v_fma_mix_f32 v145, v209, v227, v235 op_sel:[1,0,0] op_sel_hi:[1,0,0]
    v_fma_mix_f32 v234, v213, v226, v234 op_sel:[0,0,0] op_sel_hi:[1,0,0]
    v_mfma_f32_16x16x32_bf16 v[72:75], a[220:223], v[152:155], v[72:75]
    s_waitcnt lgkmcnt(12)
    buffer_load_dwordx4 v11, s[8:11], s27 offen offset:1024 lds
    v_mfma_f32_16x16x32_bf16 v[80:83], a[224:227], v[152:155], v[80:83]
    v_cvt_pk_bf16_f32 v145, v15, v145
    v_fma_mix_f32 v235, v213, v227, v235 op_sel:[1,0,0] op_sel_hi:[1,0,0]
    v_mfma_f32_16x16x32_bf16 v[84:87], a[224:227], v[156:159], v[84:87]
    v_cvt_pk_bf16_f32 v149, v234, v235
    v_fma_mix_f32 v15, v210, v228, v236 op_sel:[0,0,0] op_sel_hi:[1,0,0]
    v_fma_mix_f32 v146, v210, v229, v237 op_sel:[1,0,0] op_sel_hi:[1,0,0]
    v_mfma_f32_16x16x32_bf16 v[92:95], a[228:231], v[156:159], v[92:95]
    s_waitcnt vmcnt(12) lgkmcnt(0)
    v_fma_mix_f32 v236, v214, v228, v236 op_sel:[0,0,0] op_sel_hi:[1,0,0]
    v_cvt_pk_bf16_f32 v146, v15, v146
    v_mfma_f32_16x16x32_bf16 v[88:91], a[228:231], v[152:155], v[88:91]
    s_barrier
    v_fma_mix_f32 v237, v214, v229, v237 op_sel:[1,0,0] op_sel_hi:[1,0,0]
    v_cvt_pk_bf16_f32 v150, v236, v237
    v_mfma_f32_16x16x32_bf16 v[96:99], a[232:235], v[152:155], v[96:99]
    ds_read_b64_tr_b16 a[192:193], v1 offset:32768
    v_fma_mix_f32 v15, v211, v230, v238 op_sel:[0,0,0] op_sel_hi:[1,0,0]
    v_mfma_f32_16x16x32_bf16 v[100:103], a[232:235], v[156:159], v[100:103]
    s_add_u32 m0, s37, 0
    ds_read_b64_tr_b16 a[194:195], v1 offset:40960
    ds_read_b64_tr_b16 a[196:197], v2 offset:32768
    v_mfma_f32_16x16x32_bf16 v[108:111], a[236:239], v[156:159], v[108:111]
    s_mov_b32 s27, 16384
    buffer_load_dwordx4 v10, s[8:11], s27 offen lds
    v_fma_mix_f32 v147, v211, v231, v239 op_sel:[1,0,0] op_sel_hi:[1,0,0]
    v_mfma_f32_16x16x32_bf16 v[104:107], a[236:239], v[152:155], v[104:107]
    ds_read_b64_tr_b16 a[198:199], v2 offset:40960
    v_fma_mix_f32 v238, v215, v230, v238 op_sel:[0,0,0] op_sel_hi:[1,0,0]
    v_mfma_f32_16x16x32_bf16 v[112:115], a[240:243], v[152:155], v[112:115]
    ds_read_b64_tr_b16 a[200:201], v3 offset:32768
    ds_read_b64_tr_b16 a[202:203], v3 offset:40960
    v_mfma_f32_16x16x32_bf16 v[116:119], a[240:243], v[156:159], v[116:119]
    ds_read_b64_tr_b16 a[204:205], v4 offset:32768
    v_cvt_pk_bf16_f32 v147, v15, v147
    v_mfma_f32_16x16x32_bf16 v[124:127], a[244:247], v[156:159], v[124:127]
    ds_read_b64_tr_b16 a[206:207], v4 offset:40960
    ds_read_b64_tr_b16 a[208:209], v5 offset:32768
    v_mfma_f32_16x16x32_bf16 v[120:123], a[244:247], v[152:155], v[120:123]
    buffer_load_dwordx4 v11, s[8:11], s27 offen offset:1024 lds
    v_fma_mix_f32 v239, v215, v231, v239 op_sel:[1,0,0] op_sel_hi:[1,0,0]
    v_mfma_f32_16x16x32_bf16 v[128:131], a[248:251], v[152:155], v[128:131]
    ds_read_b64_tr_b16 a[210:211], v5 offset:40960
    v_cvt_pk_bf16_f32 v151, v238, v239
    v_mfma_f32_16x16x32_bf16 v[132:135], a[248:251], v[156:159], v[132:135]
    ds_read_b64_tr_b16 a[212:213], v6 offset:32768
    ds_read_b64_tr_b16 a[214:215], v6 offset:40960
    v_mfma_f32_16x16x32_bf16 v[140:143], a[252:255], v[156:159], v[140:143]
    ds_read_b64_tr_b16 a[216:217], v7 offset:32768
    v_mfma_f32_16x16x32_bf16 v[136:139], a[252:255], v[152:155], v[136:139]
    s_waitcnt lgkmcnt(9)
    ds_read_b64_tr_b16 a[218:219], v7 offset:40960
    ds_read_b64_tr_b16 a[220:221], v8 offset:32768
    v_mfma_f32_16x16x32_bf16 v[16:19], a[192:195], v[144:147], v[16:19]
    ds_read_b64_tr_b16 a[222:223], v8 offset:40960
    v_fma_mix_f32 v15, v216, v240, v248 op_sel:[0,0,0] op_sel_hi:[1,0,0]
    v_mfma_f32_16x16x32_bf16 v[20:23], a[192:195], v[148:151], v[20:23]
    s_mov_b32 s27, 24576
    buffer_load_dwordx4 v12, s[12:15], s27 offen offset:2048 lds
    v_fma_mix_f32 v152, v216, v241, v249 op_sel:[1,0,0] op_sel_hi:[1,0,0]
    v_mfma_f32_16x16x32_bf16 v[28:31], a[196:199], v[148:151], v[28:31]
    ds_read_b128 v[224:227], v9 offset:4096
    ds_read_b128 v[232:235], v9 offset:4128
    v_mfma_f32_16x16x32_bf16 v[24:27], a[196:199], v[144:147], v[24:27]
    s_waitcnt lgkmcnt(10)
    ds_read_b128 v[228:231], v9 offset:4112
    v_fma_mix_f32 v248, v220, v240, v248 op_sel:[0,0,0] op_sel_hi:[1,0,0]
    v_mfma_f32_16x16x32_bf16 v[32:35], a[200:203], v[144:147], v[32:35]
    ds_read_b128 v[236:239], v9 offset:4144
    v_cvt_pk_bf16_f32 v152, v15, v152
    v_fma_mix_f32 v249, v220, v241, v249 op_sel:[1,0,0] op_sel_hi:[1,0,0]
    v_mfma_f32_16x16x32_bf16 v[36:39], a[200:203], v[148:151], v[36:39]
    ds_read_b64_tr_b16 a[224:225], v1 offset:33024
    ds_read_b64_tr_b16 a[226:227], v1 offset:41216
    v_mfma_f32_16x16x32_bf16 v[44:47], a[204:207], v[148:151], v[44:47]
    buffer_load_dwordx4 v13, s[12:15], s27 offen offset:3072 lds
    v_cvt_pk_bf16_f32 v156, v248, v249
    v_mfma_f32_16x16x32_bf16 v[40:43], a[204:207], v[144:147], v[40:43]
    s_waitcnt lgkmcnt(10)
    ds_read_b64_tr_b16 a[228:229], v2 offset:33024
    v_fma_mix_f32 v15, v217, v242, v250 op_sel:[0,0,0] op_sel_hi:[1,0,0]
    v_mfma_f32_16x16x32_bf16 v[48:51], a[208:211], v[144:147], v[48:51]
    ds_read_b64_tr_b16 a[230:231], v2 offset:41216
    ds_read_b64_tr_b16 a[232:233], v3 offset:33024
    v_mfma_f32_16x16x32_bf16 v[52:55], a[208:211], v[148:151], v[52:55]
    ds_read_b64_tr_b16 a[234:235], v3 offset:41216
    v_fma_mix_f32 v153, v217, v243, v251 op_sel:[1,0,0] op_sel_hi:[1,0,0]
    v_fma_mix_f32 v250, v221, v242, v250 op_sel:[0,0,0] op_sel_hi:[1,0,0]
    v_mfma_f32_16x16x32_bf16 v[60:63], a[212:215], v[148:151], v[60:63]
    ds_read_b64_tr_b16 a[236:237], v4 offset:33024
    ds_read_b64_tr_b16 a[238:239], v4 offset:41216
    v_mfma_f32_16x16x32_bf16 v[56:59], a[212:215], v[144:147], v[56:59]
    s_add_u32 m0, s37, 16384
    s_waitcnt lgkmcnt(12)
    ds_read_b64_tr_b16 a[240:241], v5 offset:33024
    v_cvt_pk_bf16_f32 v153, v15, v153
    v_mfma_f32_16x16x32_bf16 v[64:67], a[216:219], v[144:147], v[64:67]
    s_mov_b32 s27, 24576
    buffer_load_dwordx4 v10, s[8:11], s27 offen lds
    v_fma_mix_f32 v251, v221, v243, v251 op_sel:[1,0,0] op_sel_hi:[1,0,0]
    v_mfma_f32_16x16x32_bf16 v[68:71], a[216:219], v[148:151], v[68:71]
    ds_read_b64_tr_b16 a[242:243], v5 offset:41216
    ds_read_b64_tr_b16 a[244:245], v6 offset:33024
    v_mfma_f32_16x16x32_bf16 v[76:79], a[220:223], v[148:151], v[76:79]
    ds_read_b64_tr_b16 a[246:247], v6 offset:41216
    v_cvt_pk_bf16_f32 v157, v250, v251
    v_fma_mix_f32 v15, v218, v244, v252 op_sel:[0,0,0] op_sel_hi:[1,0,0]
    v_mfma_f32_16x16x32_bf16 v[72:75], a[220:223], v[144:147], v[72:75]
    s_waitcnt lgkmcnt(8)
    ds_read_b64_tr_b16 a[248:249], v7 offset:33024
    ds_read_b64_tr_b16 a[250:251], v7 offset:41216
    v_mfma_f32_16x16x32_bf16 v[80:83], a[224:227], v[144:147], v[80:83]
    ds_read_b64_tr_b16 a[252:253], v8 offset:33024
    v_fma_mix_f32 v154, v218, v245, v253 op_sel:[1,0,0] op_sel_hi:[1,0,0]
    v_mfma_f32_16x16x32_bf16 v[84:87], a[224:227], v[148:151], v[84:87]
    buffer_load_dwordx4 v11, s[8:11], s27 offen offset:1024 lds
    v_fma_mix_f32 v252, v222, v244, v252 op_sel:[0,0,0] op_sel_hi:[1,0,0]
    v_mfma_f32_16x16x32_bf16 v[92:95], a[228:231], v[148:151], v[92:95]
    ds_read_b64_tr_b16 a[254:255], v8 offset:41216
    ds_read_b64_tr_b16 a[192:193], v1 offset:49152
    v_mfma_f32_16x16x32_bf16 v[88:91], a[228:231], v[144:147], v[88:91]
    s_waitcnt lgkmcnt(9)
    ds_read_b64_tr_b16 a[194:195], v1 offset:57344
    v_cvt_pk_bf16_f32 v154, v15, v154
    v_mfma_f32_16x16x32_bf16 v[96:99], a[232:235], v[144:147], v[96:99]
    ds_read_b64_tr_b16 a[196:197], v2 offset:49152
    v_fma_mix_f32 v253, v222, v245, v253 op_sel:[1,0,0] op_sel_hi:[1,0,0]
    v_cvt_pk_bf16_f32 v158, v252, v253
    v_mfma_f32_16x16x32_bf16 v[100:103], a[232:235], v[148:151], v[100:103]
    ds_read_b64_tr_b16 a[198:199], v2 offset:57344
    ds_read_b64_tr_b16 a[200:201], v3 offset:49152
    v_mfma_f32_16x16x32_bf16 v[108:111], a[236:239], v[148:151], v[108:111]
    ds_read_b64_tr_b16 a[202:203], v3 offset:57344
    v_fma_mix_f32 v15, v219, v246, v254 op_sel:[0,0,0] op_sel_hi:[1,0,0]
    v_mfma_f32_16x16x32_bf16 v[104:107], a[236:239], v[144:147], v[104:107]
    s_waitcnt lgkmcnt(10)
    buffer_load_dwordx4 v12, s[12:15], s27 offen offset:2048 lds
    v_fma_mix_f32 v155, v219, v247, v255 op_sel:[1,0,0] op_sel_hi:[1,0,0]
    v_mfma_f32_16x16x32_bf16 v[112:115], a[240:243], v[144:147], v[112:115]
    ds_read_b64_tr_b16 a[204:205], v4 offset:49152
    ds_read_b64_tr_b16 a[206:207], v4 offset:57344
    v_mfma_f32_16x16x32_bf16 v[116:119], a[240:243], v[148:151], v[116:119]
    ds_read_b64_tr_b16 a[208:209], v5 offset:49152
    v_fma_mix_f32 v254, v223, v246, v254 op_sel:[0,0,0] op_sel_hi:[1,0,0]
    v_cvt_pk_bf16_f32 v155, v15, v155
    v_mfma_f32_16x16x32_bf16 v[124:127], a[244:247], v[148:151], v[124:127]
    ds_read_b64_tr_b16 a[210:211], v5 offset:57344
    ds_read_b64_tr_b16 a[212:213], v6 offset:49152
    v_mfma_f32_16x16x32_bf16 v[120:123], a[244:247], v[144:147], v[120:123]
    s_waitcnt lgkmcnt(11)
    ds_read_b64_tr_b16 a[214:215], v6 offset:57344
    v_fma_mix_f32 v255, v223, v247, v255 op_sel:[1,0,0] op_sel_hi:[1,0,0]
    v_mfma_f32_16x16x32_bf16 v[128:131], a[248:251], v[144:147], v[128:131]
    buffer_load_dwordx4 v13, s[12:15], s27 offen offset:3072 lds
    v_cvt_pk_bf16_f32 v159, v254, v255
    v_mfma_f32_16x16x32_bf16 v[132:135], a[248:251], v[148:151], v[132:135]
    ds_read_b64_tr_b16 a[216:217], v7 offset:49152
    ds_read_b64_tr_b16 a[218:219], v7 offset:57344
    v_mfma_f32_16x16x32_bf16 v[140:143], a[252:255], v[148:151], v[140:143]
    ds_read_b64_tr_b16 a[220:221], v8 offset:49152
    v_mfma_f32_16x16x32_bf16 v[136:139], a[252:255], v[144:147], v[136:139]
    s_waitcnt lgkmcnt(11)
    ds_read_b64_tr_b16 a[222:223], v8 offset:57344
    ds_read_b128 v[240:243], v9 offset:4352
    v_mfma_f32_16x16x32_bf16 v[16:19], a[192:195], v[152:155], v[16:19]
    ds_read_b128 v[248:251], v9 offset:4384
    v_fma_mix_f32 v15, v160, v224, v232 op_sel:[0,0,0] op_sel_hi:[1,0,0]
    v_mfma_f32_16x16x32_bf16 v[20:23], a[192:195], v[156:159], v[20:23]
    ds_read_b128 v[244:247], v9 offset:4368
    v_fma_mix_f32 v144, v160, v225, v233 op_sel:[1,0,0] op_sel_hi:[1,0,0]
    v_mfma_f32_16x16x32_bf16 v[28:31], a[196:199], v[156:159], v[28:31]
    ds_read_b128 v[252:255], v9 offset:4400
    ds_read_b64_tr_b16 a[224:225], v1 offset:49408
    v_fma_mix_f32 v232, v164, v224, v232 op_sel:[0,0,0] op_sel_hi:[1,0,0]
    v_mfma_f32_16x16x32_bf16 v[24:27], a[196:199], v[152:155], v[24:27]
    s_waitcnt lgkmcnt(13)
    ds_read_b64_tr_b16 a[226:227], v1 offset:57600
    v_cvt_pk_bf16_f32 v144, v15, v144
    v_mfma_f32_16x16x32_bf16 v[32:35], a[200:203], v[152:155], v[32:35]
    ds_read_b64_tr_b16 a[228:229], v2 offset:49408
    ds_read_b64_tr_b16 a[230:231], v2 offset:57600
    v_mfma_f32_16x16x32_bf16 v[36:39], a[200:203], v[156:159], v[36:39]
    ds_read_b64_tr_b16 a[232:233], v3 offset:49408
    v_fma_mix_f32 v233, v164, v225, v233 op_sel:[1,0,0] op_sel_hi:[1,0,0]
    v_mfma_f32_16x16x32_bf16 v[44:47], a[204:207], v[156:159], v[44:47]
    ds_read_b64_tr_b16 a[234:235], v3 offset:57600
    ds_read_b64_tr_b16 a[236:237], v4 offset:49408
    v_mfma_f32_16x16x32_bf16 v[40:43], a[204:207], v[152:155], v[40:43]
    s_waitcnt lgkmcnt(15)
    ds_read_b64_tr_b16 a[238:239], v4 offset:57600
    v_cvt_pk_bf16_f32 v148, v232, v233
    v_fma_mix_f32 v15, v161, v226, v234 op_sel:[0,0,0] op_sel_hi:[1,0,0]
    v_mfma_f32_16x16x32_bf16 v[48:51], a[208:211], v[152:155], v[48:51]
    ds_read_b64_tr_b16 a[240:241], v5 offset:49408
    ds_read_b64_tr_b16 a[242:243], v5 offset:57600
    v_mfma_f32_16x16x32_bf16 v[52:55], a[208:211], v[156:159], v[52:55]
    ds_read_b64_tr_b16 a[244:245], v6 offset:49408
    v_fma_mix_f32 v145, v161, v227, v235 op_sel:[1,0,0] op_sel_hi:[1,0,0]
    v_mfma_f32_16x16x32_bf16 v[60:63], a[212:215], v[156:159], v[60:63]
    ds_read_b64_tr_b16 a[246:247], v6 offset:57600
    ds_read_b64_tr_b16 a[248:249], v7 offset:49408
    v_mfma_f32_16x16x32_bf16 v[56:59], a[212:215], v[152:155], v[56:59]
    s_waitcnt lgkmcnt(15)
    ds_read_b64_tr_b16 a[250:251], v7 offset:57600
    v_fma_mix_f32 v234, v165, v226, v234 op_sel:[0,0,0] op_sel_hi:[1,0,0]
    v_mfma_f32_16x16x32_bf16 v[64:67], a[216:219], v[152:155], v[64:67]
    ds_read_b64_tr_b16 a[252:253], v8 offset:49408
    v_accvgpr_read_b32 v223, a167
    v_cvt_pk_bf16_f32 v145, v15, v145
    v_mfma_f32_16x16x32_bf16 v[68:71], a[216:219], v[156:159], v[68:71]
    ds_read_b64_tr_b16 a[254:255], v8 offset:57600
    v_fma_mix_f32 v235, v165, v227, v235 op_sel:[1,0,0] op_sel_hi:[1,0,0]
    v_mfma_f32_16x16x32_bf16 v[76:79], a[220:223], v[156:159], v[76:79]
    v_cvt_pk_bf16_f32 v149, v234, v235
    v_fma_mix_f32 v15, v162, v228, v236 op_sel:[0,0,0] op_sel_hi:[1,0,0]
    v_mfma_f32_16x16x32_bf16 v[72:75], a[220:223], v[152:155], v[72:75]
    s_waitcnt lgkmcnt(12)
    v_xor_b32 v1, 0x10000, v1
    v_xor_b32 v2, 0x10000, v2
    v_mfma_f32_16x16x32_bf16 v[80:83], a[224:227], v[152:155], v[80:83]
    v_xor_b32 v3, 0x10000, v3
    v_xor_b32 v4, 0x10000, v4
    v_mfma_f32_16x16x32_bf16 v[84:87], a[224:227], v[156:159], v[84:87]
    v_xor_b32 v5, 0x10000, v5
    v_xor_b32 v6, 0x10000, v6
    v_fma_mix_f32 v146, v162, v229, v237 op_sel:[1,0,0] op_sel_hi:[1,0,0]
    v_mfma_f32_16x16x32_bf16 v[92:95], a[228:231], v[156:159], v[92:95]
    s_waitcnt vmcnt(12) lgkmcnt(0)
    v_xor_b32 v7, 0x10000, v7
    v_xor_b32 v8, 0x10000, v8
    v_mfma_f32_16x16x32_bf16 v[88:91], a[228:231], v[152:155], v[88:91]
    s_barrier
    v_fma_mix_f32 v236, v166, v228, v236 op_sel:[0,0,0] op_sel_hi:[1,0,0]
    v_cvt_pk_bf16_f32 v146, v15, v146
    v_mfma_f32_16x16x32_bf16 v[96:99], a[232:235], v[152:155], v[96:99]
    ds_read_b64_tr_b16 a[192:193], v1 offset:0
    v_fma_mix_f32 v237, v166, v229, v237 op_sel:[1,0,0] op_sel_hi:[1,0,0]
    v_mfma_f32_16x16x32_bf16 v[100:103], a[232:235], v[156:159], v[100:103]
    s_mov_b32 m0, s39
    ds_read_b64_tr_b16 a[194:195], v1 offset:8192
    ds_read_b64_tr_b16 a[196:197], v2 offset:0
    v_mfma_f32_16x16x32_bf16 v[108:111], a[236:239], v[156:159], v[108:111]
    s_xor_b32 s39, s39, 4096
    buffer_load_dwordx4 v223, s[52:55], s56 offen lds
    v_cvt_pk_bf16_f32 v150, v236, v237
    v_mfma_f32_16x16x32_bf16 v[104:107], a[236:239], v[152:155], v[104:107]
    ds_read_b64_tr_b16 a[198:199], v2 offset:8192
    v_fma_mix_f32 v15, v163, v230, v238 op_sel:[0,0,0] op_sel_hi:[1,0,0]
    v_mfma_f32_16x16x32_bf16 v[112:115], a[240:243], v[152:155], v[112:115]
    ds_read_b64_tr_b16 a[200:201], v3 offset:0
    v_fma_mix_f32 v147, v163, v231, v239 op_sel:[1,0,0] op_sel_hi:[1,0,0]
    v_mfma_f32_16x16x32_bf16 v[116:119], a[240:243], v[156:159], v[116:119]
    s_add_u32 m0, s37, 32768
    ds_read_b64_tr_b16 a[202:203], v3 offset:8192
    ds_read_b64_tr_b16 a[204:205], v4 offset:0
    v_mfma_f32_16x16x32_bf16 v[124:127], a[244:247], v[156:159], v[124:127]
    s_mov_b32 s27, 32768
    buffer_load_dwordx4 v10, s[8:11], s27 offen lds
    v_mfma_f32_16x16x32_bf16 v[120:123], a[244:247], v[152:155], v[120:123]
    ds_read_b64_tr_b16 a[206:207], v4 offset:8192
    v_fma_mix_f32 v238, v167, v230, v238 op_sel:[0,0,0] op_sel_hi:[1,0,0]
    v_cvt_pk_bf16_f32 v147, v15, v147
    v_mfma_f32_16x16x32_bf16 v[128:131], a[248:251], v[152:155], v[128:131]
    ds_read_b64_tr_b16 a[208:209], v5 offset:0
    v_fma_mix_f32 v239, v167, v231, v239 op_sel:[1,0,0] op_sel_hi:[1,0,0]
    v_mfma_f32_16x16x32_bf16 v[132:135], a[248:251], v[156:159], v[132:135]
    ds_read_b64_tr_b16 a[210:211], v5 offset:8192
    v_cvt_pk_bf16_f32 v151, v238, v239
    v_mfma_f32_16x16x32_bf16 v[140:143], a[252:255], v[156:159], v[140:143]
    ds_read_b64_tr_b16 a[212:213], v6 offset:0
    ds_read_b64_tr_b16 a[214:215], v6 offset:8192
    v_mfma_f32_16x16x32_bf16 v[136:139], a[252:255], v[152:155], v[136:139]
    s_waitcnt lgkmcnt(8)
    buffer_load_dwordx4 v11, s[8:11], s27 offen offset:1024 lds
    v_mfma_f32_16x16x32_bf16 v[16:19], a[192:195], v[144:147], v[16:19]
    ds_read_b64_tr_b16 a[216:217], v7 offset:0
    v_fma_mix_f32 v15, v168, v240, v248 op_sel:[0,0,0] op_sel_hi:[1,0,0]
    v_mfma_f32_16x16x32_bf16 v[20:23], a[192:195], v[148:151], v[20:23]
    ds_read_b64_tr_b16 a[218:219], v7 offset:8192
    v_fma_mix_f32 v152, v168, v241, v249 op_sel:[1,0,0] op_sel_hi:[1,0,0]
    v_mfma_f32_16x16x32_bf16 v[28:31], a[196:199], v[148:151], v[28:31]
    ds_read_b64_tr_b16 a[220:221], v8 offset:0
    ds_read_b64_tr_b16 a[222:223], v8 offset:8192
    v_fma_mix_f32 v248, v172, v240, v248 op_sel:[0,0,0] op_sel_hi:[1,0,0]
    v_mfma_f32_16x16x32_bf16 v[24:27], a[196:199], v[144:147], v[24:27]
    s_waitcnt lgkmcnt(8)
    ds_read_b64_tr_b16 a[224:225], v1 offset:256
    v_cvt_pk_bf16_f32 v152, v15, v152
    v_mfma_f32_16x16x32_bf16 v[32:35], a[200:203], v[144:147], v[32:35]
    buffer_load_dwordx4 v12, s[12:15], s27 offen offset:2048 lds
    v_mfma_f32_16x16x32_bf16 v[36:39], a[200:203], v[148:151], v[36:39]
    ds_read_b64_tr_b16 a[226:227], v1 offset:8448
    v_fma_mix_f32 v249, v172, v241, v249 op_sel:[1,0,0] op_sel_hi:[1,0,0]
    v_mfma_f32_16x16x32_bf16 v[44:47], a[204:207], v[148:151], v[44:47]
    ds_read_b64_tr_b16 a[228:229], v2 offset:256
    ds_read_b64_tr_b16 a[230:231], v2 offset:8448
    v_cvt_pk_bf16_f32 v156, v248, v249
    v_mfma_f32_16x16x32_bf16 v[40:43], a[204:207], v[144:147], v[40:43]
    s_waitcnt lgkmcnt(8)
    ds_read_b64_tr_b16 a[232:233], v3 offset:256
    v_fma_mix_f32 v15, v169, v242, v250 op_sel:[0,0,0] op_sel_hi:[1,0,0]
    v_mfma_f32_16x16x32_bf16 v[48:51], a[208:211], v[144:147], v[48:51]
    ds_read_b64_tr_b16 a[234:235], v3 offset:8448
    v_fma_mix_f32 v153, v169, v243, v251 op_sel:[1,0,0] op_sel_hi:[1,0,0]
    v_mfma_f32_16x16x32_bf16 v[52:55], a[208:211], v[148:151], v[52:55]
    buffer_load_dwordx4 v13, s[12:15], s27 offen offset:3072 lds
    v_mfma_f32_16x16x32_bf16 v[60:63], a[212:215], v[148:151], v[60:63]
    ds_read_b64_tr_b16 a[236:237], v4 offset:256
    ds_read_b64_tr_b16 a[238:239], v4 offset:8448
    v_fma_mix_f32 v250, v173, v242, v250 op_sel:[0,0,0] op_sel_hi:[1,0,0]
    v_mfma_f32_16x16x32_bf16 v[56:59], a[212:215], v[144:147], v[56:59]
    s_waitcnt lgkmcnt(8)
    ds_read_b64_tr_b16 a[240:241], v5 offset:256
    v_cvt_pk_bf16_f32 v153, v15, v153
    v_mfma_f32_16x16x32_bf16 v[64:67], a[216:219], v[144:147], v[64:67]
    ds_read_b64_tr_b16 a[242:243], v5 offset:8448
    v_fma_mix_f32 v251, v173, v243, v251 op_sel:[1,0,0] op_sel_hi:[1,0,0]
    v_mfma_f32_16x16x32_bf16 v[68:71], a[216:219], v[148:151], v[68:71]
    s_add_u32 m0, s37, 49152
    ds_read_b64_tr_b16 a[244:245], v6 offset:256
    v_cvt_pk_bf16_f32 v157, v250, v251
    v_mfma_f32_16x16x32_bf16 v[76:79], a[220:223], v[148:151], v[76:79]
    s_mov_b32 s27, 40960
    buffer_load_dwordx4 v10, s[8:11], s27 offen lds
    v_fma_mix_f32 v15, v170, v244, v252 op_sel:[0,0,0] op_sel_hi:[1,0,0]
    v_mfma_f32_16x16x32_bf16 v[72:75], a[220:223], v[144:147], v[72:75]
    s_waitcnt lgkmcnt(7)
    ds_read_b64_tr_b16 a[246:247], v6 offset:8448
    ds_read_b64_tr_b16 a[248:249], v7 offset:256
    v_mfma_f32_16x16x32_bf16 v[80:83], a[224:227], v[144:147], v[80:83]
    ds_read_b64_tr_b16 a[250:251], v7 offset:8448
    v_fma_mix_f32 v154, v170, v245, v253 op_sel:[1,0,0] op_sel_hi:[1,0,0]
    v_mfma_f32_16x16x32_bf16 v[84:87], a[224:227], v[148:151], v[84:87]
    ds_read_b64_tr_b16 a[252:253], v8 offset:256
    v_fma_mix_f32 v252, v174, v244, v252 op_sel:[0,0,0] op_sel_hi:[1,0,0]
    v_mfma_f32_16x16x32_bf16 v[92:95], a[228:231], v[148:151], v[92:95]
    ds_read_b64_tr_b16 a[254:255], v8 offset:8448
    ds_read_b64_tr_b16 a[192:193], v1 offset:16384
    v_mfma_f32_16x16x32_bf16 v[88:91], a[228:231], v[144:147], v[88:91]
    s_waitcnt lgkmcnt(9)
    buffer_load_dwordx4 v11, s[8:11], s27 offen offset:1024 lds
    v_cvt_pk_bf16_f32 v154, v15, v154
    v_mfma_f32_16x16x32_bf16 v[96:99], a[232:235], v[144:147], v[96:99]
    ds_read_b64_tr_b16 a[194:195], v1 offset:24576
    v_fma_mix_f32 v253, v174, v245, v253 op_sel:[1,0,0] op_sel_hi:[1,0,0]
    v_mfma_f32_16x16x32_bf16 v[100:103], a[232:235], v[148:151], v[100:103]
    ds_read_b64_tr_b16 a[196:197], v2 offset:16384
    v_cvt_pk_bf16_f32 v158, v252, v253
    v_mfma_f32_16x16x32_bf16 v[108:111], a[236:239], v[148:151], v[108:111]
    ds_read_b64_tr_b16 a[198:199], v2 offset:24576
    ds_read_b64_tr_b16 a[200:201], v3 offset:16384
    v_mfma_f32_16x16x32_bf16 v[104:107], a[236:239], v[144:147], v[104:107]
    s_waitcnt lgkmcnt(9)
    ds_read_b64_tr_b16 a[202:203], v3 offset:24576
    v_fma_mix_f32 v15, v171, v246, v254 op_sel:[0,0,0] op_sel_hi:[1,0,0]
    v_fma_mix_f32 v155, v171, v247, v255 op_sel:[1,0,0] op_sel_hi:[1,0,0]
    v_mfma_f32_16x16x32_bf16 v[112:115], a[240:243], v[144:147], v[112:115]
    buffer_load_dwordx4 v12, s[12:15], s27 offen offset:2048 lds
    v_mfma_f32_16x16x32_bf16 v[116:119], a[240:243], v[148:151], v[116:119]
    ds_read_b64_tr_b16 a[204:205], v4 offset:16384
    v_fma_mix_f32 v254, v175, v246, v254 op_sel:[0,0,0] op_sel_hi:[1,0,0]
    v_mfma_f32_16x16x32_bf16 v[124:127], a[244:247], v[148:151], v[124:127]
    ds_read_b64_tr_b16 a[206:207], v4 offset:24576
    v_cvt_pk_bf16_f32 v155, v15, v155
    v_mfma_f32_16x16x32_bf16 v[120:123], a[244:247], v[144:147], v[120:123]
    s_waitcnt lgkmcnt(8)
    ds_read_b64_tr_b16 a[208:209], v5 offset:16384
    ds_read_b64_tr_b16 a[210:211], v5 offset:24576
    v_fma_mix_f32 v255, v175, v247, v255 op_sel:[1,0,0] op_sel_hi:[1,0,0]
    v_mfma_f32_16x16x32_bf16 v[128:131], a[248:251], v[144:147], v[128:131]
    ds_read_b64_tr_b16 a[212:213], v6 offset:16384
    v_cvt_pk_bf16_f32 v159, v254, v255
    v_mfma_f32_16x16x32_bf16 v[132:135], a[248:251], v[148:151], v[132:135]
    buffer_load_dwordx4 v13, s[12:15], s27 offen offset:3072 lds
    v_mfma_f32_16x16x32_bf16 v[140:143], a[252:255], v[148:151], v[140:143]
    ds_read_b64_tr_b16 a[214:215], v6 offset:24576
    v_mfma_f32_16x16x32_bf16 v[136:139], a[252:255], v[144:147], v[136:139]
    s_waitcnt lgkmcnt(8)
    ds_read_b64_tr_b16 a[216:217], v7 offset:16384
    ds_read_b64_tr_b16 a[218:219], v7 offset:24576
    v_mfma_f32_16x16x32_bf16 v[16:19], a[192:195], v[152:155], v[16:19]
    ds_read_b64_tr_b16 a[220:221], v8 offset:16384
    v_accvgpr_read_b32 v224, a165
    v_mfma_f32_16x16x32_bf16 v[20:23], a[192:195], v[156:159], v[20:23]
    ds_read_b64_tr_b16 a[222:223], v8 offset:24576
    v_xor_b32 v225, 64, v224
    v_mfma_f32_16x16x32_bf16 v[28:31], a[196:199], v[156:159], v[28:31]
    ds_read_b64_tr_b16 a[224:225], v1 offset:16640
    ds_read_b64_tr_b16 a[226:227], v1 offset:24832
    v_mfma_f32_16x16x32_bf16 v[24:27], a[196:199], v[152:155], v[24:27]
    s_waitcnt lgkmcnt(10)
    ds_read_b64_tr_b16 a[228:229], v2 offset:16640
    v_mfma_f32_16x16x32_bf16 v[32:35], a[200:203], v[152:155], v[32:35]
    ds_read_b64_tr_b16 a[230:231], v2 offset:24832
    v_xor_b32 v226, 128, v224
    v_mfma_f32_16x16x32_bf16 v[36:39], a[200:203], v[156:159], v[36:39]
    ds_read_b64_tr_b16 a[232:233], v3 offset:16640
    ds_read_b64_tr_b16 a[234:235], v3 offset:24832
    v_mfma_f32_16x16x32_bf16 v[44:47], a[204:207], v[156:159], v[44:47]
    ds_read_b64_tr_b16 a[236:237], v4 offset:16640
    v_xor_b32 v227, 192, v224
    v_mfma_f32_16x16x32_bf16 v[40:43], a[204:207], v[152:155], v[40:43]
    s_waitcnt lgkmcnt(11)
    ds_read_b64_tr_b16 a[238:239], v4 offset:24832
    v_mfma_f32_16x16x32_bf16 v[48:51], a[208:211], v[152:155], v[48:51]
    ds_read_b64_tr_b16 a[240:241], v5 offset:16640
    v_cvt_pk_bf16_f32 v160, v16, v17
    v_mfma_f32_16x16x32_bf16 v[52:55], a[208:211], v[156:159], v[52:55]
    ds_read_b64_tr_b16 a[242:243], v5 offset:24832
    ds_read_b64_tr_b16 a[244:245], v6 offset:16640
    v_mfma_f32_16x16x32_bf16 v[60:63], a[212:215], v[156:159], v[60:63]
    ds_read_b64_tr_b16 a[246:247], v6 offset:24832
    v_cvt_pk_bf16_f32 v161, v18, v19
    v_cvt_pk_bf16_f32 v162, v24, v25
    v_mfma_f32_16x16x32_bf16 v[56:59], a[212:215], v[152:155], v[56:59]
    s_waitcnt lgkmcnt(12)
    ds_read_b64_tr_b16 a[248:249], v7 offset:16640
    v_cvt_pk_bf16_f32 v163, v26, v27
    v_mfma_f32_16x16x32_bf16 v[64:67], a[216:219], v[152:155], v[64:67]
    ds_read_b64_tr_b16 a[250:251], v7 offset:24832
    ds_read_b64_tr_b16 a[252:253], v8 offset:16640
    v_mfma_f32_16x16x32_bf16 v[68:71], a[216:219], v[156:159], v[68:71]
    ds_read_b64_tr_b16 a[254:255], v8 offset:24832
    v_cvt_pk_bf16_f32 v176, v20, v21
    v_mfma_f32_16x16x32_bf16 v[76:79], a[220:223], v[156:159], v[76:79]
    v_cvt_pk_bf16_f32 v177, v22, v23
    v_cvt_pk_bf16_f32 v178, v28, v29
    v_mfma_f32_16x16x32_bf16 v[72:75], a[220:223], v[152:155], v[72:75]
    s_waitcnt lgkmcnt(12)
    v_cvt_pk_bf16_f32 v179, v30, v31
    v_permlane16_swap_b32 v160, v162
    v_permlane16_swap_b32 v161, v163
    v_mfma_f32_16x16x32_bf16 v[80:83], a[224:227], v[152:155], v[80:83]
    v_cvt_pk_bf16_f32 v164, v32, v33
    v_cvt_pk_bf16_f32 v165, v34, v35
    v_mfma_f32_16x16x32_bf16 v[84:87], a[224:227], v[156:159], v[84:87]
    v_cvt_pk_bf16_f32 v166, v40, v41
    v_cvt_pk_bf16_f32 v167, v42, v43
    v_mfma_f32_16x16x32_bf16 v[92:95], a[228:231], v[156:159], v[92:95]
    s_waitcnt vmcnt(17) lgkmcnt(0)
    v_permlane16_swap_b32 v176, v178
    v_permlane16_swap_b32 v177, v179
    v_mfma_f32_16x16x32_bf16 v[88:91], a[228:231], v[152:155], v[88:91]
    s_barrier
    v_cvt_pk_bf16_f32 v180, v36, v37
    v_cvt_pk_bf16_f32 v181, v38, v39
    v_mfma_f32_16x16x32_bf16 v[96:99], a[232:235], v[152:155], v[96:99]
    ds_read_b128 a[128:131], v224 offset:32768
    v_cvt_pk_bf16_f32 v182, v44, v45
    v_mfma_f32_16x16x32_bf16 v[100:103], a[232:235], v[156:159], v[100:103]
    ds_read_b128 a[132:135], v225 offset:32768
    v_cvt_pk_bf16_f32 v183, v46, v47
    v_mfma_f32_16x16x32_bf16 v[108:111], a[236:239], v[156:159], v[108:111]
    ds_read_b128 a[136:139], v226 offset:32768
    v_permlane16_swap_b32 v164, v166
    v_mfma_f32_16x16x32_bf16 v[104:107], a[236:239], v[152:155], v[104:107]
    ds_read_b128 a[140:143], v227 offset:32768
    v_permlane16_swap_b32 v165, v167
    v_mfma_f32_16x16x32_bf16 v[112:115], a[240:243], v[152:155], v[112:115]
    ds_read_b128 a[144:147], v224 offset:40960
    v_cvt_pk_bf16_f32 v168, v48, v49
    v_cvt_pk_bf16_f32 v169, v50, v51
    v_mfma_f32_16x16x32_bf16 v[116:119], a[240:243], v[156:159], v[116:119]
    ds_read_b128 a[148:151], v225 offset:40960
    v_cvt_pk_bf16_f32 v170, v56, v57
    v_mfma_f32_16x16x32_bf16 v[124:127], a[244:247], v[156:159], v[124:127]
    ds_read_b128 a[152:155], v226 offset:40960
    v_cvt_pk_bf16_f32 v171, v58, v59
    v_mfma_f32_16x16x32_bf16 v[120:123], a[244:247], v[152:155], v[120:123]
    ds_read_b128 a[156:159], v227 offset:40960
    v_permlane16_swap_b32 v180, v182
    v_mfma_f32_16x16x32_bf16 v[128:131], a[248:251], v[152:155], v[128:131]
    v_permlane16_swap_b32 v181, v183
    v_cvt_pk_bf16_f32 v184, v52, v53
    v_mfma_f32_16x16x32_bf16 v[132:135], a[248:251], v[156:159], v[132:135]
    v_cvt_pk_bf16_f32 v185, v54, v55
    v_cvt_pk_bf16_f32 v186, v60, v61
    v_cvt_pk_bf16_f32 v187, v62, v63
    v_mfma_f32_16x16x32_bf16 v[140:143], a[252:255], v[156:159], v[140:143]
    v_permlane16_swap_b32 v168, v170
    v_permlane16_swap_b32 v169, v171
    v_mfma_f32_16x16x32_bf16 v[136:139], a[252:255], v[152:155], v[136:139]
    v_cvt_pk_bf16_f32 v172, v64, v65
    v_cvt_pk_bf16_f32 v173, v66, v67
    v_cvt_pk_bf16_f32 v174, v72, v73
    v_cvt_pk_bf16_f32 v175, v74, v75
    v_permlane16_swap_b32 v184, v186
    v_permlane16_swap_b32 v185, v187
    v_cvt_pk_bf16_f32 v188, v68, v69
    v_cvt_pk_bf16_f32 v189, v70, v71
    v_cvt_pk_bf16_f32 v190, v76, v77
    v_cvt_pk_bf16_f32 v191, v78, v79
    v_permlane16_swap_b32 v172, v174
    v_permlane16_swap_b32 v173, v175
    v_nop
    v_nop
    v_permlane16_swap_b32 v188, v190
    v_permlane16_swap_b32 v189, v191
    s_waitcnt lgkmcnt(0)
    s_nop 0
    v_mfma_f32_16x16x32_bf16 v[16:19], a[128:131], v[160:163], 0
    v_cvt_pk_bf16_f32 v192, v80, v81
    v_cvt_pk_bf16_f32 v193, v82, v83
    v_cvt_pk_bf16_f32 v194, v88, v89
    v_mfma_f32_16x16x32_bf16 v[16:19], a[132:135], v[164:167], v[16:19]
    v_cvt_pk_bf16_f32 v195, v90, v91
    v_cvt_pk_bf16_f32 v208, v84, v85
    v_cvt_pk_bf16_f32 v209, v86, v87
    v_cvt_pk_bf16_f32 v210, v92, v93
    v_mfma_f32_16x16x32_bf16 v[16:19], a[136:139], v[168:171], v[16:19]
    v_cvt_pk_bf16_f32 v211, v94, v95
    v_permlane16_swap_b32 v192, v194
    v_permlane16_swap_b32 v193, v195
    v_mfma_f32_16x16x32_bf16 v[16:19], a[140:143], v[172:175], v[16:19]
    v_cvt_pk_bf16_f32 v196, v96, v97
    v_cvt_pk_bf16_f32 v197, v98, v99
    v_cvt_pk_bf16_f32 v198, v104, v105
    v_mfma_f32_16x16x32_bf16 v[20:23], a[144:147], v[160:163], 0
    v_cvt_pk_bf16_f32 v199, v106, v107
    v_permlane16_swap_b32 v208, v210
    v_permlane16_swap_b32 v209, v211
    v_cvt_pk_bf16_f32 v212, v100, v101
    v_mfma_f32_16x16x32_bf16 v[20:23], a[148:151], v[164:167], v[20:23]
    v_cvt_pk_bf16_f32 v213, v102, v103
    v_cvt_pk_bf16_f32 v214, v108, v109
    v_cvt_pk_bf16_f32 v215, v110, v111
    v_mfma_f32_16x16x32_bf16 v[20:23], a[152:155], v[168:171], v[20:23]
    v_permlane16_swap_b32 v196, v198
    v_permlane16_swap_b32 v197, v199
    v_cvt_pk_bf16_f32 v200, v112, v113
    v_mfma_f32_16x16x32_bf16 v[20:23], a[156:159], v[172:175], v[20:23]
    v_cvt_pk_bf16_f32 v201, v114, v115
    v_cvt_pk_bf16_f32 v202, v120, v121
    v_cvt_pk_bf16_f32 v203, v122, v123
    v_permlane16_swap_b32 v212, v214
    v_mfma_f32_16x16x32_bf16 v[24:27], a[128:131], v[176:179], 0
    v_permlane16_swap_b32 v213, v215
    v_cvt_pk_bf16_f32 v216, v116, v117
    v_cvt_pk_bf16_f32 v217, v118, v119
    v_mfma_f32_16x16x32_bf16 v[24:27], a[132:135], v[180:183], v[24:27]
    v_cvt_pk_bf16_f32 v218, v124, v125
    v_cvt_pk_bf16_f32 v219, v126, v127
    v_permlane16_swap_b32 v200, v202
    v_mfma_f32_16x16x32_bf16 v[24:27], a[136:139], v[184:187], v[24:27]
    v_permlane16_swap_b32 v201, v203
    v_cvt_pk_bf16_f32 v204, v128, v129
    v_cvt_pk_bf16_f32 v205, v130, v131
    v_cvt_pk_bf16_f32 v206, v136, v137
    v_mfma_f32_16x16x32_bf16 v[24:27], a[140:143], v[188:191], v[24:27]
    v_cvt_pk_bf16_f32 v207, v138, v139
    v_permlane16_swap_b32 v216, v218
    v_permlane16_swap_b32 v217, v219
    v_mfma_f32_16x16x32_bf16 v[28:31], a[144:147], v[176:179], 0
    v_cvt_pk_bf16_f32 v220, v132, v133
    v_cvt_pk_bf16_f32 v221, v134, v135
    v_cvt_pk_bf16_f32 v222, v140, v141
    v_mfma_f32_16x16x32_bf16 v[28:31], a[148:151], v[180:183], v[28:31]
    v_cvt_pk_bf16_f32 v223, v142, v143
    v_permlane16_swap_b32 v204, v206
    v_permlane16_swap_b32 v205, v207
    v_nop
    v_mfma_f32_16x16x32_bf16 v[28:31], a[152:155], v[184:187], v[28:31]
    v_nop
    v_permlane16_swap_b32 v220, v222
    v_permlane16_swap_b32 v221, v223
    v_mfma_f32_16x16x32_bf16 v[28:31], a[156:159], v[188:191], v[28:31]
    v_accvgpr_read_b32 v228, a164
    v_accvgpr_read_b32 v15, a166
    v_xor_b32 v229, 32, v228
    v_xor_b32 v230, 64, v228
    v_mfma_f32_16x16x32_bf16 v[32:35], a[128:131], v[192:195], 0
    v_xor_b32 v231, 96, v228
    v_xor_b32 v232, 128, v228
    v_xor_b32 v233, 160, v228
    v_xor_b32 v234, 192, v228
    v_mfma_f32_16x16x32_bf16 v[32:35], a[132:135], v[196:199], v[32:35]
    v_xor_b32 v235, 224, v228
    v_accvgpr_write_b32 a192, v15
    v_accvgpr_write_b32 a193, v15
    v_accvgpr_write_b32 a194, v15
    v_accvgpr_write_b32 a195, v15
    v_mfma_f32_16x16x32_bf16 v[32:35], a[136:139], v[200:203], v[32:35]
    v_bfe_u32 v104, v0, 2, 1
    v_mul_u32_u24 v104, 0xaaaa, v104
    v_add_u32 v104, 0x4444, v104
    v_max3_f32 v244, v16, v17, v18
    v_mfma_f32_16x16x32_bf16 v[32:35], a[140:143], v[204:207], v[32:35]
    v_max3_f32 v246, v24, v25, v26
    v_max3_f32 v244, v244, v19, v20
    v_max3_f32 v246, v246, v27, v28
    v_max3_f32 v244, v244, v21, v22
    v_mfma_f32_16x16x32_bf16 v[36:39], a[144:147], v[192:195], 0
    v_max3_f32 v246, v246, v29, v30
    v_max_f32 v244, v244, v23
    v_max_f32 v246, v246, v31
    v_mov_b32 v245, v244
    v_mfma_f32_16x16x32_bf16 v[36:39], a[148:151], v[196:199], v[36:39]
    v_mov_b32 v247, v246
    v_nop
    v_permlane32_swap_b32 v244, v245
    v_permlane32_swap_b32 v246, v247
    v_max_f32 v244, v244, v245
    v_mfma_f32_16x16x32_bf16 v[36:39], a[152:155], v[200:203], v[36:39]
    v_max_f32 v246, v246, v247
    v_mov_b32 v245, v244
    v_mov_b32 v247, v246
    v_nop
    v_mfma_f32_16x16x32_bf16 v[36:39], a[156:159], v[204:207], v[36:39]
    v_permlane16_swap_b32 v244, v245
    v_permlane16_swap_b32 v246, v247
    v_max_f32 v244, v244, v245
    v_max_f32 v246, v246, v247
    v_mfma_f32_16x16x32_bf16 v[40:43], a[128:131], v[208:211], 0
    ds_read_b128 a[128:131], v224 offset:49152
    v_add_f32 v244, s38, v244
    v_add_f32 v246, s38, v246
    v_sub_f32 v80, 0, v244
    v_mfma_f32_16x16x32_bf16 v[40:43], a[132:135], v[212:215], v[40:43]
    ds_read_b128 a[132:135], v225 offset:49152
    v_sub_f32 v84, 0, v246
    v_sub_f32 v81, 0, v244
    v_sub_f32 v85, 0, v246
    v_sub_f32 v82, 0, v244
    v_mfma_f32_16x16x32_bf16 v[40:43], a[136:139], v[216:219], v[40:43]
    ds_read_b128 a[136:139], v226 offset:49152
    v_sub_f32 v86, 0, v246
    v_sub_f32 v83, 0, v244
    v_sub_f32 v87, 0, v246
    v_mfma_f32_16x16x32_bf16 v[40:43], a[140:143], v[220:223], v[40:43]
    ds_read_b128 a[140:143], v227 offset:49152
    v_sub_f32 v16, v16, v244
    v_sub_f32 v24, v24, v246
    v_sub_f32 v17, v17, v244
    v_mfma_f32_16x16x32_bf16 v[44:47], a[144:147], v[208:211], 0
    ds_read_b128 a[144:147], v224 offset:57344
    v_sub_f32 v25, v25, v246
    v_sub_f32 v18, v18, v244
    v_sub_f32 v26, v26, v246
    v_mfma_f32_16x16x32_bf16 v[44:47], a[148:151], v[212:215], v[44:47]
    ds_read_b128 a[148:151], v225 offset:57344
    v_sub_f32 v19, v19, v244
    v_sub_f32 v27, v27, v246
    v_sub_f32 v20, v20, v244
    v_sub_f32 v28, v28, v246
    v_mfma_f32_16x16x32_bf16 v[44:47], a[152:155], v[216:219], v[44:47]
    ds_read_b128 a[152:155], v226 offset:57344
    v_sub_f32 v21, v21, v244
    v_sub_f32 v29, v29, v246
    v_sub_f32 v22, v22, v244
    v_mfma_f32_16x16x32_bf16 v[44:47], a[156:159], v[220:223], v[44:47]
    ds_read_b128 a[156:159], v227 offset:57344
    v_sub_f32 v30, v30, v246
    v_sub_f32 v23, v23, v244
    v_sub_f32 v31, v31, v246
    v_accvgpr_read_b32 v1, a167
    v_accvgpr_read_b32 v2, a168
    s_add_u32 s56, s56, s57
    s_xor_b32 s57, s57, s58
    buffer_load_dword a200, v14, s[52:55], s54 offen
    v_mov_b32 v144, 0
    v_mov_b32 v145, 0
    v_mov_b32 v146, 0
    v_mov_b32 v147, 0
    s_add_u32 m0, s37, 65536
    s_mov_b32 s27, 49152
    buffer_load_dwordx4 v10, s[8:11], s27 offen lds
    v_mov_b32 v148, 0
    v_mov_b32 v149, 0
    v_mov_b32 v150, 0
    v_mov_b32 v151, 0
    buffer_load_dwordx4 v11, s[8:11], s27 offen offset:1024 lds
    v_mov_b32 v152, 0
    v_mov_b32 v153, 0
    v_mov_b32 v154, 0
    v_mov_b32 v155, 0
    buffer_load_dwordx4 v12, s[12:15], s27 offen offset:2048 lds
    v_mov_b32 v156, 0
    v_mov_b32 v157, 0
    v_mov_b32 v158, 0
    v_mov_b32 v159, 0
    buffer_load_dwordx4 v13, s[12:15], s27 offen offset:3072 lds
    v_mov_b32 v96, 0
    v_mov_b32 v97, 0
    v_mov_b32 v98, 0
    v_mov_b32 v99, 0
    s_add_u32 m0, s37, 81920
    s_mov_b32 s27, 57344
    buffer_load_dwordx4 v10, s[8:11], s27 offen lds
    v_mov_b32 v100, 0
    v_mov_b32 v101, 0
    v_mov_b32 v102, 0
    v_mov_b32 v103, 0
    buffer_load_dwordx4 v11, s[8:11], s27 offen offset:1024 lds
    buffer_load_dwordx4 v12, s[12:15], s27 offen offset:2048 lds
    buffer_load_dwordx4 v13, s[12:15], s27 offen offset:3072 lds
    v_max3_f32 v244, v32, v33, v34
    v_max3_f32 v246, v40, v41, v42
    v_max3_f32 v244, v244, v35, v36
    v_max3_f32 v246, v246, v43, v44
    v_max3_f32 v244, v244, v37, v38
    v_max3_f32 v246, v246, v45, v46
    v_max_f32 v244, v244, v39
    v_max_f32 v246, v246, v47
    v_mov_b32 v245, v244
    v_mov_b32 v247, v246
    v_nop
    v_permlane32_swap_b32 v244, v245
    v_permlane32_swap_b32 v246, v247
    v_max_f32 v244, v244, v245
    v_max_f32 v246, v246, v247
    v_mov_b32 v245, v244
    v_mov_b32 v247, v246
    v_nop
    v_permlane16_swap_b32 v244, v245
    v_permlane16_swap_b32 v246, v247
    v_max_f32 v244, v244, v245
    v_max_f32 v246, v246, v247
    v_add_f32 v244, s38, v244
    v_add_f32 v246, s38, v246
    v_sub_f32 v88, 0, v244
    v_sub_f32 v92, 0, v246
    v_sub_f32 v89, 0, v244
    v_sub_f32 v93, 0, v246
    v_sub_f32 v90, 0, v244
    v_sub_f32 v94, 0, v246
    v_sub_f32 v91, 0, v244
    v_sub_f32 v95, 0, v246
    v_sub_f32 v32, v32, v244
    v_sub_f32 v40, v40, v246
    v_sub_f32 v33, v33, v244
    v_sub_f32 v41, v41, v246
    v_sub_f32 v34, v34, v244
    v_sub_f32 v42, v42, v246
    v_sub_f32 v35, v35, v244
    v_sub_f32 v43, v43, v246
    v_sub_f32 v36, v36, v244
    v_sub_f32 v44, v44, v246
    v_sub_f32 v37, v37, v244
    v_sub_f32 v45, v45, v246
    v_sub_f32 v38, v38, v244
    v_sub_f32 v46, v46, v246
    v_sub_f32 v39, v39, v244
    v_sub_f32 v47, v47, v246
    s_mov_b32 s27, 57344
    s_mov_b32 s6, 8192
    s_mov_b32 s7, 8192
    s_mov_b32 s3, 548864
    s_add_u32 s28, s37, 0x10000
    v_xor_b32 v224, 0x10000, v224
    v_xor_b32 v225, 0x10000, v225
    v_xor_b32 v226, 0x10000, v226
    v_xor_b32 v227, 0x10000, v227
    s_waitcnt vmcnt(18) lgkmcnt(0)
    s_barrier
    .p2align 6
LOOP_adaLN_cond__gqa_block_cached__glu_gated_geglu__prompt_kernel:
    v_mfma_f32_16x16x32_bf16 v[48:51], a[128:131], v[160:163], v[80:83]
    v_exp_f32 v236, v16 clamp
    v_mfma_f32_16x16x32_bf16 v[48:51], a[132:135], v[164:167], v[48:51]
    v_exp_f32 v237, v17 clamp
    v_mfma_f32_16x16x32_bf16 v[48:51], a[136:139], v[168:171], v[48:51]
    ds_read_b64_tr_b16 a[160:161], v228 offset:0
    v_cvt_pk_bf16_f32 v128, v236, v237
    v_mfma_f32_16x16x32_bf16 v[48:51], a[140:143], v[172:175], v[48:51]
    ds_read_b64_tr_b16 a[162:163], v228 offset:8192
    ds_read_b64_tr_b16 a[164:165], v229 offset:0
    v_mfma_f32_16x16x32_bf16 v[52:55], a[144:147], v[160:163], v[80:83]
    v_exp_f32 v238, v18 clamp
    v_mfma_f32_16x16x32_bf16 v[52:55], a[148:151], v[164:167], v[52:55]
    s_add_u32 m0, s28, 32768
    v_exp_f32 v239, v19 clamp
    v_mfma_f32_16x16x32_bf16 v[52:55], a[152:155], v[168:171], v[52:55]
    s_add_u32 s27, s27, s6
    ds_read_b64_tr_b16 a[166:167], v229 offset:8192
    v_cvt_pk_bf16_f32 v129, v238, v239
    v_mfma_f32_16x16x32_bf16 v[52:55], a[156:159], v[172:175], v[52:55]
    buffer_load_dwordx4 v10, s[8:11], s27 offen lds
    v_mfma_f32_16x16x32_bf16 v[56:59], a[128:131], v[176:179], v[84:87]
    v_exp_f32 v236, v20 clamp
    v_mfma_f32_16x16x32_bf16 v[56:59], a[132:135], v[180:183], v[56:59]
    v_exp_f32 v237, v21 clamp
    v_mfma_f32_16x16x32_bf16 v[56:59], a[136:139], v[184:187], v[56:59]
    ds_read_b64_tr_b16 a[168:169], v230 offset:0
    v_cvt_pk_bf16_f32 v130, v236, v237
    v_mfma_f32_16x16x32_bf16 v[56:59], a[140:143], v[188:191], v[56:59]
    ds_read_b64_tr_b16 a[170:171], v230 offset:8192
    ds_read_b64_tr_b16 a[172:173], v231 offset:0
    v_mfma_f32_16x16x32_bf16 v[60:63], a[144:147], v[176:179], v[84:87]
    v_exp_f32 v238, v22 clamp
    v_mfma_f32_16x16x32_bf16 v[60:63], a[148:151], v[180:183], v[60:63]
    v_exp_f32 v239, v23 clamp
    v_mfma_f32_16x16x32_bf16 v[60:63], a[152:155], v[184:187], v[60:63]
    ds_read_b64_tr_b16 a[174:175], v231 offset:8192
    v_cvt_pk_bf16_f32 v131, v238, v239
    v_mfma_f32_16x16x32_bf16 v[60:63], a[156:159], v[188:191], v[60:63]
    v_exp_f32 v236, v24 clamp
    v_mfma_f32_16x16x32_bf16 v[64:67], a[128:131], v[192:195], v[88:91]
    v_exp_f32 v237, v25 clamp
    v_mfma_f32_16x16x32_bf16 v[64:67], a[132:135], v[196:199], v[64:67]
    ds_read_b64_tr_b16 a[176:177], v232 offset:0
    v_cvt_pk_bf16_f32 v132, v236, v237
    v_mfma_f32_16x16x32_bf16 v[64:67], a[136:139], v[200:203], v[64:67]
    ds_read_b64_tr_b16 a[178:179], v232 offset:8192
    ds_read_b64_tr_b16 a[180:181], v233 offset:0
    v_mfma_f32_16x16x32_bf16 v[64:67], a[140:143], v[204:207], v[64:67]
    v_exp_f32 v238, v26 clamp
    v_mfma_f32_16x16x32_bf16 v[68:71], a[144:147], v[192:195], v[88:91]
    v_exp_f32 v239, v27 clamp
    v_mfma_f32_16x16x32_bf16 v[68:71], a[148:151], v[196:199], v[68:71]
    ds_read_b64_tr_b16 a[182:183], v233 offset:8192
    v_cvt_pk_bf16_f32 v133, v238, v239
    v_mfma_f32_16x16x32_bf16 v[68:71], a[152:155], v[200:203], v[68:71]
    buffer_load_dwordx4 v11, s[8:11], s27 offen offset:1024 lds
    v_mfma_f32_16x16x32_bf16 v[68:71], a[156:159], v[204:207], v[68:71]
    v_exp_f32 v236, v28 clamp
    v_mfma_f32_16x16x32_bf16 v[72:75], a[128:131], v[208:211], v[92:95]
    v_exp_f32 v237, v29 clamp
    v_mfma_f32_16x16x32_bf16 v[72:75], a[132:135], v[212:215], v[72:75]
    ds_read_b64_tr_b16 a[184:185], v234 offset:0
    v_cvt_pk_bf16_f32 v134, v236, v237
    v_mfma_f32_16x16x32_bf16 v[72:75], a[136:139], v[216:219], v[72:75]
    ds_read_b64_tr_b16 a[186:187], v234 offset:8192
    ds_read_b64_tr_b16 a[188:189], v235 offset:0
    v_mfma_f32_16x16x32_bf16 v[72:75], a[140:143], v[220:223], v[72:75]
    v_exp_f32 v238, v30 clamp
    v_mfma_f32_16x16x32_bf16 v[76:79], a[144:147], v[208:211], v[92:95]
    v_exp_f32 v239, v31 clamp
    v_mfma_f32_16x16x32_bf16 v[76:79], a[148:151], v[212:215], v[76:79]
    ds_read_b64_tr_b16 a[190:191], v235 offset:8192
    v_cvt_pk_bf16_f32 v135, v238, v239
    v_mfma_f32_16x16x32_bf16 v[76:79], a[152:155], v[216:219], v[76:79]
    v_exp_f32 v236, v32 clamp
    v_smfmac_f32_16x16x64_bf16 v[96:99], a[192:195], v[128:135], v104
    v_exp_f32 v237, v33 clamp
    v_mfma_f32_16x16x32_bf16 v[76:79], a[156:159], v[220:223], v[76:79]
    s_waitcnt lgkmcnt(8)
    ds_read_b128 a[128:131], v224 offset:0
    v_cvt_pk_bf16_f32 v136, v236, v237
    v_mfma_f32_16x16x32_bf16 a[0:3], a[160:163], v[144:147], a[0:3]
    v_exp_f32 v238, v34 clamp
    v_mfma_f32_16x16x32_bf16 a[4:7], a[160:163], v[148:151], a[4:7]
    v_exp_f32 v239, v35 clamp
    v_mfma_f32_16x16x32_bf16 a[8:11], a[160:163], v[152:155], a[8:11]
    ds_read_b128 a[132:135], v225 offset:0
    v_cvt_pk_bf16_f32 v137, v238, v239
    v_mfma_f32_16x16x32_bf16 a[12:15], a[160:163], v[156:159], a[12:15]
    buffer_load_dwordx4 v12, s[12:15], s27 offen offset:2048 lds
    v_mfma_f32_16x16x32_bf16 a[28:31], a[164:167], v[156:159], a[28:31]
    v_exp_f32 v236, v36 clamp
    v_mfma_f32_16x16x32_bf16 a[24:27], a[164:167], v[152:155], a[24:27]
    v_exp_f32 v237, v37 clamp
    v_mfma_f32_16x16x32_bf16 a[20:23], a[164:167], v[148:151], a[20:23]
    ds_read_b128 a[136:139], v226 offset:0
    v_cvt_pk_bf16_f32 v138, v236, v237
    v_mfma_f32_16x16x32_bf16 a[16:19], a[164:167], v[144:147], a[16:19]
    v_exp_f32 v238, v38 clamp
    v_mfma_f32_16x16x32_bf16 a[32:35], a[168:171], v[144:147], a[32:35]
    v_exp_f32 v239, v39 clamp
    v_mfma_f32_16x16x32_bf16 a[36:39], a[168:171], v[148:151], a[36:39]
    ds_read_b128 a[140:143], v227 offset:0
    v_cvt_pk_bf16_f32 v139, v238, v239
    v_mfma_f32_16x16x32_bf16 a[40:43], a[168:171], v[152:155], a[40:43]
    v_exp_f32 v236, v40 clamp
    v_mfma_f32_16x16x32_bf16 a[44:47], a[168:171], v[156:159], a[44:47]
    v_exp_f32 v237, v41 clamp
    v_mfma_f32_16x16x32_bf16 a[60:63], a[172:175], v[156:159], a[60:63]
    ds_read_b128 a[144:147], v224 offset:8192
    v_cvt_pk_bf16_f32 v140, v236, v237
    v_mfma_f32_16x16x32_bf16 a[56:59], a[172:175], v[152:155], a[56:59]
    v_exp_f32 v238, v42 clamp
    v_mfma_f32_16x16x32_bf16 a[52:55], a[172:175], v[148:151], a[52:55]
    v_exp_f32 v239, v43 clamp
    v_mfma_f32_16x16x32_bf16 a[48:51], a[172:175], v[144:147], a[48:51]
    s_waitcnt lgkmcnt(5)
    ds_read_b128 a[148:151], v225 offset:8192
    v_cvt_pk_bf16_f32 v141, v238, v239
    v_mfma_f32_16x16x32_bf16 a[64:67], a[176:179], v[144:147], a[64:67]
    buffer_load_dwordx4 v13, s[12:15], s27 offen offset:3072 lds
    v_mfma_f32_16x16x32_bf16 a[68:71], a[176:179], v[148:151], a[68:71]
    v_exp_f32 v236, v44 clamp
    v_mfma_f32_16x16x32_bf16 a[72:75], a[176:179], v[152:155], a[72:75]
    v_exp_f32 v237, v45 clamp
    v_mfma_f32_16x16x32_bf16 a[76:79], a[176:179], v[156:159], a[76:79]
    ds_read_b128 a[152:155], v226 offset:8192
    v_cvt_pk_bf16_f32 v142, v236, v237
    v_mfma_f32_16x16x32_bf16 a[92:95], a[180:183], v[156:159], a[92:95]
    v_exp_f32 v238, v46 clamp
    v_mfma_f32_16x16x32_bf16 a[88:91], a[180:183], v[152:155], a[88:91]
    v_exp_f32 v239, v47 clamp
    v_mfma_f32_16x16x32_bf16 a[84:87], a[180:183], v[148:151], a[84:87]
    ds_read_b128 a[156:159], v227 offset:8192
    v_cvt_pk_bf16_f32 v143, v238, v239
    v_mfma_f32_16x16x32_bf16 a[80:83], a[180:183], v[144:147], a[80:83]
    s_nop 0
    v_smfmac_f32_16x16x64_bf16 v[100:103], a[192:195], v[136:143], v104
    s_mov_b32 m0, s39
    v_mfma_f32_16x16x32_bf16 a[96:99], a[184:187], v[144:147], a[96:99]
    s_xor_b32 s39, s39, 4096
    v_mfma_f32_16x16x32_bf16 a[100:103], a[184:187], v[148:151], a[100:103]
    buffer_load_dwordx4 v1, s[52:55], s56 offen lds
    v_mfma_f32_16x16x32_bf16 a[104:107], a[184:187], v[152:155], a[104:107]
    s_add_u32 s56, s56, s57
    s_waitcnt lgkmcnt(0)
    v_mfma_f32_16x16x32_bf16 a[108:111], a[184:187], v[156:159], a[108:111]
    s_xor_b32 s57, s57, s58
    v_mfma_f32_16x16x32_bf16 a[124:127], a[188:191], v[156:159], a[124:127]
    v_mfma_f32_16x16x32_bf16 a[120:123], a[188:191], v[152:155], a[120:123]
    v_max_f32 v244, v96, v100
    v_cmp_lt_f32 vcc, s31, v244
    v_mfma_f32_16x16x32_bf16 a[116:119], a[188:191], v[148:151], a[116:119]
    v_mfma_f32_16x16x32_bf16 a[112:115], a[188:191], v[144:147], a[112:115]
    s_cbranch_vccnz SLOW0_adaLN_cond__gqa_block_cached__glu_gated_geglu__prompt_kernel
BACK0_adaLN_cond__gqa_block_cached__glu_gated_geglu__prompt_kernel:
    v_mfma_f32_16x16x32_bf16 v[16:19], a[128:131], v[160:163], v[80:83]
    v_exp_f32 v236, v48 clamp
    v_mfma_f32_16x16x32_bf16 v[16:19], a[132:135], v[164:167], v[16:19]
    v_exp_f32 v237, v49 clamp
    v_mfma_f32_16x16x32_bf16 v[16:19], a[136:139], v[168:171], v[16:19]
    ds_read_b64_tr_b16 a[160:161], v228 offset:16384
    v_cvt_pk_bf16_f32 v144, v236, v237
    v_mfma_f32_16x16x32_bf16 v[16:19], a[140:143], v[172:175], v[16:19]
    ds_read_b64_tr_b16 a[162:163], v228 offset:24576
    ds_read_b64_tr_b16 a[164:165], v229 offset:16384
    v_mfma_f32_16x16x32_bf16 v[20:23], a[144:147], v[160:163], v[80:83]
    v_exp_f32 v238, v50 clamp
    v_mfma_f32_16x16x32_bf16 v[20:23], a[148:151], v[164:167], v[20:23]
    s_add_u32 m0, s28, 49152
    v_exp_f32 v239, v51 clamp
    v_mfma_f32_16x16x32_bf16 v[20:23], a[152:155], v[168:171], v[20:23]
    s_add_u32 s27, s27, s7
    ds_read_b64_tr_b16 a[166:167], v229 offset:24576
    v_cvt_pk_bf16_f32 v145, v238, v239
    v_mfma_f32_16x16x32_bf16 v[20:23], a[156:159], v[172:175], v[20:23]
    buffer_load_dwordx4 v10, s[8:11], s27 offen lds
    v_mfma_f32_16x16x32_bf16 v[24:27], a[128:131], v[176:179], v[84:87]
    v_exp_f32 v236, v52 clamp
    v_mfma_f32_16x16x32_bf16 v[24:27], a[132:135], v[180:183], v[24:27]
    v_exp_f32 v237, v53 clamp
    v_mfma_f32_16x16x32_bf16 v[24:27], a[136:139], v[184:187], v[24:27]
    ds_read_b64_tr_b16 a[168:169], v230 offset:16384
    v_cvt_pk_bf16_f32 v146, v236, v237
    v_mfma_f32_16x16x32_bf16 v[24:27], a[140:143], v[188:191], v[24:27]
    ds_read_b64_tr_b16 a[170:171], v230 offset:24576
    ds_read_b64_tr_b16 a[172:173], v231 offset:16384
    v_mfma_f32_16x16x32_bf16 v[28:31], a[144:147], v[176:179], v[84:87]
    v_exp_f32 v238, v54 clamp
    v_mfma_f32_16x16x32_bf16 v[28:31], a[148:151], v[180:183], v[28:31]
    v_exp_f32 v239, v55 clamp
    v_mfma_f32_16x16x32_bf16 v[28:31], a[152:155], v[184:187], v[28:31]
    ds_read_b64_tr_b16 a[174:175], v231 offset:24576
    v_cvt_pk_bf16_f32 v147, v238, v239
    v_mfma_f32_16x16x32_bf16 v[28:31], a[156:159], v[188:191], v[28:31]
    v_exp_f32 v236, v56 clamp
    v_mfma_f32_16x16x32_bf16 v[32:35], a[128:131], v[192:195], v[88:91]
    v_exp_f32 v237, v57 clamp
    v_mfma_f32_16x16x32_bf16 v[32:35], a[132:135], v[196:199], v[32:35]
    ds_read_b64_tr_b16 a[176:177], v232 offset:16384
    v_cvt_pk_bf16_f32 v148, v236, v237
    v_mfma_f32_16x16x32_bf16 v[32:35], a[136:139], v[200:203], v[32:35]
    ds_read_b64_tr_b16 a[178:179], v232 offset:24576
    ds_read_b64_tr_b16 a[180:181], v233 offset:16384
    v_mfma_f32_16x16x32_bf16 v[32:35], a[140:143], v[204:207], v[32:35]
    v_exp_f32 v238, v58 clamp
    v_mfma_f32_16x16x32_bf16 v[36:39], a[144:147], v[192:195], v[88:91]
    v_exp_f32 v239, v59 clamp
    v_mfma_f32_16x16x32_bf16 v[36:39], a[148:151], v[196:199], v[36:39]
    ds_read_b64_tr_b16 a[182:183], v233 offset:24576
    v_cvt_pk_bf16_f32 v149, v238, v239
    v_mfma_f32_16x16x32_bf16 v[36:39], a[152:155], v[200:203], v[36:39]
    buffer_load_dwordx4 v11, s[8:11], s27 offen offset:1024 lds
    v_mfma_f32_16x16x32_bf16 v[36:39], a[156:159], v[204:207], v[36:39]
    v_exp_f32 v236, v60 clamp
    v_mfma_f32_16x16x32_bf16 v[40:43], a[128:131], v[208:211], v[92:95]
    v_exp_f32 v237, v61 clamp
    v_mfma_f32_16x16x32_bf16 v[40:43], a[132:135], v[212:215], v[40:43]
    ds_read_b64_tr_b16 a[184:185], v234 offset:16384
    v_cvt_pk_bf16_f32 v150, v236, v237
    v_mfma_f32_16x16x32_bf16 v[40:43], a[136:139], v[216:219], v[40:43]
    ds_read_b64_tr_b16 a[186:187], v234 offset:24576
    ds_read_b64_tr_b16 a[188:189], v235 offset:16384
    v_mfma_f32_16x16x32_bf16 v[40:43], a[140:143], v[220:223], v[40:43]
    v_exp_f32 v238, v62 clamp
    v_mfma_f32_16x16x32_bf16 v[44:47], a[144:147], v[208:211], v[92:95]
    v_exp_f32 v239, v63 clamp
    v_mfma_f32_16x16x32_bf16 v[44:47], a[148:151], v[212:215], v[44:47]
    ds_read_b64_tr_b16 a[190:191], v235 offset:24576
    v_cvt_pk_bf16_f32 v151, v238, v239
    v_mfma_f32_16x16x32_bf16 v[44:47], a[152:155], v[216:219], v[44:47]
    v_exp_f32 v236, v64 clamp
    v_smfmac_f32_16x16x64_bf16 v[96:99], a[192:195], v[144:151], v104
    v_exp_f32 v237, v65 clamp
    v_mfma_f32_16x16x32_bf16 v[44:47], a[156:159], v[220:223], v[44:47]
    s_waitcnt lgkmcnt(8)
    ds_read_b128 a[128:131], v224 offset:16384
    v_cvt_pk_bf16_f32 v152, v236, v237
    v_mfma_f32_16x16x32_bf16 a[0:3], a[160:163], v[128:131], a[0:3]
    v_exp_f32 v238, v66 clamp
    v_mfma_f32_16x16x32_bf16 a[4:7], a[160:163], v[132:135], a[4:7]
    v_exp_f32 v239, v67 clamp
    v_mfma_f32_16x16x32_bf16 a[8:11], a[160:163], v[136:139], a[8:11]
    ds_read_b128 a[132:135], v225 offset:16384
    v_cvt_pk_bf16_f32 v153, v238, v239
    v_mfma_f32_16x16x32_bf16 a[12:15], a[160:163], v[140:143], a[12:15]
    buffer_load_dwordx4 v12, s[12:15], s27 offen offset:2048 lds
    v_mfma_f32_16x16x32_bf16 a[28:31], a[164:167], v[140:143], a[28:31]
    v_exp_f32 v236, v68 clamp
    v_mfma_f32_16x16x32_bf16 a[24:27], a[164:167], v[136:139], a[24:27]
    v_exp_f32 v237, v69 clamp
    v_mfma_f32_16x16x32_bf16 a[20:23], a[164:167], v[132:135], a[20:23]
    ds_read_b128 a[136:139], v226 offset:16384
    v_cvt_pk_bf16_f32 v154, v236, v237
    v_mfma_f32_16x16x32_bf16 a[16:19], a[164:167], v[128:131], a[16:19]
    v_exp_f32 v238, v70 clamp
    v_mfma_f32_16x16x32_bf16 a[32:35], a[168:171], v[128:131], a[32:35]
    v_exp_f32 v239, v71 clamp
    v_mfma_f32_16x16x32_bf16 a[36:39], a[168:171], v[132:135], a[36:39]
    ds_read_b128 a[140:143], v227 offset:16384
    v_cvt_pk_bf16_f32 v155, v238, v239
    v_mfma_f32_16x16x32_bf16 a[40:43], a[168:171], v[136:139], a[40:43]
    v_exp_f32 v236, v72 clamp
    v_mfma_f32_16x16x32_bf16 a[44:47], a[168:171], v[140:143], a[44:47]
    v_exp_f32 v237, v73 clamp
    v_mfma_f32_16x16x32_bf16 a[60:63], a[172:175], v[140:143], a[60:63]
    ds_read_b128 a[144:147], v224 offset:24576
    v_cvt_pk_bf16_f32 v156, v236, v237
    v_mfma_f32_16x16x32_bf16 a[56:59], a[172:175], v[136:139], a[56:59]
    v_exp_f32 v238, v74 clamp
    v_mfma_f32_16x16x32_bf16 a[52:55], a[172:175], v[132:135], a[52:55]
    v_exp_f32 v239, v75 clamp
    v_mfma_f32_16x16x32_bf16 a[48:51], a[172:175], v[128:131], a[48:51]
    s_waitcnt lgkmcnt(5)
    ds_read_b128 a[148:151], v225 offset:24576
    v_cvt_pk_bf16_f32 v157, v238, v239
    v_mfma_f32_16x16x32_bf16 a[64:67], a[176:179], v[128:131], a[64:67]
    buffer_load_dwordx4 v13, s[12:15], s27 offen offset:3072 lds
    v_mfma_f32_16x16x32_bf16 a[68:71], a[176:179], v[132:135], a[68:71]
    v_exp_f32 v236, v76 clamp
    v_mfma_f32_16x16x32_bf16 a[72:75], a[176:179], v[136:139], a[72:75]
    v_exp_f32 v237, v77 clamp
    v_mfma_f32_16x16x32_bf16 a[76:79], a[176:179], v[140:143], a[76:79]
    ds_read_b128 a[152:155], v226 offset:24576
    v_cvt_pk_bf16_f32 v158, v236, v237
    v_mfma_f32_16x16x32_bf16 a[92:95], a[180:183], v[140:143], a[92:95]
    v_exp_f32 v238, v78 clamp
    v_mfma_f32_16x16x32_bf16 a[88:91], a[180:183], v[136:139], a[88:91]
    v_exp_f32 v239, v79 clamp
    v_mfma_f32_16x16x32_bf16 a[84:87], a[180:183], v[132:135], a[84:87]
    ds_read_b128 a[156:159], v227 offset:24576
    v_cvt_pk_bf16_f32 v159, v238, v239
    v_mfma_f32_16x16x32_bf16 a[80:83], a[180:183], v[128:131], a[80:83]
    s_nop 0
    v_smfmac_f32_16x16x64_bf16 v[100:103], a[192:195], v[152:159], v104
    v_mfma_f32_16x16x32_bf16 a[96:99], a[184:187], v[128:131], a[96:99]
    v_mfma_f32_16x16x32_bf16 a[100:103], a[184:187], v[132:135], a[100:103]
    v_mfma_f32_16x16x32_bf16 a[104:107], a[184:187], v[136:139], a[104:107]
    s_waitcnt vmcnt(18) lgkmcnt(0)
    v_mfma_f32_16x16x32_bf16 a[108:111], a[184:187], v[140:143], a[108:111]
    s_barrier
    v_mfma_f32_16x16x32_bf16 a[124:127], a[188:191], v[140:143], a[124:127]
    v_mfma_f32_16x16x32_bf16 a[120:123], a[188:191], v[136:139], a[120:123]
    v_max_f32 v244, v96, v100
    v_cmp_lt_f32 vcc, s31, v244
    v_mfma_f32_16x16x32_bf16 a[116:119], a[188:191], v[132:135], a[116:119]
    v_mfma_f32_16x16x32_bf16 a[112:115], a[188:191], v[128:131], a[112:115]
    s_cbranch_vccnz SLOW1_adaLN_cond__gqa_block_cached__glu_gated_geglu__prompt_kernel
BACK1_adaLN_cond__gqa_block_cached__glu_gated_geglu__prompt_kernel:
    v_mfma_f32_16x16x32_bf16 v[48:51], a[128:131], v[160:163], v[80:83]
    v_exp_f32 v236, v16 clamp
    v_mfma_f32_16x16x32_bf16 v[48:51], a[132:135], v[164:167], v[48:51]
    v_exp_f32 v237, v17 clamp
    v_mfma_f32_16x16x32_bf16 v[48:51], a[136:139], v[168:171], v[48:51]
    ds_read_b64_tr_b16 a[160:161], v228 offset:32768
    v_cvt_pk_bf16_f32 v128, v236, v237
    v_mfma_f32_16x16x32_bf16 v[48:51], a[140:143], v[172:175], v[48:51]
    ds_read_b64_tr_b16 a[162:163], v228 offset:40960
    ds_read_b64_tr_b16 a[164:165], v229 offset:32768
    v_mfma_f32_16x16x32_bf16 v[52:55], a[144:147], v[160:163], v[80:83]
    s_xor_b32 s28, s28, 0x10000
    v_exp_f32 v238, v18 clamp
    v_mfma_f32_16x16x32_bf16 v[52:55], a[148:151], v[164:167], v[52:55]
    s_add_u32 m0, s28, 0
    v_exp_f32 v239, v19 clamp
    v_mfma_f32_16x16x32_bf16 v[52:55], a[152:155], v[168:171], v[52:55]
    s_add_u32 s27, s27, s6
    ds_read_b64_tr_b16 a[166:167], v229 offset:40960
    v_cvt_pk_bf16_f32 v129, v238, v239
    v_mfma_f32_16x16x32_bf16 v[52:55], a[156:159], v[172:175], v[52:55]
    buffer_load_dwordx4 v10, s[8:11], s27 offen lds
    v_mfma_f32_16x16x32_bf16 v[56:59], a[128:131], v[176:179], v[84:87]
    v_exp_f32 v236, v20 clamp
    v_mfma_f32_16x16x32_bf16 v[56:59], a[132:135], v[180:183], v[56:59]
    v_exp_f32 v237, v21 clamp
    v_mfma_f32_16x16x32_bf16 v[56:59], a[136:139], v[184:187], v[56:59]
    ds_read_b64_tr_b16 a[168:169], v230 offset:32768
    v_cvt_pk_bf16_f32 v130, v236, v237
    v_mfma_f32_16x16x32_bf16 v[56:59], a[140:143], v[188:191], v[56:59]
    ds_read_b64_tr_b16 a[170:171], v230 offset:40960
    ds_read_b64_tr_b16 a[172:173], v231 offset:32768
    v_mfma_f32_16x16x32_bf16 v[60:63], a[144:147], v[176:179], v[84:87]
    v_exp_f32 v238, v22 clamp
    v_mfma_f32_16x16x32_bf16 v[60:63], a[148:151], v[180:183], v[60:63]
    v_exp_f32 v239, v23 clamp
    v_mfma_f32_16x16x32_bf16 v[60:63], a[152:155], v[184:187], v[60:63]
    ds_read_b64_tr_b16 a[174:175], v231 offset:40960
    v_cvt_pk_bf16_f32 v131, v238, v239
    v_mfma_f32_16x16x32_bf16 v[60:63], a[156:159], v[188:191], v[60:63]
    v_exp_f32 v236, v24 clamp
    v_mfma_f32_16x16x32_bf16 v[64:67], a[128:131], v[192:195], v[88:91]
    v_exp_f32 v237, v25 clamp
    v_mfma_f32_16x16x32_bf16 v[64:67], a[132:135], v[196:199], v[64:67]
    ds_read_b64_tr_b16 a[176:177], v232 offset:32768
    v_cvt_pk_bf16_f32 v132, v236, v237
    v_mfma_f32_16x16x32_bf16 v[64:67], a[136:139], v[200:203], v[64:67]
    ds_read_b64_tr_b16 a[178:179], v232 offset:40960
    ds_read_b64_tr_b16 a[180:181], v233 offset:32768
    v_mfma_f32_16x16x32_bf16 v[64:67], a[140:143], v[204:207], v[64:67]
    v_exp_f32 v238, v26 clamp
    v_mfma_f32_16x16x32_bf16 v[68:71], a[144:147], v[192:195], v[88:91]
    v_exp_f32 v239, v27 clamp
    v_mfma_f32_16x16x32_bf16 v[68:71], a[148:151], v[196:199], v[68:71]
    ds_read_b64_tr_b16 a[182:183], v233 offset:40960
    v_cvt_pk_bf16_f32 v133, v238, v239
    v_mfma_f32_16x16x32_bf16 v[68:71], a[152:155], v[200:203], v[68:71]
    buffer_load_dwordx4 v11, s[8:11], s27 offen offset:1024 lds
    v_mfma_f32_16x16x32_bf16 v[68:71], a[156:159], v[204:207], v[68:71]
    v_exp_f32 v236, v28 clamp
    v_mfma_f32_16x16x32_bf16 v[72:75], a[128:131], v[208:211], v[92:95]
    v_exp_f32 v237, v29 clamp
    v_mfma_f32_16x16x32_bf16 v[72:75], a[132:135], v[212:215], v[72:75]
    ds_read_b64_tr_b16 a[184:185], v234 offset:32768
    v_cvt_pk_bf16_f32 v134, v236, v237
    v_mfma_f32_16x16x32_bf16 v[72:75], a[136:139], v[216:219], v[72:75]
    ds_read_b64_tr_b16 a[186:187], v234 offset:40960
    ds_read_b64_tr_b16 a[188:189], v235 offset:32768
    v_mfma_f32_16x16x32_bf16 v[72:75], a[140:143], v[220:223], v[72:75]
    v_exp_f32 v238, v30 clamp
    v_mfma_f32_16x16x32_bf16 v[76:79], a[144:147], v[208:211], v[92:95]
    v_exp_f32 v239, v31 clamp
    v_mfma_f32_16x16x32_bf16 v[76:79], a[148:151], v[212:215], v[76:79]
    ds_read_b64_tr_b16 a[190:191], v235 offset:40960
    v_cvt_pk_bf16_f32 v135, v238, v239
    v_mfma_f32_16x16x32_bf16 v[76:79], a[152:155], v[216:219], v[76:79]
    v_exp_f32 v236, v32 clamp
    v_smfmac_f32_16x16x64_bf16 v[96:99], a[192:195], v[128:135], v104
    v_exp_f32 v237, v33 clamp
    v_mfma_f32_16x16x32_bf16 v[76:79], a[156:159], v[220:223], v[76:79]
    s_waitcnt lgkmcnt(8)
    ds_read_b128 a[128:131], v224 offset:32768
    v_cvt_pk_bf16_f32 v136, v236, v237
    v_mfma_f32_16x16x32_bf16 a[0:3], a[160:163], v[144:147], a[0:3]
    v_exp_f32 v238, v34 clamp
    v_mfma_f32_16x16x32_bf16 a[4:7], a[160:163], v[148:151], a[4:7]
    v_exp_f32 v239, v35 clamp
    v_mfma_f32_16x16x32_bf16 a[8:11], a[160:163], v[152:155], a[8:11]
    ds_read_b128 a[132:135], v225 offset:32768
    v_cvt_pk_bf16_f32 v137, v238, v239
    v_mfma_f32_16x16x32_bf16 a[12:15], a[160:163], v[156:159], a[12:15]
    buffer_load_dwordx4 v12, s[12:15], s27 offen offset:2048 lds
    v_mfma_f32_16x16x32_bf16 a[28:31], a[164:167], v[156:159], a[28:31]
    v_exp_f32 v236, v36 clamp
    v_mfma_f32_16x16x32_bf16 a[24:27], a[164:167], v[152:155], a[24:27]
    v_exp_f32 v237, v37 clamp
    v_mfma_f32_16x16x32_bf16 a[20:23], a[164:167], v[148:151], a[20:23]
    ds_read_b128 a[136:139], v226 offset:32768
    v_cvt_pk_bf16_f32 v138, v236, v237
    v_mfma_f32_16x16x32_bf16 a[16:19], a[164:167], v[144:147], a[16:19]
    v_exp_f32 v238, v38 clamp
    v_mfma_f32_16x16x32_bf16 a[32:35], a[168:171], v[144:147], a[32:35]
    v_exp_f32 v239, v39 clamp
    v_mfma_f32_16x16x32_bf16 a[36:39], a[168:171], v[148:151], a[36:39]
    ds_read_b128 a[140:143], v227 offset:32768
    v_cvt_pk_bf16_f32 v139, v238, v239
    v_mfma_f32_16x16x32_bf16 a[40:43], a[168:171], v[152:155], a[40:43]
    v_exp_f32 v236, v40 clamp
    v_mfma_f32_16x16x32_bf16 a[44:47], a[168:171], v[156:159], a[44:47]
    v_exp_f32 v237, v41 clamp
    v_mfma_f32_16x16x32_bf16 a[60:63], a[172:175], v[156:159], a[60:63]
    ds_read_b128 a[144:147], v224 offset:40960
    v_cvt_pk_bf16_f32 v140, v236, v237
    v_mfma_f32_16x16x32_bf16 a[56:59], a[172:175], v[152:155], a[56:59]
    v_exp_f32 v238, v42 clamp
    v_mfma_f32_16x16x32_bf16 a[52:55], a[172:175], v[148:151], a[52:55]
    v_exp_f32 v239, v43 clamp
    v_mfma_f32_16x16x32_bf16 a[48:51], a[172:175], v[144:147], a[48:51]
    s_waitcnt lgkmcnt(5)
    ds_read_b128 a[148:151], v225 offset:40960
    v_cvt_pk_bf16_f32 v141, v238, v239
    v_mfma_f32_16x16x32_bf16 a[64:67], a[176:179], v[144:147], a[64:67]
    buffer_load_dwordx4 v13, s[12:15], s27 offen offset:3072 lds
    v_mfma_f32_16x16x32_bf16 a[68:71], a[176:179], v[148:151], a[68:71]
    v_exp_f32 v236, v44 clamp
    v_mfma_f32_16x16x32_bf16 a[72:75], a[176:179], v[152:155], a[72:75]
    v_exp_f32 v237, v45 clamp
    v_mfma_f32_16x16x32_bf16 a[76:79], a[176:179], v[156:159], a[76:79]
    ds_read_b128 a[152:155], v226 offset:40960
    v_cvt_pk_bf16_f32 v142, v236, v237
    v_mfma_f32_16x16x32_bf16 a[92:95], a[180:183], v[156:159], a[92:95]
    v_exp_f32 v238, v46 clamp
    v_mfma_f32_16x16x32_bf16 a[88:91], a[180:183], v[152:155], a[88:91]
    v_exp_f32 v239, v47 clamp
    v_mfma_f32_16x16x32_bf16 a[84:87], a[180:183], v[148:151], a[84:87]
    ds_read_b128 a[156:159], v227 offset:40960
    v_cvt_pk_bf16_f32 v143, v238, v239
    v_mfma_f32_16x16x32_bf16 a[80:83], a[180:183], v[144:147], a[80:83]
    ds_read_b64_tr_b16 a[196:197], v2 offset:0
    ds_read_b64_tr_b16 a[198:199], v2 offset:2048
    v_smfmac_f32_16x16x64_bf16 v[100:103], a[192:195], v[136:143], v104
    v_mfma_f32_16x16x32_bf16 a[96:99], a[184:187], v[144:147], a[96:99]
    v_xor_b32 v2, 0x1000, v2
    v_mfma_f32_16x16x32_bf16 a[100:103], a[184:187], v[148:151], a[100:103]
    v_mfma_f32_16x16x32_bf16 a[104:107], a[184:187], v[152:155], a[104:107]
    s_waitcnt lgkmcnt(0)
    v_mfma_f32_16x16x32_bf16 a[108:111], a[184:187], v[156:159], a[108:111]
    v_mfma_f32_16x16x32_bf16 a[124:127], a[188:191], v[156:159], a[124:127]
    buffer_store_dwordx4 a[196:199], v14, s[20:23], s50 offen sc1
    v_mfma_f32_16x16x32_bf16 a[120:123], a[188:191], v[152:155], a[120:123]
    v_max_f32 v244, v96, v100
    v_cmp_lt_f32 vcc, s31, v244
    v_mfma_f32_16x16x32_bf16 a[116:119], a[188:191], v[148:151], a[116:119]
    v_mfma_f32_16x16x32_bf16 a[112:115], a[188:191], v[144:147], a[112:115]
    s_cbranch_vccnz SLOW2_adaLN_cond__gqa_block_cached__glu_gated_geglu__prompt_kernel
BACK2_adaLN_cond__gqa_block_cached__glu_gated_geglu__prompt_kernel:
    v_mfma_f32_16x16x32_bf16 v[16:19], a[128:131], v[160:163], v[80:83]
    s_add_u32 s50, s50, s51
    v_exp_f32 v236, v48 clamp
    v_mfma_f32_16x16x32_bf16 v[16:19], a[132:135], v[164:167], v[16:19]
    s_xor_b32 s51, s51, s59
    v_exp_f32 v237, v49 clamp
    v_mfma_f32_16x16x32_bf16 v[16:19], a[136:139], v[168:171], v[16:19]
    ds_read_b64_tr_b16 a[160:161], v228 offset:49152
    v_cvt_pk_bf16_f32 v144, v236, v237
    v_mfma_f32_16x16x32_bf16 v[16:19], a[140:143], v[172:175], v[16:19]
    ds_read_b64_tr_b16 a[162:163], v228 offset:57344
    ds_read_b64_tr_b16 a[164:165], v229 offset:49152
    v_mfma_f32_16x16x32_bf16 v[20:23], a[144:147], v[160:163], v[80:83]
    v_exp_f32 v238, v50 clamp
    v_mfma_f32_16x16x32_bf16 v[20:23], a[148:151], v[164:167], v[20:23]
    s_add_u32 m0, s28, 16384
    v_exp_f32 v239, v51 clamp
    v_mfma_f32_16x16x32_bf16 v[20:23], a[152:155], v[168:171], v[20:23]
    s_add_u32 s27, s27, s7
    ds_read_b64_tr_b16 a[166:167], v229 offset:57344
    v_cvt_pk_bf16_f32 v145, v238, v239
    v_mfma_f32_16x16x32_bf16 v[20:23], a[156:159], v[172:175], v[20:23]
    buffer_load_dwordx4 v10, s[8:11], s27 offen lds
    v_mfma_f32_16x16x32_bf16 v[24:27], a[128:131], v[176:179], v[84:87]
    v_exp_f32 v236, v52 clamp
    v_mfma_f32_16x16x32_bf16 v[24:27], a[132:135], v[180:183], v[24:27]
    v_exp_f32 v237, v53 clamp
    v_mfma_f32_16x16x32_bf16 v[24:27], a[136:139], v[184:187], v[24:27]
    ds_read_b64_tr_b16 a[168:169], v230 offset:49152
    v_cvt_pk_bf16_f32 v146, v236, v237
    v_mfma_f32_16x16x32_bf16 v[24:27], a[140:143], v[188:191], v[24:27]
    ds_read_b64_tr_b16 a[170:171], v230 offset:57344
    ds_read_b64_tr_b16 a[172:173], v231 offset:49152
    v_mfma_f32_16x16x32_bf16 v[28:31], a[144:147], v[176:179], v[84:87]
    v_exp_f32 v238, v54 clamp
    v_mfma_f32_16x16x32_bf16 v[28:31], a[148:151], v[180:183], v[28:31]
    v_exp_f32 v239, v55 clamp
    v_mfma_f32_16x16x32_bf16 v[28:31], a[152:155], v[184:187], v[28:31]
    ds_read_b64_tr_b16 a[174:175], v231 offset:57344
    v_cvt_pk_bf16_f32 v147, v238, v239
    v_mfma_f32_16x16x32_bf16 v[28:31], a[156:159], v[188:191], v[28:31]
    v_exp_f32 v236, v56 clamp
    v_mfma_f32_16x16x32_bf16 v[32:35], a[128:131], v[192:195], v[88:91]
    v_exp_f32 v237, v57 clamp
    v_mfma_f32_16x16x32_bf16 v[32:35], a[132:135], v[196:199], v[32:35]
    ds_read_b64_tr_b16 a[176:177], v232 offset:49152
    v_cvt_pk_bf16_f32 v148, v236, v237
    v_mfma_f32_16x16x32_bf16 v[32:35], a[136:139], v[200:203], v[32:35]
    ds_read_b64_tr_b16 a[178:179], v232 offset:57344
    ds_read_b64_tr_b16 a[180:181], v233 offset:49152
    v_mfma_f32_16x16x32_bf16 v[32:35], a[140:143], v[204:207], v[32:35]
    v_exp_f32 v238, v58 clamp
    v_mfma_f32_16x16x32_bf16 v[36:39], a[144:147], v[192:195], v[88:91]
    v_exp_f32 v239, v59 clamp
    v_mfma_f32_16x16x32_bf16 v[36:39], a[148:151], v[196:199], v[36:39]
    ds_read_b64_tr_b16 a[182:183], v233 offset:57344
    v_cvt_pk_bf16_f32 v149, v238, v239
    v_mfma_f32_16x16x32_bf16 v[36:39], a[152:155], v[200:203], v[36:39]
    buffer_load_dwordx4 v11, s[8:11], s27 offen offset:1024 lds
    v_mfma_f32_16x16x32_bf16 v[36:39], a[156:159], v[204:207], v[36:39]
    v_exp_f32 v236, v60 clamp
    v_mfma_f32_16x16x32_bf16 v[40:43], a[128:131], v[208:211], v[92:95]
    v_exp_f32 v237, v61 clamp
    v_mfma_f32_16x16x32_bf16 v[40:43], a[132:135], v[212:215], v[40:43]
    ds_read_b64_tr_b16 a[184:185], v234 offset:49152
    v_cvt_pk_bf16_f32 v150, v236, v237
    v_mfma_f32_16x16x32_bf16 v[40:43], a[136:139], v[216:219], v[40:43]
    ds_read_b64_tr_b16 a[186:187], v234 offset:57344
    ds_read_b64_tr_b16 a[188:189], v235 offset:49152
    v_mfma_f32_16x16x32_bf16 v[40:43], a[140:143], v[220:223], v[40:43]
    v_exp_f32 v238, v62 clamp
    v_mfma_f32_16x16x32_bf16 v[44:47], a[144:147], v[208:211], v[92:95]
    v_exp_f32 v239, v63 clamp
    v_mfma_f32_16x16x32_bf16 v[44:47], a[148:151], v[212:215], v[44:47]
    ds_read_b64_tr_b16 a[190:191], v235 offset:57344
    v_cvt_pk_bf16_f32 v151, v238, v239
    v_mfma_f32_16x16x32_bf16 v[44:47], a[152:155], v[216:219], v[44:47]
    v_exp_f32 v236, v64 clamp
    v_smfmac_f32_16x16x64_bf16 v[96:99], a[192:195], v[144:151], v104
    v_exp_f32 v237, v65 clamp
    v_mfma_f32_16x16x32_bf16 v[44:47], a[156:159], v[220:223], v[44:47]
    s_waitcnt lgkmcnt(8)
    ds_read_b128 a[128:131], v224 offset:49152
    v_cvt_pk_bf16_f32 v152, v236, v237
    v_mfma_f32_16x16x32_bf16 a[0:3], a[160:163], v[128:131], a[0:3]
    v_exp_f32 v238, v66 clamp
    v_mfma_f32_16x16x32_bf16 a[4:7], a[160:163], v[132:135], a[4:7]
    v_exp_f32 v239, v67 clamp
    v_mfma_f32_16x16x32_bf16 a[8:11], a[160:163], v[136:139], a[8:11]
    ds_read_b128 a[132:135], v225 offset:49152
    v_cvt_pk_bf16_f32 v153, v238, v239
    v_mfma_f32_16x16x32_bf16 a[12:15], a[160:163], v[140:143], a[12:15]
    buffer_load_dwordx4 v12, s[12:15], s27 offen offset:2048 lds
    v_mfma_f32_16x16x32_bf16 a[28:31], a[164:167], v[140:143], a[28:31]
    v_exp_f32 v236, v68 clamp
    v_mfma_f32_16x16x32_bf16 a[24:27], a[164:167], v[136:139], a[24:27]
    v_exp_f32 v237, v69 clamp
    v_mfma_f32_16x16x32_bf16 a[20:23], a[164:167], v[132:135], a[20:23]
    ds_read_b128 a[136:139], v226 offset:49152
    v_cvt_pk_bf16_f32 v154, v236, v237
    v_mfma_f32_16x16x32_bf16 a[16:19], a[164:167], v[128:131], a[16:19]
    v_exp_f32 v238, v70 clamp
    v_mfma_f32_16x16x32_bf16 a[32:35], a[168:171], v[128:131], a[32:35]
    v_exp_f32 v239, v71 clamp
    v_mfma_f32_16x16x32_bf16 a[36:39], a[168:171], v[132:135], a[36:39]
    ds_read_b128 a[140:143], v227 offset:49152
    v_cvt_pk_bf16_f32 v155, v238, v239
    v_mfma_f32_16x16x32_bf16 a[40:43], a[168:171], v[136:139], a[40:43]
    v_exp_f32 v236, v72 clamp
    v_mfma_f32_16x16x32_bf16 a[44:47], a[168:171], v[140:143], a[44:47]
    v_exp_f32 v237, v73 clamp
    v_mfma_f32_16x16x32_bf16 a[60:63], a[172:175], v[140:143], a[60:63]
    ds_read_b128 a[144:147], v224 offset:57344
    v_cvt_pk_bf16_f32 v156, v236, v237
    v_mfma_f32_16x16x32_bf16 a[56:59], a[172:175], v[136:139], a[56:59]
    v_exp_f32 v238, v74 clamp
    v_mfma_f32_16x16x32_bf16 a[52:55], a[172:175], v[132:135], a[52:55]
    v_exp_f32 v239, v75 clamp
    v_mfma_f32_16x16x32_bf16 a[48:51], a[172:175], v[128:131], a[48:51]
    s_waitcnt lgkmcnt(5)
    ds_read_b128 a[148:151], v225 offset:57344
    v_cvt_pk_bf16_f32 v157, v238, v239
    v_mfma_f32_16x16x32_bf16 a[64:67], a[176:179], v[128:131], a[64:67]
    buffer_load_dwordx4 v13, s[12:15], s27 offen offset:3072 lds
    v_mfma_f32_16x16x32_bf16 a[68:71], a[176:179], v[132:135], a[68:71]
    v_exp_f32 v236, v76 clamp
    v_mfma_f32_16x16x32_bf16 a[72:75], a[176:179], v[136:139], a[72:75]
    v_exp_f32 v237, v77 clamp
    v_mfma_f32_16x16x32_bf16 a[76:79], a[176:179], v[140:143], a[76:79]
    ds_read_b128 a[152:155], v226 offset:57344
    v_cvt_pk_bf16_f32 v158, v236, v237
    v_mfma_f32_16x16x32_bf16 a[92:95], a[180:183], v[140:143], a[92:95]
    v_exp_f32 v238, v78 clamp
    v_mfma_f32_16x16x32_bf16 a[88:91], a[180:183], v[136:139], a[88:91]
    v_exp_f32 v239, v79 clamp
    v_mfma_f32_16x16x32_bf16 a[84:87], a[180:183], v[132:135], a[84:87]
    ds_read_b128 a[156:159], v227 offset:57344
    v_cvt_pk_bf16_f32 v159, v238, v239
    v_mfma_f32_16x16x32_bf16 a[80:83], a[180:183], v[128:131], a[80:83]
    v_xor_b32 v228, 0x10000, v228
    v_xor_b32 v229, 0x10000, v229
    v_smfmac_f32_16x16x64_bf16 v[100:103], a[192:195], v[152:159], v104
    v_xor_b32 v230, 0x10000, v230
    v_mfma_f32_16x16x32_bf16 a[96:99], a[184:187], v[128:131], a[96:99]
    v_xor_b32 v231, 0x10000, v231
    v_xor_b32 v232, 0x10000, v232
    v_mfma_f32_16x16x32_bf16 a[100:103], a[184:187], v[132:135], a[100:103]
    v_xor_b32 v233, 0x10000, v233
    v_mfma_f32_16x16x32_bf16 a[104:107], a[184:187], v[136:139], a[104:107]
    s_waitcnt vmcnt(18) lgkmcnt(0)
    v_xor_b32 v234, 0x10000, v234
    v_xor_b32 v235, 0x10000, v235
    v_mfma_f32_16x16x32_bf16 a[108:111], a[184:187], v[140:143], a[108:111]
    s_barrier
    v_xor_b32 v224, 0x10000, v224
    v_mfma_f32_16x16x32_bf16 a[124:127], a[188:191], v[140:143], a[124:127]
    v_xor_b32 v225, 0x10000, v225
    v_xor_b32 v226, 0x10000, v226
    v_mfma_f32_16x16x32_bf16 a[120:123], a[188:191], v[136:139], a[120:123]
    v_max_f32 v244, v96, v100
    v_cmp_lt_f32 vcc, s31, v244
    v_mfma_f32_16x16x32_bf16 a[116:119], a[188:191], v[132:135], a[116:119]
    s_cmp_lt_u32 s27, s3
    v_xor_b32 v227, 0x10000, v227
    v_mfma_f32_16x16x32_bf16 a[112:115], a[188:191], v[128:131], a[112:115]
    s_cbranch_vccnz SLOW3_adaLN_cond__gqa_block_cached__glu_gated_geglu__prompt_kernel
BACK3_adaLN_cond__gqa_block_cached__glu_gated_geglu__prompt_kernel:
    s_cbranch_scc1 LOOP_adaLN_cond__gqa_block_cached__glu_gated_geglu__prompt_kernel
    s_cmp_eq_u32 s3, 0
    s_cbranch_scc1 TAIL_adaLN_cond__gqa_block_cached__glu_gated_geglu__prompt_kernel
    s_mul_i32 s29, s25, 294912
    v_lshrrev_b32 v3, 3, v0
    s_add_u32 s8, s4, s29
    v_and_b32 v4, 7, v0
    s_addc_u32 s9, s5, 0
    v_lshrrev_b32 v5, 4, v0
    s_and_b32 s9, s9, 0xffff
    v_lshlrev_b32 v5, 1, v5
    s_mov_b32 s10, 294912
    v_xor_b32 v4, v4, v5
    s_mov_b32 s12, s8
    v_mul_u32_u24 v3, 1152, v3
    s_mov_b32 s13, s9
    v_lshl_add_u32 v3, v4, 4, v3
    s_mul_i32 s29, s24, 36864
    s_mov_b32 s14, 294912
    v_add_u32 v10, s29, v3
    s_mov_b32 s27, 147328
    v_add_u32 v11, 8192, v10
    s_mov_b32 s6, 4294819968
    v_add_u32 v12, 16384, v10
    s_mov_b32 s7, 147456
    v_add_u32 v13, 24576, v10
    s_mov_b32 s3, 0
    s_branch LOOP_adaLN_cond__gqa_block_cached__glu_gated_geglu__prompt_kernel
TAIL_adaLN_cond__gqa_block_cached__glu_gated_geglu__prompt_kernel:
    ds_read_b64_tr_b16 a[160:161], v228 offset:0
    ds_read_b64_tr_b16 a[162:163], v228 offset:8192
    ds_read_b64_tr_b16 a[164:165], v229 offset:0
    ds_read_b64_tr_b16 a[166:167], v229 offset:8192
    ds_read_b64_tr_b16 a[168:169], v230 offset:0
    ds_read_b64_tr_b16 a[170:171], v230 offset:8192
    ds_read_b64_tr_b16 a[172:173], v231 offset:0
    ds_read_b64_tr_b16 a[174:175], v231 offset:8192
    ds_read_b64_tr_b16 a[176:177], v232 offset:0
    ds_read_b64_tr_b16 a[178:179], v232 offset:8192
    ds_read_b64_tr_b16 a[180:181], v233 offset:0
    ds_read_b64_tr_b16 a[182:183], v233 offset:8192
    ds_read_b64_tr_b16 a[184:185], v234 offset:0
    ds_read_b64_tr_b16 a[186:187], v234 offset:8192
    ds_read_b64_tr_b16 a[188:189], v235 offset:0
    ds_read_b64_tr_b16 a[190:191], v235 offset:8192
    v_mov_b32 v97, v96
    v_mov_b32 v101, v100
    v_nop
    v_permlane16_swap_b32 v96, v97
    v_permlane16_swap_b32 v100, v101
    v_add_f32 v96, v96, v97
    v_add_f32 v100, v100, v101
    v_mov_b32 v97, v96
    v_mov_b32 v101, v100
    v_nop
    v_permlane32_swap_b32 v96, v97
    v_permlane32_swap_b32 v100, v101
    v_rcp_f32 v236, v96
    v_rcp_f32 v238, v97
    v_rcp_f32 v240, v100
    v_rcp_f32 v242, v101
    s_lshl_b32 s48, s26, 2
    s_add_u32 s48, s48, s24
    s_mul_i32 s48, s48, 589824
    s_mul_i32 s29, s25, 9216
    s_add_u32 s48, s48, s29
    s_add_u32 s48, s48, 67108864
    s_add_u32 s49, s48, 294912
    s_waitcnt lgkmcnt(14)
    v_mfma_f32_16x16x32_bf16 a[0:3], a[160:163], v[144:147], a[0:3]
    v_lshrrev_b32 v3, 2, v0
    v_bfe_u32 v4, v0, 3, 2
    v_mfma_f32_16x16x32_bf16 a[4:7], a[160:163], v[148:151], a[4:7]
    v_and_b32 v5, 3, v0
    v_mfma_f32_16x16x32_bf16 a[8:11], a[160:163], v[152:155], a[8:11]
    v_lshlrev_b32 v5, 3, v5
    v_lshl_add_u32 v5, v4, 5, v5
    v_mfma_f32_16x16x32_bf16 a[12:15], a[160:163], v[156:159], a[12:15]
    s_waitcnt lgkmcnt(12)
    v_lshl_add_u32 v64, v3, 7, v5
    v_xor_b32 v65, 32, v64
    v_mfma_f32_16x16x32_bf16 a[16:19], a[164:167], v[144:147], a[16:19]
    v_xor_b32 v66, 64, v64
    v_xor_b32 v67, 0x60, v64
    v_mfma_f32_16x16x32_bf16 a[20:23], a[164:167], v[148:151], a[20:23]
    v_add_u32 v68, 0x10000, v64
    v_mfma_f32_16x16x32_bf16 a[24:27], a[164:167], v[152:155], a[24:27]
    v_add_u32 v69, 0x10000, v65
    v_add_u32 v70, 0x10000, v66
    v_mfma_f32_16x16x32_bf16 a[28:31], a[164:167], v[156:159], a[28:31]
    s_waitcnt lgkmcnt(10)
    v_add_u32 v71, 0x10000, v67
    v_bfe_u32 v3, v0, 3, 1
    v_mfma_f32_16x16x32_bf16 a[32:35], a[168:171], v[144:147], a[32:35]
    v_mul_u32_u24 v3, 147456, v3
    v_lshrrev_b32 v4, 4, v0
    v_mfma_f32_16x16x32_bf16 a[36:39], a[168:171], v[148:151], a[36:39]
    v_lshl_add_u32 v3, v4, 7, v3
    v_mfma_f32_16x16x32_bf16 a[40:43], a[168:171], v[152:155], a[40:43]
    v_and_b32 v4, 7, v0
    v_lshl_add_u32 v72, v4, 4, v3
    v_mfma_f32_16x16x32_bf16 a[44:47], a[168:171], v[156:159], a[44:47]
    s_waitcnt lgkmcnt(8)
    v_accvgpr_read_b32 v16, a0
    v_accvgpr_read_b32 v17, a1
    v_mfma_f32_16x16x32_bf16 a[48:51], a[172:175], v[144:147], a[48:51]
    v_accvgpr_read_b32 v18, a2
    v_accvgpr_read_b32 v19, a3
    v_mfma_f32_16x16x32_bf16 a[52:55], a[172:175], v[148:151], a[52:55]
    v_accvgpr_read_b32 v20, a16
    v_accvgpr_read_b32 v21, a17
    v_mfma_f32_16x16x32_bf16 a[56:59], a[172:175], v[152:155], a[56:59]
    v_accvgpr_read_b32 v22, a18
    v_accvgpr_read_b32 v23, a19
    v_mfma_f32_16x16x32_bf16 a[60:63], a[172:175], v[156:159], a[60:63]
    s_waitcnt lgkmcnt(6)
    v_mul_f32 v16, v16, v236
    v_mul_f32 v17, v17, v236
    v_mfma_f32_16x16x32_bf16 a[64:67], a[176:179], v[144:147], a[64:67]
    v_mul_f32 v18, v18, v236
    v_mfma_f32_16x16x32_bf16 a[68:71], a[176:179], v[148:151], a[68:71]
    v_mul_f32 v19, v19, v236
    v_mul_f32 v20, v20, v236
    v_mfma_f32_16x16x32_bf16 a[72:75], a[176:179], v[152:155], a[72:75]
    v_mul_f32 v21, v21, v236
    v_mul_f32 v22, v22, v236
    v_mfma_f32_16x16x32_bf16 a[76:79], a[176:179], v[156:159], a[76:79]
    s_waitcnt lgkmcnt(4)
    v_mul_f32 v23, v23, v236
    v_cvt_pk_bf16_f32 v160, v16, v17
    v_mfma_f32_16x16x32_bf16 a[80:83], a[180:183], v[144:147], a[80:83]
    v_cvt_pk_bf16_f32 v161, v18, v19
    v_cvt_pk_bf16_f32 v162, v20, v21
    v_mfma_f32_16x16x32_bf16 a[84:87], a[180:183], v[148:151], a[84:87]
    v_cvt_pk_bf16_f32 v163, v22, v23
    v_accvgpr_read_b32 v24, a4
    v_mfma_f32_16x16x32_bf16 a[88:91], a[180:183], v[152:155], a[88:91]
    v_accvgpr_read_b32 v25, a5
    v_accvgpr_read_b32 v26, a6
    v_mfma_f32_16x16x32_bf16 a[92:95], a[180:183], v[156:159], a[92:95]
    s_waitcnt lgkmcnt(2)
    v_accvgpr_read_b32 v27, a7
    v_accvgpr_read_b32 v28, a20
    v_mfma_f32_16x16x32_bf16 a[96:99], a[184:187], v[144:147], a[96:99]
    v_accvgpr_read_b32 v29, a21
    v_accvgpr_read_b32 v30, a22
    v_mfma_f32_16x16x32_bf16 a[100:103], a[184:187], v[148:151], a[100:103]
    v_accvgpr_read_b32 v31, a23
    v_mul_f32 v24, v24, v238
    v_mfma_f32_16x16x32_bf16 a[104:107], a[184:187], v[152:155], a[104:107]
    v_mul_f32 v25, v25, v238
    v_mfma_f32_16x16x32_bf16 a[108:111], a[184:187], v[156:159], a[108:111]
    s_waitcnt lgkmcnt(0)
    v_mul_f32 v26, v26, v238
    v_mul_f32 v27, v27, v238
    v_mfma_f32_16x16x32_bf16 a[112:115], a[188:191], v[144:147], a[112:115]
    v_mul_f32 v28, v28, v238
    v_mul_f32 v29, v29, v238
    v_mfma_f32_16x16x32_bf16 a[116:119], a[188:191], v[148:151], a[116:119]
    v_mul_f32 v30, v30, v238
    v_mul_f32 v31, v31, v238
    v_mfma_f32_16x16x32_bf16 a[120:123], a[188:191], v[152:155], a[120:123]
    v_cvt_pk_bf16_f32 v164, v24, v25
    v_cvt_pk_bf16_f32 v165, v26, v27
    v_mfma_f32_16x16x32_bf16 a[124:127], a[188:191], v[156:159], a[124:127]
    v_cvt_pk_bf16_f32 v166, v28, v29
    v_cvt_pk_bf16_f32 v167, v30, v31
    v_accvgpr_read_b32 v32, a8
    v_accvgpr_read_b32 v33, a9
    s_add_u32 m0, s37, 98304
    s_mov_b32 s27, 256
    buffer_load_dwordx4 v10, s[8:11], s27 offen offset:0 lds
    v_accvgpr_read_b32 v34, a10
    v_accvgpr_read_b32 v35, a11
    v_accvgpr_read_b32 v36, a24
    v_accvgpr_read_b32 v37, a25
    v_accvgpr_read_b32 v38, a26
    v_accvgpr_read_b32 v39, a27
    v_pk_mul_f32 v[32:33], v[32:33], v[240:241] op_sel_hi:[1,0]
    v_pk_mul_f32 v[34:35], v[34:35], v[240:241] op_sel_hi:[1,0]
    v_pk_mul_f32 v[36:37], v[36:37], v[240:241] op_sel_hi:[1,0]
    v_pk_mul_f32 v[38:39], v[38:39], v[240:241] op_sel_hi:[1,0]
    buffer_load_dwordx4 v11, s[8:11], s27 offen offset:1024 lds
    v_cvt_pk_bf16_f32 v192, v32, v33
    v_cvt_pk_bf16_f32 v193, v34, v35
    v_cvt_pk_bf16_f32 v194, v36, v37
    v_cvt_pk_bf16_f32 v195, v38, v39
    v_accvgpr_read_b32 v40, a12
    v_accvgpr_read_b32 v41, a13
    v_accvgpr_read_b32 v42, a14
    v_accvgpr_read_b32 v43, a15
    v_accvgpr_read_b32 v44, a28
    v_accvgpr_read_b32 v45, a29
    buffer_load_dwordx4 v12, s[8:11], s27 offen offset:2048 lds
    v_accvgpr_read_b32 v46, a30
    v_accvgpr_read_b32 v47, a31
    v_pk_mul_f32 v[40:41], v[40:41], v[242:243] op_sel_hi:[1,0]
    v_pk_mul_f32 v[42:43], v[42:43], v[242:243] op_sel_hi:[1,0]
    v_pk_mul_f32 v[44:45], v[44:45], v[242:243] op_sel_hi:[1,0]
    v_pk_mul_f32 v[46:47], v[46:47], v[242:243] op_sel_hi:[1,0]
    v_cvt_pk_bf16_f32 v196, v40, v41
    v_cvt_pk_bf16_f32 v197, v42, v43
    v_cvt_pk_bf16_f32 v198, v44, v45
    v_cvt_pk_bf16_f32 v199, v46, v47
    buffer_load_dwordx4 v13, s[8:11], s27 offen offset:3072 lds
    v_accvgpr_read_b32 v16, a32
    v_accvgpr_read_b32 v17, a33
    v_accvgpr_read_b32 v18, a34
    v_accvgpr_read_b32 v19, a35
    v_accvgpr_read_b32 v20, a48
    v_accvgpr_read_b32 v21, a49
    v_accvgpr_read_b32 v22, a50
    v_accvgpr_read_b32 v23, a51
    v_pk_mul_f32 v[16:17], v[16:17], v[236:237] op_sel_hi:[1,0]
    v_pk_mul_f32 v[18:19], v[18:19], v[236:237] op_sel_hi:[1,0]
    s_add_u32 m0, s37, 114688
    s_mov_b32 s27, 147712
    buffer_load_dwordx4 v10, s[8:11], s27 offen offset:0 lds
    v_pk_mul_f32 v[20:21], v[20:21], v[236:237] op_sel_hi:[1,0]
    v_pk_mul_f32 v[22:23], v[22:23], v[236:237] op_sel_hi:[1,0]
    v_cvt_pk_bf16_f32 v168, v16, v17
    v_cvt_pk_bf16_f32 v169, v18, v19
    v_cvt_pk_bf16_f32 v170, v20, v21
    v_cvt_pk_bf16_f32 v171, v22, v23
    v_accvgpr_read_b32 v24, a36
    v_accvgpr_read_b32 v25, a37
    v_accvgpr_read_b32 v26, a38
    v_accvgpr_read_b32 v27, a39
    buffer_load_dwordx4 v11, s[8:11], s27 offen offset:1024 lds
    v_accvgpr_read_b32 v28, a52
    v_accvgpr_read_b32 v29, a53
    v_accvgpr_read_b32 v30, a54
    v_accvgpr_read_b32 v31, a55
    v_pk_mul_f32 v[24:25], v[24:25], v[238:239] op_sel_hi:[1,0]
    v_pk_mul_f32 v[26:27], v[26:27], v[238:239] op_sel_hi:[1,0]
    v_pk_mul_f32 v[28:29], v[28:29], v[238:239] op_sel_hi:[1,0]
    v_pk_mul_f32 v[30:31], v[30:31], v[238:239] op_sel_hi:[1,0]
    v_cvt_pk_bf16_f32 v172, v24, v25
    v_cvt_pk_bf16_f32 v173, v26, v27
    buffer_load_dwordx4 v12, s[8:11], s27 offen offset:2048 lds
    v_cvt_pk_bf16_f32 v174, v28, v29
    v_cvt_pk_bf16_f32 v175, v30, v31
    v_accvgpr_read_b32 v32, a40
    v_accvgpr_read_b32 v33, a41
    v_accvgpr_read_b32 v34, a42
    v_accvgpr_read_b32 v35, a43
    v_accvgpr_read_b32 v36, a56
    v_accvgpr_read_b32 v37, a57
    v_accvgpr_read_b32 v38, a58
    v_accvgpr_read_b32 v39, a59
    buffer_load_dwordx4 v13, s[8:11], s27 offen offset:3072 lds
    v_pk_mul_f32 v[32:33], v[32:33], v[240:241] op_sel_hi:[1,0]
    v_pk_mul_f32 v[34:35], v[34:35], v[240:241] op_sel_hi:[1,0]
    v_pk_mul_f32 v[36:37], v[36:37], v[240:241] op_sel_hi:[1,0]
    v_pk_mul_f32 v[38:39], v[38:39], v[240:241] op_sel_hi:[1,0]
    v_cvt_pk_bf16_f32 v200, v32, v33
    v_cvt_pk_bf16_f32 v201, v34, v35
    v_cvt_pk_bf16_f32 v202, v36, v37
    v_cvt_pk_bf16_f32 v203, v38, v39
    v_accvgpr_read_b32 v40, a44
    v_accvgpr_read_b32 v41, a45
    v_accvgpr_read_b32 v42, a46
    v_accvgpr_read_b32 v43, a47
    v_accvgpr_read_b32 v44, a60
    v_accvgpr_read_b32 v45, a61
    v_accvgpr_read_b32 v46, a62
    v_accvgpr_read_b32 v47, a63
    v_pk_mul_f32 v[40:41], v[40:41], v[242:243] op_sel_hi:[1,0]
    v_pk_mul_f32 v[42:43], v[42:43], v[242:243] op_sel_hi:[1,0]
    v_pk_mul_f32 v[44:45], v[44:45], v[242:243] op_sel_hi:[1,0]
    v_pk_mul_f32 v[46:47], v[46:47], v[242:243] op_sel_hi:[1,0]
    v_cvt_pk_bf16_f32 v204, v40, v41
    v_cvt_pk_bf16_f32 v205, v42, v43
    v_cvt_pk_bf16_f32 v206, v44, v45
    v_cvt_pk_bf16_f32 v207, v46, v47
    v_accvgpr_read_b32 v16, a64
    v_accvgpr_read_b32 v17, a65
    v_accvgpr_read_b32 v18, a66
    v_accvgpr_read_b32 v19, a67
    s_waitcnt vmcnt(17)
    s_barrier
    v_accvgpr_read_b32 v20, a80
    v_accvgpr_read_b32 v21, a81
    v_accvgpr_read_b32 v22, a82
    v_accvgpr_read_b32 v23, a83
    s_add_u32 m0, s37, 0
    s_mov_b32 s27, 384
    buffer_load_dwordx4 v10, s[8:11], s27 offen offset:0 lds
    v_pk_mul_f32 v[16:17], v[16:17], v[236:237] op_sel_hi:[1,0]
    v_pk_mul_f32 v[18:19], v[18:19], v[236:237] op_sel_hi:[1,0]
    v_pk_mul_f32 v[20:21], v[20:21], v[236:237] op_sel_hi:[1,0]
    v_pk_mul_f32 v[22:23], v[22:23], v[236:237] op_sel_hi:[1,0]
    v_cvt_pk_bf16_f32 v176, v16, v17
    v_cvt_pk_bf16_f32 v177, v18, v19
    v_cvt_pk_bf16_f32 v178, v20, v21
    v_cvt_pk_bf16_f32 v179, v22, v23
    v_accvgpr_read_b32 v24, a68
    v_accvgpr_read_b32 v25, a69
    buffer_load_dwordx4 v11, s[8:11], s27 offen offset:1024 lds
    v_accvgpr_read_b32 v26, a70
    v_accvgpr_read_b32 v27, a71
    v_accvgpr_read_b32 v28, a84
    v_accvgpr_read_b32 v29, a85
    v_accvgpr_read_b32 v30, a86
    v_accvgpr_read_b32 v31, a87
    v_pk_mul_f32 v[24:25], v[24:25], v[238:239] op_sel_hi:[1,0]
    v_pk_mul_f32 v[26:27], v[26:27], v[238:239] op_sel_hi:[1,0]
    v_pk_mul_f32 v[28:29], v[28:29], v[238:239] op_sel_hi:[1,0]
    v_pk_mul_f32 v[30:31], v[30:31], v[238:239] op_sel_hi:[1,0]
    buffer_load_dwordx4 v12, s[8:11], s27 offen offset:2048 lds
    v_cvt_pk_bf16_f32 v180, v24, v25
    v_cvt_pk_bf16_f32 v181, v26, v27
    v_cvt_pk_bf16_f32 v182, v28, v29
    v_cvt_pk_bf16_f32 v183, v30, v31
    v_accvgpr_read_b32 v32, a72
    v_accvgpr_read_b32 v33, a73
    v_accvgpr_read_b32 v34, a74
    v_accvgpr_read_b32 v35, a75
    v_accvgpr_read_b32 v36, a88
    v_accvgpr_read_b32 v37, a89
    buffer_load_dwordx4 v13, s[8:11], s27 offen offset:3072 lds
    v_accvgpr_read_b32 v38, a90
    v_accvgpr_read_b32 v39, a91
    v_pk_mul_f32 v[32:33], v[32:33], v[240:241] op_sel_hi:[1,0]
    v_pk_mul_f32 v[34:35], v[34:35], v[240:241] op_sel_hi:[1,0]
    v_pk_mul_f32 v[36:37], v[36:37], v[240:241] op_sel_hi:[1,0]
    v_pk_mul_f32 v[38:39], v[38:39], v[240:241] op_sel_hi:[1,0]
    v_cvt_pk_bf16_f32 v208, v32, v33
    v_cvt_pk_bf16_f32 v209, v34, v35
    v_cvt_pk_bf16_f32 v210, v36, v37
    v_cvt_pk_bf16_f32 v211, v38, v39
    s_add_u32 m0, s37, 16384
    s_mov_b32 s27, 147840
    buffer_load_dwordx4 v10, s[8:11], s27 offen offset:0 lds
    v_accvgpr_read_b32 v40, a76
    v_accvgpr_read_b32 v41, a77
    v_accvgpr_read_b32 v42, a78
    v_accvgpr_read_b32 v43, a79
    v_accvgpr_read_b32 v44, a92
    v_accvgpr_read_b32 v45, a93
    v_accvgpr_read_b32 v46, a94
    v_accvgpr_read_b32 v47, a95
    v_pk_mul_f32 v[40:41], v[40:41], v[242:243] op_sel_hi:[1,0]
    v_pk_mul_f32 v[42:43], v[42:43], v[242:243] op_sel_hi:[1,0]
    buffer_load_dwordx4 v11, s[8:11], s27 offen offset:1024 lds
    v_pk_mul_f32 v[44:45], v[44:45], v[242:243] op_sel_hi:[1,0]
    v_pk_mul_f32 v[46:47], v[46:47], v[242:243] op_sel_hi:[1,0]
    v_cvt_pk_bf16_f32 v212, v40, v41
    v_cvt_pk_bf16_f32 v213, v42, v43
    v_cvt_pk_bf16_f32 v214, v44, v45
    v_cvt_pk_bf16_f32 v215, v46, v47
    v_accvgpr_read_b32 v16, a96
    v_accvgpr_read_b32 v17, a97
    v_accvgpr_read_b32 v18, a98
    v_accvgpr_read_b32 v19, a99
    buffer_load_dwordx4 v12, s[8:11], s27 offen offset:2048 lds
    v_accvgpr_read_b32 v20, a112
    v_accvgpr_read_b32 v21, a113
    v_accvgpr_read_b32 v22, a114
    v_accvgpr_read_b32 v23, a115
    v_pk_mul_f32 v[16:17], v[16:17], v[236:237] op_sel_hi:[1,0]
    v_pk_mul_f32 v[18:19], v[18:19], v[236:237] op_sel_hi:[1,0]
    v_pk_mul_f32 v[20:21], v[20:21], v[236:237] op_sel_hi:[1,0]
    v_pk_mul_f32 v[22:23], v[22:23], v[236:237] op_sel_hi:[1,0]
    v_cvt_pk_bf16_f32 v184, v16, v17
    v_cvt_pk_bf16_f32 v185, v18, v19
    buffer_load_dwordx4 v13, s[8:11], s27 offen offset:3072 lds
    v_cvt_pk_bf16_f32 v186, v20, v21
    v_cvt_pk_bf16_f32 v187, v22, v23
    v_accvgpr_read_b32 v24, a100
    v_accvgpr_read_b32 v25, a101
    v_accvgpr_read_b32 v26, a102
    v_accvgpr_read_b32 v27, a103
    v_accvgpr_read_b32 v28, a116
    v_accvgpr_read_b32 v29, a117
    v_accvgpr_read_b32 v30, a118
    v_accvgpr_read_b32 v31, a119
    v_pk_mul_f32 v[24:25], v[24:25], v[238:239] op_sel_hi:[1,0]
    v_pk_mul_f32 v[26:27], v[26:27], v[238:239] op_sel_hi:[1,0]
    v_pk_mul_f32 v[28:29], v[28:29], v[238:239] op_sel_hi:[1,0]
    v_pk_mul_f32 v[30:31], v[30:31], v[238:239] op_sel_hi:[1,0]
    v_cvt_pk_bf16_f32 v188, v24, v25
    v_cvt_pk_bf16_f32 v189, v26, v27
    v_cvt_pk_bf16_f32 v190, v28, v29
    v_cvt_pk_bf16_f32 v191, v30, v31
    ds_read_b64_tr_b16 a[192:193], v64 offset:32768
    v_accvgpr_read_b32 v32, a104
    v_accvgpr_read_b32 v33, a105
    ds_read_b64_tr_b16 a[194:195], v64 offset:34816
    v_accvgpr_read_b32 v34, a106
    v_accvgpr_read_b32 v35, a107
    ds_read_b64_tr_b16 a[196:197], v65 offset:32768
    v_accvgpr_read_b32 v36, a120
    v_accvgpr_read_b32 v37, a121
    ds_read_b64_tr_b16 a[198:199], v65 offset:34816
    v_accvgpr_read_b32 v38, a122
    v_accvgpr_read_b32 v39, a123
    ds_read_b64_tr_b16 a[200:201], v64 offset:36864
    v_pk_mul_f32 v[32:33], v[32:33], v[240:241] op_sel_hi:[1,0]
    v_pk_mul_f32 v[34:35], v[34:35], v[240:241] op_sel_hi:[1,0]
    ds_read_b64_tr_b16 a[202:203], v64 offset:38912
    v_pk_mul_f32 v[36:37], v[36:37], v[240:241] op_sel_hi:[1,0]
    v_pk_mul_f32 v[38:39], v[38:39], v[240:241] op_sel_hi:[1,0]
    ds_read_b64_tr_b16 a[204:205], v65 offset:36864
    v_cvt_pk_bf16_f32 v216, v32, v33
    v_cvt_pk_bf16_f32 v217, v34, v35
    ds_read_b64_tr_b16 a[206:207], v65 offset:38912
    v_cvt_pk_bf16_f32 v218, v36, v37
    v_cvt_pk_bf16_f32 v219, v38, v39
    ds_read_b64_tr_b16 a[208:209], v64 offset:40960
    v_accvgpr_read_b32 v40, a108
    v_accvgpr_read_b32 v41, a109
    ds_read_b64_tr_b16 a[210:211], v64 offset:43008
    v_accvgpr_read_b32 v42, a110
    v_accvgpr_read_b32 v43, a111
    ds_read_b64_tr_b16 a[212:213], v65 offset:40960
    v_accvgpr_read_b32 v44, a124
    v_accvgpr_read_b32 v45, a125
    ds_read_b64_tr_b16 a[214:215], v65 offset:43008
    v_accvgpr_read_b32 v46, a126
    v_accvgpr_read_b32 v47, a127
    v_pk_mul_f32 v[40:41], v[40:41], v[242:243] op_sel_hi:[1,0]
    v_pk_mul_f32 v[42:43], v[42:43], v[242:243] op_sel_hi:[1,0]
    v_pk_mul_f32 v[44:45], v[44:45], v[242:243] op_sel_hi:[1,0]
    v_pk_mul_f32 v[46:47], v[46:47], v[242:243] op_sel_hi:[1,0]
    v_cvt_pk_bf16_f32 v220, v40, v41
    v_cvt_pk_bf16_f32 v221, v42, v43
    v_cvt_pk_bf16_f32 v222, v44, v45
    v_cvt_pk_bf16_f32 v223, v46, v47
    s_waitcnt lgkmcnt(8)
    s_nop 0
    v_mfma_f32_16x16x32_bf16 v[80:83], a[192:195], v[160:163], 0
    s_lshl_b32 s96, s24, 8
    ds_read_b64_tr_b16 a[216:217], v64 offset:45056
    v_mfma_f32_16x16x32_bf16 v[84:87], a[192:195], v[164:167], 0
    s_add_u32 s96, s96, s2
    ds_read_b64_tr_b16 a[218:219], v64 offset:47104
    ds_read_b64_tr_b16 a[220:221], v65 offset:45056
    v_mfma_f32_16x16x32_bf16 v[92:95], a[196:199], v[164:167], 0
    s_cmp_lt_u32 s96, 72
    s_cselect_b32 s96, 64, 0
    s_cselect_b32 s98, 16, 0
    v_mfma_f32_16x16x32_bf16 v[88:91], a[196:199], v[160:163], 0
    s_waitcnt lgkmcnt(7)
    ds_read_b64_tr_b16 a[222:223], v65 offset:47104
    v_mfma_f32_16x16x32_bf16 v[80:83], a[200:203], v[168:171], v[80:83]
    ds_read_b64_tr_b16 a[224:225], v64 offset:49152
    v_lshrrev_b32 v112, 4, v0
    v_mfma_f32_16x16x32_bf16 v[84:87], a[200:203], v[172:175], v[84:87]
    ds_read_b64_tr_b16 a[226:227], v64 offset:51200
    ds_read_b64_tr_b16 a[228:229], v65 offset:49152
    v_mfma_f32_16x16x32_bf16 v[92:95], a[204:207], v[172:175], v[92:95]
    ds_read_b64_tr_b16 a[230:231], v65 offset:51200
    v_mul_u32_u24 v112, 13824, v112
    v_mfma_f32_16x16x32_bf16 v[88:91], a[204:207], v[168:171], v[88:91]
    s_waitcnt lgkmcnt(8)
    ds_read_b64_tr_b16 a[232:233], v64 offset:53248
    ds_read_b64_tr_b16 a[234:235], v64 offset:55296
    v_mfma_f32_16x16x32_bf16 v[80:83], a[208:211], v[176:179], v[80:83]
    s_lshl_b32 s95, s2, 5
    ds_read_b64_tr_b16 a[236:237], v65 offset:53248
    v_mfma_f32_16x16x32_bf16 v[84:87], a[208:211], v[180:183], v[84:87]
    ds_read_b64_tr_b16 a[238:239], v65 offset:55296
    v_bfe_u32 v113, v0, 2, 2
    v_mfma_f32_16x16x32_bf16 v[92:95], a[212:215], v[180:183], v[92:95]
    s_add_u32 s95, s95, 2363904
    ds_read_b64_tr_b16 a[240:241], v64 offset:57344
    ds_read_b64_tr_b16 a[242:243], v64 offset:59392
    v_mfma_f32_16x16x32_bf16 v[88:91], a[212:215], v[176:179], v[88:91]
    s_waitcnt lgkmcnt(10)
    ds_read_b64_tr_b16 a[244:245], v65 offset:57344
    v_cmp_eq_u32 vcc, 2, v113
    v_mfma_f32_16x16x32_bf16 v[80:83], a[216:219], v[184:187], v[80:83]
    s_lshl_b32 s97, s2, 7
    ds_read_b64_tr_b16 a[246:247], v65 offset:59392
    v_mul_u32_u24 v113, 2304, v113
    v_mfma_f32_16x16x32_bf16 v[84:87], a[216:219], v[188:191], v[84:87]
    ds_read_b64_tr_b16 a[248:249], v64 offset:61440
    ds_read_b64_tr_b16 a[250:251], v64 offset:63488
    v_mfma_f32_16x16x32_bf16 v[92:95], a[220:223], v[188:191], v[92:95]
    s_add_u32 s97, s97, 2424832
    ds_read_b64_tr_b16 a[252:253], v65 offset:61440
    v_mfma_f32_16x16x32_bf16 v[88:91], a[220:223], v[184:187], v[88:91]
    s_waitcnt lgkmcnt(11)
    ds_read_b64_tr_b16 a[254:255], v65 offset:63488
    v_add_u32 v112, v112, v113
    v_mfma_f32_16x16x32_bf16 v[80:83], a[224:227], v[192:195], v[80:83]
    ds_read_b64_tr_b16 a[192:193], v66 offset:32768
    ds_read_b64_tr_b16 a[194:195], v66 offset:34816
    v_mfma_f32_16x16x32_bf16 v[84:87], a[224:227], v[196:199], v[84:87]
    ds_read_b64_tr_b16 a[196:197], v67 offset:32768
    v_cndmask_b32 v118, 0, 1.0, vcc
    v_mfma_f32_16x16x32_bf16 v[92:95], a[228:231], v[196:199], v[92:95]
    ds_read_b64_tr_b16 a[198:199], v67 offset:34816
    ds_read_b64_tr_b16 a[200:201], v66 offset:36864
    v_mfma_f32_16x16x32_bf16 v[88:91], a[228:231], v[192:195], v[88:91]
    s_waitcnt lgkmcnt(13)
    ds_read_b64_tr_b16 a[202:203], v66 offset:38912
    v_and_b32 v113, 3, v0
    v_mfma_f32_16x16x32_bf16 v[80:83], a[232:235], v[200:203], v[80:83]
    ds_read_b64_tr_b16 a[204:205], v67 offset:36864
    v_lshl_add_u32 v112, v113, 3, v112
    v_mfma_f32_16x16x32_bf16 v[84:87], a[232:235], v[204:207], v[84:87]
    ds_read_b64_tr_b16 a[206:207], v67 offset:38912
    ds_read_b64_tr_b16 a[208:209], v66 offset:40960
    v_mfma_f32_16x16x32_bf16 v[92:95], a[236:239], v[204:207], v[92:95]
    ds_read_b64_tr_b16 a[210:211], v66 offset:43008
    v_mfma_f32_16x16x32_bf16 v[88:91], a[236:239], v[200:203], v[88:91]
    s_waitcnt lgkmcnt(14)
    ds_read_b64_tr_b16 a[212:213], v67 offset:40960
    v_cmp_gt_u32 vcc, s98, v0
    v_mfma_f32_16x16x32_bf16 v[80:83], a[240:243], v[208:211], v[80:83]
    ds_read_b64_tr_b16 a[214:215], v67 offset:43008
    ds_read_b64_tr_b16 a[216:217], v66 offset:45056
    v_mfma_f32_16x16x32_bf16 v[84:87], a[240:243], v[212:215], v[84:87]
    ds_read_b64_tr_b16 a[218:219], v66 offset:47104
    v_lshlrev_b32 v113, 3, v0
    v_mfma_f32_16x16x32_bf16 v[92:95], a[244:247], v[212:215], v[92:95]
    ds_read_b64_tr_b16 a[220:221], v67 offset:45056
    v_mov_b32 v116, 0x40000000
    v_mfma_f32_16x16x32_bf16 v[88:91], a[244:247], v[208:211], v[88:91]
    s_waitcnt lgkmcnt(15)
    ds_read_b64_tr_b16 a[222:223], v67 offset:47104
    ds_read_b64_tr_b16 a[224:225], v66 offset:49152
    v_mfma_f32_16x16x32_bf16 v[80:83], a[248:251], v[216:219], v[80:83]
    ds_read_b64_tr_b16 a[226:227], v66 offset:51200
    v_mfma_f32_16x16x32_bf16 v[84:87], a[248:251], v[220:223], v[84:87]
    ds_read_b64_tr_b16 a[228:229], v67 offset:49152
    ds_read_b64_tr_b16 a[230:231], v67 offset:51200
    v_mfma_f32_16x16x32_bf16 v[92:95], a[252:255], v[220:223], v[92:95]
    ds_read_b64_tr_b16 a[232:233], v66 offset:53248
    v_cndmask_b32 v113, v116, v113, vcc
    v_mfma_f32_16x16x32_bf16 v[88:91], a[252:255], v[216:219], v[88:91]
    s_waitcnt lgkmcnt(15)
    ds_read_b64_tr_b16 a[234:235], v66 offset:55296
    v_cmp_gt_u32 vcc, s96, v0
    v_mfma_f32_16x16x32_bf16 v[96:99], a[192:195], v[160:163], 0
    ds_read_b64_tr_b16 a[236:237], v67 offset:53248
    ds_read_b64_tr_b16 a[238:239], v67 offset:55296
    v_mfma_f32_16x16x32_bf16 v[100:103], a[192:195], v[164:167], 0
    ds_read_b64_tr_b16 a[240:241], v66 offset:57344
    v_nop
    v_mfma_f32_16x16x32_bf16 v[108:111], a[196:199], v[164:167], 0
    v_cvt_pk_bf16_f32 v48, v80, v81
    v_mfma_f32_16x16x32_bf16 v[104:107], a[196:199], v[160:163], 0
    s_waitcnt lgkmcnt(15)
    ds_read_b64_tr_b16 a[242:243], v66 offset:59392
    v_cvt_pk_bf16_f32 v49, v82, v83
    v_mfma_f32_16x16x32_bf16 v[96:99], a[200:203], v[168:171], v[96:99]
    ds_read_b64_tr_b16 a[244:245], v67 offset:57344
    v_nop
    v_mfma_f32_16x16x32_bf16 v[100:103], a[200:203], v[172:175], v[100:103]
    v_cvt_pk_bf16_f32 v50, v88, v89
    v_cndmask_b32 v112, v116, v112, vcc
    v_mfma_f32_16x16x32_bf16 v[108:111], a[204:207], v[172:175], v[108:111]
    ds_read_b64_tr_b16 a[246:247], v67 offset:59392
    v_cvt_pk_bf16_f32 v51, v90, v91
    v_mfma_f32_16x16x32_bf16 v[104:107], a[204:207], v[168:171], v[104:107]
    s_waitcnt lgkmcnt(15)
    v_cvt_pk_bf16_f32 v52, v84, v85
    v_mfma_f32_16x16x32_bf16 v[96:99], a[208:211], v[176:179], v[96:99]
    ds_read_b64_tr_b16 a[248:249], v66 offset:61440
    v_cvt_pk_bf16_f32 v53, v86, v87
    v_mfma_f32_16x16x32_bf16 v[100:103], a[208:211], v[180:183], v[100:103]
    buffer_load_dwordx2 v[114:115], v112, s[20:23], s95 offen
    v_mfma_f32_16x16x32_bf16 v[108:111], a[212:215], v[180:183], v[108:111]
    ds_read_b64_tr_b16 a[250:251], v66 offset:63488
    v_mfma_f32_16x16x32_bf16 v[104:107], a[212:215], v[176:179], v[104:107]
    s_waitcnt lgkmcnt(14)
    v_cvt_pk_bf16_f32 v54, v92, v93
    v_mfma_f32_16x16x32_bf16 v[96:99], a[216:219], v[184:187], v[96:99]
    ds_read_b64_tr_b16 a[252:253], v67 offset:61440
    v_cvt_pk_bf16_f32 v55, v94, v95
    v_mfma_f32_16x16x32_bf16 v[100:103], a[216:219], v[188:191], v[100:103]
    ds_read_b64_tr_b16 a[254:255], v67 offset:63488
    v_mfma_f32_16x16x32_bf16 v[108:111], a[220:223], v[188:191], v[108:111]
    buffer_store_dwordx4 v[48:51], v72, s[20:23], s48 offen offset:0 sc1
    v_mfma_f32_16x16x32_bf16 v[104:107], a[220:223], v[184:187], v[104:107]
    s_waitcnt lgkmcnt(12)
    v_mfma_f32_16x16x32_bf16 v[96:99], a[224:227], v[192:195], v[96:99]
    v_mfma_f32_16x16x32_bf16 v[100:103], a[224:227], v[196:199], v[100:103]
    v_mfma_f32_16x16x32_bf16 v[108:111], a[228:231], v[196:199], v[108:111]
    s_waitcnt vmcnt(18) lgkmcnt(0)
    v_mfma_f32_16x16x32_bf16 v[104:107], a[228:231], v[192:195], v[104:107]
    s_barrier
    buffer_store_dwordx4 v[52:55], v72, s[20:23], s49 offen offset:0 sc1
    v_mfma_f32_16x16x32_bf16 v[96:99], a[232:235], v[200:203], v[96:99]
    ds_read_b64_tr_b16 a[192:193], v68 offset:0
    ds_read_b64_tr_b16 a[194:195], v68 offset:2048
    v_mfma_f32_16x16x32_bf16 v[100:103], a[232:235], v[204:207], v[100:103]
    s_add_u32 m0, s37, 32768
    ds_read_b64_tr_b16 a[196:197], v69 offset:0
    v_mfma_f32_16x16x32_bf16 v[108:111], a[236:239], v[204:207], v[108:111]
    s_mov_b32 s27, 512
    buffer_load_dwordx4 v10, s[8:11], s27 offen offset:0 lds
    v_mfma_f32_16x16x32_bf16 v[104:107], a[236:239], v[200:203], v[104:107]
    ds_read_b64_tr_b16 a[198:199], v69 offset:2048
    ds_read_b64_tr_b16 a[200:201], v68 offset:4096
    v_mfma_f32_16x16x32_bf16 v[96:99], a[240:243], v[208:211], v[96:99]
    ds_read_b64_tr_b16 a[202:203], v68 offset:6144
    ds_read_b64_tr_b16 a[204:205], v69 offset:4096
    v_mfma_f32_16x16x32_bf16 v[100:103], a[240:243], v[212:215], v[100:103]
    ds_read_b64_tr_b16 a[206:207], v69 offset:6144
    v_mfma_f32_16x16x32_bf16 v[108:111], a[244:247], v[212:215], v[108:111]
    ds_read_b64_tr_b16 a[208:209], v68 offset:8192
    ds_read_b64_tr_b16 a[210:211], v68 offset:10240
    v_mfma_f32_16x16x32_bf16 v[104:107], a[244:247], v[208:211], v[104:107]
    ds_read_b64_tr_b16 a[212:213], v69 offset:8192
    ds_read_b64_tr_b16 a[214:215], v69 offset:10240
    v_mfma_f32_16x16x32_bf16 v[96:99], a[248:251], v[216:219], v[96:99]
    buffer_load_dwordx4 v11, s[8:11], s27 offen offset:1024 lds
    v_mfma_f32_16x16x32_bf16 v[100:103], a[248:251], v[220:223], v[100:103]
    ds_read_b64_tr_b16 a[216:217], v68 offset:12288
    v_mfma_f32_16x16x32_bf16 v[108:111], a[252:255], v[220:223], v[108:111]
    ds_read_b64_tr_b16 a[218:219], v68 offset:14336
    ds_read_b64_tr_b16 a[220:221], v69 offset:12288
    v_mfma_f32_16x16x32_bf16 v[104:107], a[252:255], v[216:219], v[104:107]
    s_waitcnt lgkmcnt(11)
    ds_read_b64_tr_b16 a[222:223], v69 offset:14336
    ds_read_b64_tr_b16 a[224:225], v68 offset:16384
    v_mfma_f32_16x16x32_bf16 v[80:83], a[192:195], v[160:163], 0
    ds_read_b64_tr_b16 a[226:227], v68 offset:18432
    v_mfma_f32_16x16x32_bf16 v[84:87], a[192:195], v[164:167], 0
    ds_read_b64_tr_b16 a[228:229], v69 offset:16384
    ds_read_b64_tr_b16 a[230:231], v69 offset:18432
    v_mfma_f32_16x16x32_bf16 v[92:95], a[196:199], v[164:167], 0
    buffer_load_dwordx4 v12, s[8:11], s27 offen offset:2048 lds
    v_mfma_f32_16x16x32_bf16 v[88:91], a[196:199], v[160:163], 0
    s_waitcnt lgkmcnt(12)
    ds_read_b64_tr_b16 a[232:233], v68 offset:20480
    v_cvt_pk_bf16_f32 v56, v96, v97
    v_mfma_f32_16x16x32_bf16 v[80:83], a[200:203], v[168:171], v[80:83]
    v_cvt_pk_bf16_f32 v57, v98, v99
    v_mfma_f32_16x16x32_bf16 v[84:87], a[200:203], v[172:175], v[84:87]
    ds_read_b64_tr_b16 a[234:235], v68 offset:22528
    v_cvt_pk_bf16_f32 v58, v104, v105
    v_mfma_f32_16x16x32_bf16 v[92:95], a[204:207], v[172:175], v[92:95]
    ds_read_b64_tr_b16 a[236:237], v69 offset:20480
    v_cvt_pk_bf16_f32 v59, v106, v107
    v_mfma_f32_16x16x32_bf16 v[88:91], a[204:207], v[168:171], v[88:91]
    s_waitcnt lgkmcnt(11)
    ds_read_b64_tr_b16 a[238:239], v69 offset:22528
    v_mfma_f32_16x16x32_bf16 v[80:83], a[208:211], v[176:179], v[80:83]
    buffer_load_dwordx4 v13, s[8:11], s27 offen offset:3072 lds
    v_mfma_f32_16x16x32_bf16 v[84:87], a[208:211], v[180:183], v[84:87]
    ds_read_b64_tr_b16 a[240:241], v68 offset:24576
    v_cvt_pk_bf16_f32 v60, v100, v101
    v_mfma_f32_16x16x32_bf16 v[92:95], a[212:215], v[180:183], v[92:95]
    ds_read_b64_tr_b16 a[242:243], v68 offset:26624
    v_cvt_pk_bf16_f32 v61, v102, v103
    v_mfma_f32_16x16x32_bf16 v[88:91], a[212:215], v[176:179], v[88:91]
    s_waitcnt lgkmcnt(10)
    v_cvt_pk_bf16_f32 v62, v108, v109
    v_mfma_f32_16x16x32_bf16 v[80:83], a[216:219], v[184:187], v[80:83]
    ds_read_b64_tr_b16 a[244:245], v69 offset:24576
    v_cvt_pk_bf16_f32 v63, v110, v111
    v_mfma_f32_16x16x32_bf16 v[84:87], a[216:219], v[188:191], v[84:87]
    ds_read_b64_tr_b16 a[246:247], v69 offset:26624
    ds_read_b64_tr_b16 a[248:249], v68 offset:28672
    v_mfma_f32_16x16x32_bf16 v[92:95], a[220:223], v[188:191], v[92:95]
    s_add_u32 m0, s37, 49152
    buffer_store_dwordx4 v[56:59], v72, s[20:23], s48 offen offset:512 sc1
    v_mfma_f32_16x16x32_bf16 v[88:91], a[220:223], v[184:187], v[88:91]
    s_mov_b32 s27, 147968
    s_waitcnt lgkmcnt(9)
    buffer_load_dwordx4 v10, s[8:11], s27 offen offset:0 lds
    v_mfma_f32_16x16x32_bf16 v[80:83], a[224:227], v[192:195], v[80:83]
    ds_read_b64_tr_b16 a[250:251], v68 offset:30720
    v_mfma_f32_16x16x32_bf16 v[84:87], a[224:227], v[196:199], v[84:87]
    ds_read_b64_tr_b16 a[252:253], v69 offset:28672
    ds_read_b64_tr_b16 a[254:255], v69 offset:30720
    v_mfma_f32_16x16x32_bf16 v[92:95], a[228:231], v[196:199], v[92:95]
    ds_read_b64_tr_b16 a[192:193], v70 offset:0
    ds_read_b64_tr_b16 a[194:195], v70 offset:2048
    v_mfma_f32_16x16x32_bf16 v[88:91], a[228:231], v[192:195], v[88:91]
    s_waitcnt lgkmcnt(10)
    buffer_store_dwordx4 v[60:63], v72, s[20:23], s49 offen offset:512 sc1
    v_mfma_f32_16x16x32_bf16 v[80:83], a[232:235], v[200:203], v[80:83]
    ds_read_b64_tr_b16 a[196:197], v71 offset:0
    v_mfma_f32_16x16x32_bf16 v[84:87], a[232:235], v[204:207], v[84:87]
    buffer_load_dwordx4 v11, s[8:11], s27 offen offset:1024 lds
    v_mfma_f32_16x16x32_bf16 v[92:95], a[236:239], v[204:207], v[92:95]
    ds_read_b64_tr_b16 a[198:199], v71 offset:2048
    ds_read_b64_tr_b16 a[200:201], v70 offset:4096
    v_mfma_f32_16x16x32_bf16 v[88:91], a[236:239], v[200:203], v[88:91]
    s_waitcnt lgkmcnt(9)
    ds_read_b64_tr_b16 a[202:203], v70 offset:6144
    ds_read_b64_tr_b16 a[204:205], v71 offset:4096
    v_mfma_f32_16x16x32_bf16 v[80:83], a[240:243], v[208:211], v[80:83]
    ds_read_b64_tr_b16 a[206:207], v71 offset:6144
    v_mfma_f32_16x16x32_bf16 v[84:87], a[240:243], v[212:215], v[84:87]
    ds_read_b64_tr_b16 a[208:209], v70 offset:8192
    ds_read_b64_tr_b16 a[210:211], v70 offset:10240
    v_mfma_f32_16x16x32_bf16 v[92:95], a[244:247], v[212:215], v[92:95]
    ds_read_b64_tr_b16 a[212:213], v71 offset:8192
    ds_read_b64_tr_b16 a[214:215], v71 offset:10240
    v_mfma_f32_16x16x32_bf16 v[88:91], a[244:247], v[208:211], v[88:91]
    s_waitcnt lgkmcnt(12)
    buffer_load_dwordx4 v12, s[8:11], s27 offen offset:2048 lds
    v_mfma_f32_16x16x32_bf16 v[80:83], a[248:251], v[216:219], v[80:83]
    ds_read_b64_tr_b16 a[216:217], v70 offset:12288
    v_mfma_f32_16x16x32_bf16 v[84:87], a[248:251], v[220:223], v[84:87]
    ds_read_b64_tr_b16 a[218:219], v70 offset:14336
    ds_read_b64_tr_b16 a[220:221], v71 offset:12288
    v_mfma_f32_16x16x32_bf16 v[92:95], a[252:255], v[220:223], v[92:95]
    ds_read_b64_tr_b16 a[222:223], v71 offset:14336
    ds_read_b64_tr_b16 a[224:225], v70 offset:16384
    v_mfma_f32_16x16x32_bf16 v[88:91], a[252:255], v[216:219], v[88:91]
    s_waitcnt lgkmcnt(13)
    ds_read_b64_tr_b16 a[226:227], v70 offset:18432
    v_mfma_f32_16x16x32_bf16 v[96:99], a[192:195], v[160:163], 0
    ds_read_b64_tr_b16 a[228:229], v71 offset:16384
    ds_read_b64_tr_b16 a[230:231], v71 offset:18432
    v_mfma_f32_16x16x32_bf16 v[100:103], a[192:195], v[164:167], 0
    buffer_load_dwordx4 v13, s[8:11], s27 offen offset:3072 lds
    v_mfma_f32_16x16x32_bf16 v[108:111], a[196:199], v[164:167], 0
    ds_read_b64_tr_b16 a[232:233], v70 offset:20480
    v_cvt_pk_bf16_f32 v48, v80, v81
    v_mfma_f32_16x16x32_bf16 v[104:107], a[196:199], v[160:163], 0
    s_waitcnt lgkmcnt(13)
    ds_read_b64_tr_b16 a[234:235], v70 offset:22528
    v_mfma_f32_16x16x32_bf16 v[96:99], a[200:203], v[168:171], v[96:99]
    ds_read_b64_tr_b16 a[236:237], v71 offset:20480
    v_cvt_pk_bf16_f32 v49, v82, v83
    v_mfma_f32_16x16x32_bf16 v[100:103], a[200:203], v[172:175], v[100:103]
    ds_read_b64_tr_b16 a[238:239], v71 offset:22528
    v_cvt_pk_bf16_f32 v50, v88, v89
    v_mfma_f32_16x16x32_bf16 v[108:111], a[204:207], v[172:175], v[108:111]
    v_cvt_pk_bf16_f32 v51, v90, v91
    v_mfma_f32_16x16x32_bf16 v[104:107], a[204:207], v[168:171], v[104:107]
    s_waitcnt lgkmcnt(12)
    ds_read_b64_tr_b16 a[240:241], v70 offset:24576
    ds_read_b64_tr_b16 a[242:243], v70 offset:26624
    v_mfma_f32_16x16x32_bf16 v[96:99], a[208:211], v[176:179], v[96:99]
    ds_read_b64_tr_b16 a[244:245], v71 offset:24576
    v_cvt_pk_bf16_f32 v52, v84, v85
    v_mfma_f32_16x16x32_bf16 v[100:103], a[208:211], v[180:183], v[100:103]
    v_cvt_pk_bf16_f32 v53, v86, v87
    v_mfma_f32_16x16x32_bf16 v[108:111], a[212:215], v[180:183], v[108:111]
    ds_read_b64_tr_b16 a[246:247], v71 offset:26624
    v_cvt_pk_bf16_f32 v54, v92, v93
    v_mfma_f32_16x16x32_bf16 v[104:107], a[212:215], v[176:179], v[104:107]
    s_waitcnt lgkmcnt(12)
    ds_read_b64_tr_b16 a[248:249], v70 offset:28672
    ds_read_b64_tr_b16 a[250:251], v70 offset:30720
    v_mfma_f32_16x16x32_bf16 v[96:99], a[216:219], v[184:187], v[96:99]
    v_cvt_pk_bf16_f32 v55, v94, v95
    v_mfma_f32_16x16x32_bf16 v[100:103], a[216:219], v[188:191], v[100:103]
    ds_read_b64_tr_b16 a[252:253], v71 offset:28672
    ds_read_b64_tr_b16 a[254:255], v71 offset:30720
    v_mfma_f32_16x16x32_bf16 v[108:111], a[220:223], v[188:191], v[108:111]
    buffer_store_dwordx4 v[48:51], v72, s[20:23], s48 offen offset:1024 sc1
    v_mfma_f32_16x16x32_bf16 v[104:107], a[220:223], v[184:187], v[104:107]
    s_waitcnt lgkmcnt(12)
    v_mfma_f32_16x16x32_bf16 v[96:99], a[224:227], v[192:195], v[96:99]
    v_mfma_f32_16x16x32_bf16 v[100:103], a[224:227], v[196:199], v[100:103]
    v_mfma_f32_16x16x32_bf16 v[108:111], a[228:231], v[196:199], v[108:111]
    s_waitcnt vmcnt(22) lgkmcnt(0)
    v_mfma_f32_16x16x32_bf16 v[104:107], a[228:231], v[192:195], v[104:107]
    s_barrier
    buffer_store_dwordx4 v[52:55], v72, s[20:23], s49 offen offset:1024 sc1
    v_mfma_f32_16x16x32_bf16 v[96:99], a[232:235], v[200:203], v[96:99]
    ds_read_b64_tr_b16 a[192:193], v68 offset:32768
    ds_read_b64_tr_b16 a[194:195], v68 offset:34816
    v_mfma_f32_16x16x32_bf16 v[100:103], a[232:235], v[204:207], v[100:103]
    s_add_u32 m0, s37, 65536
    ds_read_b64_tr_b16 a[196:197], v69 offset:32768
    v_mfma_f32_16x16x32_bf16 v[108:111], a[236:239], v[204:207], v[108:111]
    s_mov_b32 s27, 640
    buffer_load_dwordx4 v10, s[8:11], s27 offen offset:0 lds
    v_mfma_f32_16x16x32_bf16 v[104:107], a[236:239], v[200:203], v[104:107]
    ds_read_b64_tr_b16 a[198:199], v69 offset:34816
    ds_read_b64_tr_b16 a[200:201], v68 offset:36864
    v_mfma_f32_16x16x32_bf16 v[96:99], a[240:243], v[208:211], v[96:99]
    ds_read_b64_tr_b16 a[202:203], v68 offset:38912
    ds_read_b64_tr_b16 a[204:205], v69 offset:36864
    v_mfma_f32_16x16x32_bf16 v[100:103], a[240:243], v[212:215], v[100:103]
    ds_read_b64_tr_b16 a[206:207], v69 offset:38912
    v_mfma_f32_16x16x32_bf16 v[108:111], a[244:247], v[212:215], v[108:111]
    ds_read_b64_tr_b16 a[208:209], v68 offset:40960
    ds_read_b64_tr_b16 a[210:211], v68 offset:43008
    v_mfma_f32_16x16x32_bf16 v[104:107], a[244:247], v[208:211], v[104:107]
    ds_read_b64_tr_b16 a[212:213], v69 offset:40960
    ds_read_b64_tr_b16 a[214:215], v69 offset:43008
    v_mfma_f32_16x16x32_bf16 v[96:99], a[248:251], v[216:219], v[96:99]
    buffer_load_dwordx4 v11, s[8:11], s27 offen offset:1024 lds
    v_mfma_f32_16x16x32_bf16 v[100:103], a[248:251], v[220:223], v[100:103]
    ds_read_b64_tr_b16 a[216:217], v68 offset:45056
    v_mfma_f32_16x16x32_bf16 v[108:111], a[252:255], v[220:223], v[108:111]
    ds_read_b64_tr_b16 a[218:219], v68 offset:47104
    ds_read_b64_tr_b16 a[220:221], v69 offset:45056
    v_mfma_f32_16x16x32_bf16 v[104:107], a[252:255], v[216:219], v[104:107]
    s_waitcnt lgkmcnt(11)
    ds_read_b64_tr_b16 a[222:223], v69 offset:47104
    ds_read_b64_tr_b16 a[224:225], v68 offset:49152
    v_mfma_f32_16x16x32_bf16 v[80:83], a[192:195], v[160:163], 0
    ds_read_b64_tr_b16 a[226:227], v68 offset:51200
    v_mfma_f32_16x16x32_bf16 v[84:87], a[192:195], v[164:167], 0
    ds_read_b64_tr_b16 a[228:229], v69 offset:49152
    ds_read_b64_tr_b16 a[230:231], v69 offset:51200
    v_mfma_f32_16x16x32_bf16 v[92:95], a[196:199], v[164:167], 0
    buffer_load_dwordx4 v12, s[8:11], s27 offen offset:2048 lds
    v_mfma_f32_16x16x32_bf16 v[88:91], a[196:199], v[160:163], 0
    s_waitcnt lgkmcnt(12)
    ds_read_b64_tr_b16 a[232:233], v68 offset:53248
    v_cvt_pk_bf16_f32 v56, v96, v97
    v_mfma_f32_16x16x32_bf16 v[80:83], a[200:203], v[168:171], v[80:83]
    v_cvt_pk_bf16_f32 v57, v98, v99
    v_mfma_f32_16x16x32_bf16 v[84:87], a[200:203], v[172:175], v[84:87]
    ds_read_b64_tr_b16 a[234:235], v68 offset:55296
    v_cvt_pk_bf16_f32 v58, v104, v105
    v_mfma_f32_16x16x32_bf16 v[92:95], a[204:207], v[172:175], v[92:95]
    ds_read_b64_tr_b16 a[236:237], v69 offset:53248
    v_cvt_pk_bf16_f32 v59, v106, v107
    v_mfma_f32_16x16x32_bf16 v[88:91], a[204:207], v[168:171], v[88:91]
    s_waitcnt lgkmcnt(11)
    ds_read_b64_tr_b16 a[238:239], v69 offset:55296
    v_mfma_f32_16x16x32_bf16 v[80:83], a[208:211], v[176:179], v[80:83]
    buffer_load_dwordx4 v13, s[8:11], s27 offen offset:3072 lds
    v_mfma_f32_16x16x32_bf16 v[84:87], a[208:211], v[180:183], v[84:87]
    ds_read_b64_tr_b16 a[240:241], v68 offset:57344
    v_cvt_pk_bf16_f32 v60, v100, v101
    v_mfma_f32_16x16x32_bf16 v[92:95], a[212:215], v[180:183], v[92:95]
    ds_read_b64_tr_b16 a[242:243], v68 offset:59392
    v_cvt_pk_bf16_f32 v61, v102, v103
    v_mfma_f32_16x16x32_bf16 v[88:91], a[212:215], v[176:179], v[88:91]
    s_waitcnt lgkmcnt(10)
    v_cvt_pk_bf16_f32 v62, v108, v109
    v_mfma_f32_16x16x32_bf16 v[80:83], a[216:219], v[184:187], v[80:83]
    ds_read_b64_tr_b16 a[244:245], v69 offset:57344
    v_cvt_pk_bf16_f32 v63, v110, v111
    v_mfma_f32_16x16x32_bf16 v[84:87], a[216:219], v[188:191], v[84:87]
    ds_read_b64_tr_b16 a[246:247], v69 offset:59392
    ds_read_b64_tr_b16 a[248:249], v68 offset:61440
    v_mfma_f32_16x16x32_bf16 v[92:95], a[220:223], v[188:191], v[92:95]
    s_add_u32 m0, s37, 81920
    buffer_store_dwordx4 v[56:59], v72, s[20:23], s48 offen offset:1536 sc1
    v_mfma_f32_16x16x32_bf16 v[88:91], a[220:223], v[184:187], v[88:91]
    s_mov_b32 s27, 148096
    s_waitcnt lgkmcnt(9)
    buffer_load_dwordx4 v10, s[8:11], s27 offen offset:0 lds
    v_mfma_f32_16x16x32_bf16 v[80:83], a[224:227], v[192:195], v[80:83]
    ds_read_b64_tr_b16 a[250:251], v68 offset:63488
    v_mfma_f32_16x16x32_bf16 v[84:87], a[224:227], v[196:199], v[84:87]
    ds_read_b64_tr_b16 a[252:253], v69 offset:61440
    ds_read_b64_tr_b16 a[254:255], v69 offset:63488
    v_mfma_f32_16x16x32_bf16 v[92:95], a[228:231], v[196:199], v[92:95]
    ds_read_b64_tr_b16 a[192:193], v70 offset:32768
    ds_read_b64_tr_b16 a[194:195], v70 offset:34816
    v_mfma_f32_16x16x32_bf16 v[88:91], a[228:231], v[192:195], v[88:91]
    s_waitcnt lgkmcnt(10)
    buffer_store_dwordx4 v[60:63], v72, s[20:23], s49 offen offset:1536 sc1
    v_mfma_f32_16x16x32_bf16 v[80:83], a[232:235], v[200:203], v[80:83]
    ds_read_b64_tr_b16 a[196:197], v71 offset:32768
    v_mfma_f32_16x16x32_bf16 v[84:87], a[232:235], v[204:207], v[84:87]
    buffer_load_dwordx4 v11, s[8:11], s27 offen offset:1024 lds
    v_mfma_f32_16x16x32_bf16 v[92:95], a[236:239], v[204:207], v[92:95]
    ds_read_b64_tr_b16 a[198:199], v71 offset:34816
    ds_read_b64_tr_b16 a[200:201], v70 offset:36864
    v_mfma_f32_16x16x32_bf16 v[88:91], a[236:239], v[200:203], v[88:91]
    s_waitcnt lgkmcnt(9)
    ds_read_b64_tr_b16 a[202:203], v70 offset:38912
    ds_read_b64_tr_b16 a[204:205], v71 offset:36864
    v_mfma_f32_16x16x32_bf16 v[80:83], a[240:243], v[208:211], v[80:83]
    ds_read_b64_tr_b16 a[206:207], v71 offset:38912
    v_mfma_f32_16x16x32_bf16 v[84:87], a[240:243], v[212:215], v[84:87]
    ds_read_b64_tr_b16 a[208:209], v70 offset:40960
    ds_read_b64_tr_b16 a[210:211], v70 offset:43008
    v_mfma_f32_16x16x32_bf16 v[92:95], a[244:247], v[212:215], v[92:95]
    ds_read_b64_tr_b16 a[212:213], v71 offset:40960
    ds_read_b64_tr_b16 a[214:215], v71 offset:43008
    v_mfma_f32_16x16x32_bf16 v[88:91], a[244:247], v[208:211], v[88:91]
    s_waitcnt lgkmcnt(12)
    buffer_load_dwordx4 v12, s[8:11], s27 offen offset:2048 lds
    v_mfma_f32_16x16x32_bf16 v[80:83], a[248:251], v[216:219], v[80:83]
    ds_read_b64_tr_b16 a[216:217], v70 offset:45056
    v_mfma_f32_16x16x32_bf16 v[84:87], a[248:251], v[220:223], v[84:87]
    ds_read_b64_tr_b16 a[218:219], v70 offset:47104
    ds_read_b64_tr_b16 a[220:221], v71 offset:45056
    v_mfma_f32_16x16x32_bf16 v[92:95], a[252:255], v[220:223], v[92:95]
    ds_read_b64_tr_b16 a[222:223], v71 offset:47104
    ds_read_b64_tr_b16 a[224:225], v70 offset:49152
    v_mfma_f32_16x16x32_bf16 v[88:91], a[252:255], v[216:219], v[88:91]
    s_waitcnt lgkmcnt(13)
    ds_read_b64_tr_b16 a[226:227], v70 offset:51200
    v_mfma_f32_16x16x32_bf16 v[96:99], a[192:195], v[160:163], 0
    ds_read_b64_tr_b16 a[228:229], v71 offset:49152
    ds_read_b64_tr_b16 a[230:231], v71 offset:51200
    v_mfma_f32_16x16x32_bf16 v[100:103], a[192:195], v[164:167], 0
    buffer_load_dwordx4 v13, s[8:11], s27 offen offset:3072 lds
    v_mfma_f32_16x16x32_bf16 v[108:111], a[196:199], v[164:167], 0
    ds_read_b64_tr_b16 a[232:233], v70 offset:53248
    v_cvt_pk_bf16_f32 v48, v80, v81
    v_mfma_f32_16x16x32_bf16 v[104:107], a[196:199], v[160:163], 0
    s_waitcnt lgkmcnt(13)
    ds_read_b64_tr_b16 a[234:235], v70 offset:55296
    v_mfma_f32_16x16x32_bf16 v[96:99], a[200:203], v[168:171], v[96:99]
    ds_read_b64_tr_b16 a[236:237], v71 offset:53248
    v_cvt_pk_bf16_f32 v49, v82, v83
    v_mfma_f32_16x16x32_bf16 v[100:103], a[200:203], v[172:175], v[100:103]
    ds_read_b64_tr_b16 a[238:239], v71 offset:55296
    v_cvt_pk_bf16_f32 v50, v88, v89
    v_mfma_f32_16x16x32_bf16 v[108:111], a[204:207], v[172:175], v[108:111]
    v_cvt_pk_bf16_f32 v51, v90, v91
    v_mfma_f32_16x16x32_bf16 v[104:107], a[204:207], v[168:171], v[104:107]
    s_waitcnt lgkmcnt(12)
    ds_read_b64_tr_b16 a[240:241], v70 offset:57344
    ds_read_b64_tr_b16 a[242:243], v70 offset:59392
    v_mfma_f32_16x16x32_bf16 v[96:99], a[208:211], v[176:179], v[96:99]
    ds_read_b64_tr_b16 a[244:245], v71 offset:57344
    v_cvt_pk_bf16_f32 v52, v84, v85
    v_mfma_f32_16x16x32_bf16 v[100:103], a[208:211], v[180:183], v[100:103]
    v_cvt_pk_bf16_f32 v53, v86, v87
    v_mfma_f32_16x16x32_bf16 v[108:111], a[212:215], v[180:183], v[108:111]
    ds_read_b64_tr_b16 a[246:247], v71 offset:59392
    v_cvt_pk_bf16_f32 v54, v92, v93
    v_mfma_f32_16x16x32_bf16 v[104:107], a[212:215], v[176:179], v[104:107]
    s_waitcnt lgkmcnt(12)
    ds_read_b64_tr_b16 a[248:249], v70 offset:61440
    ds_read_b64_tr_b16 a[250:251], v70 offset:63488
    v_mfma_f32_16x16x32_bf16 v[96:99], a[216:219], v[184:187], v[96:99]
    v_cvt_pk_bf16_f32 v55, v94, v95
    v_mfma_f32_16x16x32_bf16 v[100:103], a[216:219], v[188:191], v[100:103]
    ds_read_b64_tr_b16 a[252:253], v71 offset:61440
    ds_read_b64_tr_b16 a[254:255], v71 offset:63488
    v_mfma_f32_16x16x32_bf16 v[108:111], a[220:223], v[188:191], v[108:111]
    buffer_store_dwordx4 v[48:51], v72, s[20:23], s48 offen offset:2048 sc1
    v_mfma_f32_16x16x32_bf16 v[104:107], a[220:223], v[184:187], v[104:107]
    s_waitcnt lgkmcnt(12)
    v_mfma_f32_16x16x32_bf16 v[96:99], a[224:227], v[192:195], v[96:99]
    v_mfma_f32_16x16x32_bf16 v[100:103], a[224:227], v[196:199], v[100:103]
    v_mfma_f32_16x16x32_bf16 v[108:111], a[228:231], v[196:199], v[108:111]
    s_waitcnt vmcnt(26) lgkmcnt(0)
    v_mfma_f32_16x16x32_bf16 v[104:107], a[228:231], v[192:195], v[104:107]
    s_barrier
    buffer_store_dwordx4 v[52:55], v72, s[20:23], s49 offen offset:2048 sc1
    v_mfma_f32_16x16x32_bf16 v[96:99], a[232:235], v[200:203], v[96:99]
    ds_read_b64_tr_b16 a[192:193], v64 offset:0
    ds_read_b64_tr_b16 a[194:195], v64 offset:2048
    v_mfma_f32_16x16x32_bf16 v[100:103], a[232:235], v[204:207], v[100:103]
    s_add_u32 m0, s37, 98304
    ds_read_b64_tr_b16 a[196:197], v65 offset:0
    v_mfma_f32_16x16x32_bf16 v[108:111], a[236:239], v[204:207], v[108:111]
    s_mov_b32 s27, 768
    buffer_load_dwordx4 v10, s[8:11], s27 offen offset:0 lds
    v_mfma_f32_16x16x32_bf16 v[104:107], a[236:239], v[200:203], v[104:107]
    ds_read_b64_tr_b16 a[198:199], v65 offset:2048
    ds_read_b64_tr_b16 a[200:201], v64 offset:4096
    v_mfma_f32_16x16x32_bf16 v[96:99], a[240:243], v[208:211], v[96:99]
    ds_read_b64_tr_b16 a[202:203], v64 offset:6144
    ds_read_b64_tr_b16 a[204:205], v65 offset:4096
    v_mfma_f32_16x16x32_bf16 v[100:103], a[240:243], v[212:215], v[100:103]
    ds_read_b64_tr_b16 a[206:207], v65 offset:6144
    ds_read_b64_tr_b16 a[208:209], v64 offset:8192
    v_mfma_f32_16x16x32_bf16 v[108:111], a[244:247], v[212:215], v[108:111]
    s_waitcnt vmcnt(27)
    ds_read_b64_tr_b16 a[210:211], v64 offset:10240
    v_mov_b32 v116, v114
    v_mfma_f32_16x16x32_bf16 v[104:107], a[244:247], v[208:211], v[104:107]
    ds_read_b64_tr_b16 a[212:213], v65 offset:8192
    ds_read_b64_tr_b16 a[214:215], v65 offset:10240
    v_mfma_f32_16x16x32_bf16 v[96:99], a[248:251], v[216:219], v[96:99]
    buffer_load_dwordx4 v11, s[8:11], s27 offen offset:1024 lds
    v_mov_b32 v117, v115
    v_mfma_f32_16x16x32_bf16 v[100:103], a[248:251], v[220:223], v[100:103]
    ds_read_b64_tr_b16 a[216:217], v64 offset:12288
    ds_read_b64_tr_b16 a[218:219], v64 offset:14336
    v_mfma_f32_16x16x32_bf16 v[108:111], a[252:255], v[220:223], v[108:111]
    ds_read_b64_tr_b16 a[220:221], v65 offset:12288
    v_nop
    v_mfma_f32_16x16x32_bf16 v[104:107], a[252:255], v[216:219], v[104:107]
    s_waitcnt lgkmcnt(11)
    ds_read_b64_tr_b16 a[222:223], v65 offset:14336
    ds_read_b64_tr_b16 a[224:225], v64 offset:16384
    v_mfma_f32_16x16x32_bf16 v[80:83], a[192:195], v[160:163], 0
    ds_read_b64_tr_b16 a[226:227], v64 offset:18432
    ds_read_b64_tr_b16 a[228:229], v65 offset:16384
    v_permlane16_swap_b32 v114, v116
    v_mfma_f32_16x16x32_bf16 v[84:87], a[192:195], v[164:167], 0
    ds_read_b64_tr_b16 a[230:231], v65 offset:18432
    v_permlane16_swap_b32 v115, v117
    v_mfma_f32_16x16x32_bf16 v[92:95], a[196:199], v[164:167], 0
    buffer_load_dwordx4 v12, s[8:11], s27 offen offset:2048 lds
    v_mfma_f32_16x16x32_bf16 v[88:91], a[196:199], v[160:163], 0
    s_waitcnt lgkmcnt(12)
    ds_read_b64_tr_b16 a[232:233], v64 offset:20480
    v_cvt_pk_bf16_f32 v56, v96, v97
    v_mfma_f32_16x16x32_bf16 v[80:83], a[200:203], v[168:171], v[80:83]
    ds_read_b64_tr_b16 a[234:235], v64 offset:22528
    v_cvt_pk_bf16_f32 v57, v98, v99
    v_add_f32 v114, v114, v116
    v_mfma_f32_16x16x32_bf16 v[84:87], a[200:203], v[172:175], v[84:87]
    ds_read_b64_tr_b16 a[236:237], v65 offset:20480
    v_cvt_pk_bf16_f32 v58, v104, v105
    v_mfma_f32_16x16x32_bf16 v[92:95], a[204:207], v[172:175], v[92:95]
    v_cvt_pk_bf16_f32 v59, v106, v107
    v_add_f32 v115, v115, v117
    v_mfma_f32_16x16x32_bf16 v[88:91], a[204:207], v[168:171], v[88:91]
    s_waitcnt lgkmcnt(11)
    ds_read_b64_tr_b16 a[238:239], v65 offset:22528
    ds_read_b64_tr_b16 a[240:241], v64 offset:24576
    v_mfma_f32_16x16x32_bf16 v[80:83], a[208:211], v[176:179], v[80:83]
    buffer_load_dwordx4 v13, s[8:11], s27 offen offset:3072 lds
    v_mov_b32 v116, v114
    v_mfma_f32_16x16x32_bf16 v[84:87], a[208:211], v[180:183], v[84:87]
    ds_read_b64_tr_b16 a[242:243], v64 offset:26624
    v_cvt_pk_bf16_f32 v60, v100, v101
    v_mfma_f32_16x16x32_bf16 v[92:95], a[212:215], v[180:183], v[92:95]
    v_cvt_pk_bf16_f32 v61, v102, v103
    v_mov_b32 v117, v115
    v_mfma_f32_16x16x32_bf16 v[88:91], a[212:215], v[176:179], v[88:91]
    s_waitcnt lgkmcnt(10)
    ds_read_b64_tr_b16 a[244:245], v65 offset:24576
    v_cvt_pk_bf16_f32 v62, v108, v109
    v_mfma_f32_16x16x32_bf16 v[80:83], a[216:219], v[184:187], v[80:83]
    ds_read_b64_tr_b16 a[246:247], v65 offset:26624
    v_cvt_pk_bf16_f32 v63, v110, v111
    v_nop
    v_mfma_f32_16x16x32_bf16 v[84:87], a[216:219], v[188:191], v[84:87]
    ds_read_b64_tr_b16 a[248:249], v64 offset:28672
    v_permlane32_swap_b32 v114, v116
    v_mfma_f32_16x16x32_bf16 v[92:95], a[220:223], v[188:191], v[92:95]
    s_add_u32 m0, s37, 114688
    buffer_store_dwordx4 v[56:59], v72, s[20:23], s48 offen offset:2560 sc1
    v_mfma_f32_16x16x32_bf16 v[88:91], a[220:223], v[184:187], v[88:91]
    s_mov_b32 s27, 148224
    s_waitcnt lgkmcnt(9)
    buffer_load_dwordx4 v10, s[8:11], s27 offen offset:0 lds
    v_mfma_f32_16x16x32_bf16 v[80:83], a[224:227], v[192:195], v[80:83]
    ds_read_b64_tr_b16 a[250:251], v64 offset:30720
    ds_read_b64_tr_b16 a[252:253], v65 offset:28672
    v_permlane32_swap_b32 v115, v117
    v_mfma_f32_16x16x32_bf16 v[84:87], a[224:227], v[196:199], v[84:87]
    ds_read_b64_tr_b16 a[254:255], v65 offset:30720
    ds_read_b64_tr_b16 a[192:193], v66 offset:0
    v_mfma_f32_16x16x32_bf16 v[92:95], a[228:231], v[196:199], v[92:95]
    ds_read_b64_tr_b16 a[194:195], v66 offset:2048
    ds_read_b64_tr_b16 a[196:197], v67 offset:0
    v_mfma_f32_16x16x32_bf16 v[88:91], a[228:231], v[192:195], v[88:91]
    s_waitcnt lgkmcnt(11)
    buffer_store_dwordx4 v[60:63], v72, s[20:23], s49 offen offset:2560 sc1
    v_mfma_f32_16x16x32_bf16 v[80:83], a[232:235], v[200:203], v[80:83]
    ds_read_b64_tr_b16 a[198:199], v67 offset:2048
    v_add_f32 v114, v114, v116
    v_add_f32 v115, v115, v117
    v_mfma_f32_16x16x32_bf16 v[84:87], a[232:235], v[204:207], v[84:87]
    buffer_load_dwordx4 v11, s[8:11], s27 offen offset:1024 lds
    v_mfma_f32_16x16x32_bf16 v[92:95], a[236:239], v[204:207], v[92:95]
    ds_read_b64_tr_b16 a[200:201], v66 offset:4096
    ds_read_b64_tr_b16 a[202:203], v66 offset:6144
    v_mfma_f32_16x16x32_bf16 v[88:91], a[236:239], v[200:203], v[88:91]
    s_waitcnt lgkmcnt(10)
    ds_read_b64_tr_b16 a[204:205], v67 offset:4096
    ds_read_b64_tr_b16 a[206:207], v67 offset:6144
    v_mfma_f32_16x16x32_bf16 v[80:83], a[240:243], v[208:211], v[80:83]
    ds_read_b64_tr_b16 a[208:209], v66 offset:8192
    v_cvt_pk_bf16_f32 v115, v114, v115
    v_lshlrev_b32 v114, 16, v115
    v_mfma_f32_16x16x32_bf16 v[84:87], a[240:243], v[212:215], v[84:87]
    ds_read_b64_tr_b16 a[210:211], v66 offset:10240
    ds_read_b64_tr_b16 a[212:213], v67 offset:8192
    v_mfma_f32_16x16x32_bf16 v[92:95], a[244:247], v[212:215], v[92:95]
    ds_read_b64_tr_b16 a[214:215], v67 offset:10240
    ds_read_b64_tr_b16 a[216:217], v66 offset:12288
    v_mfma_f32_16x16x32_bf16 v[88:91], a[244:247], v[208:211], v[88:91]
    s_waitcnt lgkmcnt(13)
    buffer_load_dwordx4 v12, s[8:11], s27 offen offset:2048 lds
    v_mfma_f32_16x16x32_bf16 v[80:83], a[248:251], v[216:219], v[80:83]
    ds_read_b64_tr_b16 a[218:219], v66 offset:14336
    v_and_b32 v115, 0xffff0000, v115
    v_add_f32 v114, v118, v114
    v_mfma_f32_16x16x32_bf16 v[84:87], a[248:251], v[220:223], v[84:87]
    ds_read_b64_tr_b16 a[220:221], v67 offset:12288
    ds_read_b64_tr_b16 a[222:223], v67 offset:14336
    v_mfma_f32_16x16x32_bf16 v[92:95], a[252:255], v[220:223], v[92:95]
    ds_read_b64_tr_b16 a[224:225], v66 offset:16384
    ds_read_b64_tr_b16 a[226:227], v66 offset:18432
    v_mfma_f32_16x16x32_bf16 v[88:91], a[252:255], v[216:219], v[88:91]
    s_waitcnt lgkmcnt(14)
    ds_read_b64_tr_b16 a[228:229], v67 offset:16384
    ds_read_b64_tr_b16 a[230:231], v67 offset:18432
    v_mfma_f32_16x16x32_bf16 v[96:99], a[192:195], v[160:163], 0
    ds_read_b64_tr_b16 a[232:233], v66 offset:20480
    v_add_f32 v115, v118, v115
    v_cvt_pk_bf16_f32 v115, v114, v115
    v_mfma_f32_16x16x32_bf16 v[100:103], a[192:195], v[164:167], 0
    buffer_load_dwordx4 v13, s[8:11], s27 offen offset:3072 lds
    v_mfma_f32_16x16x32_bf16 v[108:111], a[196:199], v[164:167], 0
    ds_read_b64_tr_b16 a[234:235], v66 offset:22528
    v_cvt_pk_bf16_f32 v48, v80, v81
    v_mfma_f32_16x16x32_bf16 v[104:107], a[196:199], v[160:163], 0
    s_waitcnt lgkmcnt(14)
    ds_read_b64_tr_b16 a[236:237], v67 offset:20480
    v_cvt_pk_bf16_f32 v49, v82, v83
    v_mfma_f32_16x16x32_bf16 v[96:99], a[200:203], v[168:171], v[96:99]
    ds_read_b64_tr_b16 a[238:239], v67 offset:22528
    v_lshlrev_b32 v114, 16, v115
    v_and_b32 v115, 0xffff0000, v115
    v_mfma_f32_16x16x32_bf16 v[100:103], a[200:203], v[172:175], v[100:103]
    ds_read_b64_tr_b16 a[240:241], v66 offset:24576
    v_cvt_pk_bf16_f32 v50, v88, v89
    v_mfma_f32_16x16x32_bf16 v[108:111], a[204:207], v[172:175], v[108:111]
    ds_read_b64_tr_b16 a[242:243], v66 offset:26624
    v_cvt_pk_bf16_f32 v51, v90, v91
    v_mfma_f32_16x16x32_bf16 v[104:107], a[204:207], v[168:171], v[104:107]
    s_waitcnt lgkmcnt(14)
    v_cvt_pk_bf16_f32 v52, v84, v85
    v_mfma_f32_16x16x32_bf16 v[96:99], a[208:211], v[176:179], v[96:99]
    ds_read_b64_tr_b16 a[244:245], v67 offset:24576
    v_cvt_pk_bf16_f32 v53, v86, v87
    v_mfma_f32_16x16x32_bf16 v[100:103], a[208:211], v[180:183], v[100:103]
    buffer_store_dwordx2 v[114:115], v113, s[20:23], s97 offen sc1
    v_mfma_f32_16x16x32_bf16 v[108:111], a[212:215], v[180:183], v[108:111]
    ds_read_b64_tr_b16 a[246:247], v67 offset:26624
    ds_read_b64_tr_b16 a[248:249], v66 offset:28672
    v_mfma_f32_16x16x32_bf16 v[104:107], a[212:215], v[176:179], v[104:107]
    s_waitcnt lgkmcnt(13)
    ds_read_b64_tr_b16 a[250:251], v66 offset:30720
    v_cvt_pk_bf16_f32 v54, v92, v93
    v_mfma_f32_16x16x32_bf16 v[96:99], a[216:219], v[184:187], v[96:99]
    v_cvt_pk_bf16_f32 v55, v94, v95
    v_mfma_f32_16x16x32_bf16 v[100:103], a[216:219], v[188:191], v[100:103]
    ds_read_b64_tr_b16 a[252:253], v67 offset:28672
    ds_read_b64_tr_b16 a[254:255], v67 offset:30720
    v_mfma_f32_16x16x32_bf16 v[108:111], a[220:223], v[188:191], v[108:111]
    buffer_store_dwordx4 v[48:51], v72, s[20:23], s48 offen offset:3072 sc1
    v_mfma_f32_16x16x32_bf16 v[104:107], a[220:223], v[184:187], v[104:107]
    s_waitcnt lgkmcnt(12)
    v_mfma_f32_16x16x32_bf16 v[96:99], a[224:227], v[192:195], v[96:99]
    v_mfma_f32_16x16x32_bf16 v[100:103], a[224:227], v[196:199], v[100:103]
    v_mfma_f32_16x16x32_bf16 v[108:111], a[228:231], v[196:199], v[108:111]
    s_waitcnt vmcnt(26) lgkmcnt(0)
    v_mfma_f32_16x16x32_bf16 v[104:107], a[228:231], v[192:195], v[104:107]
    s_barrier
    buffer_store_dwordx4 v[52:55], v72, s[20:23], s49 offen offset:3072 sc1
    v_mfma_f32_16x16x32_bf16 v[96:99], a[232:235], v[200:203], v[96:99]
    ds_read_b64_tr_b16 a[192:193], v64 offset:32768
    ds_read_b64_tr_b16 a[194:195], v64 offset:34816
    v_mfma_f32_16x16x32_bf16 v[100:103], a[232:235], v[204:207], v[100:103]
    s_add_u32 m0, s37, 0
    ds_read_b64_tr_b16 a[196:197], v65 offset:32768
    v_mfma_f32_16x16x32_bf16 v[108:111], a[236:239], v[204:207], v[108:111]
    s_mov_b32 s27, 896
    buffer_load_dwordx4 v10, s[8:11], s27 offen offset:0 lds
    v_mfma_f32_16x16x32_bf16 v[104:107], a[236:239], v[200:203], v[104:107]
    ds_read_b64_tr_b16 a[198:199], v65 offset:34816
    ds_read_b64_tr_b16 a[200:201], v64 offset:36864
    v_mfma_f32_16x16x32_bf16 v[96:99], a[240:243], v[208:211], v[96:99]
    ds_read_b64_tr_b16 a[202:203], v64 offset:38912
    ds_read_b64_tr_b16 a[204:205], v65 offset:36864
    v_mfma_f32_16x16x32_bf16 v[100:103], a[240:243], v[212:215], v[100:103]
    ds_read_b64_tr_b16 a[206:207], v65 offset:38912
    v_mfma_f32_16x16x32_bf16 v[108:111], a[244:247], v[212:215], v[108:111]
    ds_read_b64_tr_b16 a[208:209], v64 offset:40960
    ds_read_b64_tr_b16 a[210:211], v64 offset:43008
    v_mfma_f32_16x16x32_bf16 v[104:107], a[244:247], v[208:211], v[104:107]
    ds_read_b64_tr_b16 a[212:213], v65 offset:40960
    ds_read_b64_tr_b16 a[214:215], v65 offset:43008
    v_mfma_f32_16x16x32_bf16 v[96:99], a[248:251], v[216:219], v[96:99]
    buffer_load_dwordx4 v11, s[8:11], s27 offen offset:1024 lds
    v_mfma_f32_16x16x32_bf16 v[100:103], a[248:251], v[220:223], v[100:103]
    ds_read_b64_tr_b16 a[216:217], v64 offset:45056
    v_mfma_f32_16x16x32_bf16 v[108:111], a[252:255], v[220:223], v[108:111]
    ds_read_b64_tr_b16 a[218:219], v64 offset:47104
    ds_read_b64_tr_b16 a[220:221], v65 offset:45056
    v_mfma_f32_16x16x32_bf16 v[104:107], a[252:255], v[216:219], v[104:107]
    s_waitcnt lgkmcnt(11)
    ds_read_b64_tr_b16 a[222:223], v65 offset:47104
    ds_read_b64_tr_b16 a[224:225], v64 offset:49152
    v_mfma_f32_16x16x32_bf16 v[80:83], a[192:195], v[160:163], 0
    ds_read_b64_tr_b16 a[226:227], v64 offset:51200
    v_mfma_f32_16x16x32_bf16 v[84:87], a[192:195], v[164:167], 0
    ds_read_b64_tr_b16 a[228:229], v65 offset:49152
    ds_read_b64_tr_b16 a[230:231], v65 offset:51200
    v_mfma_f32_16x16x32_bf16 v[92:95], a[196:199], v[164:167], 0
    buffer_load_dwordx4 v12, s[8:11], s27 offen offset:2048 lds
    v_mfma_f32_16x16x32_bf16 v[88:91], a[196:199], v[160:163], 0
    s_waitcnt lgkmcnt(12)
    ds_read_b64_tr_b16 a[232:233], v64 offset:53248
    v_cvt_pk_bf16_f32 v56, v96, v97
    v_mfma_f32_16x16x32_bf16 v[80:83], a[200:203], v[168:171], v[80:83]
    v_cvt_pk_bf16_f32 v57, v98, v99
    v_mfma_f32_16x16x32_bf16 v[84:87], a[200:203], v[172:175], v[84:87]
    ds_read_b64_tr_b16 a[234:235], v64 offset:55296
    v_cvt_pk_bf16_f32 v58, v104, v105
    v_mfma_f32_16x16x32_bf16 v[92:95], a[204:207], v[172:175], v[92:95]
    ds_read_b64_tr_b16 a[236:237], v65 offset:53248
    v_cvt_pk_bf16_f32 v59, v106, v107
    v_mfma_f32_16x16x32_bf16 v[88:91], a[204:207], v[168:171], v[88:91]
    s_waitcnt lgkmcnt(11)
    ds_read_b64_tr_b16 a[238:239], v65 offset:55296
    v_mfma_f32_16x16x32_bf16 v[80:83], a[208:211], v[176:179], v[80:83]
    buffer_load_dwordx4 v13, s[8:11], s27 offen offset:3072 lds
    v_mfma_f32_16x16x32_bf16 v[84:87], a[208:211], v[180:183], v[84:87]
    ds_read_b64_tr_b16 a[240:241], v64 offset:57344
    v_cvt_pk_bf16_f32 v60, v100, v101
    v_mfma_f32_16x16x32_bf16 v[92:95], a[212:215], v[180:183], v[92:95]
    ds_read_b64_tr_b16 a[242:243], v64 offset:59392
    v_cvt_pk_bf16_f32 v61, v102, v103
    v_mfma_f32_16x16x32_bf16 v[88:91], a[212:215], v[176:179], v[88:91]
    s_waitcnt lgkmcnt(10)
    v_cvt_pk_bf16_f32 v62, v108, v109
    v_mfma_f32_16x16x32_bf16 v[80:83], a[216:219], v[184:187], v[80:83]
    ds_read_b64_tr_b16 a[244:245], v65 offset:57344
    v_cvt_pk_bf16_f32 v63, v110, v111
    v_mfma_f32_16x16x32_bf16 v[84:87], a[216:219], v[188:191], v[84:87]
    ds_read_b64_tr_b16 a[246:247], v65 offset:59392
    ds_read_b64_tr_b16 a[248:249], v64 offset:61440
    v_mfma_f32_16x16x32_bf16 v[92:95], a[220:223], v[188:191], v[92:95]
    s_add_u32 m0, s37, 16384
    buffer_store_dwordx4 v[56:59], v72, s[20:23], s48 offen offset:3584 sc1
    v_mfma_f32_16x16x32_bf16 v[88:91], a[220:223], v[184:187], v[88:91]
    s_mov_b32 s27, 148352
    s_waitcnt lgkmcnt(9)
    buffer_load_dwordx4 v10, s[8:11], s27 offen offset:0 lds
    v_mfma_f32_16x16x32_bf16 v[80:83], a[224:227], v[192:195], v[80:83]
    ds_read_b64_tr_b16 a[250:251], v64 offset:63488
    v_mfma_f32_16x16x32_bf16 v[84:87], a[224:227], v[196:199], v[84:87]
    ds_read_b64_tr_b16 a[252:253], v65 offset:61440
    ds_read_b64_tr_b16 a[254:255], v65 offset:63488
    v_mfma_f32_16x16x32_bf16 v[92:95], a[228:231], v[196:199], v[92:95]
    ds_read_b64_tr_b16 a[192:193], v66 offset:32768
    ds_read_b64_tr_b16 a[194:195], v66 offset:34816
    v_mfma_f32_16x16x32_bf16 v[88:91], a[228:231], v[192:195], v[88:91]
    s_waitcnt lgkmcnt(10)
    buffer_store_dwordx4 v[60:63], v72, s[20:23], s49 offen offset:3584 sc1
    v_mfma_f32_16x16x32_bf16 v[80:83], a[232:235], v[200:203], v[80:83]
    ds_read_b64_tr_b16 a[196:197], v67 offset:32768
    v_mfma_f32_16x16x32_bf16 v[84:87], a[232:235], v[204:207], v[84:87]
    buffer_load_dwordx4 v11, s[8:11], s27 offen offset:1024 lds
    v_mfma_f32_16x16x32_bf16 v[92:95], a[236:239], v[204:207], v[92:95]
    ds_read_b64_tr_b16 a[198:199], v67 offset:34816
    ds_read_b64_tr_b16 a[200:201], v66 offset:36864
    v_mfma_f32_16x16x32_bf16 v[88:91], a[236:239], v[200:203], v[88:91]
    s_waitcnt lgkmcnt(9)
    ds_read_b64_tr_b16 a[202:203], v66 offset:38912
    ds_read_b64_tr_b16 a[204:205], v67 offset:36864
    v_mfma_f32_16x16x32_bf16 v[80:83], a[240:243], v[208:211], v[80:83]
    ds_read_b64_tr_b16 a[206:207], v67 offset:38912
    v_mfma_f32_16x16x32_bf16 v[84:87], a[240:243], v[212:215], v[84:87]
    ds_read_b64_tr_b16 a[208:209], v66 offset:40960
    ds_read_b64_tr_b16 a[210:211], v66 offset:43008
    v_mfma_f32_16x16x32_bf16 v[92:95], a[244:247], v[212:215], v[92:95]
    ds_read_b64_tr_b16 a[212:213], v67 offset:40960
    ds_read_b64_tr_b16 a[214:215], v67 offset:43008
    v_mfma_f32_16x16x32_bf16 v[88:91], a[244:247], v[208:211], v[88:91]
    s_waitcnt lgkmcnt(12)
    buffer_load_dwordx4 v12, s[8:11], s27 offen offset:2048 lds
    v_mfma_f32_16x16x32_bf16 v[80:83], a[248:251], v[216:219], v[80:83]
    ds_read_b64_tr_b16 a[216:217], v66 offset:45056
    v_mfma_f32_16x16x32_bf16 v[84:87], a[248:251], v[220:223], v[84:87]
    ds_read_b64_tr_b16 a[218:219], v66 offset:47104
    ds_read_b64_tr_b16 a[220:221], v67 offset:45056
    v_mfma_f32_16x16x32_bf16 v[92:95], a[252:255], v[220:223], v[92:95]
    ds_read_b64_tr_b16 a[222:223], v67 offset:47104
    ds_read_b64_tr_b16 a[224:225], v66 offset:49152
    v_mfma_f32_16x16x32_bf16 v[88:91], a[252:255], v[216:219], v[88:91]
    s_waitcnt lgkmcnt(13)
    ds_read_b64_tr_b16 a[226:227], v66 offset:51200
    v_mfma_f32_16x16x32_bf16 v[96:99], a[192:195], v[160:163], 0
    ds_read_b64_tr_b16 a[228:229], v67 offset:49152
    ds_read_b64_tr_b16 a[230:231], v67 offset:51200
    v_mfma_f32_16x16x32_bf16 v[100:103], a[192:195], v[164:167], 0
    buffer_load_dwordx4 v13, s[8:11], s27 offen offset:3072 lds
    v_mfma_f32_16x16x32_bf16 v[108:111], a[196:199], v[164:167], 0
    ds_read_b64_tr_b16 a[232:233], v66 offset:53248
    v_cvt_pk_bf16_f32 v48, v80, v81
    v_mfma_f32_16x16x32_bf16 v[104:107], a[196:199], v[160:163], 0
    s_waitcnt lgkmcnt(13)
    ds_read_b64_tr_b16 a[234:235], v66 offset:55296
    v_mfma_f32_16x16x32_bf16 v[96:99], a[200:203], v[168:171], v[96:99]
    ds_read_b64_tr_b16 a[236:237], v67 offset:53248
    v_cvt_pk_bf16_f32 v49, v82, v83
    v_mfma_f32_16x16x32_bf16 v[100:103], a[200:203], v[172:175], v[100:103]
    ds_read_b64_tr_b16 a[238:239], v67 offset:55296
    v_cvt_pk_bf16_f32 v50, v88, v89
    v_mfma_f32_16x16x32_bf16 v[108:111], a[204:207], v[172:175], v[108:111]
    v_cvt_pk_bf16_f32 v51, v90, v91
    v_mfma_f32_16x16x32_bf16 v[104:107], a[204:207], v[168:171], v[104:107]
    s_waitcnt lgkmcnt(12)
    ds_read_b64_tr_b16 a[240:241], v66 offset:57344
    ds_read_b64_tr_b16 a[242:243], v66 offset:59392
    v_mfma_f32_16x16x32_bf16 v[96:99], a[208:211], v[176:179], v[96:99]
    ds_read_b64_tr_b16 a[244:245], v67 offset:57344
    v_cvt_pk_bf16_f32 v52, v84, v85
    v_mfma_f32_16x16x32_bf16 v[100:103], a[208:211], v[180:183], v[100:103]
    v_cvt_pk_bf16_f32 v53, v86, v87
    v_mfma_f32_16x16x32_bf16 v[108:111], a[212:215], v[180:183], v[108:111]
    ds_read_b64_tr_b16 a[246:247], v67 offset:59392
    v_cvt_pk_bf16_f32 v54, v92, v93
    v_mfma_f32_16x16x32_bf16 v[104:107], a[212:215], v[176:179], v[104:107]
    s_waitcnt lgkmcnt(12)
    ds_read_b64_tr_b16 a[248:249], v66 offset:61440
    ds_read_b64_tr_b16 a[250:251], v66 offset:63488
    v_mfma_f32_16x16x32_bf16 v[96:99], a[216:219], v[184:187], v[96:99]
    v_cvt_pk_bf16_f32 v55, v94, v95
    v_mfma_f32_16x16x32_bf16 v[100:103], a[216:219], v[188:191], v[100:103]
    ds_read_b64_tr_b16 a[252:253], v67 offset:61440
    ds_read_b64_tr_b16 a[254:255], v67 offset:63488
    v_mfma_f32_16x16x32_bf16 v[108:111], a[220:223], v[188:191], v[108:111]
    s_add_u32 s48, s48, 4096
    buffer_store_dwordx4 v[48:51], v72, s[20:23], s48 offen offset:0 sc1
    v_mfma_f32_16x16x32_bf16 v[104:107], a[220:223], v[184:187], v[104:107]
    s_waitcnt lgkmcnt(12)
    v_mfma_f32_16x16x32_bf16 v[96:99], a[224:227], v[192:195], v[96:99]
    v_mfma_f32_16x16x32_bf16 v[100:103], a[224:227], v[196:199], v[100:103]
    v_mfma_f32_16x16x32_bf16 v[108:111], a[228:231], v[196:199], v[108:111]
    s_waitcnt vmcnt(26) lgkmcnt(0)
    v_mfma_f32_16x16x32_bf16 v[104:107], a[228:231], v[192:195], v[104:107]
    s_add_u32 s49, s49, 4096
    s_barrier
    buffer_store_dwordx4 v[52:55], v72, s[20:23], s49 offen offset:0 sc1
    v_mfma_f32_16x16x32_bf16 v[96:99], a[232:235], v[200:203], v[96:99]
    ds_read_b64_tr_b16 a[192:193], v68 offset:0
    ds_read_b64_tr_b16 a[194:195], v68 offset:2048
    v_mfma_f32_16x16x32_bf16 v[100:103], a[232:235], v[204:207], v[100:103]
    s_add_u32 m0, s37, 32768
    ds_read_b64_tr_b16 a[196:197], v69 offset:0
    v_mfma_f32_16x16x32_bf16 v[108:111], a[236:239], v[204:207], v[108:111]
    s_mov_b32 s27, 1024
    buffer_load_dwordx4 v10, s[8:11], s27 offen offset:0 lds
    v_mfma_f32_16x16x32_bf16 v[104:107], a[236:239], v[200:203], v[104:107]
    ds_read_b64_tr_b16 a[198:199], v69 offset:2048
    ds_read_b64_tr_b16 a[200:201], v68 offset:4096
    v_mfma_f32_16x16x32_bf16 v[96:99], a[240:243], v[208:211], v[96:99]
    ds_read_b64_tr_b16 a[202:203], v68 offset:6144
    ds_read_b64_tr_b16 a[204:205], v69 offset:4096
    v_mfma_f32_16x16x32_bf16 v[100:103], a[240:243], v[212:215], v[100:103]
    ds_read_b64_tr_b16 a[206:207], v69 offset:6144
    v_mfma_f32_16x16x32_bf16 v[108:111], a[244:247], v[212:215], v[108:111]
    ds_read_b64_tr_b16 a[208:209], v68 offset:8192
    ds_read_b64_tr_b16 a[210:211], v68 offset:10240
    v_mfma_f32_16x16x32_bf16 v[104:107], a[244:247], v[208:211], v[104:107]
    ds_read_b64_tr_b16 a[212:213], v69 offset:8192
    ds_read_b64_tr_b16 a[214:215], v69 offset:10240
    v_mfma_f32_16x16x32_bf16 v[96:99], a[248:251], v[216:219], v[96:99]
    buffer_load_dwordx4 v11, s[8:11], s27 offen offset:1024 lds
    v_mfma_f32_16x16x32_bf16 v[100:103], a[248:251], v[220:223], v[100:103]
    ds_read_b64_tr_b16 a[216:217], v68 offset:12288
    v_mfma_f32_16x16x32_bf16 v[108:111], a[252:255], v[220:223], v[108:111]
    ds_read_b64_tr_b16 a[218:219], v68 offset:14336
    ds_read_b64_tr_b16 a[220:221], v69 offset:12288
    v_mfma_f32_16x16x32_bf16 v[104:107], a[252:255], v[216:219], v[104:107]
    s_waitcnt lgkmcnt(11)
    ds_read_b64_tr_b16 a[222:223], v69 offset:14336
    ds_read_b64_tr_b16 a[224:225], v68 offset:16384
    v_mfma_f32_16x16x32_bf16 v[80:83], a[192:195], v[160:163], 0
    ds_read_b64_tr_b16 a[226:227], v68 offset:18432
    v_mfma_f32_16x16x32_bf16 v[84:87], a[192:195], v[164:167], 0
    ds_read_b64_tr_b16 a[228:229], v69 offset:16384
    ds_read_b64_tr_b16 a[230:231], v69 offset:18432
    v_mfma_f32_16x16x32_bf16 v[92:95], a[196:199], v[164:167], 0
    buffer_load_dwordx4 v12, s[8:11], s27 offen offset:2048 lds
    v_mfma_f32_16x16x32_bf16 v[88:91], a[196:199], v[160:163], 0
    s_waitcnt lgkmcnt(12)
    ds_read_b64_tr_b16 a[232:233], v68 offset:20480
    v_cvt_pk_bf16_f32 v56, v96, v97
    v_mfma_f32_16x16x32_bf16 v[80:83], a[200:203], v[168:171], v[80:83]
    v_cvt_pk_bf16_f32 v57, v98, v99
    v_mfma_f32_16x16x32_bf16 v[84:87], a[200:203], v[172:175], v[84:87]
    ds_read_b64_tr_b16 a[234:235], v68 offset:22528
    v_cvt_pk_bf16_f32 v58, v104, v105
    v_mfma_f32_16x16x32_bf16 v[92:95], a[204:207], v[172:175], v[92:95]
    ds_read_b64_tr_b16 a[236:237], v69 offset:20480
    v_cvt_pk_bf16_f32 v59, v106, v107
    v_mfma_f32_16x16x32_bf16 v[88:91], a[204:207], v[168:171], v[88:91]
    s_waitcnt lgkmcnt(11)
    ds_read_b64_tr_b16 a[238:239], v69 offset:22528
    v_mfma_f32_16x16x32_bf16 v[80:83], a[208:211], v[176:179], v[80:83]
    buffer_load_dwordx4 v13, s[8:11], s27 offen offset:3072 lds
    v_mfma_f32_16x16x32_bf16 v[84:87], a[208:211], v[180:183], v[84:87]
    ds_read_b64_tr_b16 a[240:241], v68 offset:24576
    v_cvt_pk_bf16_f32 v60, v100, v101
    v_mfma_f32_16x16x32_bf16 v[92:95], a[212:215], v[180:183], v[92:95]
    ds_read_b64_tr_b16 a[242:243], v68 offset:26624
    v_cvt_pk_bf16_f32 v61, v102, v103
    v_mfma_f32_16x16x32_bf16 v[88:91], a[212:215], v[176:179], v[88:91]
    s_waitcnt lgkmcnt(10)
    v_cvt_pk_bf16_f32 v62, v108, v109
    v_mfma_f32_16x16x32_bf16 v[80:83], a[216:219], v[184:187], v[80:83]
    ds_read_b64_tr_b16 a[244:245], v69 offset:24576
    v_cvt_pk_bf16_f32 v63, v110, v111
    v_mfma_f32_16x16x32_bf16 v[84:87], a[216:219], v[188:191], v[84:87]
    ds_read_b64_tr_b16 a[246:247], v69 offset:26624
    ds_read_b64_tr_b16 a[248:249], v68 offset:28672
    v_mfma_f32_16x16x32_bf16 v[92:95], a[220:223], v[188:191], v[92:95]
    s_add_u32 m0, s37, 49152
    buffer_store_dwordx4 v[56:59], v72, s[20:23], s48 offen offset:512 sc1
    v_mfma_f32_16x16x32_bf16 v[88:91], a[220:223], v[184:187], v[88:91]
    s_mov_b32 s27, 148480
    s_waitcnt lgkmcnt(9)
    buffer_load_dwordx4 v10, s[8:11], s27 offen offset:0 lds
    v_mfma_f32_16x16x32_bf16 v[80:83], a[224:227], v[192:195], v[80:83]
    ds_read_b64_tr_b16 a[250:251], v68 offset:30720
    v_mfma_f32_16x16x32_bf16 v[84:87], a[224:227], v[196:199], v[84:87]
    ds_read_b64_tr_b16 a[252:253], v69 offset:28672
    ds_read_b64_tr_b16 a[254:255], v69 offset:30720
    v_mfma_f32_16x16x32_bf16 v[92:95], a[228:231], v[196:199], v[92:95]
    ds_read_b64_tr_b16 a[192:193], v70 offset:0
    ds_read_b64_tr_b16 a[194:195], v70 offset:2048
    v_mfma_f32_16x16x32_bf16 v[88:91], a[228:231], v[192:195], v[88:91]
    s_waitcnt lgkmcnt(10)
    buffer_store_dwordx4 v[60:63], v72, s[20:23], s49 offen offset:512 sc1
    v_mfma_f32_16x16x32_bf16 v[80:83], a[232:235], v[200:203], v[80:83]
    ds_read_b64_tr_b16 a[196:197], v71 offset:0
    v_mfma_f32_16x16x32_bf16 v[84:87], a[232:235], v[204:207], v[84:87]
    buffer_load_dwordx4 v11, s[8:11], s27 offen offset:1024 lds
    v_mfma_f32_16x16x32_bf16 v[92:95], a[236:239], v[204:207], v[92:95]
    ds_read_b64_tr_b16 a[198:199], v71 offset:2048
    ds_read_b64_tr_b16 a[200:201], v70 offset:4096
    v_mfma_f32_16x16x32_bf16 v[88:91], a[236:239], v[200:203], v[88:91]
    s_waitcnt lgkmcnt(9)
    ds_read_b64_tr_b16 a[202:203], v70 offset:6144
    ds_read_b64_tr_b16 a[204:205], v71 offset:4096
    v_mfma_f32_16x16x32_bf16 v[80:83], a[240:243], v[208:211], v[80:83]
    ds_read_b64_tr_b16 a[206:207], v71 offset:6144
    v_mfma_f32_16x16x32_bf16 v[84:87], a[240:243], v[212:215], v[84:87]
    ds_read_b64_tr_b16 a[208:209], v70 offset:8192
    ds_read_b64_tr_b16 a[210:211], v70 offset:10240
    v_mfma_f32_16x16x32_bf16 v[92:95], a[244:247], v[212:215], v[92:95]
    ds_read_b64_tr_b16 a[212:213], v71 offset:8192
    ds_read_b64_tr_b16 a[214:215], v71 offset:10240
    v_mfma_f32_16x16x32_bf16 v[88:91], a[244:247], v[208:211], v[88:91]
    s_waitcnt lgkmcnt(12)
    buffer_load_dwordx4 v12, s[8:11], s27 offen offset:2048 lds
    v_mfma_f32_16x16x32_bf16 v[80:83], a[248:251], v[216:219], v[80:83]
    ds_read_b64_tr_b16 a[216:217], v70 offset:12288
    v_mfma_f32_16x16x32_bf16 v[84:87], a[248:251], v[220:223], v[84:87]
    ds_read_b64_tr_b16 a[218:219], v70 offset:14336
    ds_read_b64_tr_b16 a[220:221], v71 offset:12288
    v_mfma_f32_16x16x32_bf16 v[92:95], a[252:255], v[220:223], v[92:95]
    ds_read_b64_tr_b16 a[222:223], v71 offset:14336
    ds_read_b64_tr_b16 a[224:225], v70 offset:16384
    v_mfma_f32_16x16x32_bf16 v[88:91], a[252:255], v[216:219], v[88:91]
    s_waitcnt lgkmcnt(13)
    ds_read_b64_tr_b16 a[226:227], v70 offset:18432
    v_mfma_f32_16x16x32_bf16 v[96:99], a[192:195], v[160:163], 0
    ds_read_b64_tr_b16 a[228:229], v71 offset:16384
    ds_read_b64_tr_b16 a[230:231], v71 offset:18432
    v_mfma_f32_16x16x32_bf16 v[100:103], a[192:195], v[164:167], 0
    buffer_load_dwordx4 v13, s[8:11], s27 offen offset:3072 lds
    v_mfma_f32_16x16x32_bf16 v[108:111], a[196:199], v[164:167], 0
    ds_read_b64_tr_b16 a[232:233], v70 offset:20480
    v_cvt_pk_bf16_f32 v48, v80, v81
    v_mfma_f32_16x16x32_bf16 v[104:107], a[196:199], v[160:163], 0
    s_waitcnt lgkmcnt(13)
    ds_read_b64_tr_b16 a[234:235], v70 offset:22528
    v_mfma_f32_16x16x32_bf16 v[96:99], a[200:203], v[168:171], v[96:99]
    ds_read_b64_tr_b16 a[236:237], v71 offset:20480
    v_cvt_pk_bf16_f32 v49, v82, v83
    v_mfma_f32_16x16x32_bf16 v[100:103], a[200:203], v[172:175], v[100:103]
    ds_read_b64_tr_b16 a[238:239], v71 offset:22528
    v_cvt_pk_bf16_f32 v50, v88, v89
    v_mfma_f32_16x16x32_bf16 v[108:111], a[204:207], v[172:175], v[108:111]
    v_cvt_pk_bf16_f32 v51, v90, v91
    v_mfma_f32_16x16x32_bf16 v[104:107], a[204:207], v[168:171], v[104:107]
    s_waitcnt lgkmcnt(12)
    ds_read_b64_tr_b16 a[240:241], v70 offset:24576
    ds_read_b64_tr_b16 a[242:243], v70 offset:26624
    v_mfma_f32_16x16x32_bf16 v[96:99], a[208:211], v[176:179], v[96:99]
    ds_read_b64_tr_b16 a[244:245], v71 offset:24576
    v_cvt_pk_bf16_f32 v52, v84, v85
    v_mfma_f32_16x16x32_bf16 v[100:103], a[208:211], v[180:183], v[100:103]
    v_cvt_pk_bf16_f32 v53, v86, v87
    v_mfma_f32_16x16x32_bf16 v[108:111], a[212:215], v[180:183], v[108:111]
    ds_read_b64_tr_b16 a[246:247], v71 offset:26624
    v_cvt_pk_bf16_f32 v54, v92, v93
    v_mfma_f32_16x16x32_bf16 v[104:107], a[212:215], v[176:179], v[104:107]
    s_waitcnt lgkmcnt(12)
    ds_read_b64_tr_b16 a[248:249], v70 offset:28672
    ds_read_b64_tr_b16 a[250:251], v70 offset:30720
    v_mfma_f32_16x16x32_bf16 v[96:99], a[216:219], v[184:187], v[96:99]
    v_cvt_pk_bf16_f32 v55, v94, v95
    v_mfma_f32_16x16x32_bf16 v[100:103], a[216:219], v[188:191], v[100:103]
    ds_read_b64_tr_b16 a[252:253], v71 offset:28672
    ds_read_b64_tr_b16 a[254:255], v71 offset:30720
    v_mfma_f32_16x16x32_bf16 v[108:111], a[220:223], v[188:191], v[108:111]
    buffer_store_dwordx4 v[48:51], v72, s[20:23], s48 offen offset:1024 sc1
    v_mfma_f32_16x16x32_bf16 v[104:107], a[220:223], v[184:187], v[104:107]
    s_waitcnt lgkmcnt(12)
    v_mfma_f32_16x16x32_bf16 v[96:99], a[224:227], v[192:195], v[96:99]
    v_mfma_f32_16x16x32_bf16 v[100:103], a[224:227], v[196:199], v[100:103]
    v_mfma_f32_16x16x32_bf16 v[108:111], a[228:231], v[196:199], v[108:111]
    s_waitcnt vmcnt(26) lgkmcnt(0)
    v_mfma_f32_16x16x32_bf16 v[104:107], a[228:231], v[192:195], v[104:107]
    s_barrier
    buffer_store_dwordx4 v[52:55], v72, s[20:23], s49 offen offset:1024 sc1
    v_mfma_f32_16x16x32_bf16 v[96:99], a[232:235], v[200:203], v[96:99]
    ds_read_b64_tr_b16 a[192:193], v68 offset:32768
    v_mfma_f32_16x16x32_bf16 v[100:103], a[232:235], v[204:207], v[100:103]
    ds_read_b64_tr_b16 a[194:195], v68 offset:34816
    ds_read_b64_tr_b16 a[196:197], v69 offset:32768
    v_mfma_f32_16x16x32_bf16 v[108:111], a[236:239], v[204:207], v[108:111]
    ds_read_b64_tr_b16 a[198:199], v69 offset:34816
    v_mfma_f32_16x16x32_bf16 v[104:107], a[236:239], v[200:203], v[104:107]
    ds_read_b64_tr_b16 a[200:201], v68 offset:36864
    ds_read_b64_tr_b16 a[202:203], v68 offset:38912
    v_mfma_f32_16x16x32_bf16 v[96:99], a[240:243], v[208:211], v[96:99]
    ds_read_b64_tr_b16 a[204:205], v69 offset:36864
    v_mfma_f32_16x16x32_bf16 v[100:103], a[240:243], v[212:215], v[100:103]
    ds_read_b64_tr_b16 a[206:207], v69 offset:38912
    ds_read_b64_tr_b16 a[208:209], v68 offset:40960
    v_mfma_f32_16x16x32_bf16 v[108:111], a[244:247], v[212:215], v[108:111]
    ds_read_b64_tr_b16 a[210:211], v68 offset:43008
    v_mfma_f32_16x16x32_bf16 v[104:107], a[244:247], v[208:211], v[104:107]
    ds_read_b64_tr_b16 a[212:213], v69 offset:40960
    v_mfma_f32_16x16x32_bf16 v[96:99], a[248:251], v[216:219], v[96:99]
    ds_read_b64_tr_b16 a[214:215], v69 offset:43008
    ds_read_b64_tr_b16 a[216:217], v68 offset:45056
    v_mfma_f32_16x16x32_bf16 v[100:103], a[248:251], v[220:223], v[100:103]
    ds_read_b64_tr_b16 a[218:219], v68 offset:47104
    v_mfma_f32_16x16x32_bf16 v[108:111], a[252:255], v[220:223], v[108:111]
    ds_read_b64_tr_b16 a[220:221], v69 offset:45056
    ds_read_b64_tr_b16 a[222:223], v69 offset:47104
    v_mfma_f32_16x16x32_bf16 v[104:107], a[252:255], v[216:219], v[104:107]
    s_waitcnt lgkmcnt(12)
    ds_read_b64_tr_b16 a[224:225], v68 offset:49152
    v_mfma_f32_16x16x32_bf16 v[80:83], a[192:195], v[160:163], 0
    ds_read_b64_tr_b16 a[226:227], v68 offset:51200
    ds_read_b64_tr_b16 a[228:229], v69 offset:49152
    v_mfma_f32_16x16x32_bf16 v[84:87], a[192:195], v[164:167], 0
    ds_read_b64_tr_b16 a[230:231], v69 offset:51200
    v_mfma_f32_16x16x32_bf16 v[92:95], a[196:199], v[164:167], 0
    v_cvt_pk_bf16_f32 v56, v96, v97
    v_mfma_f32_16x16x32_bf16 v[88:91], a[196:199], v[160:163], 0
    s_waitcnt lgkmcnt(12)
    ds_read_b64_tr_b16 a[232:233], v68 offset:53248
    ds_read_b64_tr_b16 a[234:235], v68 offset:55296
    v_mfma_f32_16x16x32_bf16 v[80:83], a[200:203], v[168:171], v[80:83]
    v_cvt_pk_bf16_f32 v57, v98, v99
    v_mfma_f32_16x16x32_bf16 v[84:87], a[200:203], v[172:175], v[84:87]
    ds_read_b64_tr_b16 a[236:237], v69 offset:53248
    v_cvt_pk_bf16_f32 v58, v104, v105
    v_mfma_f32_16x16x32_bf16 v[92:95], a[204:207], v[172:175], v[92:95]
    v_cvt_pk_bf16_f32 v59, v106, v107
    v_mfma_f32_16x16x32_bf16 v[88:91], a[204:207], v[168:171], v[88:91]
    s_waitcnt lgkmcnt(11)
    ds_read_b64_tr_b16 a[238:239], v69 offset:55296
    ds_read_b64_tr_b16 a[240:241], v68 offset:57344
    v_mfma_f32_16x16x32_bf16 v[80:83], a[208:211], v[176:179], v[80:83]
    v_cvt_pk_bf16_f32 v60, v100, v101
    v_mfma_f32_16x16x32_bf16 v[84:87], a[208:211], v[180:183], v[84:87]
    v_cvt_pk_bf16_f32 v61, v102, v103
    v_mfma_f32_16x16x32_bf16 v[92:95], a[212:215], v[180:183], v[92:95]
    ds_read_b64_tr_b16 a[242:243], v68 offset:59392
    v_cvt_pk_bf16_f32 v62, v108, v109
    v_mfma_f32_16x16x32_bf16 v[88:91], a[212:215], v[176:179], v[88:91]
    s_waitcnt lgkmcnt(10)
    ds_read_b64_tr_b16 a[244:245], v69 offset:57344
    v_mfma_f32_16x16x32_bf16 v[80:83], a[216:219], v[184:187], v[80:83]
    ds_read_b64_tr_b16 a[246:247], v69 offset:59392
    v_cvt_pk_bf16_f32 v63, v110, v111
    v_mfma_f32_16x16x32_bf16 v[84:87], a[216:219], v[188:191], v[84:87]
    ds_read_b64_tr_b16 a[248:249], v68 offset:61440
    v_mfma_f32_16x16x32_bf16 v[92:95], a[220:223], v[188:191], v[92:95]
    buffer_store_dwordx4 v[56:59], v72, s[20:23], s48 offen offset:1536 sc1
    v_mfma_f32_16x16x32_bf16 v[88:91], a[220:223], v[184:187], v[88:91]
    s_waitcnt lgkmcnt(9)
    ds_read_b64_tr_b16 a[250:251], v68 offset:63488
    ds_read_b64_tr_b16 a[252:253], v69 offset:61440
    v_mfma_f32_16x16x32_bf16 v[80:83], a[224:227], v[192:195], v[80:83]
    ds_read_b64_tr_b16 a[254:255], v69 offset:63488
    v_mfma_f32_16x16x32_bf16 v[84:87], a[224:227], v[196:199], v[84:87]
    ds_read_b64_tr_b16 a[192:193], v70 offset:32768
    v_mfma_f32_16x16x32_bf16 v[92:95], a[228:231], v[196:199], v[92:95]
    ds_read_b64_tr_b16 a[194:195], v70 offset:34816
    ds_read_b64_tr_b16 a[196:197], v71 offset:32768
    v_mfma_f32_16x16x32_bf16 v[88:91], a[228:231], v[192:195], v[88:91]
    s_waitcnt lgkmcnt(11)
    buffer_store_dwordx4 v[60:63], v72, s[20:23], s49 offen offset:1536 sc1
    v_mfma_f32_16x16x32_bf16 v[80:83], a[232:235], v[200:203], v[80:83]
    ds_read_b64_tr_b16 a[198:199], v71 offset:34816
    v_mfma_f32_16x16x32_bf16 v[84:87], a[232:235], v[204:207], v[84:87]
    ds_read_b64_tr_b16 a[200:201], v70 offset:36864
    ds_read_b64_tr_b16 a[202:203], v70 offset:38912
    v_mfma_f32_16x16x32_bf16 v[92:95], a[236:239], v[204:207], v[92:95]
    ds_read_b64_tr_b16 a[204:205], v71 offset:36864
    v_mfma_f32_16x16x32_bf16 v[88:91], a[236:239], v[200:203], v[88:91]
    s_waitcnt lgkmcnt(11)
    ds_read_b64_tr_b16 a[206:207], v71 offset:38912
    ds_read_b64_tr_b16 a[208:209], v70 offset:40960
    v_mfma_f32_16x16x32_bf16 v[80:83], a[240:243], v[208:211], v[80:83]
    ds_read_b64_tr_b16 a[210:211], v70 offset:43008
    v_mfma_f32_16x16x32_bf16 v[84:87], a[240:243], v[212:215], v[84:87]
    ds_read_b64_tr_b16 a[212:213], v71 offset:40960
    v_mfma_f32_16x16x32_bf16 v[92:95], a[244:247], v[212:215], v[92:95]
    ds_read_b64_tr_b16 a[214:215], v71 offset:43008
    ds_read_b64_tr_b16 a[216:217], v70 offset:45056
    v_mfma_f32_16x16x32_bf16 v[88:91], a[244:247], v[208:211], v[88:91]
    s_waitcnt lgkmcnt(13)
    ds_read_b64_tr_b16 a[218:219], v70 offset:47104
    v_mfma_f32_16x16x32_bf16 v[80:83], a[248:251], v[216:219], v[80:83]
    ds_read_b64_tr_b16 a[220:221], v71 offset:45056
    ds_read_b64_tr_b16 a[222:223], v71 offset:47104
    v_mfma_f32_16x16x32_bf16 v[84:87], a[248:251], v[220:223], v[84:87]
    ds_read_b64_tr_b16 a[224:225], v70 offset:49152
    v_mfma_f32_16x16x32_bf16 v[92:95], a[252:255], v[220:223], v[92:95]
    ds_read_b64_tr_b16 a[226:227], v70 offset:51200
    ds_read_b64_tr_b16 a[228:229], v71 offset:49152
    v_mfma_f32_16x16x32_bf16 v[88:91], a[252:255], v[216:219], v[88:91]
    s_waitcnt lgkmcnt(15)
    ds_read_b64_tr_b16 a[230:231], v71 offset:51200
    v_mfma_f32_16x16x32_bf16 v[96:99], a[192:195], v[160:163], 0
    ds_read_b64_tr_b16 a[232:233], v70 offset:53248
    v_mfma_f32_16x16x32_bf16 v[100:103], a[192:195], v[164:167], 0
    ds_read_b64_tr_b16 a[234:235], v70 offset:55296
    ds_read_b64_tr_b16 a[236:237], v71 offset:53248
    v_mfma_f32_16x16x32_bf16 v[108:111], a[196:199], v[164:167], 0
    v_cvt_pk_bf16_f32 v48, v80, v81
    v_mfma_f32_16x16x32_bf16 v[104:107], a[196:199], v[160:163], 0
    s_waitcnt lgkmcnt(15)
    ds_read_b64_tr_b16 a[238:239], v71 offset:55296
    ds_read_b64_tr_b16 a[240:241], v70 offset:57344
    v_mfma_f32_16x16x32_bf16 v[96:99], a[200:203], v[168:171], v[96:99]
    v_cvt_pk_bf16_f32 v49, v82, v83
    v_mfma_f32_16x16x32_bf16 v[100:103], a[200:203], v[172:175], v[100:103]
    ds_read_b64_tr_b16 a[242:243], v70 offset:59392
    v_cvt_pk_bf16_f32 v50, v88, v89
    v_mfma_f32_16x16x32_bf16 v[108:111], a[204:207], v[172:175], v[108:111]
    v_cvt_pk_bf16_f32 v51, v90, v91
    v_mfma_f32_16x16x32_bf16 v[104:107], a[204:207], v[168:171], v[104:107]
    s_waitcnt lgkmcnt(14)
    ds_read_b64_tr_b16 a[244:245], v71 offset:57344
    v_mfma_f32_16x16x32_bf16 v[96:99], a[208:211], v[176:179], v[96:99]
    ds_read_b64_tr_b16 a[246:247], v71 offset:59392
    v_cvt_pk_bf16_f32 v52, v84, v85
    v_mfma_f32_16x16x32_bf16 v[100:103], a[208:211], v[180:183], v[100:103]
    v_cvt_pk_bf16_f32 v53, v86, v87
    v_mfma_f32_16x16x32_bf16 v[108:111], a[212:215], v[180:183], v[108:111]
    ds_read_b64_tr_b16 a[248:249], v70 offset:61440
    v_cvt_pk_bf16_f32 v54, v92, v93
    v_mfma_f32_16x16x32_bf16 v[104:107], a[212:215], v[176:179], v[104:107]
    s_waitcnt lgkmcnt(13)
    ds_read_b64_tr_b16 a[250:251], v70 offset:63488
    v_mfma_f32_16x16x32_bf16 v[96:99], a[216:219], v[184:187], v[96:99]
    ds_read_b64_tr_b16 a[252:253], v71 offset:61440
    v_cvt_pk_bf16_f32 v55, v94, v95
    v_mfma_f32_16x16x32_bf16 v[100:103], a[216:219], v[188:191], v[100:103]
    ds_read_b64_tr_b16 a[254:255], v71 offset:63488
    v_mfma_f32_16x16x32_bf16 v[108:111], a[220:223], v[188:191], v[108:111]
    buffer_store_dwordx4 v[48:51], v72, s[20:23], s48 offen offset:2048 sc1
    v_mfma_f32_16x16x32_bf16 v[104:107], a[220:223], v[184:187], v[104:107]
    s_waitcnt lgkmcnt(12)
    v_mfma_f32_16x16x32_bf16 v[96:99], a[224:227], v[192:195], v[96:99]
    v_mfma_f32_16x16x32_bf16 v[100:103], a[224:227], v[196:199], v[100:103]
    v_mfma_f32_16x16x32_bf16 v[108:111], a[228:231], v[196:199], v[108:111]
    s_waitcnt vmcnt(17) lgkmcnt(0)
    v_mfma_f32_16x16x32_bf16 v[104:107], a[228:231], v[192:195], v[104:107]
    s_barrier
    buffer_store_dwordx4 v[52:55], v72, s[20:23], s49 offen offset:2048 sc1
    v_mfma_f32_16x16x32_bf16 v[96:99], a[232:235], v[200:203], v[96:99]
    ds_read_b64_tr_b16 a[192:193], v64 offset:0
    v_mfma_f32_16x16x32_bf16 v[100:103], a[232:235], v[204:207], v[100:103]
    ds_read_b64_tr_b16 a[194:195], v64 offset:2048
    ds_read_b64_tr_b16 a[196:197], v65 offset:0
    v_mfma_f32_16x16x32_bf16 v[108:111], a[236:239], v[204:207], v[108:111]
    ds_read_b64_tr_b16 a[198:199], v65 offset:2048
    v_mfma_f32_16x16x32_bf16 v[104:107], a[236:239], v[200:203], v[104:107]
    ds_read_b64_tr_b16 a[200:201], v64 offset:4096
    ds_read_b64_tr_b16 a[202:203], v64 offset:6144
    v_mfma_f32_16x16x32_bf16 v[96:99], a[240:243], v[208:211], v[96:99]
    ds_read_b64_tr_b16 a[204:205], v65 offset:4096
    v_mfma_f32_16x16x32_bf16 v[100:103], a[240:243], v[212:215], v[100:103]
    ds_read_b64_tr_b16 a[206:207], v65 offset:6144
    ds_read_b64_tr_b16 a[208:209], v64 offset:8192
    v_mfma_f32_16x16x32_bf16 v[108:111], a[244:247], v[212:215], v[108:111]
    ds_read_b64_tr_b16 a[210:211], v64 offset:10240
    v_mfma_f32_16x16x32_bf16 v[104:107], a[244:247], v[208:211], v[104:107]
    ds_read_b64_tr_b16 a[212:213], v65 offset:8192
    v_mfma_f32_16x16x32_bf16 v[96:99], a[248:251], v[216:219], v[96:99]
    ds_read_b64_tr_b16 a[214:215], v65 offset:10240
    ds_read_b64_tr_b16 a[216:217], v64 offset:12288
    v_mfma_f32_16x16x32_bf16 v[100:103], a[248:251], v[220:223], v[100:103]
    ds_read_b64_tr_b16 a[218:219], v64 offset:14336
    v_mfma_f32_16x16x32_bf16 v[108:111], a[252:255], v[220:223], v[108:111]
    ds_read_b64_tr_b16 a[220:221], v65 offset:12288
    ds_read_b64_tr_b16 a[222:223], v65 offset:14336
    v_mfma_f32_16x16x32_bf16 v[104:107], a[252:255], v[216:219], v[104:107]
    s_waitcnt lgkmcnt(12)
    ds_read_b64_tr_b16 a[224:225], v64 offset:16384
    v_mfma_f32_16x16x32_bf16 v[80:83], a[192:195], v[160:163], 0
    ds_read_b64_tr_b16 a[226:227], v64 offset:18432
    ds_read_b64_tr_b16 a[228:229], v65 offset:16384
    v_mfma_f32_16x16x32_bf16 v[84:87], a[192:195], v[164:167], 0
    ds_read_b64_tr_b16 a[230:231], v65 offset:18432
    v_mfma_f32_16x16x32_bf16 v[92:95], a[196:199], v[164:167], 0
    v_cvt_pk_bf16_f32 v56, v96, v97
    v_mfma_f32_16x16x32_bf16 v[88:91], a[196:199], v[160:163], 0
    s_waitcnt lgkmcnt(12)
    ds_read_b64_tr_b16 a[232:233], v64 offset:20480
    ds_read_b64_tr_b16 a[234:235], v64 offset:22528
    v_mfma_f32_16x16x32_bf16 v[80:83], a[200:203], v[168:171], v[80:83]
    v_cvt_pk_bf16_f32 v57, v98, v99
    v_mfma_f32_16x16x32_bf16 v[84:87], a[200:203], v[172:175], v[84:87]
    ds_read_b64_tr_b16 a[236:237], v65 offset:20480
    v_cvt_pk_bf16_f32 v58, v104, v105
    v_mfma_f32_16x16x32_bf16 v[92:95], a[204:207], v[172:175], v[92:95]
    v_cvt_pk_bf16_f32 v59, v106, v107
    v_mfma_f32_16x16x32_bf16 v[88:91], a[204:207], v[168:171], v[88:91]
    s_waitcnt lgkmcnt(11)
    ds_read_b64_tr_b16 a[238:239], v65 offset:22528
    ds_read_b64_tr_b16 a[240:241], v64 offset:24576
    v_mfma_f32_16x16x32_bf16 v[80:83], a[208:211], v[176:179], v[80:83]
    v_cvt_pk_bf16_f32 v60, v100, v101
    v_mfma_f32_16x16x32_bf16 v[84:87], a[208:211], v[180:183], v[84:87]
    v_cvt_pk_bf16_f32 v61, v102, v103
    v_mfma_f32_16x16x32_bf16 v[92:95], a[212:215], v[180:183], v[92:95]
    ds_read_b64_tr_b16 a[242:243], v64 offset:26624
    v_cvt_pk_bf16_f32 v62, v108, v109
    v_mfma_f32_16x16x32_bf16 v[88:91], a[212:215], v[176:179], v[88:91]
    s_waitcnt lgkmcnt(10)
    ds_read_b64_tr_b16 a[244:245], v65 offset:24576
    v_mfma_f32_16x16x32_bf16 v[80:83], a[216:219], v[184:187], v[80:83]
    ds_read_b64_tr_b16 a[246:247], v65 offset:26624
    v_cvt_pk_bf16_f32 v63, v110, v111
    v_mfma_f32_16x16x32_bf16 v[84:87], a[216:219], v[188:191], v[84:87]
    ds_read_b64_tr_b16 a[248:249], v64 offset:28672
    v_mfma_f32_16x16x32_bf16 v[92:95], a[220:223], v[188:191], v[92:95]
    buffer_store_dwordx4 v[56:59], v72, s[20:23], s48 offen offset:2560 sc1
    v_mfma_f32_16x16x32_bf16 v[88:91], a[220:223], v[184:187], v[88:91]
    s_waitcnt lgkmcnt(9)
    ds_read_b64_tr_b16 a[250:251], v64 offset:30720
    ds_read_b64_tr_b16 a[252:253], v65 offset:28672
    v_mfma_f32_16x16x32_bf16 v[80:83], a[224:227], v[192:195], v[80:83]
    ds_read_b64_tr_b16 a[254:255], v65 offset:30720
    v_mfma_f32_16x16x32_bf16 v[84:87], a[224:227], v[196:199], v[84:87]
    ds_read_b64_tr_b16 a[192:193], v66 offset:0
    v_mfma_f32_16x16x32_bf16 v[92:95], a[228:231], v[196:199], v[92:95]
    ds_read_b64_tr_b16 a[194:195], v66 offset:2048
    ds_read_b64_tr_b16 a[196:197], v67 offset:0
    v_mfma_f32_16x16x32_bf16 v[88:91], a[228:231], v[192:195], v[88:91]
    s_waitcnt lgkmcnt(11)
    buffer_store_dwordx4 v[60:63], v72, s[20:23], s49 offen offset:2560 sc1
    v_mfma_f32_16x16x32_bf16 v[80:83], a[232:235], v[200:203], v[80:83]
    ds_read_b64_tr_b16 a[198:199], v67 offset:2048
    v_mfma_f32_16x16x32_bf16 v[84:87], a[232:235], v[204:207], v[84:87]
    ds_read_b64_tr_b16 a[200:201], v66 offset:4096
    ds_read_b64_tr_b16 a[202:203], v66 offset:6144
    v_mfma_f32_16x16x32_bf16 v[92:95], a[236:239], v[204:207], v[92:95]
    ds_read_b64_tr_b16 a[204:205], v67 offset:4096
    v_mfma_f32_16x16x32_bf16 v[88:91], a[236:239], v[200:203], v[88:91]
    s_waitcnt lgkmcnt(11)
    ds_read_b64_tr_b16 a[206:207], v67 offset:6144
    ds_read_b64_tr_b16 a[208:209], v66 offset:8192
    v_mfma_f32_16x16x32_bf16 v[80:83], a[240:243], v[208:211], v[80:83]
    ds_read_b64_tr_b16 a[210:211], v66 offset:10240
    v_mfma_f32_16x16x32_bf16 v[84:87], a[240:243], v[212:215], v[84:87]
    ds_read_b64_tr_b16 a[212:213], v67 offset:8192
    v_mfma_f32_16x16x32_bf16 v[92:95], a[244:247], v[212:215], v[92:95]
    ds_read_b64_tr_b16 a[214:215], v67 offset:10240
    ds_read_b64_tr_b16 a[216:217], v66 offset:12288
    v_mfma_f32_16x16x32_bf16 v[88:91], a[244:247], v[208:211], v[88:91]
    s_waitcnt lgkmcnt(13)
    ds_read_b64_tr_b16 a[218:219], v66 offset:14336
    v_mfma_f32_16x16x32_bf16 v[80:83], a[248:251], v[216:219], v[80:83]
    ds_read_b64_tr_b16 a[220:221], v67 offset:12288
    ds_read_b64_tr_b16 a[222:223], v67 offset:14336
    v_mfma_f32_16x16x32_bf16 v[84:87], a[248:251], v[220:223], v[84:87]
    ds_read_b64_tr_b16 a[224:225], v66 offset:16384
    v_mfma_f32_16x16x32_bf16 v[92:95], a[252:255], v[220:223], v[92:95]
    ds_read_b64_tr_b16 a[226:227], v66 offset:18432
    ds_read_b64_tr_b16 a[228:229], v67 offset:16384
    v_mfma_f32_16x16x32_bf16 v[88:91], a[252:255], v[216:219], v[88:91]
    s_waitcnt lgkmcnt(15)
    ds_read_b64_tr_b16 a[230:231], v67 offset:18432
    v_mfma_f32_16x16x32_bf16 v[96:99], a[192:195], v[160:163], 0
    ds_read_b64_tr_b16 a[232:233], v66 offset:20480
    v_mfma_f32_16x16x32_bf16 v[100:103], a[192:195], v[164:167], 0
    ds_read_b64_tr_b16 a[234:235], v66 offset:22528
    ds_read_b64_tr_b16 a[236:237], v67 offset:20480
    v_mfma_f32_16x16x32_bf16 v[108:111], a[196:199], v[164:167], 0
    v_cvt_pk_bf16_f32 v48, v80, v81
    v_mfma_f32_16x16x32_bf16 v[104:107], a[196:199], v[160:163], 0
    s_waitcnt lgkmcnt(15)
    ds_read_b64_tr_b16 a[238:239], v67 offset:22528
    ds_read_b64_tr_b16 a[240:241], v66 offset:24576
    v_mfma_f32_16x16x32_bf16 v[96:99], a[200:203], v[168:171], v[96:99]
    v_cvt_pk_bf16_f32 v49, v82, v83
    v_mfma_f32_16x16x32_bf16 v[100:103], a[200:203], v[172:175], v[100:103]
    ds_read_b64_tr_b16 a[242:243], v66 offset:26624
    v_cvt_pk_bf16_f32 v50, v88, v89
    v_mfma_f32_16x16x32_bf16 v[108:111], a[204:207], v[172:175], v[108:111]
    v_cvt_pk_bf16_f32 v51, v90, v91
    v_mfma_f32_16x16x32_bf16 v[104:107], a[204:207], v[168:171], v[104:107]
    s_waitcnt lgkmcnt(14)
    ds_read_b64_tr_b16 a[244:245], v67 offset:24576
    v_mfma_f32_16x16x32_bf16 v[96:99], a[208:211], v[176:179], v[96:99]
    ds_read_b64_tr_b16 a[246:247], v67 offset:26624
    v_cvt_pk_bf16_f32 v52, v84, v85
    v_mfma_f32_16x16x32_bf16 v[100:103], a[208:211], v[180:183], v[100:103]
    v_cvt_pk_bf16_f32 v53, v86, v87
    v_mfma_f32_16x16x32_bf16 v[108:111], a[212:215], v[180:183], v[108:111]
    ds_read_b64_tr_b16 a[248:249], v66 offset:28672
    v_cvt_pk_bf16_f32 v54, v92, v93
    v_mfma_f32_16x16x32_bf16 v[104:107], a[212:215], v[176:179], v[104:107]
    s_waitcnt lgkmcnt(13)
    ds_read_b64_tr_b16 a[250:251], v66 offset:30720
    v_mfma_f32_16x16x32_bf16 v[96:99], a[216:219], v[184:187], v[96:99]
    ds_read_b64_tr_b16 a[252:253], v67 offset:28672
    v_cvt_pk_bf16_f32 v55, v94, v95
    v_mfma_f32_16x16x32_bf16 v[100:103], a[216:219], v[188:191], v[100:103]
    ds_read_b64_tr_b16 a[254:255], v67 offset:30720
    v_mfma_f32_16x16x32_bf16 v[108:111], a[220:223], v[188:191], v[108:111]
    buffer_store_dwordx4 v[48:51], v72, s[20:23], s48 offen offset:3072 sc1
    v_mfma_f32_16x16x32_bf16 v[104:107], a[220:223], v[184:187], v[104:107]
    s_waitcnt lgkmcnt(12)
    v_mfma_f32_16x16x32_bf16 v[96:99], a[224:227], v[192:195], v[96:99]
    v_mfma_f32_16x16x32_bf16 v[100:103], a[224:227], v[196:199], v[100:103]
    v_mfma_f32_16x16x32_bf16 v[108:111], a[228:231], v[196:199], v[108:111]
    s_waitcnt vmcnt(9) lgkmcnt(0)
    v_mfma_f32_16x16x32_bf16 v[104:107], a[228:231], v[192:195], v[104:107]
    s_barrier
    buffer_store_dwordx4 v[52:55], v72, s[20:23], s49 offen offset:3072 sc1
    v_mfma_f32_16x16x32_bf16 v[96:99], a[232:235], v[200:203], v[96:99]
    ds_read_b64_tr_b16 a[192:193], v64 offset:32768
    v_mfma_f32_16x16x32_bf16 v[100:103], a[232:235], v[204:207], v[100:103]
    ds_read_b64_tr_b16 a[194:195], v64 offset:34816
    ds_read_b64_tr_b16 a[196:197], v65 offset:32768
    v_mfma_f32_16x16x32_bf16 v[108:111], a[236:239], v[204:207], v[108:111]
    ds_read_b64_tr_b16 a[198:199], v65 offset:34816
    v_mfma_f32_16x16x32_bf16 v[104:107], a[236:239], v[200:203], v[104:107]
    ds_read_b64_tr_b16 a[200:201], v64 offset:36864
    ds_read_b64_tr_b16 a[202:203], v64 offset:38912
    v_mfma_f32_16x16x32_bf16 v[96:99], a[240:243], v[208:211], v[96:99]
    ds_read_b64_tr_b16 a[204:205], v65 offset:36864
    v_mfma_f32_16x16x32_bf16 v[100:103], a[240:243], v[212:215], v[100:103]
    ds_read_b64_tr_b16 a[206:207], v65 offset:38912
    ds_read_b64_tr_b16 a[208:209], v64 offset:40960
    v_mfma_f32_16x16x32_bf16 v[108:111], a[244:247], v[212:215], v[108:111]
    ds_read_b64_tr_b16 a[210:211], v64 offset:43008
    v_mfma_f32_16x16x32_bf16 v[104:107], a[244:247], v[208:211], v[104:107]
    ds_read_b64_tr_b16 a[212:213], v65 offset:40960
    v_mfma_f32_16x16x32_bf16 v[96:99], a[248:251], v[216:219], v[96:99]
    ds_read_b64_tr_b16 a[214:215], v65 offset:43008
    ds_read_b64_tr_b16 a[216:217], v64 offset:45056
    v_mfma_f32_16x16x32_bf16 v[100:103], a[248:251], v[220:223], v[100:103]
    ds_read_b64_tr_b16 a[218:219], v64 offset:47104
    v_mfma_f32_16x16x32_bf16 v[108:111], a[252:255], v[220:223], v[108:111]
    ds_read_b64_tr_b16 a[220:221], v65 offset:45056
    ds_read_b64_tr_b16 a[222:223], v65 offset:47104
    v_mfma_f32_16x16x32_bf16 v[104:107], a[252:255], v[216:219], v[104:107]
    s_waitcnt lgkmcnt(12)
    ds_read_b64_tr_b16 a[224:225], v64 offset:49152
    v_mfma_f32_16x16x32_bf16 v[80:83], a[192:195], v[160:163], 0
    ds_read_b64_tr_b16 a[226:227], v64 offset:51200
    ds_read_b64_tr_b16 a[228:229], v65 offset:49152
    v_mfma_f32_16x16x32_bf16 v[84:87], a[192:195], v[164:167], 0
    ds_read_b64_tr_b16 a[230:231], v65 offset:51200
    v_mfma_f32_16x16x32_bf16 v[92:95], a[196:199], v[164:167], 0
    v_cvt_pk_bf16_f32 v56, v96, v97
    v_mfma_f32_16x16x32_bf16 v[88:91], a[196:199], v[160:163], 0
    s_waitcnt lgkmcnt(12)
    ds_read_b64_tr_b16 a[232:233], v64 offset:53248
    ds_read_b64_tr_b16 a[234:235], v64 offset:55296
    v_mfma_f32_16x16x32_bf16 v[80:83], a[200:203], v[168:171], v[80:83]
    v_cvt_pk_bf16_f32 v57, v98, v99
    v_mfma_f32_16x16x32_bf16 v[84:87], a[200:203], v[172:175], v[84:87]
    ds_read_b64_tr_b16 a[236:237], v65 offset:53248
    v_cvt_pk_bf16_f32 v58, v104, v105
    v_mfma_f32_16x16x32_bf16 v[92:95], a[204:207], v[172:175], v[92:95]
    v_cvt_pk_bf16_f32 v59, v106, v107
    v_mfma_f32_16x16x32_bf16 v[88:91], a[204:207], v[168:171], v[88:91]
    s_waitcnt lgkmcnt(11)
    ds_read_b64_tr_b16 a[238:239], v65 offset:55296
    ds_read_b64_tr_b16 a[240:241], v64 offset:57344
    v_mfma_f32_16x16x32_bf16 v[80:83], a[208:211], v[176:179], v[80:83]
    v_cvt_pk_bf16_f32 v60, v100, v101
    v_mfma_f32_16x16x32_bf16 v[84:87], a[208:211], v[180:183], v[84:87]
    v_cvt_pk_bf16_f32 v61, v102, v103
    v_mfma_f32_16x16x32_bf16 v[92:95], a[212:215], v[180:183], v[92:95]
    ds_read_b64_tr_b16 a[242:243], v64 offset:59392
    v_cvt_pk_bf16_f32 v62, v108, v109
    v_mfma_f32_16x16x32_bf16 v[88:91], a[212:215], v[176:179], v[88:91]
    s_waitcnt lgkmcnt(10)
    ds_read_b64_tr_b16 a[244:245], v65 offset:57344
    v_mfma_f32_16x16x32_bf16 v[80:83], a[216:219], v[184:187], v[80:83]
    ds_read_b64_tr_b16 a[246:247], v65 offset:59392
    v_cvt_pk_bf16_f32 v63, v110, v111
    v_mfma_f32_16x16x32_bf16 v[84:87], a[216:219], v[188:191], v[84:87]
    ds_read_b64_tr_b16 a[248:249], v64 offset:61440
    v_mfma_f32_16x16x32_bf16 v[92:95], a[220:223], v[188:191], v[92:95]
    buffer_store_dwordx4 v[56:59], v72, s[20:23], s48 offen offset:3584 sc1
    v_mfma_f32_16x16x32_bf16 v[88:91], a[220:223], v[184:187], v[88:91]
    s_waitcnt lgkmcnt(9)
    ds_read_b64_tr_b16 a[250:251], v64 offset:63488
    ds_read_b64_tr_b16 a[252:253], v65 offset:61440
    v_mfma_f32_16x16x32_bf16 v[80:83], a[224:227], v[192:195], v[80:83]
    ds_read_b64_tr_b16 a[254:255], v65 offset:63488
    v_mfma_f32_16x16x32_bf16 v[84:87], a[224:227], v[196:199], v[84:87]
    ds_read_b64_tr_b16 a[192:193], v66 offset:32768
    v_mfma_f32_16x16x32_bf16 v[92:95], a[228:231], v[196:199], v[92:95]
    ds_read_b64_tr_b16 a[194:195], v66 offset:34816
    ds_read_b64_tr_b16 a[196:197], v67 offset:32768
    v_mfma_f32_16x16x32_bf16 v[88:91], a[228:231], v[192:195], v[88:91]
    s_waitcnt lgkmcnt(11)
    buffer_store_dwordx4 v[60:63], v72, s[20:23], s49 offen offset:3584 sc1
    v_mfma_f32_16x16x32_bf16 v[80:83], a[232:235], v[200:203], v[80:83]
    ds_read_b64_tr_b16 a[198:199], v67 offset:34816
    v_mfma_f32_16x16x32_bf16 v[84:87], a[232:235], v[204:207], v[84:87]
    ds_read_b64_tr_b16 a[200:201], v66 offset:36864
    ds_read_b64_tr_b16 a[202:203], v66 offset:38912
    v_mfma_f32_16x16x32_bf16 v[92:95], a[236:239], v[204:207], v[92:95]
    ds_read_b64_tr_b16 a[204:205], v67 offset:36864
    v_mfma_f32_16x16x32_bf16 v[88:91], a[236:239], v[200:203], v[88:91]
    s_waitcnt lgkmcnt(11)
    ds_read_b64_tr_b16 a[206:207], v67 offset:38912
    ds_read_b64_tr_b16 a[208:209], v66 offset:40960
    v_mfma_f32_16x16x32_bf16 v[80:83], a[240:243], v[208:211], v[80:83]
    ds_read_b64_tr_b16 a[210:211], v66 offset:43008
    v_mfma_f32_16x16x32_bf16 v[84:87], a[240:243], v[212:215], v[84:87]
    ds_read_b64_tr_b16 a[212:213], v67 offset:40960
    v_mfma_f32_16x16x32_bf16 v[92:95], a[244:247], v[212:215], v[92:95]
    ds_read_b64_tr_b16 a[214:215], v67 offset:43008
    ds_read_b64_tr_b16 a[216:217], v66 offset:45056
    v_mfma_f32_16x16x32_bf16 v[88:91], a[244:247], v[208:211], v[88:91]
    s_waitcnt lgkmcnt(13)
    ds_read_b64_tr_b16 a[218:219], v66 offset:47104
    v_mfma_f32_16x16x32_bf16 v[80:83], a[248:251], v[216:219], v[80:83]
    ds_read_b64_tr_b16 a[220:221], v67 offset:45056
    ds_read_b64_tr_b16 a[222:223], v67 offset:47104
    v_mfma_f32_16x16x32_bf16 v[84:87], a[248:251], v[220:223], v[84:87]
    ds_read_b64_tr_b16 a[224:225], v66 offset:49152
    v_mfma_f32_16x16x32_bf16 v[92:95], a[252:255], v[220:223], v[92:95]
    ds_read_b64_tr_b16 a[226:227], v66 offset:51200
    ds_read_b64_tr_b16 a[228:229], v67 offset:49152
    v_mfma_f32_16x16x32_bf16 v[88:91], a[252:255], v[216:219], v[88:91]
    s_waitcnt lgkmcnt(15)
    ds_read_b64_tr_b16 a[230:231], v67 offset:51200
    v_mfma_f32_16x16x32_bf16 v[96:99], a[192:195], v[160:163], 0
    ds_read_b64_tr_b16 a[232:233], v66 offset:53248
    v_mfma_f32_16x16x32_bf16 v[100:103], a[192:195], v[164:167], 0
    ds_read_b64_tr_b16 a[234:235], v66 offset:55296
    ds_read_b64_tr_b16 a[236:237], v67 offset:53248
    v_mfma_f32_16x16x32_bf16 v[108:111], a[196:199], v[164:167], 0
    v_cvt_pk_bf16_f32 v48, v80, v81
    v_mfma_f32_16x16x32_bf16 v[104:107], a[196:199], v[160:163], 0
    s_waitcnt lgkmcnt(15)
    ds_read_b64_tr_b16 a[238:239], v67 offset:55296
    ds_read_b64_tr_b16 a[240:241], v66 offset:57344
    v_mfma_f32_16x16x32_bf16 v[96:99], a[200:203], v[168:171], v[96:99]
    v_cvt_pk_bf16_f32 v49, v82, v83
    v_mfma_f32_16x16x32_bf16 v[100:103], a[200:203], v[172:175], v[100:103]
    ds_read_b64_tr_b16 a[242:243], v66 offset:59392
    v_cvt_pk_bf16_f32 v50, v88, v89
    v_mfma_f32_16x16x32_bf16 v[108:111], a[204:207], v[172:175], v[108:111]
    v_cvt_pk_bf16_f32 v51, v90, v91
    v_mfma_f32_16x16x32_bf16 v[104:107], a[204:207], v[168:171], v[104:107]
    s_waitcnt lgkmcnt(14)
    ds_read_b64_tr_b16 a[244:245], v67 offset:57344
    v_mfma_f32_16x16x32_bf16 v[96:99], a[208:211], v[176:179], v[96:99]
    ds_read_b64_tr_b16 a[246:247], v67 offset:59392
    v_cvt_pk_bf16_f32 v52, v84, v85
    v_mfma_f32_16x16x32_bf16 v[100:103], a[208:211], v[180:183], v[100:103]
    v_cvt_pk_bf16_f32 v53, v86, v87
    v_mfma_f32_16x16x32_bf16 v[108:111], a[212:215], v[180:183], v[108:111]
    ds_read_b64_tr_b16 a[248:249], v66 offset:61440
    v_cvt_pk_bf16_f32 v54, v92, v93
    v_mfma_f32_16x16x32_bf16 v[104:107], a[212:215], v[176:179], v[104:107]
    s_waitcnt lgkmcnt(13)
    ds_read_b64_tr_b16 a[250:251], v66 offset:63488
    v_mfma_f32_16x16x32_bf16 v[96:99], a[216:219], v[184:187], v[96:99]
    ds_read_b64_tr_b16 a[252:253], v67 offset:61440
    v_cvt_pk_bf16_f32 v55, v94, v95
    v_mfma_f32_16x16x32_bf16 v[100:103], a[216:219], v[188:191], v[100:103]
    ds_read_b64_tr_b16 a[254:255], v67 offset:63488
    v_mfma_f32_16x16x32_bf16 v[108:111], a[220:223], v[188:191], v[108:111]
    s_add_u32 s48, s48, 4096
    buffer_store_dwordx4 v[48:51], v72, s[20:23], s48 offen offset:0 sc1
    v_mfma_f32_16x16x32_bf16 v[104:107], a[220:223], v[184:187], v[104:107]
    s_waitcnt lgkmcnt(12)
    v_mfma_f32_16x16x32_bf16 v[96:99], a[224:227], v[192:195], v[96:99]
    v_mfma_f32_16x16x32_bf16 v[100:103], a[224:227], v[196:199], v[100:103]
    v_mfma_f32_16x16x32_bf16 v[108:111], a[228:231], v[196:199], v[108:111]
    v_mfma_f32_16x16x32_bf16 v[104:107], a[228:231], v[192:195], v[104:107]
    s_add_u32 s49, s49, 4096
    s_waitcnt lgkmcnt(8)
    buffer_store_dwordx4 v[52:55], v72, s[20:23], s49 offen offset:0 sc1
    v_mfma_f32_16x16x32_bf16 v[96:99], a[232:235], v[200:203], v[96:99]
    v_mfma_f32_16x16x32_bf16 v[100:103], a[232:235], v[204:207], v[100:103]
    v_mfma_f32_16x16x32_bf16 v[108:111], a[236:239], v[204:207], v[108:111]
    v_mfma_f32_16x16x32_bf16 v[104:107], a[236:239], v[200:203], v[104:107]
    s_waitcnt lgkmcnt(4)
    v_mfma_f32_16x16x32_bf16 v[96:99], a[240:243], v[208:211], v[96:99]
    v_mfma_f32_16x16x32_bf16 v[100:103], a[240:243], v[212:215], v[100:103]
    v_mfma_f32_16x16x32_bf16 v[108:111], a[244:247], v[212:215], v[108:111]
    v_mfma_f32_16x16x32_bf16 v[104:107], a[244:247], v[208:211], v[104:107]
    s_waitcnt lgkmcnt(0)
    v_mfma_f32_16x16x32_bf16 v[96:99], a[248:251], v[216:219], v[96:99]
    v_mfma_f32_16x16x32_bf16 v[100:103], a[248:251], v[220:223], v[100:103]
    v_mfma_f32_16x16x32_bf16 v[108:111], a[252:255], v[220:223], v[108:111]
    v_mfma_f32_16x16x32_bf16 v[104:107], a[252:255], v[216:219], v[104:107]
    s_nop 7
    s_load_dwordx2 s[96:97], s[0:1], 0
    s_lshl_b32 s12, s26, 8
    s_add_u32 s12, s12, 3153920
    buffer_load_dword v118, off, s[20:23], s12 sc1
    v_cvt_pk_bf16_f32 v56, v96, v97
    v_cvt_pk_bf16_f32 v57, v98, v99
    v_cvt_pk_bf16_f32 v58, v104, v105
    v_cvt_pk_bf16_f32 v59, v106, v107
    v_cvt_pk_bf16_f32 v60, v100, v101
    v_cvt_pk_bf16_f32 v61, v102, v103
    v_cvt_pk_bf16_f32 v62, v108, v109
    v_cvt_pk_bf16_f32 v63, v110, v111
    buffer_store_dwordx4 v[56:59], v72, s[20:23], s48 offen offset:512 sc1
    buffer_store_dwordx4 v[60:63], v72, s[20:23], s49 offen offset:512 sc1
    s_mov_b32 s13, s25
    s_mov_b32 s84, 0
    v_mov_b32 v1, 131072
    v_mov_b32 v116, 0
    v_mov_b32 v117, 0
    ds_write_b64 v1, v[116:117]
    s_waitcnt vmcnt(0) lgkmcnt(0)
    s_barrier
    v_readfirstlane_b32 s16, v118
    v_mov_b32 v10, 131072
    s_lshl_b32 s87, 1, s25
    s_cmp_lg_u32 s24, 3
    s_cbranch_scc1 WORK_adaLN_cond__gqa_block_cached__glu_gated_geglu__prompt_kernel
    s_mov_b64 exec, 1
    v_mov_b32 v12, s87
    v_mov_b32 v13, 0
    buffer_atomic_add v12, off, s[20:23], s12 sc0 sc1
    s_waitcnt vmcnt(0)
    v_readfirstlane_b32 s16, v12
    s_or_b32 s16, s16, s87
    s_and_b32 s88, s16, 65535
    s_cmp_eq_u32 s88, 65535
    s_cbranch_scc1 TELL_adaLN_cond__gqa_block_cached__glu_gated_geglu__prompt_kernel
POLL_adaLN_cond__gqa_block_cached__glu_gated_geglu__prompt_kernel:
    buffer_load_dword v14, off, s[20:23], s12 sc1
    v_mov_b32 v12, s88
    s_add_u32 s84, s84, 1
    ds_write_b32 v10, v12
    s_waitcnt vmcnt(0) lgkmcnt(0)
    v_readfirstlane_b32 s88, v14
    s_and_b32 s88, s88, 65535
    s_mov_b32 s16, s88
    s_cmp_eq_u32 s88, 65535
    s_cbranch_scc1 TELL_adaLN_cond__gqa_block_cached__glu_gated_geglu__prompt_kernel
    s_cmp_lt_u32 s84, 16384
    s_cbranch_scc1 POLL_adaLN_cond__gqa_block_cached__glu_gated_geglu__prompt_kernel
    s_lshl_b32 s87, s87, 16
    v_mov_b32 v12, s87
    buffer_atomic_add v12, off, s[20:23], s12 sc0 sc1
    s_waitcnt vmcnt(0)
    v_readfirstlane_b32 s16, v12
    s_and_b32 s16, s16, 65535
    s_cmp_lg_u32 s16, 65535
    s_cselect_b32 s87, 1, 0
    v_mov_b32 v13, s87
TELL_adaLN_cond__gqa_block_cached__glu_gated_geglu__prompt_kernel:
    v_mov_b32 v12, s16
    ds_write_b64 v10, v[12:13]
    s_mov_b64 exec, -1
    s_waitcnt lgkmcnt(0)
    s_branch FIN_adaLN_cond__gqa_block_cached__glu_gated_geglu__prompt_kernel
WORK_adaLN_cond__gqa_block_cached__glu_gated_geglu__prompt_kernel:
    s_or_b32 s16, s16, s87
    s_mul_i32 s87, s24, 3072
    v_and_b32 v1, 7, v0
    v_lshlrev_b32 v6, 4, v0
    v_add_u32 v5, s87, v6
    v_lshrrev_b32 v2, 5, v0
    v_lshl_add_u32 v3, v1, 4, s87
    v_lshl_add_u32 v3, v2, 9, v3
    v_bfe_u32 v2, v0, 3, 1
    v_lshl_add_u32 v3, v2, 8, v3
    v_bfe_u32 v2, v0, 4, 1
    v_lshl_add_u32 v3, v2, 7, v3
    v_cmp_gt_u32 vcc, 48, v0
    v_lshrrev_b32 v2, 3, v0
    v_lshl_add_u32 v7, v2, 5, s87
    v_cndmask_b32 v6, 2.0, v6, vcc
    v_lshlrev_b32 v8, 8, v2
    v_lshl_add_u32 v8, v1, 4, v8
    s_mul_i32 s87, s24, 384
    v_mul_u32_u24 v4, 1152, v1
    v_lshl_add_u32 v4, v2, 4, v4
    v_add_u32 v4, s87, v4
    s_mov_b32 s8, s96
    s_and_b32 s9, s97, 0xffff
    s_mov_b32 s10, 2359296
    s_mov_b32 s11, 0x00020000
PIECE_adaLN_cond__gqa_block_cached__glu_gated_geglu__prompt_kernel:
    s_mul_i32 s95, s26, 16
    s_add_u32 s95, s95, s13
    s_mul_i32 s19, s95, 9216
    s_mul_i32 s17, s19, 16
    s_add_u32 s17, s17, 67108864
    s_add_u32 s18, s19, 20971520
    s_or_b32 s89, s13, 1
    s_add_u32 s89, s89, 1
    s_mov_b32 s15, 0
    s_mov_b32 s94, 16
    s_mov_b32 s85, 0x3f80
    s_mov_b32 s86, 0x3f800000
    buffer_load_dwordx4 a[0:3], v4, s[8:11], s19 offen offset:0
    buffer_load_dwordx4 a[4:7], v4, s[8:11], s19 offen offset:128
    buffer_load_dwordx4 a[8:11], v4, s[8:11], s19 offen offset:256
    s_mul_i32 s87, s24, 768
    s_add_u32 s88, s87, 2363904
    buffer_load_dwordx4 v[16:19], v6, s[20:23], s88 offen
    s_add_u32 s88, s87, 2377728
    buffer_load_dwordx4 v[20:23], v6, s[20:23], s88 offen
    s_add_u32 s88, s87, 2391552
    buffer_load_dwordx4 v[24:27], v6, s[20:23], s88 offen
    s_add_u32 s88, s87, 2405376
    buffer_load_dwordx4 v[28:31], v6, s[20:23], s88 offen
    s_add_u32 s88, s87, 2366208
    buffer_load_dwordx4 v[32:35], v6, s[20:23], s88 offen
    s_add_u32 s88, s87, 2380032
    buffer_load_dwordx4 v[36:39], v6, s[20:23], s88 offen
    s_add_u32 s88, s87, 2393856
    buffer_load_dwordx4 v[40:43], v6, s[20:23], s88 offen
    s_add_u32 s88, s87, 2407680
    buffer_load_dwordx4 v[44:47], v6, s[20:23], s88 offen
    s_add_u32 s88, s87, 2368512
    buffer_load_dwordx4 v[48:51], v6, s[20:23], s88 offen
    s_add_u32 s88, s87, 2382336
    buffer_load_dwordx4 v[52:55], v6, s[20:23], s88 offen
    s_add_u32 s88, s87, 2396160
    buffer_load_dwordx4 v[56:59], v6, s[20:23], s88 offen
    s_add_u32 s88, s87, 2409984
    buffer_load_dwordx4 v[60:63], v6, s[20:23], s88 offen
    s_branch LOOK_adaLN_cond__gqa_block_cached__glu_gated_geglu__prompt_kernel
SPIN_adaLN_cond__gqa_block_cached__glu_gated_geglu__prompt_kernel:
    s_waitcnt vmcnt(0)
    ds_read_b64 v[12:13], v10
    s_waitcnt lgkmcnt(0)
    v_readfirstlane_b32 s87, v13
    v_readfirstlane_b32 s16, v12
    s_cmp_lg_u32 s87, 0
    s_cbranch_scc1 QUIT_adaLN_cond__gqa_block_cached__glu_gated_geglu__prompt_kernel
LOOK_adaLN_cond__gqa_block_cached__glu_gated_geglu__prompt_kernel:
    s_and_b32 s16, s16, 65535
    s_mul_i32 s16, s16, 65537
    s_lshr_b32 s16, s16, s89
    s_and_b32 s16, s16, 65535
    s_cmp_eq_u32 s16, 65535
    s_cselect_b32 s88, 0, -1
    s_andn2_b32 s16, s16, s15
    s_cbranch_scc0 SPIN_adaLN_cond__gqa_block_cached__glu_gated_geglu__prompt_kernel
    s_and_b32 s88, s88, s16
    s_sub_u32 s87, s88, 1
    s_and_b32 s88, s88, s87
    s_sub_u32 s87, s88, 1
    s_and_b32 s88, s88, s87
    s_sub_u32 s87, s88, 1
    s_and_b32 s88, s88, s87
    s_xor_b32 s16, s16, s88
    s_or_b32 s88, s15, s16
    s_ff0_i32_b32 s87, s88
    s_lshr_b32 s88, s88, s87
    s_cselect_b32 s87, s87, 16
    s_min_u32 s94, s94, s87
    s_bitcmp1_b32 s16, 0
    s_cbranch_scc0 SK0_adaLN_cond__gqa_block_cached__glu_gated_geglu__prompt_kernel
    s_add_u32 s87, s89, 0
    s_and_b32 s87, s87, 15
    s_mul_i32 s87, s87, 9216
    s_add_u32 s87, s87, s17
    buffer_load_dwordx4 v[64:67], v3, s[20:23], s87 offen offset:0 sc1
    buffer_load_dwordx4 v[68:71], v3, s[20:23], s87 offen offset:1024 sc1
    buffer_load_dwordx4 v[72:75], v3, s[20:23], s87 offen offset:2048 sc1
SK0_adaLN_cond__gqa_block_cached__glu_gated_geglu__prompt_kernel:
    s_bitcmp1_b32 s16, 1
    s_cbranch_scc0 SK1_adaLN_cond__gqa_block_cached__glu_gated_geglu__prompt_kernel
    s_add_u32 s87, s89, 1
    s_and_b32 s87, s87, 15
    s_mul_i32 s87, s87, 9216
    s_add_u32 s87, s87, s17
    buffer_load_dwordx4 v[76:79], v3, s[20:23], s87 offen offset:0 sc1
    buffer_load_dwordx4 v[80:83], v3, s[20:23], s87 offen offset:1024 sc1
    buffer_load_dwordx4 v[84:87], v3, s[20:23], s87 offen offset:2048 sc1
SK1_adaLN_cond__gqa_block_cached__glu_gated_geglu__prompt_kernel:
    s_bitcmp1_b32 s16, 2
    s_cbranch_scc0 SK2_adaLN_cond__gqa_block_cached__glu_gated_geglu__prompt_kernel
    s_add_u32 s87, s89, 2
    s_and_b32 s87, s87, 15
    s_mul_i32 s87, s87, 9216
    s_add_u32 s87, s87, s17
    buffer_load_dwordx4 v[88:91], v3, s[20:23], s87 offen offset:0 sc1
    buffer_load_dwordx4 v[92:95], v3, s[20:23], s87 offen offset:1024 sc1
    buffer_load_dwordx4 v[96:99], v3, s[20:23], s87 offen offset:2048 sc1
SK2_adaLN_cond__gqa_block_cached__glu_gated_geglu__prompt_kernel:
    s_bitcmp1_b32 s16, 3
    s_cbranch_scc0 SK3_adaLN_cond__gqa_block_cached__glu_gated_geglu__prompt_kernel
    s_add_u32 s87, s89, 3
    s_and_b32 s87, s87, 15
    s_mul_i32 s87, s87, 9216
    s_add_u32 s87, s87, s17
    buffer_load_dwordx4 v[100:103], v3, s[20:23], s87 offen offset:0 sc1
    buffer_load_dwordx4 v[104:107], v3, s[20:23], s87 offen offset:1024 sc1
    buffer_load_dwordx4 v[108:111], v3, s[20:23], s87 offen offset:2048 sc1
SK3_adaLN_cond__gqa_block_cached__glu_gated_geglu__prompt_kernel:
    s_bitcmp1_b32 s16, 4
    s_cbranch_scc0 SK4_adaLN_cond__gqa_block_cached__glu_gated_geglu__prompt_kernel
    s_add_u32 s87, s89, 4
    s_and_b32 s87, s87, 15
    s_mul_i32 s87, s87, 9216
    s_add_u32 s87, s87, s17
    buffer_load_dwordx4 v[112:115], v3, s[20:23], s87 offen offset:0 sc1
    buffer_load_dwordx4 v[116:119], v3, s[20:23], s87 offen offset:1024 sc1
    buffer_load_dwordx4 v[120:123], v3, s[20:23], s87 offen offset:2048 sc1
SK4_adaLN_cond__gqa_block_cached__glu_gated_geglu__prompt_kernel:
    s_bitcmp1_b32 s16, 5
    s_cbranch_scc0 SK5_adaLN_cond__gqa_block_cached__glu_gated_geglu__prompt_kernel
    s_add_u32 s87, s89, 5
    s_and_b32 s87, s87, 15
    s_mul_i32 s87, s87, 9216
    s_add_u32 s87, s87, s17
    buffer_load_dwordx4 v[124:127], v3, s[20:23], s87 offen offset:0 sc1
    buffer_load_dwordx4 v[128:131], v3, s[20:23], s87 offen offset:1024 sc1
    buffer_load_dwordx4 v[132:135], v3, s[20:23], s87 offen offset:2048 sc1
SK5_adaLN_cond__gqa_block_cached__glu_gated_geglu__prompt_kernel:
    s_bitcmp1_b32 s16, 6
    s_cbranch_scc0 SK6_adaLN_cond__gqa_block_cached__glu_gated_geglu__prompt_kernel
    s_add_u32 s87, s89, 6
    s_and_b32 s87, s87, 15
    s_mul_i32 s87, s87, 9216
    s_add_u32 s87, s87, s17
    buffer_load_dwordx4 v[136:139], v3, s[20:23], s87 offen offset:0 sc1
    buffer_load_dwordx4 v[140:143], v3, s[20:23], s87 offen offset:1024 sc1
    buffer_load_dwordx4 v[144:147], v3, s[20:23], s87 offen offset:2048 sc1
SK6_adaLN_cond__gqa_block_cached__glu_gated_geglu__prompt_kernel:
    s_bitcmp1_b32 s16, 7
    s_cbranch_scc0 SK7_adaLN_cond__gqa_block_cached__glu_gated_geglu__prompt_kernel
    s_add_u32 s87, s89, 7
    s_and_b32 s87, s87, 15
    s_mul_i32 s87, s87, 9216
    s_add_u32 s87, s87, s17
    buffer_load_dwordx4 v[148:151], v3, s[20:23], s87 offen offset:0 sc1
    buffer_load_dwordx4 v[152:155], v3, s[20:23], s87 offen offset:1024 sc1
    buffer_load_dwordx4 v[156:159], v3, s[20:23], s87 offen offset:2048 sc1
SK7_adaLN_cond__gqa_block_cached__glu_gated_geglu__prompt_kernel:
    s_bitcmp1_b32 s16, 8
    s_cbranch_scc0 SK8_adaLN_cond__gqa_block_cached__glu_gated_geglu__prompt_kernel
    s_add_u32 s87, s89, 8
    s_and_b32 s87, s87, 15
    s_mul_i32 s87, s87, 9216
    s_add_u32 s87, s87, s17
    buffer_load_dwordx4 v[160:163], v3, s[20:23], s87 offen offset:0 sc1
    buffer_load_dwordx4 v[164:167], v3, s[20:23], s87 offen offset:1024 sc1
    buffer_load_dwordx4 v[168:171], v3, s[20:23], s87 offen offset:2048 sc1
SK8_adaLN_cond__gqa_block_cached__glu_gated_geglu__prompt_kernel:
    s_bitcmp1_b32 s16, 9
    s_cbranch_scc0 SK9_adaLN_cond__gqa_block_cached__glu_gated_geglu__prompt_kernel
    s_add_u32 s87, s89, 9
    s_and_b32 s87, s87, 15
    s_mul_i32 s87, s87, 9216
    s_add_u32 s87, s87, s17
    buffer_load_dwordx4 v[172:175], v3, s[20:23], s87 offen offset:0 sc1
    buffer_load_dwordx4 v[176:179], v3, s[20:23], s87 offen offset:1024 sc1
    buffer_load_dwordx4 v[180:183], v3, s[20:23], s87 offen offset:2048 sc1
SK9_adaLN_cond__gqa_block_cached__glu_gated_geglu__prompt_kernel:
    s_bitcmp1_b32 s16, 10
    s_cbranch_scc0 SK10_adaLN_cond__gqa_block_cached__glu_gated_geglu__prompt_kernel
    s_add_u32 s87, s89, 10
    s_and_b32 s87, s87, 15
    s_mul_i32 s87, s87, 9216
    s_add_u32 s87, s87, s17
    buffer_load_dwordx4 v[184:187], v3, s[20:23], s87 offen offset:0 sc1
    buffer_load_dwordx4 v[188:191], v3, s[20:23], s87 offen offset:1024 sc1
    buffer_load_dwordx4 v[192:195], v3, s[20:23], s87 offen offset:2048 sc1
SK10_adaLN_cond__gqa_block_cached__glu_gated_geglu__prompt_kernel:
    s_bitcmp1_b32 s16, 11
    s_cbranch_scc0 SK11_adaLN_cond__gqa_block_cached__glu_gated_geglu__prompt_kernel
    s_add_u32 s87, s89, 11
    s_and_b32 s87, s87, 15
    s_mul_i32 s87, s87, 9216
    s_add_u32 s87, s87, s17
    buffer_load_dwordx4 v[196:199], v3, s[20:23], s87 offen offset:0 sc1
    buffer_load_dwordx4 v[200:203], v3, s[20:23], s87 offen offset:1024 sc1
    buffer_load_dwordx4 v[204:207], v3, s[20:23], s87 offen offset:2048 sc1
SK11_adaLN_cond__gqa_block_cached__glu_gated_geglu__prompt_kernel:
    s_bitcmp1_b32 s16, 12
    s_cbranch_scc0 SK12_adaLN_cond__gqa_block_cached__glu_gated_geglu__prompt_kernel
    s_add_u32 s87, s89, 12
    s_and_b32 s87, s87, 15
    s_mul_i32 s87, s87, 9216
    s_add_u32 s87, s87, s17
    buffer_load_dwordx4 v[208:211], v3, s[20:23], s87 offen offset:0 sc1
    buffer_load_dwordx4 v[212:215], v3, s[20:23], s87 offen offset:1024 sc1
    buffer_load_dwordx4 v[216:219], v3, s[20:23], s87 offen offset:2048 sc1
SK12_adaLN_cond__gqa_block_cached__glu_gated_geglu__prompt_kernel:
    s_bitcmp1_b32 s16, 13
    s_cbranch_scc0 SK13_adaLN_cond__gqa_block_cached__glu_gated_geglu__prompt_kernel
    s_add_u32 s87, s89, 13
    s_and_b32 s87, s87, 15
    s_mul_i32 s87, s87, 9216
    s_add_u32 s87, s87, s17
    buffer_load_dwordx4 v[220:223], v3, s[20:23], s87 offen offset:0 sc1
    buffer_load_dwordx4 v[224:227], v3, s[20:23], s87 offen offset:1024 sc1
    buffer_load_dwordx4 v[228:231], v3, s[20:23], s87 offen offset:2048 sc1
SK13_adaLN_cond__gqa_block_cached__glu_gated_geglu__prompt_kernel:
    s_bitcmp1_b32 s16, 14
    s_cbranch_scc0 SK14_adaLN_cond__gqa_block_cached__glu_gated_geglu__prompt_kernel
    s_add_u32 s87, s89, 14
    s_and_b32 s87, s87, 15
    s_mul_i32 s87, s87, 9216
    s_add_u32 s87, s87, s17
    buffer_load_dwordx4 v[232:235], v3, s[20:23], s87 offen offset:0 sc1
    buffer_load_dwordx4 v[236:239], v3, s[20:23], s87 offen offset:1024 sc1
    buffer_load_dwordx4 v[240:243], v3, s[20:23], s87 offen offset:2048 sc1
SK14_adaLN_cond__gqa_block_cached__glu_gated_geglu__prompt_kernel:
    s_bitcmp1_b32 s16, 15
    s_cbranch_scc0 SK15_adaLN_cond__gqa_block_cached__glu_gated_geglu__prompt_kernel
    s_add_u32 s87, s89, 15
    s_and_b32 s87, s87, 15
    s_mul_i32 s87, s87, 9216
    s_add_u32 s87, s87, s17
    buffer_load_dwordx4 v[244:247], v3, s[20:23], s87 offen offset:0 sc1
    buffer_load_dwordx4 v[248:251], v3, s[20:23], s87 offen offset:1024 sc1
    buffer_load_dwordx4 v[252:255], v3, s[20:23], s87 offen offset:2048 sc1
SK15_adaLN_cond__gqa_block_cached__glu_gated_geglu__prompt_kernel:
    s_or_b32 s15, s15, s16
    s_cmp_lg_u32 s15, 65535
    s_cbranch_scc1 SPIN_adaLN_cond__gqa_block_cached__glu_gated_geglu__prompt_kernel
    s_waitcnt vmcnt(48)
    v_pk_add_f32 v[16:17], v[16:17], v[20:21]
    v_pk_add_f32 v[18:19], v[18:19], v[22:23]
    v_pk_add_f32 v[24:25], v[24:25], v[28:29]
    v_pk_add_f32 v[26:27], v[26:27], v[30:31]
    v_pk_add_f32 v[16:17], v[16:17], v[24:25]
    v_pk_add_f32 v[18:19], v[18:19], v[26:27]
    v_cvt_pk_bf16_f32 v17, v16, v17
    v_cvt_pk_bf16_f32 v19, v18, v19
    v_lshlrev_b32 v16, 16, v17
    v_and_b32 v17, 0xffff0000, v17
    v_lshlrev_b32 v18, 16, v19
    v_and_b32 v19, 0xffff0000, v19
    ds_write_b128 v5, v[16:19] offset:0
    v_pk_add_f32 v[32:33], v[32:33], v[36:37]
    v_pk_add_f32 v[34:35], v[34:35], v[38:39]
    v_pk_add_f32 v[40:41], v[40:41], v[44:45]
    v_pk_add_f32 v[42:43], v[42:43], v[46:47]
    v_pk_add_f32 v[32:33], v[32:33], v[40:41]
    v_pk_add_f32 v[34:35], v[34:35], v[42:43]
    v_cvt_pk_bf16_f32 v33, v32, v33
    v_cvt_pk_bf16_f32 v35, v34, v35
    v_lshlrev_b32 v32, 16, v33
    v_and_b32 v33, 0xffff0000, v33
    v_lshlrev_b32 v34, 16, v35
    v_and_b32 v35, 0xffff0000, v35
    ds_write_b128 v5, v[32:35] offset:1024
    v_pk_add_f32 v[48:49], v[48:49], v[52:53]
    v_pk_add_f32 v[50:51], v[50:51], v[54:55]
    v_pk_add_f32 v[56:57], v[56:57], v[60:61]
    v_pk_add_f32 v[58:59], v[58:59], v[62:63]
    v_pk_add_f32 v[48:49], v[48:49], v[56:57]
    v_pk_add_f32 v[50:51], v[50:51], v[58:59]
    v_cvt_pk_bf16_f32 v49, v48, v49
    v_cvt_pk_bf16_f32 v51, v50, v51
    v_lshlrev_b32 v48, 16, v49
    v_and_b32 v49, 0xffff0000, v49
    v_lshlrev_b32 v50, 16, v51
    v_and_b32 v51, 0xffff0000, v51
    v_add_f32 v48, 1.0, v48
    v_add_f32 v49, 1.0, v49
    v_add_f32 v50, 1.0, v50
    v_add_f32 v51, 1.0, v51
    v_cvt_pk_bf16_f32 v49, v48, v49
    v_cvt_pk_bf16_f32 v51, v50, v51
    v_lshlrev_b32 v48, 16, v49
    v_and_b32 v49, 0xffff0000, v49
    v_lshlrev_b32 v50, 16, v51
    v_and_b32 v51, 0xffff0000, v51
    ds_write_b128 v5, v[48:51] offset:2048
    s_waitcnt lgkmcnt(0)
    v_accvgpr_read_b32 v40, a0
    v_accvgpr_read_b32 v41, a1
    v_accvgpr_read_b32 v42, a2
    v_accvgpr_read_b32 v43, a3
    v_accvgpr_read_b32 v44, a4
    v_accvgpr_read_b32 v45, a5
    v_accvgpr_read_b32 v46, a6
    v_accvgpr_read_b32 v47, a7
    v_accvgpr_read_b32 v48, a8
    v_accvgpr_read_b32 v49, a9
    v_accvgpr_read_b32 v50, a10
    v_accvgpr_read_b32 v51, a11
    s_waitcnt vmcnt(45)
    s_cmp_lg_u32 s94, 0
    s_cbranch_scc1 NW0_adaLN_cond__gqa_block_cached__glu_gated_geglu__prompt_kernel
    s_waitcnt vmcnt(0)
NW0_adaLN_cond__gqa_block_cached__glu_gated_geglu__prompt_kernel:
    v_lshlrev_b32 v16, 16, v64
    v_and_b32 v17, 0xffff0000, v64
    v_lshlrev_b32 v18, 16, v65
    v_and_b32 v19, 0xffff0000, v65
    v_lshlrev_b32 v20, 16, v66
    v_and_b32 v21, 0xffff0000, v66
    v_lshlrev_b32 v22, 16, v67
    v_and_b32 v23, 0xffff0000, v67
    v_lshlrev_b32 v24, 16, v68
    v_and_b32 v25, 0xffff0000, v68
    v_lshlrev_b32 v26, 16, v69
    v_and_b32 v27, 0xffff0000, v69
    v_lshlrev_b32 v28, 16, v70
    v_and_b32 v29, 0xffff0000, v70
    v_lshlrev_b32 v30, 16, v71
    v_and_b32 v31, 0xffff0000, v71
    v_lshlrev_b32 v32, 16, v72
    v_and_b32 v33, 0xffff0000, v72
    v_lshlrev_b32 v34, 16, v73
    v_and_b32 v35, 0xffff0000, v73
    v_lshlrev_b32 v36, 16, v74
    v_and_b32 v37, 0xffff0000, v74
    v_lshlrev_b32 v38, 16, v75
    v_and_b32 v39, 0xffff0000, v75
    s_waitcnt vmcnt(42)
    s_cmp_lg_u32 s94, 1
    s_cbranch_scc1 NW1_adaLN_cond__gqa_block_cached__glu_gated_geglu__prompt_kernel
    s_waitcnt vmcnt(0)
NW1_adaLN_cond__gqa_block_cached__glu_gated_geglu__prompt_kernel:
    v_dot2c_f32_bf16 v16, s85, v76
    v_dot2c_f32_bf16 v17, s86, v76
    v_dot2c_f32_bf16 v18, s85, v77
    v_dot2c_f32_bf16 v19, s86, v77
    v_dot2c_f32_bf16 v20, s85, v78
    v_dot2c_f32_bf16 v21, s86, v78
    v_dot2c_f32_bf16 v22, s85, v79
    v_dot2c_f32_bf16 v23, s86, v79
    v_dot2c_f32_bf16 v24, s85, v80
    v_dot2c_f32_bf16 v25, s86, v80
    v_dot2c_f32_bf16 v26, s85, v81
    v_dot2c_f32_bf16 v27, s86, v81
    v_dot2c_f32_bf16 v28, s85, v82
    v_dot2c_f32_bf16 v29, s86, v82
    v_dot2c_f32_bf16 v30, s85, v83
    v_dot2c_f32_bf16 v31, s86, v83
    v_dot2c_f32_bf16 v32, s85, v84
    v_dot2c_f32_bf16 v33, s86, v84
    v_dot2c_f32_bf16 v34, s85, v85
    v_dot2c_f32_bf16 v35, s86, v85
    v_dot2c_f32_bf16 v36, s85, v86
    v_dot2c_f32_bf16 v37, s86, v86
    v_dot2c_f32_bf16 v38, s85, v87
    v_dot2c_f32_bf16 v39, s86, v87
    s_waitcnt vmcnt(39)
    s_cmp_lg_u32 s94, 2
    s_cbranch_scc1 NW2_adaLN_cond__gqa_block_cached__glu_gated_geglu__prompt_kernel
    s_waitcnt vmcnt(0)
NW2_adaLN_cond__gqa_block_cached__glu_gated_geglu__prompt_kernel:
    v_dot2c_f32_bf16 v16, s85, v88
    v_dot2c_f32_bf16 v17, s86, v88
    v_dot2c_f32_bf16 v18, s85, v89
    v_dot2c_f32_bf16 v19, s86, v89
    v_dot2c_f32_bf16 v20, s85, v90
    v_dot2c_f32_bf16 v21, s86, v90
    v_dot2c_f32_bf16 v22, s85, v91
    v_dot2c_f32_bf16 v23, s86, v91
    v_dot2c_f32_bf16 v24, s85, v92
    v_dot2c_f32_bf16 v25, s86, v92
    v_dot2c_f32_bf16 v26, s85, v93
    v_dot2c_f32_bf16 v27, s86, v93
    v_dot2c_f32_bf16 v28, s85, v94
    v_dot2c_f32_bf16 v29, s86, v94
    v_dot2c_f32_bf16 v30, s85, v95
    v_dot2c_f32_bf16 v31, s86, v95
    v_dot2c_f32_bf16 v32, s85, v96
    v_dot2c_f32_bf16 v33, s86, v96
    v_dot2c_f32_bf16 v34, s85, v97
    v_dot2c_f32_bf16 v35, s86, v97
    v_dot2c_f32_bf16 v36, s85, v98
    v_dot2c_f32_bf16 v37, s86, v98
    v_dot2c_f32_bf16 v38, s85, v99
    v_dot2c_f32_bf16 v39, s86, v99
    s_waitcnt vmcnt(36)
    s_cmp_lg_u32 s94, 3
    s_cbranch_scc1 NW3_adaLN_cond__gqa_block_cached__glu_gated_geglu__prompt_kernel
    s_waitcnt vmcnt(0)
NW3_adaLN_cond__gqa_block_cached__glu_gated_geglu__prompt_kernel:
    v_dot2c_f32_bf16 v16, s85, v100
    v_dot2c_f32_bf16 v17, s86, v100
    v_dot2c_f32_bf16 v18, s85, v101
    v_dot2c_f32_bf16 v19, s86, v101
    v_dot2c_f32_bf16 v20, s85, v102
    v_dot2c_f32_bf16 v21, s86, v102
    v_dot2c_f32_bf16 v22, s85, v103
    v_dot2c_f32_bf16 v23, s86, v103
    v_dot2c_f32_bf16 v24, s85, v104
    v_dot2c_f32_bf16 v25, s86, v104
    v_dot2c_f32_bf16 v26, s85, v105
    v_dot2c_f32_bf16 v27, s86, v105
    v_dot2c_f32_bf16 v28, s85, v106
    v_dot2c_f32_bf16 v29, s86, v106
    v_dot2c_f32_bf16 v30, s85, v107
    v_dot2c_f32_bf16 v31, s86, v107
    v_dot2c_f32_bf16 v32, s85, v108
    v_dot2c_f32_bf16 v33, s86, v108
    v_dot2c_f32_bf16 v34, s85, v109
    v_dot2c_f32_bf16 v35, s86, v109
    v_dot2c_f32_bf16 v36, s85, v110
    v_dot2c_f32_bf16 v37, s86, v110
    v_dot2c_f32_bf16 v38, s85, v111
    v_dot2c_f32_bf16 v39, s86, v111
    s_waitcnt vmcnt(33)
    s_cmp_lg_u32 s94, 4
    s_cbranch_scc1 NW4_adaLN_cond__gqa_block_cached__glu_gated_geglu__prompt_kernel
    s_waitcnt vmcnt(0)
NW4_adaLN_cond__gqa_block_cached__glu_gated_geglu__prompt_kernel:
    v_dot2c_f32_bf16 v16, s85, v112
    v_dot2c_f32_bf16 v17, s86, v112
    v_dot2c_f32_bf16 v18, s85, v113
    v_dot2c_f32_bf16 v19, s86, v113
    v_dot2c_f32_bf16 v20, s85, v114
    v_dot2c_f32_bf16 v21, s86, v114
    v_dot2c_f32_bf16 v22, s85, v115
    v_dot2c_f32_bf16 v23, s86, v115
    v_dot2c_f32_bf16 v24, s85, v116
    v_dot2c_f32_bf16 v25, s86, v116
    v_dot2c_f32_bf16 v26, s85, v117
    v_dot2c_f32_bf16 v27, s86, v117
    v_dot2c_f32_bf16 v28, s85, v118
    v_dot2c_f32_bf16 v29, s86, v118
    v_dot2c_f32_bf16 v30, s85, v119
    v_dot2c_f32_bf16 v31, s86, v119
    v_dot2c_f32_bf16 v32, s85, v120
    v_dot2c_f32_bf16 v33, s86, v120
    v_dot2c_f32_bf16 v34, s85, v121
    v_dot2c_f32_bf16 v35, s86, v121
    v_dot2c_f32_bf16 v36, s85, v122
    v_dot2c_f32_bf16 v37, s86, v122
    v_dot2c_f32_bf16 v38, s85, v123
    v_dot2c_f32_bf16 v39, s86, v123
    s_waitcnt vmcnt(30)
    s_cmp_lg_u32 s94, 5
    s_cbranch_scc1 NW5_adaLN_cond__gqa_block_cached__glu_gated_geglu__prompt_kernel
    s_waitcnt vmcnt(0)
NW5_adaLN_cond__gqa_block_cached__glu_gated_geglu__prompt_kernel:
    v_dot2c_f32_bf16 v16, s85, v124
    v_dot2c_f32_bf16 v17, s86, v124
    v_dot2c_f32_bf16 v18, s85, v125
    v_dot2c_f32_bf16 v19, s86, v125
    v_dot2c_f32_bf16 v20, s85, v126
    v_dot2c_f32_bf16 v21, s86, v126
    v_dot2c_f32_bf16 v22, s85, v127
    v_dot2c_f32_bf16 v23, s86, v127
    v_dot2c_f32_bf16 v24, s85, v128
    v_dot2c_f32_bf16 v25, s86, v128
    v_dot2c_f32_bf16 v26, s85, v129
    v_dot2c_f32_bf16 v27, s86, v129
    v_dot2c_f32_bf16 v28, s85, v130
    v_dot2c_f32_bf16 v29, s86, v130
    v_dot2c_f32_bf16 v30, s85, v131
    v_dot2c_f32_bf16 v31, s86, v131
    v_dot2c_f32_bf16 v32, s85, v132
    v_dot2c_f32_bf16 v33, s86, v132
    v_dot2c_f32_bf16 v34, s85, v133
    v_dot2c_f32_bf16 v35, s86, v133
    v_dot2c_f32_bf16 v36, s85, v134
    v_dot2c_f32_bf16 v37, s86, v134
    v_dot2c_f32_bf16 v38, s85, v135
    v_dot2c_f32_bf16 v39, s86, v135
    s_waitcnt vmcnt(27)
    s_cmp_lg_u32 s94, 6
    s_cbranch_scc1 NW6_adaLN_cond__gqa_block_cached__glu_gated_geglu__prompt_kernel
    s_waitcnt vmcnt(0)
NW6_adaLN_cond__gqa_block_cached__glu_gated_geglu__prompt_kernel:
    v_dot2c_f32_bf16 v16, s85, v136
    v_dot2c_f32_bf16 v17, s86, v136
    v_dot2c_f32_bf16 v18, s85, v137
    v_dot2c_f32_bf16 v19, s86, v137
    v_dot2c_f32_bf16 v20, s85, v138
    v_dot2c_f32_bf16 v21, s86, v138
    v_dot2c_f32_bf16 v22, s85, v139
    v_dot2c_f32_bf16 v23, s86, v139
    v_dot2c_f32_bf16 v24, s85, v140
    v_dot2c_f32_bf16 v25, s86, v140
    v_dot2c_f32_bf16 v26, s85, v141
    v_dot2c_f32_bf16 v27, s86, v141
    v_dot2c_f32_bf16 v28, s85, v142
    v_dot2c_f32_bf16 v29, s86, v142
    v_dot2c_f32_bf16 v30, s85, v143
    v_dot2c_f32_bf16 v31, s86, v143
    v_dot2c_f32_bf16 v32, s85, v144
    v_dot2c_f32_bf16 v33, s86, v144
    v_dot2c_f32_bf16 v34, s85, v145
    v_dot2c_f32_bf16 v35, s86, v145
    v_dot2c_f32_bf16 v36, s85, v146
    v_dot2c_f32_bf16 v37, s86, v146
    v_dot2c_f32_bf16 v38, s85, v147
    v_dot2c_f32_bf16 v39, s86, v147
    ds_read_b128 v[64:67], v7 offset:0
    ds_read_b128 v[68:71], v7 offset:16
    ds_read_b128 v[72:75], v7 offset:256
    ds_read_b128 v[76:79], v7 offset:272
    ds_read_b128 v[80:83], v7 offset:512
    ds_read_b128 v[84:87], v7 offset:528
    s_waitcnt vmcnt(24)
    s_cmp_lg_u32 s94, 7
    s_cbranch_scc1 NW7_adaLN_cond__gqa_block_cached__glu_gated_geglu__prompt_kernel
    s_waitcnt vmcnt(0)
NW7_adaLN_cond__gqa_block_cached__glu_gated_geglu__prompt_kernel:
    v_dot2c_f32_bf16 v16, s85, v148
    v_dot2c_f32_bf16 v17, s86, v148
    v_dot2c_f32_bf16 v18, s85, v149
    v_dot2c_f32_bf16 v19, s86, v149
    v_dot2c_f32_bf16 v20, s85, v150
    v_dot2c_f32_bf16 v21, s86, v150
    v_dot2c_f32_bf16 v22, s85, v151
    v_dot2c_f32_bf16 v23, s86, v151
    v_dot2c_f32_bf16 v24, s85, v152
    v_dot2c_f32_bf16 v25, s86, v152
    v_dot2c_f32_bf16 v26, s85, v153
    v_dot2c_f32_bf16 v27, s86, v153
    v_dot2c_f32_bf16 v28, s85, v154
    v_dot2c_f32_bf16 v29, s86, v154
    v_dot2c_f32_bf16 v30, s85, v155
    v_dot2c_f32_bf16 v31, s86, v155
    v_dot2c_f32_bf16 v32, s85, v156
    v_dot2c_f32_bf16 v33, s86, v156
    v_dot2c_f32_bf16 v34, s85, v157
    v_dot2c_f32_bf16 v35, s86, v157
    v_dot2c_f32_bf16 v36, s85, v158
    v_dot2c_f32_bf16 v37, s86, v158
    v_dot2c_f32_bf16 v38, s85, v159
    v_dot2c_f32_bf16 v39, s86, v159
    ds_read_b128 v[88:91], v7 offset:1024
    ds_read_b128 v[92:95], v7 offset:1040
    ds_read_b128 v[96:99], v7 offset:1280
    ds_read_b128 v[100:103], v7 offset:1296
    ds_read_b128 v[104:107], v7 offset:1536
    ds_read_b128 v[108:111], v7 offset:1552
    s_waitcnt vmcnt(21)
    s_cmp_lg_u32 s94, 8
    s_cbranch_scc1 NW8_adaLN_cond__gqa_block_cached__glu_gated_geglu__prompt_kernel
    s_waitcnt vmcnt(0)
NW8_adaLN_cond__gqa_block_cached__glu_gated_geglu__prompt_kernel:
    v_dot2c_f32_bf16 v16, s85, v160
    v_dot2c_f32_bf16 v17, s86, v160
    v_dot2c_f32_bf16 v18, s85, v161
    v_dot2c_f32_bf16 v19, s86, v161
    v_dot2c_f32_bf16 v20, s85, v162
    v_dot2c_f32_bf16 v21, s86, v162
    v_dot2c_f32_bf16 v22, s85, v163
    v_dot2c_f32_bf16 v23, s86, v163
    v_dot2c_f32_bf16 v24, s85, v164
    v_dot2c_f32_bf16 v25, s86, v164
    v_dot2c_f32_bf16 v26, s85, v165
    v_dot2c_f32_bf16 v27, s86, v165
    v_dot2c_f32_bf16 v28, s85, v166
    v_dot2c_f32_bf16 v29, s86, v166
    v_dot2c_f32_bf16 v30, s85, v167
    v_dot2c_f32_bf16 v31, s86, v167
    v_dot2c_f32_bf16 v32, s85, v168
    v_dot2c_f32_bf16 v33, s86, v168
    v_dot2c_f32_bf16 v34, s85, v169
    v_dot2c_f32_bf16 v35, s86, v169
    v_dot2c_f32_bf16 v36, s85, v170
    v_dot2c_f32_bf16 v37, s86, v170
    v_dot2c_f32_bf16 v38, s85, v171
    v_dot2c_f32_bf16 v39, s86, v171
    ds_read_b128 v[112:115], v7 offset:2048
    ds_read_b128 v[116:119], v7 offset:2064
    ds_read_b128 v[120:123], v7 offset:2304
    ds_read_b128 v[124:127], v7 offset:2320
    ds_read_b128 v[128:131], v7 offset:2560
    ds_read_b128 v[132:135], v7 offset:2576
    s_waitcnt vmcnt(18)
    s_cmp_lg_u32 s94, 9
    s_cbranch_scc1 NW9_adaLN_cond__gqa_block_cached__glu_gated_geglu__prompt_kernel
    s_waitcnt vmcnt(0)
NW9_adaLN_cond__gqa_block_cached__glu_gated_geglu__prompt_kernel:
    v_dot2c_f32_bf16 v16, s85, v172
    v_dot2c_f32_bf16 v17, s86, v172
    v_dot2c_f32_bf16 v18, s85, v173
    v_dot2c_f32_bf16 v19, s86, v173
    v_dot2c_f32_bf16 v20, s85, v174
    v_dot2c_f32_bf16 v21, s86, v174
    v_dot2c_f32_bf16 v22, s85, v175
    v_dot2c_f32_bf16 v23, s86, v175
    v_dot2c_f32_bf16 v24, s85, v176
    v_dot2c_f32_bf16 v25, s86, v176
    v_dot2c_f32_bf16 v26, s85, v177
    v_dot2c_f32_bf16 v27, s86, v177
    v_dot2c_f32_bf16 v28, s85, v178
    v_dot2c_f32_bf16 v29, s86, v178
    v_dot2c_f32_bf16 v30, s85, v179
    v_dot2c_f32_bf16 v31, s86, v179
    v_dot2c_f32_bf16 v32, s85, v180
    v_dot2c_f32_bf16 v33, s86, v180
    v_dot2c_f32_bf16 v34, s85, v181
    v_dot2c_f32_bf16 v35, s86, v181
    v_dot2c_f32_bf16 v36, s85, v182
    v_dot2c_f32_bf16 v37, s86, v182
    v_dot2c_f32_bf16 v38, s85, v183
    v_dot2c_f32_bf16 v39, s86, v183
    v_lshlrev_b32 v136, 16, v40
    v_and_b32 v137, 0xffff0000, v40
    v_lshlrev_b32 v138, 16, v41
    v_and_b32 v139, 0xffff0000, v41
    v_lshlrev_b32 v140, 16, v42
    v_and_b32 v141, 0xffff0000, v42
    v_lshlrev_b32 v142, 16, v43
    v_and_b32 v143, 0xffff0000, v43
    v_lshlrev_b32 v144, 16, v44
    v_and_b32 v145, 0xffff0000, v44
    v_lshlrev_b32 v146, 16, v45
    v_and_b32 v147, 0xffff0000, v45
    v_lshlrev_b32 v148, 16, v46
    v_and_b32 v149, 0xffff0000, v46
    v_lshlrev_b32 v150, 16, v47
    v_and_b32 v151, 0xffff0000, v47
    v_lshlrev_b32 v152, 16, v48
    v_and_b32 v153, 0xffff0000, v48
    v_lshlrev_b32 v154, 16, v49
    v_and_b32 v155, 0xffff0000, v49
    v_lshlrev_b32 v156, 16, v50
    v_and_b32 v157, 0xffff0000, v50
    v_lshlrev_b32 v158, 16, v51
    v_and_b32 v159, 0xffff0000, v51
    s_waitcnt vmcnt(15)
    s_cmp_lg_u32 s94, 10
    s_cbranch_scc1 NW10_adaLN_cond__gqa_block_cached__glu_gated_geglu__prompt_kernel
    s_waitcnt vmcnt(0)
NW10_adaLN_cond__gqa_block_cached__glu_gated_geglu__prompt_kernel:
    v_dot2c_f32_bf16 v16, s85, v184
    v_dot2c_f32_bf16 v17, s86, v184
    v_dot2c_f32_bf16 v18, s85, v185
    v_dot2c_f32_bf16 v19, s86, v185
    v_dot2c_f32_bf16 v20, s85, v186
    v_dot2c_f32_bf16 v21, s86, v186
    v_dot2c_f32_bf16 v22, s85, v187
    v_dot2c_f32_bf16 v23, s86, v187
    v_dot2c_f32_bf16 v24, s85, v188
    v_dot2c_f32_bf16 v25, s86, v188
    v_dot2c_f32_bf16 v26, s85, v189
    v_dot2c_f32_bf16 v27, s86, v189
    v_dot2c_f32_bf16 v28, s85, v190
    v_dot2c_f32_bf16 v29, s86, v190
    v_dot2c_f32_bf16 v30, s85, v191
    v_dot2c_f32_bf16 v31, s86, v191
    v_dot2c_f32_bf16 v32, s85, v192
    v_dot2c_f32_bf16 v33, s86, v192
    v_dot2c_f32_bf16 v34, s85, v193
    v_dot2c_f32_bf16 v35, s86, v193
    v_dot2c_f32_bf16 v36, s85, v194
    v_dot2c_f32_bf16 v37, s86, v194
    v_dot2c_f32_bf16 v38, s85, v195
    v_dot2c_f32_bf16 v39, s86, v195
    s_waitcnt vmcnt(12)
    s_cmp_lg_u32 s94, 11
    s_cbranch_scc1 NW11_adaLN_cond__gqa_block_cached__glu_gated_geglu__prompt_kernel
    s_waitcnt vmcnt(0)
NW11_adaLN_cond__gqa_block_cached__glu_gated_geglu__prompt_kernel:
    v_dot2c_f32_bf16 v16, s85, v196
    v_dot2c_f32_bf16 v17, s86, v196
    v_dot2c_f32_bf16 v18, s85, v197
    v_dot2c_f32_bf16 v19, s86, v197
    v_dot2c_f32_bf16 v20, s85, v198
    v_dot2c_f32_bf16 v21, s86, v198
    v_dot2c_f32_bf16 v22, s85, v199
    v_dot2c_f32_bf16 v23, s86, v199
    v_dot2c_f32_bf16 v24, s85, v200
    v_dot2c_f32_bf16 v25, s86, v200
    v_dot2c_f32_bf16 v26, s85, v201
    v_dot2c_f32_bf16 v27, s86, v201
    v_dot2c_f32_bf16 v28, s85, v202
    v_dot2c_f32_bf16 v29, s86, v202
    v_dot2c_f32_bf16 v30, s85, v203
    v_dot2c_f32_bf16 v31, s86, v203
    v_dot2c_f32_bf16 v32, s85, v204
    v_dot2c_f32_bf16 v33, s86, v204
    v_dot2c_f32_bf16 v34, s85, v205
    v_dot2c_f32_bf16 v35, s86, v205
    v_dot2c_f32_bf16 v36, s85, v206
    v_dot2c_f32_bf16 v37, s86, v206
    v_dot2c_f32_bf16 v38, s85, v207
    v_dot2c_f32_bf16 v39, s86, v207
    s_waitcnt vmcnt(9)
    s_cmp_lg_u32 s94, 12
    s_cbranch_scc1 NW12_adaLN_cond__gqa_block_cached__glu_gated_geglu__prompt_kernel
    s_waitcnt vmcnt(0)
NW12_adaLN_cond__gqa_block_cached__glu_gated_geglu__prompt_kernel:
    v_dot2c_f32_bf16 v16, s85, v208
    v_dot2c_f32_bf16 v17, s86, v208
    v_dot2c_f32_bf16 v18, s85, v209
    v_dot2c_f32_bf16 v19, s86, v209
    v_dot2c_f32_bf16 v20, s85, v210
    v_dot2c_f32_bf16 v21, s86, v210
    v_dot2c_f32_bf16 v22, s85, v211
    v_dot2c_f32_bf16 v23, s86, v211
    v_dot2c_f32_bf16 v24, s85, v212
    v_dot2c_f32_bf16 v25, s86, v212
    v_dot2c_f32_bf16 v26, s85, v213
    v_dot2c_f32_bf16 v27, s86, v213
    v_dot2c_f32_bf16 v28, s85, v214
    v_dot2c_f32_bf16 v29, s86, v214
    v_dot2c_f32_bf16 v30, s85, v215
    v_dot2c_f32_bf16 v31, s86, v215
    v_dot2c_f32_bf16 v32, s85, v216
    v_dot2c_f32_bf16 v33, s86, v216
    v_dot2c_f32_bf16 v34, s85, v217
    v_dot2c_f32_bf16 v35, s86, v217
    v_dot2c_f32_bf16 v36, s85, v218
    v_dot2c_f32_bf16 v37, s86, v218
    v_dot2c_f32_bf16 v38, s85, v219
    v_dot2c_f32_bf16 v39, s86, v219
    s_waitcnt vmcnt(6)
    s_cmp_lg_u32 s94, 13
    s_cbranch_scc1 NW13_adaLN_cond__gqa_block_cached__glu_gated_geglu__prompt_kernel
    s_waitcnt vmcnt(0)
NW13_adaLN_cond__gqa_block_cached__glu_gated_geglu__prompt_kernel:
    v_dot2c_f32_bf16 v16, s85, v220
    v_dot2c_f32_bf16 v17, s86, v220
    v_dot2c_f32_bf16 v18, s85, v221
    v_dot2c_f32_bf16 v19, s86, v221
    v_dot2c_f32_bf16 v20, s85, v222
    v_dot2c_f32_bf16 v21, s86, v222
    v_dot2c_f32_bf16 v22, s85, v223
    v_dot2c_f32_bf16 v23, s86, v223
    v_dot2c_f32_bf16 v24, s85, v224
    v_dot2c_f32_bf16 v25, s86, v224
    v_dot2c_f32_bf16 v26, s85, v225
    v_dot2c_f32_bf16 v27, s86, v225
    v_dot2c_f32_bf16 v28, s85, v226
    v_dot2c_f32_bf16 v29, s86, v226
    v_dot2c_f32_bf16 v30, s85, v227
    v_dot2c_f32_bf16 v31, s86, v227
    v_dot2c_f32_bf16 v32, s85, v228
    v_dot2c_f32_bf16 v33, s86, v228
    v_dot2c_f32_bf16 v34, s85, v229
    v_dot2c_f32_bf16 v35, s86, v229
    v_dot2c_f32_bf16 v36, s85, v230
    v_dot2c_f32_bf16 v37, s86, v230
    v_dot2c_f32_bf16 v38, s85, v231
    v_dot2c_f32_bf16 v39, s86, v231
    s_waitcnt vmcnt(3)
    s_cmp_lg_u32 s94, 14
    s_cbranch_scc1 NW14_adaLN_cond__gqa_block_cached__glu_gated_geglu__prompt_kernel
    s_waitcnt vmcnt(0)
NW14_adaLN_cond__gqa_block_cached__glu_gated_geglu__prompt_kernel:
    v_dot2c_f32_bf16 v16, s85, v232
    v_dot2c_f32_bf16 v17, s86, v232
    v_dot2c_f32_bf16 v18, s85, v233
    v_dot2c_f32_bf16 v19, s86, v233
    v_dot2c_f32_bf16 v20, s85, v234
    v_dot2c_f32_bf16 v21, s86, v234
    v_dot2c_f32_bf16 v22, s85, v235
    v_dot2c_f32_bf16 v23, s86, v235
    v_dot2c_f32_bf16 v24, s85, v236
    v_dot2c_f32_bf16 v25, s86, v236
    v_dot2c_f32_bf16 v26, s85, v237
    v_dot2c_f32_bf16 v27, s86, v237
    v_dot2c_f32_bf16 v28, s85, v238
    v_dot2c_f32_bf16 v29, s86, v238
    v_dot2c_f32_bf16 v30, s85, v239
    v_dot2c_f32_bf16 v31, s86, v239
    v_dot2c_f32_bf16 v32, s85, v240
    v_dot2c_f32_bf16 v33, s86, v240
    v_dot2c_f32_bf16 v34, s85, v241
    v_dot2c_f32_bf16 v35, s86, v241
    v_dot2c_f32_bf16 v36, s85, v242
    v_dot2c_f32_bf16 v37, s86, v242
    v_dot2c_f32_bf16 v38, s85, v243
    v_dot2c_f32_bf16 v39, s86, v243
    s_waitcnt vmcnt(0)
    s_cmp_lg_u32 s94, 15
    s_cbranch_scc1 NW15_adaLN_cond__gqa_block_cached__glu_gated_geglu__prompt_kernel
    s_waitcnt vmcnt(0)
NW15_adaLN_cond__gqa_block_cached__glu_gated_geglu__prompt_kernel:
    v_dot2c_f32_bf16 v16, s85, v244
    v_dot2c_f32_bf16 v17, s86, v244
    v_dot2c_f32_bf16 v18, s85, v245
    v_dot2c_f32_bf16 v19, s86, v245
    v_dot2c_f32_bf16 v20, s85, v246
    v_dot2c_f32_bf16 v21, s86, v246
    v_dot2c_f32_bf16 v22, s85, v247
    v_dot2c_f32_bf16 v23, s86, v247
    v_dot2c_f32_bf16 v24, s85, v248
    v_dot2c_f32_bf16 v25, s86, v248
    v_dot2c_f32_bf16 v26, s85, v249
    v_dot2c_f32_bf16 v27, s86, v249
    v_dot2c_f32_bf16 v28, s85, v250
    v_dot2c_f32_bf16 v29, s86, v250
    v_dot2c_f32_bf16 v30, s85, v251
    v_dot2c_f32_bf16 v31, s86, v251
    v_dot2c_f32_bf16 v32, s85, v252
    v_dot2c_f32_bf16 v33, s86, v252
    v_dot2c_f32_bf16 v34, s85, v253
    v_dot2c_f32_bf16 v35, s86, v253
    v_dot2c_f32_bf16 v36, s85, v254
    v_dot2c_f32_bf16 v37, s86, v254
    v_dot2c_f32_bf16 v38, s85, v255
    v_dot2c_f32_bf16 v39, s86, v255
    s_waitcnt lgkmcnt(0)
    s_min_u32 s96, s24, 1
    s_lshl_b32 s96, s96, 13
    v_lshlrev_b32 v15, 7, v0
    v_add_u32 v15, s96, v15
    s_getpc_b64 s[96:97]
PC_adaLN_cond__gqa_block_cached__glu_gated_geglu__prompt_kernel_1:
    s_add_u32 s96, s96, k45_kernel-PC_adaLN_cond__gqa_block_cached__glu_gated_geglu__prompt_kernel_1
    s_addc_u32 s97, s97, 0
    global_load_dword v11, v15, s[96:97]
    s_nop 1
    v_permlane16_swap_b32 v16, v20
    v_permlane16_swap_b32 v17, v21
    v_permlane16_swap_b32 v18, v22
    v_permlane16_swap_b32 v19, v23
    v_permlane16_swap_b32 v24, v28
    v_permlane16_swap_b32 v25, v29
    v_permlane16_swap_b32 v26, v30
    v_permlane16_swap_b32 v27, v31
    v_permlane16_swap_b32 v32, v36
    v_permlane16_swap_b32 v33, v37
    v_permlane16_swap_b32 v34, v38
    v_permlane16_swap_b32 v35, v39
    v_fma_f32 v136, v64, v16, v136
    v_fma_f32 v137, v65, v17, v137
    v_fma_f32 v138, v66, v18, v138
    v_fma_f32 v139, v67, v19, v139
    v_fma_f32 v140, v68, v20, v140
    v_fma_f32 v141, v69, v21, v141
    v_fma_f32 v142, v70, v22, v142
    v_fma_f32 v143, v71, v23, v143
    v_fma_f32 v144, v72, v24, v144
    v_fma_f32 v145, v73, v25, v145
    v_fma_f32 v146, v74, v26, v146
    v_fma_f32 v147, v75, v27, v147
    v_fma_f32 v148, v76, v28, v148
    v_fma_f32 v149, v77, v29, v149
    v_fma_f32 v150, v78, v30, v150
    v_fma_f32 v151, v79, v31, v151
    v_fma_f32 v152, v80, v32, v152
    v_fma_f32 v153, v81, v33, v153
    v_fma_f32 v154, v82, v34, v154
    v_fma_f32 v155, v83, v35, v155
    v_fma_f32 v156, v84, v36, v156
    v_fma_f32 v157, v85, v37, v157
    v_fma_f32 v158, v86, v38, v158
    v_fma_f32 v159, v87, v39, v159
    v_pk_add_f32 v[16:17], v[136:137], v[138:139]
    v_pk_mul_f32 v[18:19], v[136:137], v[136:137]
    v_pk_fma_f32 v[18:19], v[138:139], v[138:139], v[18:19]
    v_pk_fma_f32 v[18:19], v[140:141], v[140:141], v[18:19]
    v_pk_add_f32 v[16:17], v[16:17], v[140:141]
    v_pk_fma_f32 v[18:19], v[142:143], v[142:143], v[18:19]
    v_pk_add_f32 v[16:17], v[16:17], v[142:143]
    v_pk_fma_f32 v[18:19], v[144:145], v[144:145], v[18:19]
    v_pk_add_f32 v[16:17], v[16:17], v[144:145]
    v_pk_fma_f32 v[18:19], v[146:147], v[146:147], v[18:19]
    v_pk_add_f32 v[16:17], v[16:17], v[146:147]
    v_pk_fma_f32 v[18:19], v[148:149], v[148:149], v[18:19]
    v_pk_add_f32 v[16:17], v[16:17], v[148:149]
    v_pk_fma_f32 v[18:19], v[150:151], v[150:151], v[18:19]
    v_pk_add_f32 v[16:17], v[16:17], v[150:151]
    v_pk_fma_f32 v[18:19], v[152:153], v[152:153], v[18:19]
    v_pk_add_f32 v[16:17], v[16:17], v[152:153]
    v_pk_fma_f32 v[18:19], v[154:155], v[154:155], v[18:19]
    v_pk_add_f32 v[16:17], v[16:17], v[154:155]
    v_pk_fma_f32 v[18:19], v[156:157], v[156:157], v[18:19]
    v_pk_add_f32 v[16:17], v[16:17], v[156:157]
    v_pk_fma_f32 v[18:19], v[158:159], v[158:159], v[18:19]
    v_pk_add_f32 v[16:17], v[16:17], v[158:159]
    v_add_f32 v16, v16, v17
    v_add_f32 v18, v18, v19
    v_cvt_pk_bf16_f32 v40, v136, v137
    v_cvt_pk_bf16_f32 v41, v138, v139
    v_permlane32_swap_b32 v16, v18
    v_cvt_pk_bf16_f32 v42, v140, v141
    v_cvt_pk_bf16_f32 v43, v142, v143
    v_add_f32 v16, v16, v18
    v_lshlrev_b32 v20, 3, v1
    v_mov_b32 v18, v16
    v_lshrrev_b32 v2, 5, v0
    s_lshl_b32 s87, s24, 6
    v_cvt_pk_bf16_f32 v44, v144, v145
    v_permlane16_swap_b32 v16, v18
    v_lshl_add_u32 v21, v2, 2, v20
    v_cvt_pk_bf16_f32 v45, v146, v147
    v_add_f32 v16, v16, v18
    v_add_u32 v21, s87, v21
    v_cvt_pk_bf16_f32 v46, v148, v149
    v_add_f32_dpp v16, v16, v16 row_ror:8 row_mask:0xf bank_mask:0xf
    v_cvt_pk_bf16_f32 v47, v150, v151
    ds_write_b32 v21, v16 offset:9216
    v_cvt_pk_bf16_f32 v48, v152, v153
    v_cvt_pk_bf16_f32 v49, v154, v155
    v_cvt_pk_bf16_f32 v50, v156, v157
    v_cvt_pk_bf16_f32 v51, v158, v159
    s_lshr_b32 s87, s95, 1
    s_mul_i32 s87, s87, 18432
    s_and_b32 s95, s95, 1
    s_lshl_b32 s95, s95, 7
    s_add_u32 s95, s95, s87
    s_mul_i32 s87, s24, 6144
    s_add_u32 s95, s95, s87
    s_add_u32 s95, s95, 27262976
    s_add_u32 s88, s95, 4096
    s_mov_b32 s85, 987991609
    s_mov_b32 s86, 925353388
    s_waitcnt lgkmcnt(0)
    s_barrier
    ds_read_b64 v[24:25], v20 offset:9216
    ds_read_b64 v[26:27], v20 offset:9280
    ds_read_b64 v[28:29], v20 offset:9344
    buffer_store_dwordx4 v[40:43], v5, s[20:23], s18 offen offset:0 sc1
    buffer_store_dwordx4 v[44:47], v5, s[20:23], s18 offen offset:1024 sc1
    buffer_store_dwordx4 v[48:51], v5, s[20:23], s18 offen offset:2048 sc1
    s_waitcnt lgkmcnt(0)
    v_pk_add_f32 v[24:25], v[24:25], v[26:27]
    v_pk_add_f32 v[24:25], v[24:25], v[28:29]
    v_mul_f32 v24, s85, v24
    v_mul_f32 v26, s85, v25
    v_fma_f32 v26, -v24, v24, v26
    v_max_f32 v26, 0, v26
    v_add_f32 v26, s86, v26
    v_rsq_f32 v26, v26
    v_pk_add_f32 v[136:137], v[136:137], v[24:25] op_sel_hi:[1,0] neg_lo:[0,1] neg_hi:[0,1]
    v_pk_add_f32 v[138:139], v[138:139], v[24:25] op_sel_hi:[1,0] neg_lo:[0,1] neg_hi:[0,1]
    v_pk_add_f32 v[140:141], v[140:141], v[24:25] op_sel_hi:[1,0] neg_lo:[0,1] neg_hi:[0,1]
    v_pk_add_f32 v[142:143], v[142:143], v[24:25] op_sel_hi:[1,0] neg_lo:[0,1] neg_hi:[0,1]
    v_pk_mul_f32 v[136:137], v[136:137], v[26:27] op_sel_hi:[1,0]
    v_pk_mul_f32 v[138:139], v[138:139], v[26:27] op_sel_hi:[1,0]
    v_pk_mul_f32 v[140:141], v[140:141], v[26:27] op_sel_hi:[1,0]
    v_pk_mul_f32 v[142:143], v[142:143], v[26:27] op_sel_hi:[1,0]
    v_pk_fma_f32 v[136:137], v[136:137], v[112:113], v[88:89]
    v_pk_fma_f32 v[138:139], v[138:139], v[114:115], v[90:91]
    v_pk_fma_f32 v[140:141], v[140:141], v[116:117], v[92:93]
    v_pk_fma_f32 v[142:143], v[142:143], v[118:119], v[94:95]
    v_cvt_pk_bf16_f32 v52, v136, v137
    v_cvt_pk_bf16_f32 v53, v138, v139
    v_cvt_pk_bf16_f32 v54, v140, v141
    v_cvt_pk_bf16_f32 v55, v142, v143
    buffer_store_dwordx4 v[52:55], v8, s[20:23], s95 offen offset:0 sc1
    v_pk_add_f32 v[144:145], v[144:145], v[24:25] op_sel_hi:[1,0] neg_lo:[0,1] neg_hi:[0,1]
    v_pk_add_f32 v[146:147], v[146:147], v[24:25] op_sel_hi:[1,0] neg_lo:[0,1] neg_hi:[0,1]
    v_pk_add_f32 v[148:149], v[148:149], v[24:25] op_sel_hi:[1,0] neg_lo:[0,1] neg_hi:[0,1]
    v_pk_add_f32 v[150:151], v[150:151], v[24:25] op_sel_hi:[1,0] neg_lo:[0,1] neg_hi:[0,1]
    v_pk_mul_f32 v[144:145], v[144:145], v[26:27] op_sel_hi:[1,0]
    v_pk_mul_f32 v[146:147], v[146:147], v[26:27] op_sel_hi:[1,0]
    v_pk_mul_f32 v[148:149], v[148:149], v[26:27] op_sel_hi:[1,0]
    v_pk_mul_f32 v[150:151], v[150:151], v[26:27] op_sel_hi:[1,0]
    v_pk_fma_f32 v[144:145], v[144:145], v[120:121], v[96:97]
    v_pk_fma_f32 v[146:147], v[146:147], v[122:123], v[98:99]
    v_pk_fma_f32 v[148:149], v[148:149], v[124:125], v[100:101]
    v_pk_fma_f32 v[150:151], v[150:151], v[126:127], v[102:103]
    v_cvt_pk_bf16_f32 v56, v144, v145
    v_cvt_pk_bf16_f32 v57, v146, v147
    v_cvt_pk_bf16_f32 v58, v148, v149
    v_cvt_pk_bf16_f32 v59, v150, v151
    buffer_store_dwordx4 v[56:59], v8, s[20:23], s95 offen offset:2048 sc1
    v_pk_add_f32 v[152:153], v[152:153], v[24:25] op_sel_hi:[1,0] neg_lo:[0,1] neg_hi:[0,1]
    v_pk_add_f32 v[154:155], v[154:155], v[24:25] op_sel_hi:[1,0] neg_lo:[0,1] neg_hi:[0,1]
    v_pk_add_f32 v[156:157], v[156:157], v[24:25] op_sel_hi:[1,0] neg_lo:[0,1] neg_hi:[0,1]
    v_pk_add_f32 v[158:159], v[158:159], v[24:25] op_sel_hi:[1,0] neg_lo:[0,1] neg_hi:[0,1]
    v_pk_mul_f32 v[152:153], v[152:153], v[26:27] op_sel_hi:[1,0]
    v_pk_mul_f32 v[154:155], v[154:155], v[26:27] op_sel_hi:[1,0]
    v_pk_mul_f32 v[156:157], v[156:157], v[26:27] op_sel_hi:[1,0]
    v_pk_mul_f32 v[158:159], v[158:159], v[26:27] op_sel_hi:[1,0]
    v_pk_fma_f32 v[152:153], v[152:153], v[128:129], v[104:105]
    v_pk_fma_f32 v[154:155], v[154:155], v[130:131], v[106:107]
    v_pk_fma_f32 v[156:157], v[156:157], v[132:133], v[108:109]
    v_pk_fma_f32 v[158:159], v[158:159], v[134:135], v[110:111]
    v_cvt_pk_bf16_f32 v60, v152, v153
    v_cvt_pk_bf16_f32 v61, v154, v155
    v_cvt_pk_bf16_f32 v62, v156, v157
    v_cvt_pk_bf16_f32 v63, v158, v159
    buffer_store_dwordx4 v[60:63], v8, s[20:23], s88 offen offset:0 sc1
    s_cmp_lg_u32 s84, 0
    s_cbranch_scc1 TODO_adaLN_cond__gqa_block_cached__glu_gated_geglu__prompt_kernel
LAST_adaLN_cond__gqa_block_cached__glu_gated_geglu__prompt_kernel:
    ds_read_b32 v12, v10
    s_waitcnt lgkmcnt(0)
    v_readfirstlane_b32 s14, v12
    s_and_b32 s87, s14, 65535
    s_cmp_lg_u32 s87, 65535
    s_cbranch_scc1 LAST_adaLN_cond__gqa_block_cached__glu_gated_geglu__prompt_kernel
    s_lshr_b32 s14, s14, 16
TODO_adaLN_cond__gqa_block_cached__glu_gated_geglu__prompt_kernel:
    s_cmp_eq_u32 s14, 0
    s_cbranch_scc1 FIN_adaLN_cond__gqa_block_cached__glu_gated_geglu__prompt_kernel
    s_ff1_i32_b32 s13, s14
    s_bitset0_b32 s14, s13
    s_mov_b32 s16, 65535
    s_mov_b32 s84, 1
    s_waitcnt vmcnt(0)
    s_barrier
    s_branch PIECE_adaLN_cond__gqa_block_cached__glu_gated_geglu__prompt_kernel
QUIT_adaLN_cond__gqa_block_cached__glu_gated_geglu__prompt_kernel:
    s_waitcnt vmcnt(0)
FIN_adaLN_cond__gqa_block_cached__glu_gated_geglu__prompt_kernel:
END_adaLN_cond__gqa_block_cached__glu_gated_geglu__prompt_kernel:
    s_endpgm
SLOW0_adaLN_cond__gqa_block_cached__glu_gated_geglu__prompt_kernel:
    s_call_b64 s[32:33], FIX0_adaLN_cond__gqa_block_cached__glu_gated_geglu__prompt_kernel
    s_branch BACK0_adaLN_cond__gqa_block_cached__glu_gated_geglu__prompt_kernel
SLOW1_adaLN_cond__gqa_block_cached__glu_gated_geglu__prompt_kernel:
    s_call_b64 s[32:33], FIX1_adaLN_cond__gqa_block_cached__glu_gated_geglu__prompt_kernel
    s_branch BACK1_adaLN_cond__gqa_block_cached__glu_gated_geglu__prompt_kernel
SLOW2_adaLN_cond__gqa_block_cached__glu_gated_geglu__prompt_kernel:
    s_call_b64 s[32:33], FIX0_adaLN_cond__gqa_block_cached__glu_gated_geglu__prompt_kernel
    s_branch BACK2_adaLN_cond__gqa_block_cached__glu_gated_geglu__prompt_kernel
SLOW3_adaLN_cond__gqa_block_cached__glu_gated_geglu__prompt_kernel:
    s_call_b64 s[32:33], FIX1_adaLN_cond__gqa_block_cached__glu_gated_geglu__prompt_kernel
    s_branch BACK3_adaLN_cond__gqa_block_cached__glu_gated_geglu__prompt_kernel
FIX0_adaLN_cond__gqa_block_cached__glu_gated_geglu__prompt_kernel:
    s_nop 7
    v_log_f32 v246, v96
    v_cmp_lt_u32 vcc, 31, v0
    v_min_f32 v246, 3250585600, v246
    s_nop 0
    v_cndmask_b32 v246, v246, v16, vcc
    v_max3_f32 v244, v16, v17, v18
    v_max3_f32 v244, v244, v19, v20
    v_max3_f32 v244, v244, v21, v22
    v_max3_f32 v244, v244, v23, v246
    v_mov_b32 v245, v244
    v_nop
    v_nop
    v_permlane32_swap_b32 v244, v245
    v_max_f32 v244, v244, v245
    v_mov_b32 v245, v244
    v_nop
    v_nop
    v_permlane16_swap_b32 v244, v245
    v_max_f32 v244, v244, v245
    v_add_f32 v244, s38, v244
    v_ceil_f32 v244, v244
    v_max_f32 v244, 0, v244
    v_exp_f32 v245, -v244
    v_sub_f32 v80, v80, v244
    v_sub_f32 v81, v81, v244
    v_sub_f32 v82, v82, v244
    v_sub_f32 v83, v83, v244
    v_sub_f32 v16, v16, v244
    v_sub_f32 v48, v48, v244
    v_sub_f32 v17, v17, v244
    v_sub_f32 v49, v49, v244
    v_sub_f32 v18, v18, v244
    v_sub_f32 v50, v50, v244
    v_sub_f32 v19, v19, v244
    v_sub_f32 v51, v51, v244
    v_sub_f32 v20, v20, v244
    v_sub_f32 v52, v52, v244
    v_sub_f32 v21, v21, v244
    v_sub_f32 v53, v53, v244
    v_sub_f32 v22, v22, v244
    v_sub_f32 v54, v54, v244
    v_sub_f32 v23, v23, v244
    v_sub_f32 v55, v55, v244
    v_mov_b32 v105, v245
    v_accvgpr_read_b32 v236, a0
    v_mul_f32 v236, v236, v245
    v_accvgpr_write_b32 a0, v236
    v_accvgpr_read_b32 v236, a1
    v_mul_f32 v236, v236, v245
    v_accvgpr_write_b32 a1, v236
    v_accvgpr_read_b32 v236, a2
    v_mul_f32 v236, v236, v245
    v_accvgpr_write_b32 a2, v236
    v_accvgpr_read_b32 v236, a3
    v_mul_f32 v236, v236, v245
    v_accvgpr_write_b32 a3, v236
    v_accvgpr_read_b32 v236, a16
    v_mul_f32 v236, v236, v245
    v_accvgpr_write_b32 a16, v236
    v_accvgpr_read_b32 v236, a17
    v_mul_f32 v236, v236, v245
    v_accvgpr_write_b32 a17, v236
    v_accvgpr_read_b32 v236, a18
    v_mul_f32 v236, v236, v245
    v_accvgpr_write_b32 a18, v236
    v_accvgpr_read_b32 v236, a19
    v_mul_f32 v236, v236, v245
    v_accvgpr_write_b32 a19, v236
    v_accvgpr_read_b32 v236, a32
    v_mul_f32 v236, v236, v245
    v_accvgpr_write_b32 a32, v236
    v_accvgpr_read_b32 v236, a33
    v_mul_f32 v236, v236, v245
    v_accvgpr_write_b32 a33, v236
    v_accvgpr_read_b32 v236, a34
    v_mul_f32 v236, v236, v245
    v_accvgpr_write_b32 a34, v236
    v_accvgpr_read_b32 v236, a35
    v_mul_f32 v236, v236, v245
    v_accvgpr_write_b32 a35, v236
    v_accvgpr_read_b32 v236, a48
    v_mul_f32 v236, v236, v245
    v_accvgpr_write_b32 a48, v236
    v_accvgpr_read_b32 v236, a49
    v_mul_f32 v236, v236, v245
    v_accvgpr_write_b32 a49, v236
    v_accvgpr_read_b32 v236, a50
    v_mul_f32 v236, v236, v245
    v_accvgpr_write_b32 a50, v236
    v_accvgpr_read_b32 v236, a51
    v_mul_f32 v236, v236, v245
    v_accvgpr_write_b32 a51, v236
    v_accvgpr_read_b32 v236, a64
    v_mul_f32 v236, v236, v245
    v_accvgpr_write_b32 a64, v236
    v_accvgpr_read_b32 v236, a65
    v_mul_f32 v236, v236, v245
    v_accvgpr_write_b32 a65, v236
    v_accvgpr_read_b32 v236, a66
    v_mul_f32 v236, v236, v245
    v_accvgpr_write_b32 a66, v236
    v_accvgpr_read_b32 v236, a67
    v_mul_f32 v236, v236, v245
    v_accvgpr_write_b32 a67, v236
    v_accvgpr_read_b32 v236, a80
    v_mul_f32 v236, v236, v245
    v_accvgpr_write_b32 a80, v236
    v_accvgpr_read_b32 v236, a81
    v_mul_f32 v236, v236, v245
    v_accvgpr_write_b32 a81, v236
    v_accvgpr_read_b32 v236, a82
    v_mul_f32 v236, v236, v245
    v_accvgpr_write_b32 a82, v236
    v_accvgpr_read_b32 v236, a83
    v_mul_f32 v236, v236, v245
    v_accvgpr_write_b32 a83, v236
    v_accvgpr_read_b32 v236, a96
    v_mul_f32 v236, v236, v245
    v_accvgpr_write_b32 a96, v236
    v_accvgpr_read_b32 v236, a97
    v_mul_f32 v236, v236, v245
    v_accvgpr_write_b32 a97, v236
    v_accvgpr_read_b32 v236, a98
    v_mul_f32 v236, v236, v245
    v_accvgpr_write_b32 a98, v236
    v_accvgpr_read_b32 v236, a99
    v_mul_f32 v236, v236, v245
    v_accvgpr_write_b32 a99, v236
    v_accvgpr_read_b32 v236, a112
    v_mul_f32 v236, v236, v245
    v_accvgpr_write_b32 a112, v236
    v_accvgpr_read_b32 v236, a113
    v_mul_f32 v236, v236, v245
    v_accvgpr_write_b32 a113, v236
    v_accvgpr_read_b32 v236, a114
    v_mul_f32 v236, v236, v245
    v_accvgpr_write_b32 a114, v236
    v_accvgpr_read_b32 v236, a115
    v_mul_f32 v236, v236, v245
    v_accvgpr_write_b32 a115, v236
    v_exp_f32 v236, v16
    v_exp_f32 v237, v17
    s_nop 0
    v_cvt_pk_bf16_f32 v128, v236, v237
    v_exp_f32 v236, v18
    v_exp_f32 v237, v19
    s_nop 0
    v_cvt_pk_bf16_f32 v129, v236, v237
    v_exp_f32 v236, v20
    v_exp_f32 v237, v21
    s_nop 0
    v_cvt_pk_bf16_f32 v130, v236, v237
    v_exp_f32 v236, v22
    v_exp_f32 v237, v23
    s_nop 0
    v_cvt_pk_bf16_f32 v131, v236, v237
    v_log_f32 v246, v96
    v_cmp_gt_u32 vcc, 32, v0
    v_min_f32 v246, 3250585600, v246
    s_nop 0
    v_cndmask_b32 v246, v246, v24, vcc
    v_max3_f32 v244, v24, v25, v26
    v_max3_f32 v244, v244, v27, v28
    v_max3_f32 v244, v244, v29, v30
    v_max3_f32 v244, v244, v31, v246
    v_mov_b32 v245, v244
    v_nop
    v_nop
    v_permlane32_swap_b32 v244, v245
    v_max_f32 v244, v244, v245
    v_mov_b32 v245, v244
    v_nop
    v_nop
    v_permlane16_swap_b32 v244, v245
    v_max_f32 v244, v244, v245
    v_add_f32 v244, s38, v244
    v_ceil_f32 v244, v244
    v_max_f32 v244, 0, v244
    v_exp_f32 v245, -v244
    v_sub_f32 v84, v84, v244
    v_sub_f32 v85, v85, v244
    v_sub_f32 v86, v86, v244
    v_sub_f32 v87, v87, v244
    v_sub_f32 v24, v24, v244
    v_sub_f32 v56, v56, v244
    v_sub_f32 v25, v25, v244
    v_sub_f32 v57, v57, v244
    v_sub_f32 v26, v26, v244
    v_sub_f32 v58, v58, v244
    v_sub_f32 v27, v27, v244
    v_sub_f32 v59, v59, v244
    v_sub_f32 v28, v28, v244
    v_sub_f32 v60, v60, v244
    v_sub_f32 v29, v29, v244
    v_sub_f32 v61, v61, v244
    v_sub_f32 v30, v30, v244
    v_sub_f32 v62, v62, v244
    v_sub_f32 v31, v31, v244
    v_sub_f32 v63, v63, v244
    v_cndmask_b32 v105, v245, v105, vcc
    v_accvgpr_read_b32 v236, a4
    v_mul_f32 v236, v236, v245
    v_accvgpr_write_b32 a4, v236
    v_accvgpr_read_b32 v236, a5
    v_mul_f32 v236, v236, v245
    v_accvgpr_write_b32 a5, v236
    v_accvgpr_read_b32 v236, a6
    v_mul_f32 v236, v236, v245
    v_accvgpr_write_b32 a6, v236
    v_accvgpr_read_b32 v236, a7
    v_mul_f32 v236, v236, v245
    v_accvgpr_write_b32 a7, v236
    v_accvgpr_read_b32 v236, a20
    v_mul_f32 v236, v236, v245
    v_accvgpr_write_b32 a20, v236
    v_accvgpr_read_b32 v236, a21
    v_mul_f32 v236, v236, v245
    v_accvgpr_write_b32 a21, v236
    v_accvgpr_read_b32 v236, a22
    v_mul_f32 v236, v236, v245
    v_accvgpr_write_b32 a22, v236
    v_accvgpr_read_b32 v236, a23
    v_mul_f32 v236, v236, v245
    v_accvgpr_write_b32 a23, v236
    v_accvgpr_read_b32 v236, a36
    v_mul_f32 v236, v236, v245
    v_accvgpr_write_b32 a36, v236
    v_accvgpr_read_b32 v236, a37
    v_mul_f32 v236, v236, v245
    v_accvgpr_write_b32 a37, v236
    v_accvgpr_read_b32 v236, a38
    v_mul_f32 v236, v236, v245
    v_accvgpr_write_b32 a38, v236
    v_accvgpr_read_b32 v236, a39
    v_mul_f32 v236, v236, v245
    v_accvgpr_write_b32 a39, v236
    v_accvgpr_read_b32 v236, a52
    v_mul_f32 v236, v236, v245
    v_accvgpr_write_b32 a52, v236
    v_accvgpr_read_b32 v236, a53
    v_mul_f32 v236, v236, v245
    v_accvgpr_write_b32 a53, v236
    v_accvgpr_read_b32 v236, a54
    v_mul_f32 v236, v236, v245
    v_accvgpr_write_b32 a54, v236
    v_accvgpr_read_b32 v236, a55
    v_mul_f32 v236, v236, v245
    v_accvgpr_write_b32 a55, v236
    v_accvgpr_read_b32 v236, a68
    v_mul_f32 v236, v236, v245
    v_accvgpr_write_b32 a68, v236
    v_accvgpr_read_b32 v236, a69
    v_mul_f32 v236, v236, v245
    v_accvgpr_write_b32 a69, v236
    v_accvgpr_read_b32 v236, a70
    v_mul_f32 v236, v236, v245
    v_accvgpr_write_b32 a70, v236
    v_accvgpr_read_b32 v236, a71
    v_mul_f32 v236, v236, v245
    v_accvgpr_write_b32 a71, v236
    v_accvgpr_read_b32 v236, a84
    v_mul_f32 v236, v236, v245
    v_accvgpr_write_b32 a84, v236
    v_accvgpr_read_b32 v236, a85
    v_mul_f32 v236, v236, v245
    v_accvgpr_write_b32 a85, v236
    v_accvgpr_read_b32 v236, a86
    v_mul_f32 v236, v236, v245
    v_accvgpr_write_b32 a86, v236
    v_accvgpr_read_b32 v236, a87
    v_mul_f32 v236, v236, v245
    v_accvgpr_write_b32 a87, v236
    v_accvgpr_read_b32 v236, a100
    v_mul_f32 v236, v236, v245
    v_accvgpr_write_b32 a100, v236
    v_accvgpr_read_b32 v236, a101
    v_mul_f32 v236, v236, v245
    v_accvgpr_write_b32 a101, v236
    v_accvgpr_read_b32 v236, a102
    v_mul_f32 v236, v236, v245
    v_accvgpr_write_b32 a102, v236
    v_accvgpr_read_b32 v236, a103
    v_mul_f32 v236, v236, v245
    v_accvgpr_write_b32 a103, v236
    v_accvgpr_read_b32 v236, a116
    v_mul_f32 v236, v236, v245
    v_accvgpr_write_b32 a116, v236
    v_accvgpr_read_b32 v236, a117
    v_mul_f32 v236, v236, v245
    v_accvgpr_write_b32 a117, v236
    v_accvgpr_read_b32 v236, a118
    v_mul_f32 v236, v236, v245
    v_accvgpr_write_b32 a118, v236
    v_accvgpr_read_b32 v236, a119
    v_mul_f32 v236, v236, v245
    v_accvgpr_write_b32 a119, v236
    v_exp_f32 v236, v24
    v_exp_f32 v237, v25
    s_nop 0
    v_cvt_pk_bf16_f32 v132, v236, v237
    v_exp_f32 v236, v26
    v_exp_f32 v237, v27
    s_nop 0
    v_cvt_pk_bf16_f32 v133, v236, v237
    v_exp_f32 v236, v28
    v_exp_f32 v237, v29
    s_nop 0
    v_cvt_pk_bf16_f32 v134, v236, v237
    v_exp_f32 v236, v30
    v_exp_f32 v237, v31
    s_nop 0
    v_cvt_pk_bf16_f32 v135, v236, v237
    v_mov_b32 v108, 0
    v_mov_b32 v109, 0
    v_mov_b32 v110, 0
    v_mov_b32 v111, 0
    s_nop 1
    v_smfmac_f32_16x16x64_bf16 v[108:111], a[192:195], v[128:135], v104
    v_cmp_gt_f32 vcc, 1.0, v96
    v_mul_f32 v96, v96, v105
    s_nop 7
    s_nop 7
    v_cndmask_b32 v96, v108, v96, vcc
    v_log_f32 v246, v100
    v_cmp_lt_u32 vcc, 31, v0
    v_min_f32 v246, 3250585600, v246
    s_nop 0
    v_cndmask_b32 v246, v246, v32, vcc
    v_max3_f32 v244, v32, v33, v34
    v_max3_f32 v244, v244, v35, v36
    v_max3_f32 v244, v244, v37, v38
    v_max3_f32 v244, v244, v39, v246
    v_mov_b32 v245, v244
    v_nop
    v_nop
    v_permlane32_swap_b32 v244, v245
    v_max_f32 v244, v244, v245
    v_mov_b32 v245, v244
    v_nop
    v_nop
    v_permlane16_swap_b32 v244, v245
    v_max_f32 v244, v244, v245
    v_add_f32 v244, s38, v244
    v_ceil_f32 v244, v244
    v_max_f32 v244, 0, v244
    v_exp_f32 v245, -v244
    v_sub_f32 v88, v88, v244
    v_sub_f32 v89, v89, v244
    v_sub_f32 v90, v90, v244
    v_sub_f32 v91, v91, v244
    v_sub_f32 v32, v32, v244
    v_sub_f32 v64, v64, v244
    v_sub_f32 v33, v33, v244
    v_sub_f32 v65, v65, v244
    v_sub_f32 v34, v34, v244
    v_sub_f32 v66, v66, v244
    v_sub_f32 v35, v35, v244
    v_sub_f32 v67, v67, v244
    v_sub_f32 v36, v36, v244
    v_sub_f32 v68, v68, v244
    v_sub_f32 v37, v37, v244
    v_sub_f32 v69, v69, v244
    v_sub_f32 v38, v38, v244
    v_sub_f32 v70, v70, v244
    v_sub_f32 v39, v39, v244
    v_sub_f32 v71, v71, v244
    v_mov_b32 v105, v245
    v_accvgpr_read_b32 v236, a8
    v_mul_f32 v236, v236, v245
    v_accvgpr_write_b32 a8, v236
    v_accvgpr_read_b32 v236, a9
    v_mul_f32 v236, v236, v245
    v_accvgpr_write_b32 a9, v236
    v_accvgpr_read_b32 v236, a10
    v_mul_f32 v236, v236, v245
    v_accvgpr_write_b32 a10, v236
    v_accvgpr_read_b32 v236, a11
    v_mul_f32 v236, v236, v245
    v_accvgpr_write_b32 a11, v236
    v_accvgpr_read_b32 v236, a24
    v_mul_f32 v236, v236, v245
    v_accvgpr_write_b32 a24, v236
    v_accvgpr_read_b32 v236, a25
    v_mul_f32 v236, v236, v245
    v_accvgpr_write_b32 a25, v236
    v_accvgpr_read_b32 v236, a26
    v_mul_f32 v236, v236, v245
    v_accvgpr_write_b32 a26, v236
    v_accvgpr_read_b32 v236, a27
    v_mul_f32 v236, v236, v245
    v_accvgpr_write_b32 a27, v236
    v_accvgpr_read_b32 v236, a40
    v_mul_f32 v236, v236, v245
    v_accvgpr_write_b32 a40, v236
    v_accvgpr_read_b32 v236, a41
    v_mul_f32 v236, v236, v245
    v_accvgpr_write_b32 a41, v236
    v_accvgpr_read_b32 v236, a42
    v_mul_f32 v236, v236, v245
    v_accvgpr_write_b32 a42, v236
    v_accvgpr_read_b32 v236, a43
    v_mul_f32 v236, v236, v245
    v_accvgpr_write_b32 a43, v236
    v_accvgpr_read_b32 v236, a56
    v_mul_f32 v236, v236, v245
    v_accvgpr_write_b32 a56, v236
    v_accvgpr_read_b32 v236, a57
    v_mul_f32 v236, v236, v245
    v_accvgpr_write_b32 a57, v236
    v_accvgpr_read_b32 v236, a58
    v_mul_f32 v236, v236, v245
    v_accvgpr_write_b32 a58, v236
    v_accvgpr_read_b32 v236, a59
    v_mul_f32 v236, v236, v245
    v_accvgpr_write_b32 a59, v236
    v_accvgpr_read_b32 v236, a72
    v_mul_f32 v236, v236, v245
    v_accvgpr_write_b32 a72, v236
    v_accvgpr_read_b32 v236, a73
    v_mul_f32 v236, v236, v245
    v_accvgpr_write_b32 a73, v236
    v_accvgpr_read_b32 v236, a74
    v_mul_f32 v236, v236, v245
    v_accvgpr_write_b32 a74, v236
    v_accvgpr_read_b32 v236, a75
    v_mul_f32 v236, v236, v245
    v_accvgpr_write_b32 a75, v236
    v_accvgpr_read_b32 v236, a88
    v_mul_f32 v236, v236, v245
    v_accvgpr_write_b32 a88, v236
    v_accvgpr_read_b32 v236, a89
    v_mul_f32 v236, v236, v245
    v_accvgpr_write_b32 a89, v236
    v_accvgpr_read_b32 v236, a90
    v_mul_f32 v236, v236, v245
    v_accvgpr_write_b32 a90, v236
    v_accvgpr_read_b32 v236, a91
    v_mul_f32 v236, v236, v245
    v_accvgpr_write_b32 a91, v236
    v_accvgpr_read_b32 v236, a104
    v_mul_f32 v236, v236, v245
    v_accvgpr_write_b32 a104, v236
    v_accvgpr_read_b32 v236, a105
    v_mul_f32 v236, v236, v245
    v_accvgpr_write_b32 a105, v236
    v_accvgpr_read_b32 v236, a106
    v_mul_f32 v236, v236, v245
    v_accvgpr_write_b32 a106, v236
    v_accvgpr_read_b32 v236, a107
    v_mul_f32 v236, v236, v245
    v_accvgpr_write_b32 a107, v236
    v_accvgpr_read_b32 v236, a120
    v_mul_f32 v236, v236, v245
    v_accvgpr_write_b32 a120, v236
    v_accvgpr_read_b32 v236, a121
    v_mul_f32 v236, v236, v245
    v_accvgpr_write_b32 a121, v236
    v_accvgpr_read_b32 v236, a122
    v_mul_f32 v236, v236, v245
    v_accvgpr_write_b32 a122, v236
    v_accvgpr_read_b32 v236, a123
    v_mul_f32 v236, v236, v245
    v_accvgpr_write_b32 a123, v236
    v_exp_f32 v236, v32
    v_exp_f32 v237, v33
    s_nop 0
    v_cvt_pk_bf16_f32 v136, v236, v237
    v_exp_f32 v236, v34
    v_exp_f32 v237, v35
    s_nop 0
    v_cvt_pk_bf16_f32 v137, v236, v237
    v_exp_f32 v236, v36
    v_exp_f32 v237, v37
    s_nop 0
    v_cvt_pk_bf16_f32 v138, v236, v237
    v_exp_f32 v236, v38
    v_exp_f32 v237, v39
    s_nop 0
    v_cvt_pk_bf16_f32 v139, v236, v237
    v_log_f32 v246, v100
    v_cmp_gt_u32 vcc, 32, v0
    v_min_f32 v246, 3250585600, v246
    s_nop 0
    v_cndmask_b32 v246, v246, v40, vcc
    v_max3_f32 v244, v40, v41, v42
    v_max3_f32 v244, v244, v43, v44
    v_max3_f32 v244, v244, v45, v46
    v_max3_f32 v244, v244, v47, v246
    v_mov_b32 v245, v244
    v_nop
    v_nop
    v_permlane32_swap_b32 v244, v245
    v_max_f32 v244, v244, v245
    v_mov_b32 v245, v244
    v_nop
    v_nop
    v_permlane16_swap_b32 v244, v245
    v_max_f32 v244, v244, v245
    v_add_f32 v244, s38, v244
    v_ceil_f32 v244, v244
    v_max_f32 v244, 0, v244
    v_exp_f32 v245, -v244
    v_sub_f32 v92, v92, v244
    v_sub_f32 v93, v93, v244
    v_sub_f32 v94, v94, v244
    v_sub_f32 v95, v95, v244
    v_sub_f32 v40, v40, v244
    v_sub_f32 v72, v72, v244
    v_sub_f32 v41, v41, v244
    v_sub_f32 v73, v73, v244
    v_sub_f32 v42, v42, v244
    v_sub_f32 v74, v74, v244
    v_sub_f32 v43, v43, v244
    v_sub_f32 v75, v75, v244
    v_sub_f32 v44, v44, v244
    v_sub_f32 v76, v76, v244
    v_sub_f32 v45, v45, v244
    v_sub_f32 v77, v77, v244
    v_sub_f32 v46, v46, v244
    v_sub_f32 v78, v78, v244
    v_sub_f32 v47, v47, v244
    v_sub_f32 v79, v79, v244
    v_cndmask_b32 v105, v245, v105, vcc
    v_accvgpr_read_b32 v236, a12
    v_mul_f32 v236, v236, v245
    v_accvgpr_write_b32 a12, v236
    v_accvgpr_read_b32 v236, a13
    v_mul_f32 v236, v236, v245
    v_accvgpr_write_b32 a13, v236
    v_accvgpr_read_b32 v236, a14
    v_mul_f32 v236, v236, v245
    v_accvgpr_write_b32 a14, v236
    v_accvgpr_read_b32 v236, a15
    v_mul_f32 v236, v236, v245
    v_accvgpr_write_b32 a15, v236
    v_accvgpr_read_b32 v236, a28
    v_mul_f32 v236, v236, v245
    v_accvgpr_write_b32 a28, v236
    v_accvgpr_read_b32 v236, a29
    v_mul_f32 v236, v236, v245
    v_accvgpr_write_b32 a29, v236
    v_accvgpr_read_b32 v236, a30
    v_mul_f32 v236, v236, v245
    v_accvgpr_write_b32 a30, v236
    v_accvgpr_read_b32 v236, a31
    v_mul_f32 v236, v236, v245
    v_accvgpr_write_b32 a31, v236
    v_accvgpr_read_b32 v236, a44
    v_mul_f32 v236, v236, v245
    v_accvgpr_write_b32 a44, v236
    v_accvgpr_read_b32 v236, a45
    v_mul_f32 v236, v236, v245
    v_accvgpr_write_b32 a45, v236
    v_accvgpr_read_b32 v236, a46
    v_mul_f32 v236, v236, v245
    v_accvgpr_write_b32 a46, v236
    v_accvgpr_read_b32 v236, a47
    v_mul_f32 v236, v236, v245
    v_accvgpr_write_b32 a47, v236
    v_accvgpr_read_b32 v236, a60
    v_mul_f32 v236, v236, v245
    v_accvgpr_write_b32 a60, v236
    v_accvgpr_read_b32 v236, a61
    v_mul_f32 v236, v236, v245
    v_accvgpr_write_b32 a61, v236
    v_accvgpr_read_b32 v236, a62
    v_mul_f32 v236, v236, v245
    v_accvgpr_write_b32 a62, v236
    v_accvgpr_read_b32 v236, a63
    v_mul_f32 v236, v236, v245
    v_accvgpr_write_b32 a63, v236
    v_accvgpr_read_b32 v236, a76
    v_mul_f32 v236, v236, v245
    v_accvgpr_write_b32 a76, v236
    v_accvgpr_read_b32 v236, a77
    v_mul_f32 v236, v236, v245
    v_accvgpr_write_b32 a77, v236
    v_accvgpr_read_b32 v236, a78
    v_mul_f32 v236, v236, v245
    v_accvgpr_write_b32 a78, v236
    v_accvgpr_read_b32 v236, a79
    v_mul_f32 v236, v236, v245
    v_accvgpr_write_b32 a79, v236
    v_accvgpr_read_b32 v236, a92
    v_mul_f32 v236, v236, v245
    v_accvgpr_write_b32 a92, v236
    v_accvgpr_read_b32 v236, a93
    v_mul_f32 v236, v236, v245
    v_accvgpr_write_b32 a93, v236
    v_accvgpr_read_b32 v236, a94
    v_mul_f32 v236, v236, v245
    v_accvgpr_write_b32 a94, v236
    v_accvgpr_read_b32 v236, a95
    v_mul_f32 v236, v236, v245
    v_accvgpr_write_b32 a95, v236
    v_accvgpr_read_b32 v236, a108
    v_mul_f32 v236, v236, v245
    v_accvgpr_write_b32 a108, v236
    v_accvgpr_read_b32 v236, a109
    v_mul_f32 v236, v236, v245
    v_accvgpr_write_b32 a109, v236
    v_accvgpr_read_b32 v236, a110
    v_mul_f32 v236, v236, v245
    v_accvgpr_write_b32 a110, v236
    v_accvgpr_read_b32 v236, a111
    v_mul_f32 v236, v236, v245
    v_accvgpr_write_b32 a111, v236
    v_accvgpr_read_b32 v236, a124
    v_mul_f32 v236, v236, v245
    v_accvgpr_write_b32 a124, v236
    v_accvgpr_read_b32 v236, a125
    v_mul_f32 v236, v236, v245
    v_accvgpr_write_b32 a125, v236
    v_accvgpr_read_b32 v236, a126
    v_mul_f32 v236, v236, v245
    v_accvgpr_write_b32 a126, v236
    v_accvgpr_read_b32 v236, a127
    v_mul_f32 v236, v236, v245
    v_accvgpr_write_b32 a127, v236
    v_exp_f32 v236, v40
    v_exp_f32 v237, v41
    s_nop 0
    v_cvt_pk_bf16_f32 v140, v236, v237
    v_exp_f32 v236, v42
    v_exp_f32 v237, v43
    s_nop 0
    v_cvt_pk_bf16_f32 v141, v236, v237
    v_exp_f32 v236, v44
    v_exp_f32 v237, v45
    s_nop 0
    v_cvt_pk_bf16_f32 v142, v236, v237
    v_exp_f32 v236, v46
    v_exp_f32 v237, v47
    s_nop 0
    v_cvt_pk_bf16_f32 v143, v236, v237
    v_mov_b32 v108, 0
    v_mov_b32 v109, 0
    v_mov_b32 v110, 0
    v_mov_b32 v111, 0
    s_nop 1
    v_smfmac_f32_16x16x64_bf16 v[108:111], a[192:195], v[136:143], v104
    v_cmp_gt_f32 vcc, 1.0, v100
    v_mul_f32 v100, v100, v105
    s_nop 7
    s_nop 7
    v_cndmask_b32 v100, v108, v100, vcc
    s_nop 7
    s_setpc_b64 s[32:33]
FIX1_adaLN_cond__gqa_block_cached__glu_gated_geglu__prompt_kernel:
    s_nop 7
    v_log_f32 v246, v96
    v_cmp_lt_u32 vcc, 31, v0
    v_min_f32 v246, 3250585600, v246
    s_nop 0
    v_cndmask_b32 v246, v246, v48, vcc
    v_max3_f32 v244, v48, v49, v50
    v_max3_f32 v244, v244, v51, v52
    v_max3_f32 v244, v244, v53, v54
    v_max3_f32 v244, v244, v55, v246
    v_mov_b32 v245, v244
    v_nop
    v_nop
    v_permlane32_swap_b32 v244, v245
    v_max_f32 v244, v244, v245
    v_mov_b32 v245, v244
    v_nop
    v_nop
    v_permlane16_swap_b32 v244, v245
    v_max_f32 v244, v244, v245
    v_add_f32 v244, s38, v244
    v_ceil_f32 v244, v244
    v_max_f32 v244, 0, v244
    v_exp_f32 v245, -v244
    v_sub_f32 v80, v80, v244
    v_sub_f32 v81, v81, v244
    v_sub_f32 v82, v82, v244
    v_sub_f32 v83, v83, v244
    v_sub_f32 v48, v48, v244
    v_sub_f32 v16, v16, v244
    v_sub_f32 v49, v49, v244
    v_sub_f32 v17, v17, v244
    v_sub_f32 v50, v50, v244
    v_sub_f32 v18, v18, v244
    v_sub_f32 v51, v51, v244
    v_sub_f32 v19, v19, v244
    v_sub_f32 v52, v52, v244
    v_sub_f32 v20, v20, v244
    v_sub_f32 v53, v53, v244
    v_sub_f32 v21, v21, v244
    v_sub_f32 v54, v54, v244
    v_sub_f32 v22, v22, v244
    v_sub_f32 v55, v55, v244
    v_sub_f32 v23, v23, v244
    v_mov_b32 v105, v245
    v_accvgpr_read_b32 v236, a0
    v_mul_f32 v236, v236, v245
    v_accvgpr_write_b32 a0, v236
    v_accvgpr_read_b32 v236, a1
    v_mul_f32 v236, v236, v245
    v_accvgpr_write_b32 a1, v236
    v_accvgpr_read_b32 v236, a2
    v_mul_f32 v236, v236, v245
    v_accvgpr_write_b32 a2, v236
    v_accvgpr_read_b32 v236, a3
    v_mul_f32 v236, v236, v245
    v_accvgpr_write_b32 a3, v236
    v_accvgpr_read_b32 v236, a16
    v_mul_f32 v236, v236, v245
    v_accvgpr_write_b32 a16, v236
    v_accvgpr_read_b32 v236, a17
    v_mul_f32 v236, v236, v245
    v_accvgpr_write_b32 a17, v236
    v_accvgpr_read_b32 v236, a18
    v_mul_f32 v236, v236, v245
    v_accvgpr_write_b32 a18, v236
    v_accvgpr_read_b32 v236, a19
    v_mul_f32 v236, v236, v245
    v_accvgpr_write_b32 a19, v236
    v_accvgpr_read_b32 v236, a32
    v_mul_f32 v236, v236, v245
    v_accvgpr_write_b32 a32, v236
    v_accvgpr_read_b32 v236, a33
    v_mul_f32 v236, v236, v245
    v_accvgpr_write_b32 a33, v236
    v_accvgpr_read_b32 v236, a34
    v_mul_f32 v236, v236, v245
    v_accvgpr_write_b32 a34, v236
    v_accvgpr_read_b32 v236, a35
    v_mul_f32 v236, v236, v245
    v_accvgpr_write_b32 a35, v236
    v_accvgpr_read_b32 v236, a48
    v_mul_f32 v236, v236, v245
    v_accvgpr_write_b32 a48, v236
    v_accvgpr_read_b32 v236, a49
    v_mul_f32 v236, v236, v245
    v_accvgpr_write_b32 a49, v236
    v_accvgpr_read_b32 v236, a50
    v_mul_f32 v236, v236, v245
    v_accvgpr_write_b32 a50, v236
    v_accvgpr_read_b32 v236, a51
    v_mul_f32 v236, v236, v245
    v_accvgpr_write_b32 a51, v236
    v_accvgpr_read_b32 v236, a64
    v_mul_f32 v236, v236, v245
    v_accvgpr_write_b32 a64, v236
    v_accvgpr_read_b32 v236, a65
    v_mul_f32 v236, v236, v245
    v_accvgpr_write_b32 a65, v236
    v_accvgpr_read_b32 v236, a66
    v_mul_f32 v236, v236, v245
    v_accvgpr_write_b32 a66, v236
    v_accvgpr_read_b32 v236, a67
    v_mul_f32 v236, v236, v245
    v_accvgpr_write_b32 a67, v236
    v_accvgpr_read_b32 v236, a80
    v_mul_f32 v236, v236, v245
    v_accvgpr_write_b32 a80, v236
    v_accvgpr_read_b32 v236, a81
    v_mul_f32 v236, v236, v245
    v_accvgpr_write_b32 a81, v236
    v_accvgpr_read_b32 v236, a82
    v_mul_f32 v236, v236, v245
    v_accvgpr_write_b32 a82, v236
    v_accvgpr_read_b32 v236, a83
    v_mul_f32 v236, v236, v245
    v_accvgpr_write_b32 a83, v236
    v_accvgpr_read_b32 v236, a96
    v_mul_f32 v236, v236, v245
    v_accvgpr_write_b32 a96, v236
    v_accvgpr_read_b32 v236, a97
    v_mul_f32 v236, v236, v245
    v_accvgpr_write_b32 a97, v236
    v_accvgpr_read_b32 v236, a98
    v_mul_f32 v236, v236, v245
    v_accvgpr_write_b32 a98, v236
    v_accvgpr_read_b32 v236, a99
    v_mul_f32 v236, v236, v245
    v_accvgpr_write_b32 a99, v236
    v_accvgpr_read_b32 v236, a112
    v_mul_f32 v236, v236, v245
    v_accvgpr_write_b32 a112, v236
    v_accvgpr_read_b32 v236, a113
    v_mul_f32 v236, v236, v245
    v_accvgpr_write_b32 a113, v236
    v_accvgpr_read_b32 v236, a114
    v_mul_f32 v236, v236, v245
    v_accvgpr_write_b32 a114, v236
    v_accvgpr_read_b32 v236, a115
    v_mul_f32 v236, v236, v245
    v_accvgpr_write_b32 a115, v236
    v_exp_f32 v236, v48
    v_exp_f32 v237, v49
    s_nop 0
    v_cvt_pk_bf16_f32 v144, v236, v237
    v_exp_f32 v236, v50
    v_exp_f32 v237, v51
    s_nop 0
    v_cvt_pk_bf16_f32 v145, v236, v237
    v_exp_f32 v236, v52
    v_exp_f32 v237, v53
    s_nop 0
    v_cvt_pk_bf16_f32 v146, v236, v237
    v_exp_f32 v236, v54
    v_exp_f32 v237, v55
    s_nop 0
    v_cvt_pk_bf16_f32 v147, v236, v237
    v_log_f32 v246, v96
    v_cmp_gt_u32 vcc, 32, v0
    v_min_f32 v246, 3250585600, v246
    s_nop 0
    v_cndmask_b32 v246, v246, v56, vcc
    v_max3_f32 v244, v56, v57, v58
    v_max3_f32 v244, v244, v59, v60
    v_max3_f32 v244, v244, v61, v62
    v_max3_f32 v244, v244, v63, v246
    v_mov_b32 v245, v244
    v_nop
    v_nop
    v_permlane32_swap_b32 v244, v245
    v_max_f32 v244, v244, v245
    v_mov_b32 v245, v244
    v_nop
    v_nop
    v_permlane16_swap_b32 v244, v245
    v_max_f32 v244, v244, v245
    v_add_f32 v244, s38, v244
    v_ceil_f32 v244, v244
    v_max_f32 v244, 0, v244
    v_exp_f32 v245, -v244
    v_sub_f32 v84, v84, v244
    v_sub_f32 v85, v85, v244
    v_sub_f32 v86, v86, v244
    v_sub_f32 v87, v87, v244
    v_sub_f32 v56, v56, v244
    v_sub_f32 v24, v24, v244
    v_sub_f32 v57, v57, v244
    v_sub_f32 v25, v25, v244
    v_sub_f32 v58, v58, v244
    v_sub_f32 v26, v26, v244
    v_sub_f32 v59, v59, v244
    v_sub_f32 v27, v27, v244
    v_sub_f32 v60, v60, v244
    v_sub_f32 v28, v28, v244
    v_sub_f32 v61, v61, v244
    v_sub_f32 v29, v29, v244
    v_sub_f32 v62, v62, v244
    v_sub_f32 v30, v30, v244
    v_sub_f32 v63, v63, v244
    v_sub_f32 v31, v31, v244
    v_cndmask_b32 v105, v245, v105, vcc
    v_accvgpr_read_b32 v236, a4
    v_mul_f32 v236, v236, v245
    v_accvgpr_write_b32 a4, v236
    v_accvgpr_read_b32 v236, a5
    v_mul_f32 v236, v236, v245
    v_accvgpr_write_b32 a5, v236
    v_accvgpr_read_b32 v236, a6
    v_mul_f32 v236, v236, v245
    v_accvgpr_write_b32 a6, v236
    v_accvgpr_read_b32 v236, a7
    v_mul_f32 v236, v236, v245
    v_accvgpr_write_b32 a7, v236
    v_accvgpr_read_b32 v236, a20
    v_mul_f32 v236, v236, v245
    v_accvgpr_write_b32 a20, v236
    v_accvgpr_read_b32 v236, a21
    v_mul_f32 v236, v236, v245
    v_accvgpr_write_b32 a21, v236
    v_accvgpr_read_b32 v236, a22
    v_mul_f32 v236, v236, v245
    v_accvgpr_write_b32 a22, v236
    v_accvgpr_read_b32 v236, a23
    v_mul_f32 v236, v236, v245
    v_accvgpr_write_b32 a23, v236
    v_accvgpr_read_b32 v236, a36
    v_mul_f32 v236, v236, v245
    v_accvgpr_write_b32 a36, v236
    v_accvgpr_read_b32 v236, a37
    v_mul_f32 v236, v236, v245
    v_accvgpr_write_b32 a37, v236
    v_accvgpr_read_b32 v236, a38
    v_mul_f32 v236, v236, v245
    v_accvgpr_write_b32 a38, v236
    v_accvgpr_read_b32 v236, a39
    v_mul_f32 v236, v236, v245
    v_accvgpr_write_b32 a39, v236
    v_accvgpr_read_b32 v236, a52
    v_mul_f32 v236, v236, v245
    v_accvgpr_write_b32 a52, v236
    v_accvgpr_read_b32 v236, a53
    v_mul_f32 v236, v236, v245
    v_accvgpr_write_b32 a53, v236
    v_accvgpr_read_b32 v236, a54
    v_mul_f32 v236, v236, v245
    v_accvgpr_write_b32 a54, v236
    v_accvgpr_read_b32 v236, a55
    v_mul_f32 v236, v236, v245
    v_accvgpr_write_b32 a55, v236
    v_accvgpr_read_b32 v236, a68
    v_mul_f32 v236, v236, v245
    v_accvgpr_write_b32 a68, v236
    v_accvgpr_read_b32 v236, a69
    v_mul_f32 v236, v236, v245
    v_accvgpr_write_b32 a69, v236
    v_accvgpr_read_b32 v236, a70
    v_mul_f32 v236, v236, v245
    v_accvgpr_write_b32 a70, v236
    v_accvgpr_read_b32 v236, a71
    v_mul_f32 v236, v236, v245
    v_accvgpr_write_b32 a71, v236
    v_accvgpr_read_b32 v236, a84
    v_mul_f32 v236, v236, v245
    v_accvgpr_write_b32 a84, v236
    v_accvgpr_read_b32 v236, a85
    v_mul_f32 v236, v236, v245
    v_accvgpr_write_b32 a85, v236
    v_accvgpr_read_b32 v236, a86
    v_mul_f32 v236, v236, v245
    v_accvgpr_write_b32 a86, v236
    v_accvgpr_read_b32 v236, a87
    v_mul_f32 v236, v236, v245
    v_accvgpr_write_b32 a87, v236
    v_accvgpr_read_b32 v236, a100
    v_mul_f32 v236, v236, v245
    v_accvgpr_write_b32 a100, v236
    v_accvgpr_read_b32 v236, a101
    v_mul_f32 v236, v236, v245
    v_accvgpr_write_b32 a101, v236
    v_accvgpr_read_b32 v236, a102
    v_mul_f32 v236, v236, v245
    v_accvgpr_write_b32 a102, v236
    v_accvgpr_read_b32 v236, a103
    v_mul_f32 v236, v236, v245
    v_accvgpr_write_b32 a103, v236
    v_accvgpr_read_b32 v236, a116
    v_mul_f32 v236, v236, v245
    v_accvgpr_write_b32 a116, v236
    v_accvgpr_read_b32 v236, a117
    v_mul_f32 v236, v236, v245
    v_accvgpr_write_b32 a117, v236
    v_accvgpr_read_b32 v236, a118
    v_mul_f32 v236, v236, v245
    v_accvgpr_write_b32 a118, v236
    v_accvgpr_read_b32 v236, a119
    v_mul_f32 v236, v236, v245
    v_accvgpr_write_b32 a119, v236
    v_exp_f32 v236, v56
    v_exp_f32 v237, v57
    s_nop 0
    v_cvt_pk_bf16_f32 v148, v236, v237
    v_exp_f32 v236, v58
    v_exp_f32 v237, v59
    s_nop 0
    v_cvt_pk_bf16_f32 v149, v236, v237
    v_exp_f32 v236, v60
    v_exp_f32 v237, v61
    s_nop 0
    v_cvt_pk_bf16_f32 v150, v236, v237
    v_exp_f32 v236, v62
    v_exp_f32 v237, v63
    s_nop 0
    v_cvt_pk_bf16_f32 v151, v236, v237
    v_mov_b32 v108, 0
    v_mov_b32 v109, 0
    v_mov_b32 v110, 0
    v_mov_b32 v111, 0
    s_nop 1
    v_smfmac_f32_16x16x64_bf16 v[108:111], a[192:195], v[144:151], v104
    v_cmp_gt_f32 vcc, 1.0, v96
    v_mul_f32 v96, v96, v105
    s_nop 7
    s_nop 7
    v_cndmask_b32 v96, v108, v96, vcc
    v_log_f32 v246, v100
    v_cmp_lt_u32 vcc, 31, v0
    v_min_f32 v246, 3250585600, v246
    s_nop 0
    v_cndmask_b32 v246, v246, v64, vcc
    v_max3_f32 v244, v64, v65, v66
    v_max3_f32 v244, v244, v67, v68
    v_max3_f32 v244, v244, v69, v70
    v_max3_f32 v244, v244, v71, v246
    v_mov_b32 v245, v244
    v_nop
    v_nop
    v_permlane32_swap_b32 v244, v245
    v_max_f32 v244, v244, v245
    v_mov_b32 v245, v244
    v_nop
    v_nop
    v_permlane16_swap_b32 v244, v245
    v_max_f32 v244, v244, v245
    v_add_f32 v244, s38, v244
    v_ceil_f32 v244, v244
    v_max_f32 v244, 0, v244
    v_exp_f32 v245, -v244
    v_sub_f32 v88, v88, v244
    v_sub_f32 v89, v89, v244
    v_sub_f32 v90, v90, v244
    v_sub_f32 v91, v91, v244
    v_sub_f32 v64, v64, v244
    v_sub_f32 v32, v32, v244
    v_sub_f32 v65, v65, v244
    v_sub_f32 v33, v33, v244
    v_sub_f32 v66, v66, v244
    v_sub_f32 v34, v34, v244
    v_sub_f32 v67, v67, v244
    v_sub_f32 v35, v35, v244
    v_sub_f32 v68, v68, v244
    v_sub_f32 v36, v36, v244
    v_sub_f32 v69, v69, v244
    v_sub_f32 v37, v37, v244
    v_sub_f32 v70, v70, v244
    v_sub_f32 v38, v38, v244
    v_sub_f32 v71, v71, v244
    v_sub_f32 v39, v39, v244
    v_mov_b32 v105, v245
    v_accvgpr_read_b32 v236, a8
    v_mul_f32 v236, v236, v245
    v_accvgpr_write_b32 a8, v236
    v_accvgpr_read_b32 v236, a9
    v_mul_f32 v236, v236, v245
    v_accvgpr_write_b32 a9, v236
    v_accvgpr_read_b32 v236, a10
    v_mul_f32 v236, v236, v245
    v_accvgpr_write_b32 a10, v236
    v_accvgpr_read_b32 v236, a11
    v_mul_f32 v236, v236, v245
    v_accvgpr_write_b32 a11, v236
    v_accvgpr_read_b32 v236, a24
    v_mul_f32 v236, v236, v245
    v_accvgpr_write_b32 a24, v236
    v_accvgpr_read_b32 v236, a25
    v_mul_f32 v236, v236, v245
    v_accvgpr_write_b32 a25, v236
    v_accvgpr_read_b32 v236, a26
    v_mul_f32 v236, v236, v245
    v_accvgpr_write_b32 a26, v236
    v_accvgpr_read_b32 v236, a27
    v_mul_f32 v236, v236, v245
    v_accvgpr_write_b32 a27, v236
    v_accvgpr_read_b32 v236, a40
    v_mul_f32 v236, v236, v245
    v_accvgpr_write_b32 a40, v236
    v_accvgpr_read_b32 v236, a41
    v_mul_f32 v236, v236, v245
    v_accvgpr_write_b32 a41, v236
    v_accvgpr_read_b32 v236, a42
    v_mul_f32 v236, v236, v245
    v_accvgpr_write_b32 a42, v236
    v_accvgpr_read_b32 v236, a43
    v_mul_f32 v236, v236, v245
    v_accvgpr_write_b32 a43, v236
    v_accvgpr_read_b32 v236, a56
    v_mul_f32 v236, v236, v245
    v_accvgpr_write_b32 a56, v236
    v_accvgpr_read_b32 v236, a57
    v_mul_f32 v236, v236, v245
    v_accvgpr_write_b32 a57, v236
    v_accvgpr_read_b32 v236, a58
    v_mul_f32 v236, v236, v245
    v_accvgpr_write_b32 a58, v236
    v_accvgpr_read_b32 v236, a59
    v_mul_f32 v236, v236, v245
    v_accvgpr_write_b32 a59, v236
    v_accvgpr_read_b32 v236, a72
    v_mul_f32 v236, v236, v245
    v_accvgpr_write_b32 a72, v236
    v_accvgpr_read_b32 v236, a73
    v_mul_f32 v236, v236, v245
    v_accvgpr_write_b32 a73, v236
    v_accvgpr_read_b32 v236, a74
    v_mul_f32 v236, v236, v245
    v_accvgpr_write_b32 a74, v236
    v_accvgpr_read_b32 v236, a75
    v_mul_f32 v236, v236, v245
    v_accvgpr_write_b32 a75, v236
    v_accvgpr_read_b32 v236, a88
    v_mul_f32 v236, v236, v245
    v_accvgpr_write_b32 a88, v236
    v_accvgpr_read_b32 v236, a89
    v_mul_f32 v236, v236, v245
    v_accvgpr_write_b32 a89, v236
    v_accvgpr_read_b32 v236, a90
    v_mul_f32 v236, v236, v245
    v_accvgpr_write_b32 a90, v236
    v_accvgpr_read_b32 v236, a91
    v_mul_f32 v236, v236, v245
    v_accvgpr_write_b32 a91, v236
    v_accvgpr_read_b32 v236, a104
    v_mul_f32 v236, v236, v245
    v_accvgpr_write_b32 a104, v236
    v_accvgpr_read_b32 v236, a105
    v_mul_f32 v236, v236, v245
    v_accvgpr_write_b32 a105, v236
    v_accvgpr_read_b32 v236, a106
    v_mul_f32 v236, v236, v245
    v_accvgpr_write_b32 a106, v236
    v_accvgpr_read_b32 v236, a107
    v_mul_f32 v236, v236, v245
    v_accvgpr_write_b32 a107, v236
    v_accvgpr_read_b32 v236, a120
    v_mul_f32 v236, v236, v245
    v_accvgpr_write_b32 a120, v236
    v_accvgpr_read_b32 v236, a121
    v_mul_f32 v236, v236, v245
    v_accvgpr_write_b32 a121, v236
    v_accvgpr_read_b32 v236, a122
    v_mul_f32 v236, v236, v245
    v_accvgpr_write_b32 a122, v236
    v_accvgpr_read_b32 v236, a123
    v_mul_f32 v236, v236, v245
    v_accvgpr_write_b32 a123, v236
    v_exp_f32 v236, v64
    v_exp_f32 v237, v65
    s_nop 0
    v_cvt_pk_bf16_f32 v152, v236, v237
    v_exp_f32 v236, v66
    v_exp_f32 v237, v67
    s_nop 0
    v_cvt_pk_bf16_f32 v153, v236, v237
    v_exp_f32 v236, v68
    v_exp_f32 v237, v69
    s_nop 0
    v_cvt_pk_bf16_f32 v154, v236, v237
    v_exp_f32 v236, v70
    v_exp_f32 v237, v71
    s_nop 0
    v_cvt_pk_bf16_f32 v155, v236, v237
    v_log_f32 v246, v100
    v_cmp_gt_u32 vcc, 32, v0
    v_min_f32 v246, 3250585600, v246
    s_nop 0
    v_cndmask_b32 v246, v246, v72, vcc
    v_max3_f32 v244, v72, v73, v74
    v_max3_f32 v244, v244, v75, v76
    v_max3_f32 v244, v244, v77, v78
    v_max3_f32 v244, v244, v79, v246
    v_mov_b32 v245, v244
    v_nop
    v_nop
    v_permlane32_swap_b32 v244, v245
    v_max_f32 v244, v244, v245
    v_mov_b32 v245, v244
    v_nop
    v_nop
    v_permlane16_swap_b32 v244, v245
    v_max_f32 v244, v244, v245
    v_add_f32 v244, s38, v244
    v_ceil_f32 v244, v244
    v_max_f32 v244, 0, v244
    v_exp_f32 v245, -v244
    v_sub_f32 v92, v92, v244
    v_sub_f32 v93, v93, v244
    v_sub_f32 v94, v94, v244
    v_sub_f32 v95, v95, v244
    v_sub_f32 v72, v72, v244
    v_sub_f32 v40, v40, v244
    v_sub_f32 v73, v73, v244
    v_sub_f32 v41, v41, v244
    v_sub_f32 v74, v74, v244
    v_sub_f32 v42, v42, v244
    v_sub_f32 v75, v75, v244
    v_sub_f32 v43, v43, v244
    v_sub_f32 v76, v76, v244
    v_sub_f32 v44, v44, v244
    v_sub_f32 v77, v77, v244
    v_sub_f32 v45, v45, v244
    v_sub_f32 v78, v78, v244
    v_sub_f32 v46, v46, v244
    v_sub_f32 v79, v79, v244
    v_sub_f32 v47, v47, v244
    v_cndmask_b32 v105, v245, v105, vcc
    v_accvgpr_read_b32 v236, a12
    v_mul_f32 v236, v236, v245
    v_accvgpr_write_b32 a12, v236
    v_accvgpr_read_b32 v236, a13
    v_mul_f32 v236, v236, v245
    v_accvgpr_write_b32 a13, v236
    v_accvgpr_read_b32 v236, a14
    v_mul_f32 v236, v236, v245
    v_accvgpr_write_b32 a14, v236
    v_accvgpr_read_b32 v236, a15
    v_mul_f32 v236, v236, v245
    v_accvgpr_write_b32 a15, v236
    v_accvgpr_read_b32 v236, a28
    v_mul_f32 v236, v236, v245
    v_accvgpr_write_b32 a28, v236
    v_accvgpr_read_b32 v236, a29
    v_mul_f32 v236, v236, v245
    v_accvgpr_write_b32 a29, v236
    v_accvgpr_read_b32 v236, a30
    v_mul_f32 v236, v236, v245
    v_accvgpr_write_b32 a30, v236
    v_accvgpr_read_b32 v236, a31
    v_mul_f32 v236, v236, v245
    v_accvgpr_write_b32 a31, v236
    v_accvgpr_read_b32 v236, a44
    v_mul_f32 v236, v236, v245
    v_accvgpr_write_b32 a44, v236
    v_accvgpr_read_b32 v236, a45
    v_mul_f32 v236, v236, v245
    v_accvgpr_write_b32 a45, v236
    v_accvgpr_read_b32 v236, a46
    v_mul_f32 v236, v236, v245
    v_accvgpr_write_b32 a46, v236
    v_accvgpr_read_b32 v236, a47
    v_mul_f32 v236, v236, v245
    v_accvgpr_write_b32 a47, v236
    v_accvgpr_read_b32 v236, a60
    v_mul_f32 v236, v236, v245
    v_accvgpr_write_b32 a60, v236
    v_accvgpr_read_b32 v236, a61
    v_mul_f32 v236, v236, v245
    v_accvgpr_write_b32 a61, v236
    v_accvgpr_read_b32 v236, a62
    v_mul_f32 v236, v236, v245
    v_accvgpr_write_b32 a62, v236
    v_accvgpr_read_b32 v236, a63
    v_mul_f32 v236, v236, v245
    v_accvgpr_write_b32 a63, v236
    v_accvgpr_read_b32 v236, a76
    v_mul_f32 v236, v236, v245
    v_accvgpr_write_b32 a76, v236
    v_accvgpr_read_b32 v236, a77
    v_mul_f32 v236, v236, v245
    v_accvgpr_write_b32 a77, v236
    v_accvgpr_read_b32 v236, a78
    v_mul_f32 v236, v236, v245
    v_accvgpr_write_b32 a78, v236
    v_accvgpr_read_b32 v236, a79
    v_mul_f32 v236, v236, v245
    v_accvgpr_write_b32 a79, v236
    v_accvgpr_read_b32 v236, a92
    v_mul_f32 v236, v236, v245
    v_accvgpr_write_b32 a92, v236
    v_accvgpr_read_b32 v236, a93
    v_mul_f32 v236, v236, v245
    v_accvgpr_write_b32 a93, v236
    v_accvgpr_read_b32 v236, a94
    v_mul_f32 v236, v236, v245
    v_accvgpr_write_b32 a94, v236
    v_accvgpr_read_b32 v236, a95
    v_mul_f32 v236, v236, v245
    v_accvgpr_write_b32 a95, v236
    v_accvgpr_read_b32 v236, a108
    v_mul_f32 v236, v236, v245
    v_accvgpr_write_b32 a108, v236
    v_accvgpr_read_b32 v236, a109
    v_mul_f32 v236, v236, v245
    v_accvgpr_write_b32 a109, v236
    v_accvgpr_read_b32 v236, a110
    v_mul_f32 v236, v236, v245
    v_accvgpr_write_b32 a110, v236
    v_accvgpr_read_b32 v236, a111
    v_mul_f32 v236, v236, v245
    v_accvgpr_write_b32 a111, v236
    v_accvgpr_read_b32 v236, a124
    v_mul_f32 v236, v236, v245
    v_accvgpr_write_b32 a124, v236
    v_accvgpr_read_b32 v236, a125
    v_mul_f32 v236, v236, v245
    v_accvgpr_write_b32 a125, v236
    v_accvgpr_read_b32 v236, a126
    v_mul_f32 v236, v236, v245
    v_accvgpr_write_b32 a126, v236
    v_accvgpr_read_b32 v236, a127
    v_mul_f32 v236, v236, v245
    v_accvgpr_write_b32 a127, v236
    v_exp_f32 v236, v72
    v_exp_f32 v237, v73
    s_nop 0
    v_cvt_pk_bf16_f32 v156, v236, v237
    v_exp_f32 v236, v74
    v_exp_f32 v237, v75
    s_nop 0
    v_cvt_pk_bf16_f32 v157, v236, v237
    v_exp_f32 v236, v76
    v_exp_f32 v237, v77
    s_nop 0
    v_cvt_pk_bf16_f32 v158, v236, v237
    v_exp_f32 v236, v78
    v_exp_f32 v237, v79
    s_nop 0
    v_cvt_pk_bf16_f32 v159, v236, v237
    v_mov_b32 v108, 0
    v_mov_b32 v109, 0
    v_mov_b32 v110, 0
    v_mov_b32 v111, 0
    s_nop 1
    v_smfmac_f32_16x16x64_bf16 v[108:111], a[192:195], v[152:159], v104
    v_cmp_gt_f32 vcc, 1.0, v100
    v_mul_f32 v100, v100, v105
    s_nop 7
    s_nop 7
    v_cndmask_b32 v100, v108, v100, vcc
    s_nop 7
    s_setpc_b64 s[32:33]

.globl k45_kernel
.p2align 8
.type k45_kernel,@function
k45_kernel:
    s_cmp_ge_u32 s2, 256
    s_cbranch_scc1 END_k45_kernel
    s_load_dwordx2 s[4:5], s[0:1], 104
    v_lshrrev_b32 v1, 6, v0
    v_and_b32 v0, 63, v0
    v_readfirstlane_b32 s28, v1
    s_lshr_b32 s34, s2, 3
    s_and_b32 s29, s2, 3
    s_lshl_b32 s29, s29, 1
    s_and_b32 s33, s34, 1
    s_or_b32 s29, s29, s33
    s_lshr_b32 s48, s34, 1
    s_and_b32 s30, s2, 7
    s_lshr_b32 s30, s30, 2
    s_lshl_b32 s30, s30, 4
    s_add_u32 s30, s30, s48
    s_mul_i32 s33, s48, 43
    s_lshr_b32 s33, s33, 8
    s_mul_i32 s33, s33, 6
    s_sub_u32 s49, s48, s33
    s_mul_i32 s49, s49, 1
    s_mul_i32 s34, s48, 57
    s_lshr_b32 s34, s34, 9
    s_mul_i32 s34, s34, 9
    s_sub_u32 s50, s48, s34
    s_mul_i32 s50, s50, 1
    v_lshlrev_b32 v3, 4, v0
    s_lshl_b32 s39, s30, 2
    s_add_u32 s39, s39, s28
    s_mul_i32 s39, s39, 18432
    s_add_u32 s39, s39, 27262976
    s_mul_i32 s33, s49, 3072
    s_add_u32 s39, s39, s33
    s_movk_i32 s51, 3072
    s_mul_i32 s31, s28, 3072
    s_mul_i32 s32, s29, 1990656
    s_mul_i32 s33, s28, 3072
    s_add_u32 s32, s32, s33
    s_add_u32 s32, s32, 134217728
    s_mul_i32 s38, s50, 73728
    s_add_u32 s38, s38, s32
    s_add_u32 s38, s38, 1327104
    s_mul_i32 s33, s49, 24576
    s_add_u32 s32, s32, s33
    s_movk_i32 s34, 12288
    s_cmp_eq_u32 s49, 0
    s_cselect_b32 s52, -135168, s34
    s_cmp_eq_u32 s49, 5
    s_cselect_b32 s53, -135168, s34
    s_cmp_eq_u32 s49, 4
    s_cselect_b32 s54, -135168, s34
    s_cmp_eq_u32 s49, 3
    s_cselect_b32 s55, -135168, s34
    s_cmp_eq_u32 s49, 2
    s_cselect_b32 s56, -135168, s34
    s_cmp_eq_u32 s49, 1
    s_cselect_b32 s57, -135168, s34
    s_add_u32 s52, s52, 147456
    s_movk_i32 s33, 1024
    s_cmp_eq_u32 s50, 8
    s_cselect_b32 s8, -651264, s34
    s_cselect_b32 s40, -8192, s33
    s_cmp_eq_u32 s50, 7
    s_cselect_b32 s9, -651264, s34
    s_cselect_b32 s41, -8192, s33
    s_cmp_eq_u32 s50, 6
    s_cselect_b32 s10, -651264, s34
    s_cselect_b32 s42, -8192, s33
    s_cmp_eq_u32 s50, 5
    s_cselect_b32 s11, -651264, s34
    s_cselect_b32 s43, -8192, s33
    s_cmp_eq_u32 s50, 4
    s_cselect_b32 s12, -651264, s34
    s_cselect_b32 s44, -8192, s33
    s_cmp_eq_u32 s50, 3
    s_cselect_b32 s13, -651264, s34
    s_cselect_b32 s45, -8192, s33
    s_cmp_eq_u32 s50, 2
    s_cselect_b32 s14, -651264, s34
    s_cselect_b32 s46, -8192, s33
    s_cmp_eq_u32 s50, 1
    s_cselect_b32 s15, -651264, s34
    s_cselect_b32 s47, -8192, s33
    v_add_u32 v8, 49152, v3
    s_lshr_b32 s33, s28, 1
    s_lshl_b32 s33, s33, 12
    s_and_b32 s34, s28, 1
    s_lshl_b32 s34, s34, 3
    s_add_u32 s33, s33, s34
    s_add_u32 s33, s33, 73728
    v_add_u32 v4, s33, v3
    v_add_u32 v5, 73728, v3
    v_mov_b32 v7, 3222493025
    s_mov_b32 s35, 3184710632
    v_bfe_u32 v1, v0, 3, 2
    v_mul_u32_u24 v1, 73728, v1
    v_lshrrev_b32 v2, 5, v0
    v_lshl_add_u32 v1, v2, 7, v1
    v_and_b32 v2, 7, v0
    v_lshl_add_u32 v6, v2, 4, v1
    s_mul_i32 s36, s30, 589824
    s_mul_i32 s33, s29, 9216
    s_add_u32 s36, s36, s33
    s_lshl_b32 s33, s28, 8
    s_add_u32 s36, s36, s33
    s_add_u32 s36, s36, 109051904
    s_lshl_b32 s33, s50, 10
    s_add_u32 s36, s36, s33
    s_add_u32 s37, s36, 294912
    s_lshl_b32 s48, s31, 1
    s_mov_b32 s22, 268435456
    s_mov_b32 s23, 0x00020000
    s_waitcnt lgkmcnt(0)
    s_mov_b32 s20, s4
    s_and_b32 s21, s5, 0xffff
    s_add_u32 m0, s48, 0
    s_nop 0
    buffer_load_dwordx4 v3, s[20:23], s39 offen offset:0 lds
    buffer_load_dwordx4 v3, s[20:23], s39 offen offset:1024 lds
    buffer_load_dwordx4 v3, s[20:23], s39 offen offset:2048 lds
    s_add_u32 m0, s48, 3072
    s_cmp_eq_u32 s49, 5
    s_cselect_b32 s34, -15360, s51
    s_add_u32 s39, s39, s34
    buffer_load_dwordx4 v3, s[20:23], s39 offen offset:0 lds
    buffer_load_dwordx4 v3, s[20:23], s39 offen offset:1024 lds
    buffer_load_dwordx4 v3, s[20:23], s39 offen offset:2048 lds
    buffer_load_dwordx4 v[148:151], v3, s[20:23], s32 offen offset:0
    s_add_u32 s58, s32, 12288
    buffer_load_dwordx4 v[152:155], v3, s[20:23], s58 offen offset:0
    buffer_load_dwordx4 v[156:159], v3, s[20:23], s32 offen offset:1024
    buffer_load_dwordx4 v[160:163], v3, s[20:23], s58 offen offset:1024
    buffer_load_dwordx4 v[164:167], v3, s[20:23], s32 offen offset:2048
    buffer_load_dwordx4 v[168:171], v3, s[20:23], s58 offen offset:2048
    s_add_u32 m0, s48, 24576
    s_cmp_eq_u32 s49, 4
    s_cselect_b32 s34, -15360, s51
    s_add_u32 s39, s39, s34
    buffer_load_dwordx4 v3, s[20:23], s39 offen offset:0 lds
    buffer_load_dwordx4 v3, s[20:23], s39 offen offset:1024 lds
    buffer_load_dwordx4 v3, s[20:23], s39 offen offset:2048 lds
    s_add_u32 m0, s48, 27648
    s_cmp_eq_u32 s49, 3
    s_cselect_b32 s34, -15360, s51
    s_add_u32 s39, s39, s34
    buffer_load_dwordx4 v3, s[20:23], s39 offen offset:0 lds
    buffer_load_dwordx4 v3, s[20:23], s39 offen offset:1024 lds
    buffer_load_dwordx4 v3, s[20:23], s39 offen offset:2048 lds
    s_add_u32 s32, s58, s53
    buffer_load_dwordx4 v[172:175], v3, s[20:23], s32 offen offset:0
    s_add_u32 s58, s32, 12288
    buffer_load_dwordx4 v[176:179], v3, s[20:23], s58 offen offset:0
    buffer_load_dwordx4 v[180:183], v3, s[20:23], s32 offen offset:1024
    buffer_load_dwordx4 v[184:187], v3, s[20:23], s58 offen offset:1024
    buffer_load_dwordx4 v[188:191], v3, s[20:23], s32 offen offset:2048
    buffer_load_dwordx4 v[192:195], v3, s[20:23], s58 offen offset:2048
    s_waitcnt vmcnt(18)
    s_barrier
    ds_read_b128 a[0:3], v3 offset:0
    ds_read_b128 a[4:7], v3 offset:6144
    ds_read_b128 a[8:11], v3 offset:12288
    ds_read_b128 a[12:15], v3 offset:18432
    ds_read_b128 a[16:19], v3 offset:1024
    ds_read_b128 a[20:23], v3 offset:7168
    ds_read_b128 a[24:27], v3 offset:13312
    ds_read_b128 a[28:31], v3 offset:19456
    s_add_u32 m0, s48, 49152
    s_cmp_eq_u32 s49, 2
    s_cselect_b32 s34, -15360, s51
    s_add_u32 s39, s39, s34
    buffer_load_dwordx4 v3, s[20:23], s39 offen offset:0 lds
    buffer_load_dwordx4 v3, s[20:23], s39 offen offset:1024 lds
    buffer_load_dwordx4 v3, s[20:23], s39 offen offset:2048 lds
    s_add_u32 m0, s48, 52224
    s_cmp_eq_u32 s49, 1
    s_cselect_b32 s34, -15360, s51
    s_add_u32 s39, s39, s34
    buffer_load_dwordx4 v3, s[20:23], s39 offen offset:0 lds
    buffer_load_dwordx4 v3, s[20:23], s39 offen offset:1024 lds
    buffer_load_dwordx4 v3, s[20:23], s39 offen offset:2048 lds
    ds_read_b128 a[32:35], v3 offset:2048
    ds_read_b128 a[36:39], v3 offset:8192
    ds_read_b128 a[40:43], v3 offset:14336
    ds_read_b128 a[44:47], v3 offset:20480
    ds_read_b128 a[48:51], v3 offset:3072
    ds_read_b128 a[52:55], v3 offset:9216
    ds_read_b128 a[56:59], v3 offset:15360
    ds_read_b128 a[60:63], v3 offset:21504
    s_add_u32 s32, s58, s54
    buffer_load_dwordx4 v[196:199], v3, s[20:23], s32 offen offset:0
    s_add_u32 s58, s32, 12288
    buffer_load_dwordx4 v[200:203], v3, s[20:23], s58 offen offset:0
    buffer_load_dwordx4 v[204:207], v3, s[20:23], s32 offen offset:1024
    buffer_load_dwordx4 v[208:211], v3, s[20:23], s58 offen offset:1024
    buffer_load_dwordx4 v[212:215], v3, s[20:23], s32 offen offset:2048
    buffer_load_dwordx4 v[216:219], v3, s[20:23], s58 offen offset:2048
    ds_read_b128 a[64:67], v3 offset:4096
    ds_read_b128 a[68:71], v3 offset:10240
    ds_read_b128 a[72:75], v3 offset:16384
    ds_read_b128 a[76:79], v3 offset:22528
    ds_read_b128 a[80:83], v3 offset:5120
    ds_read_b128 a[84:87], v3 offset:11264
    ds_read_b128 a[88:91], v3 offset:17408
    ds_read_b128 a[92:95], v3 offset:23552
    s_waitcnt vmcnt(18) lgkmcnt(0)
    s_barrier
    v_mfma_f32_16x16x32_bf16 v[76:79], v[148:151], a[0:3], 0
    s_add_u32 s32, s58, s55
    ds_read_b128 a[96:99], v3 offset:24576
    v_mfma_f32_16x16x32_bf16 v[80:83], v[148:151], a[4:7], 0
    buffer_load_dwordx4 v[220:223], v3, s[20:23], s32 offen offset:0
    v_mfma_f32_16x16x32_bf16 v[84:87], v[148:151], a[8:11], 0
    ds_read_b128 a[100:103], v3 offset:30720
    v_mfma_f32_16x16x32_bf16 v[88:91], v[148:151], a[12:15], 0
    v_mfma_f32_16x16x32_bf16 v[104:107], v[152:155], a[12:15], 0
    s_add_u32 s58, s32, 12288
    ds_read_b128 a[104:107], v3 offset:36864
    v_mfma_f32_16x16x32_bf16 v[100:103], v[152:155], a[8:11], 0
    buffer_load_dwordx4 v[224:227], v3, s[20:23], s58 offen offset:0
    v_mfma_f32_16x16x32_bf16 v[96:99], v[152:155], a[4:7], 0
    ds_read_b128 a[108:111], v3 offset:43008
    v_mfma_f32_16x16x32_bf16 v[92:95], v[152:155], a[0:3], 0
    ds_read_b128 a[112:115], v3 offset:25600
    v_mfma_f32_16x16x32_bf16 v[76:79], v[156:159], a[16:19], v[76:79]
    v_mfma_f32_16x16x32_bf16 v[80:83], v[156:159], a[20:23], v[80:83]
    buffer_load_dwordx4 v[228:231], v3, s[20:23], s32 offen offset:1024
    v_mfma_f32_16x16x32_bf16 v[84:87], v[156:159], a[24:27], v[84:87]
    ds_read_b128 a[116:119], v3 offset:31744
    v_mfma_f32_16x16x32_bf16 v[88:91], v[156:159], a[28:31], v[88:91]
    ds_read_b128 a[120:123], v3 offset:37888
    v_mfma_f32_16x16x32_bf16 v[104:107], v[160:163], a[28:31], v[104:107]
    ds_read_b128 a[124:127], v3 offset:44032
    v_mfma_f32_16x16x32_bf16 v[100:103], v[160:163], a[24:27], v[100:103]
    buffer_load_dwordx4 v[232:235], v3, s[20:23], s58 offen offset:1024
    v_mfma_f32_16x16x32_bf16 v[96:99], v[160:163], a[20:23], v[96:99]
    ds_read_b128 a[128:131], v3 offset:26624
    v_mfma_f32_16x16x32_bf16 v[92:95], v[160:163], a[16:19], v[92:95]
    v_mfma_f32_16x16x32_bf16 v[76:79], v[164:167], a[32:35], v[76:79]
    ds_read_b128 a[132:135], v3 offset:32768
    v_mfma_f32_16x16x32_bf16 v[80:83], v[164:167], a[36:39], v[80:83]
    buffer_load_dwordx4 v[236:239], v3, s[20:23], s32 offen offset:2048
    v_mfma_f32_16x16x32_bf16 v[84:87], v[164:167], a[40:43], v[84:87]
    ds_read_b128 a[136:139], v3 offset:38912
    v_mfma_f32_16x16x32_bf16 v[88:91], v[164:167], a[44:47], v[88:91]
    ds_read_b128 a[140:143], v3 offset:45056
    v_mfma_f32_16x16x32_bf16 v[104:107], v[168:171], a[44:47], v[104:107]
    v_mfma_f32_16x16x32_bf16 v[100:103], v[168:171], a[40:43], v[100:103]
    buffer_load_dwordx4 v[240:243], v3, s[20:23], s58 offen offset:2048
    v_mfma_f32_16x16x32_bf16 v[96:99], v[168:171], a[36:39], v[96:99]
    ds_read_b128 a[144:147], v3 offset:27648
    v_mfma_f32_16x16x32_bf16 v[92:95], v[168:171], a[32:35], v[92:95]
    s_waitcnt vmcnt(23)
    ds_read_b128 a[148:151], v3 offset:33792
    v_mfma_f32_16x16x32_bf16 v[76:79], v[172:175], a[48:51], v[76:79]
    s_add_u32 s32, s58, s56
    ds_read_b128 a[152:155], v3 offset:39936
    v_mfma_f32_16x16x32_bf16 v[80:83], v[172:175], a[52:55], v[80:83]
    buffer_load_dwordx4 v[244:247], v3, s[20:23], s32 offen offset:0
    v_mfma_f32_16x16x32_bf16 v[84:87], v[172:175], a[56:59], v[84:87]
    v_mfma_f32_16x16x32_bf16 v[88:91], v[172:175], a[60:63], v[88:91]
    s_waitcnt vmcnt(23)
    ds_read_b128 a[156:159], v3 offset:46080
    v_mfma_f32_16x16x32_bf16 v[104:107], v[176:179], a[60:63], v[104:107]
    s_add_u32 s58, s32, 12288
    ds_read_b128 a[160:163], v3 offset:28672
    v_mfma_f32_16x16x32_bf16 v[100:103], v[176:179], a[56:59], v[100:103]
    buffer_load_dwordx4 v[248:251], v3, s[20:23], s58 offen offset:0
    v_mfma_f32_16x16x32_bf16 v[96:99], v[176:179], a[52:55], v[96:99]
    ds_read_b128 a[164:167], v3 offset:34816
    v_mfma_f32_16x16x32_bf16 v[92:95], v[176:179], a[48:51], v[92:95]
    s_waitcnt vmcnt(23)
    ds_read_b128 a[168:171], v3 offset:40960
    v_mfma_f32_16x16x32_bf16 v[76:79], v[180:183], a[64:67], v[76:79]
    v_mfma_f32_16x16x32_bf16 v[80:83], v[180:183], a[68:71], v[80:83]
    buffer_load_dwordx4 v[252:255], v3, s[20:23], s32 offen offset:1024
    v_mfma_f32_16x16x32_bf16 v[84:87], v[180:183], a[72:75], v[84:87]
    ds_read_b128 a[172:175], v3 offset:47104
    v_mfma_f32_16x16x32_bf16 v[88:91], v[180:183], a[76:79], v[88:91]
    s_waitcnt vmcnt(23)
    ds_read_b128 a[176:179], v3 offset:29696
    v_mfma_f32_16x16x32_bf16 v[104:107], v[184:187], a[76:79], v[104:107]
    ds_read_b128 a[180:183], v3 offset:35840
    v_mfma_f32_16x16x32_bf16 v[100:103], v[184:187], a[72:75], v[100:103]
    buffer_load_dwordx4 v[148:151], v3, s[20:23], s58 offen offset:1024
    v_mfma_f32_16x16x32_bf16 v[96:99], v[184:187], a[68:71], v[96:99]
    v_mfma_f32_16x16x32_bf16 v[92:95], v[184:187], a[64:67], v[92:95]
    s_waitcnt vmcnt(23)
    ds_read_b128 a[184:187], v3 offset:41984
    v_mfma_f32_16x16x32_bf16 v[76:79], v[188:191], a[80:83], v[76:79]
    ds_read_b128 a[188:191], v3 offset:48128
    v_mfma_f32_16x16x32_bf16 v[80:83], v[188:191], a[84:87], v[80:83]
    buffer_load_dwordx4 v[152:155], v3, s[20:23], s32 offen offset:2048
    v_mfma_f32_16x16x32_bf16 v[84:87], v[188:191], a[88:91], v[84:87]
    v_mfma_f32_16x16x32_bf16 v[88:91], v[188:191], a[92:95], v[88:91]
    s_waitcnt vmcnt(23)
    v_mfma_f32_16x16x32_bf16 v[104:107], v[192:195], a[92:95], v[104:107]
    v_mfma_f32_16x16x32_bf16 v[100:103], v[192:195], a[88:91], v[100:103]
    buffer_load_dwordx4 v[156:159], v3, s[20:23], s58 offen offset:2048
    v_mfma_f32_16x16x32_bf16 v[96:99], v[192:195], a[84:87], v[96:99]
    s_waitcnt vmcnt(17) lgkmcnt(0)
    v_mfma_f32_16x16x32_bf16 v[92:95], v[192:195], a[80:83], v[92:95]
    s_barrier
    v_mfma_f32_16x16x32_bf16 v[76:79], v[196:199], a[96:99], v[76:79]
    s_add_u32 s32, s58, s57
    ds_read_b128 a[192:195], v8 offset:0
    v_mfma_f32_16x16x32_bf16 v[80:83], v[196:199], a[100:103], v[80:83]
    buffer_load_dwordx4 v[160:163], v3, s[20:23], s32 offen offset:0
    v_mfma_f32_16x16x32_bf16 v[84:87], v[196:199], a[104:107], v[84:87]
    ds_read_b128 a[196:199], v8 offset:6144
    v_mfma_f32_16x16x32_bf16 v[88:91], v[196:199], a[108:111], v[88:91]
    s_waitcnt vmcnt(17)
    v_mfma_f32_16x16x32_bf16 v[104:107], v[200:203], a[108:111], v[104:107]
    s_add_u32 s58, s32, 12288
    ds_read_b128 a[200:203], v8 offset:12288
    v_mfma_f32_16x16x32_bf16 v[100:103], v[200:203], a[104:107], v[100:103]
    buffer_load_dwordx4 v[164:167], v3, s[20:23], s58 offen offset:0
    v_mfma_f32_16x16x32_bf16 v[96:99], v[200:203], a[100:103], v[96:99]
    ds_read_b128 a[204:207], v8 offset:18432
    v_mfma_f32_16x16x32_bf16 v[92:95], v[200:203], a[96:99], v[92:95]
    s_waitcnt vmcnt(17)
    ds_read_b128 a[208:211], v8 offset:1024
    v_mfma_f32_16x16x32_bf16 v[76:79], v[204:207], a[112:115], v[76:79]
    v_mfma_f32_16x16x32_bf16 v[80:83], v[204:207], a[116:119], v[80:83]
    buffer_load_dwordx4 v[168:171], v3, s[20:23], s32 offen offset:1024
    v_mfma_f32_16x16x32_bf16 v[84:87], v[204:207], a[120:123], v[84:87]
    ds_read_b128 a[212:215], v8 offset:7168
    v_mfma_f32_16x16x32_bf16 v[88:91], v[204:207], a[124:127], v[88:91]
    s_waitcnt vmcnt(17)
    ds_read_b128 a[216:219], v8 offset:13312
    v_mfma_f32_16x16x32_bf16 v[104:107], v[208:211], a[124:127], v[104:107]
    ds_read_b128 a[220:223], v8 offset:19456
    v_mfma_f32_16x16x32_bf16 v[100:103], v[208:211], a[120:123], v[100:103]
    buffer_load_dwordx4 v[172:175], v3, s[20:23], s58 offen offset:1024
    v_mfma_f32_16x16x32_bf16 v[96:99], v[208:211], a[116:119], v[96:99]
    ds_read_b128 a[224:227], v8 offset:2048
    v_mfma_f32_16x16x32_bf16 v[92:95], v[208:211], a[112:115], v[92:95]
    s_waitcnt vmcnt(17)
    v_mfma_f32_16x16x32_bf16 v[76:79], v[212:215], a[128:131], v[76:79]
    ds_read_b128 a[228:231], v8 offset:8192
    v_mfma_f32_16x16x32_bf16 v[80:83], v[212:215], a[132:135], v[80:83]
    buffer_load_dwordx4 v[176:179], v3, s[20:23], s32 offen offset:2048
    v_mfma_f32_16x16x32_bf16 v[84:87], v[212:215], a[136:139], v[84:87]
    ds_read_b128 a[232:235], v8 offset:14336
    v_mfma_f32_16x16x32_bf16 v[88:91], v[212:215], a[140:143], v[88:91]
    s_waitcnt vmcnt(17)
    ds_read_b128 a[236:239], v8 offset:20480
    v_mfma_f32_16x16x32_bf16 v[104:107], v[216:219], a[140:143], v[104:107]
    v_mfma_f32_16x16x32_bf16 v[100:103], v[216:219], a[136:139], v[100:103]
    buffer_load_dwordx4 v[180:183], v3, s[20:23], s58 offen offset:2048
    v_mfma_f32_16x16x32_bf16 v[96:99], v[216:219], a[132:135], v[96:99]
    ds_read_b128 a[240:243], v8 offset:3072
    v_mfma_f32_16x16x32_bf16 v[92:95], v[216:219], a[128:131], v[92:95]
    s_waitcnt vmcnt(17)
    ds_read_b128 a[244:247], v8 offset:9216
    v_mfma_f32_16x16x32_bf16 v[76:79], v[220:223], a[144:147], v[76:79]
    s_add_u32 s32, s58, s52
    ds_read_b128 a[248:251], v8 offset:15360
    v_mfma_f32_16x16x32_bf16 v[80:83], v[220:223], a[148:151], v[80:83]
    buffer_load_dwordx4 v[184:187], v3, s[20:23], s32 offen offset:0
    v_mfma_f32_16x16x32_bf16 v[84:87], v[220:223], a[152:155], v[84:87]
    v_mfma_f32_16x16x32_bf16 v[88:91], v[220:223], a[156:159], v[88:91]
    s_waitcnt vmcnt(17)
    ds_read_b128 a[252:255], v8 offset:21504
    v_mfma_f32_16x16x32_bf16 v[104:107], v[224:227], a[156:159], v[104:107]
    s_add_u32 s58, s32, 12288
    ds_read_b128 v[12:15], v8 offset:4096
    v_mfma_f32_16x16x32_bf16 v[100:103], v[224:227], a[152:155], v[100:103]
    buffer_load_dwordx4 v[188:191], v3, s[20:23], s58 offen offset:0
    v_mfma_f32_16x16x32_bf16 v[96:99], v[224:227], a[148:151], v[96:99]
    ds_read_b128 v[16:19], v8 offset:10240
    v_mfma_f32_16x16x32_bf16 v[92:95], v[224:227], a[144:147], v[92:95]
    s_waitcnt vmcnt(17)
    ds_read_b128 v[20:23], v8 offset:16384
    v_mfma_f32_16x16x32_bf16 v[76:79], v[228:231], a[160:163], v[76:79]
    v_mfma_f32_16x16x32_bf16 v[80:83], v[228:231], a[164:167], v[80:83]
    buffer_load_dwordx4 v[192:195], v3, s[20:23], s32 offen offset:1024
    v_mfma_f32_16x16x32_bf16 v[84:87], v[228:231], a[168:171], v[84:87]
    ds_read_b128 v[24:27], v8 offset:22528
    v_mfma_f32_16x16x32_bf16 v[88:91], v[228:231], a[172:175], v[88:91]
    s_waitcnt vmcnt(17)
    ds_read_b128 v[28:31], v8 offset:5120
    v_mfma_f32_16x16x32_bf16 v[104:107], v[232:235], a[172:175], v[104:107]
    ds_read_b128 v[32:35], v8 offset:11264
    v_mfma_f32_16x16x32_bf16 v[100:103], v[232:235], a[168:171], v[100:103]
    buffer_load_dwordx4 v[196:199], v3, s[20:23], s58 offen offset:1024
    v_mfma_f32_16x16x32_bf16 v[96:99], v[232:235], a[164:167], v[96:99]
    v_mfma_f32_16x16x32_bf16 v[92:95], v[232:235], a[160:163], v[92:95]
    s_waitcnt vmcnt(17)
    ds_read_b128 v[36:39], v8 offset:17408
    v_mfma_f32_16x16x32_bf16 v[76:79], v[236:239], a[176:179], v[76:79]
    ds_read_b128 v[40:43], v8 offset:23552
    v_mfma_f32_16x16x32_bf16 v[80:83], v[236:239], a[180:183], v[80:83]
    buffer_load_dwordx4 v[200:203], v3, s[20:23], s32 offen offset:2048
    v_mfma_f32_16x16x32_bf16 v[84:87], v[236:239], a[184:187], v[84:87]
    v_mfma_f32_16x16x32_bf16 v[88:91], v[236:239], a[188:191], v[88:91]
    s_waitcnt vmcnt(17)
    v_mfma_f32_16x16x32_bf16 v[104:107], v[240:243], a[188:191], v[104:107]
    v_mfma_f32_16x16x32_bf16 v[100:103], v[240:243], a[184:187], v[100:103]
    buffer_load_dwordx4 v[204:207], v3, s[20:23], s58 offen offset:2048
    v_mfma_f32_16x16x32_bf16 v[96:99], v[240:243], a[180:183], v[96:99]
    v_mfma_f32_16x16x32_bf16 v[92:95], v[240:243], a[176:179], v[92:95]
    s_waitcnt vmcnt(17) lgkmcnt(0)
    v_mfma_f32_16x16x32_bf16 v[76:79], v[244:247], a[192:195], v[76:79]
    s_add_u32 s32, s58, s53
    v_mfma_f32_16x16x32_bf16 v[80:83], v[244:247], a[196:199], v[80:83]
    buffer_load_dwordx4 v[208:211], v3, s[20:23], s32 offen offset:0
    v_mfma_f32_16x16x32_bf16 v[84:87], v[244:247], a[200:203], v[84:87]
    v_mfma_f32_16x16x32_bf16 v[88:91], v[244:247], a[204:207], v[88:91]
    s_waitcnt vmcnt(17)
    v_mfma_f32_16x16x32_bf16 v[104:107], v[248:251], a[204:207], v[104:107]
    s_add_u32 s58, s32, 12288
    v_mfma_f32_16x16x32_bf16 v[100:103], v[248:251], a[200:203], v[100:103]
    buffer_load_dwordx4 v[212:215], v3, s[20:23], s58 offen offset:0
    v_mfma_f32_16x16x32_bf16 v[96:99], v[248:251], a[196:199], v[96:99]
    v_mfma_f32_16x16x32_bf16 v[92:95], v[248:251], a[192:195], v[92:95]
    s_waitcnt vmcnt(17)
    v_mfma_f32_16x16x32_bf16 v[76:79], v[252:255], a[208:211], v[76:79]
    v_mfma_f32_16x16x32_bf16 v[80:83], v[252:255], a[212:215], v[80:83]
    buffer_load_dwordx4 v[216:219], v3, s[20:23], s32 offen offset:1024
    v_mfma_f32_16x16x32_bf16 v[84:87], v[252:255], a[216:219], v[84:87]
    v_mfma_f32_16x16x32_bf16 v[88:91], v[252:255], a[220:223], v[88:91]
    s_waitcnt vmcnt(17)
    v_mfma_f32_16x16x32_bf16 v[104:107], v[148:151], a[220:223], v[104:107]
    v_mfma_f32_16x16x32_bf16 v[100:103], v[148:151], a[216:219], v[100:103]
    buffer_load_dwordx4 v[220:223], v3, s[20:23], s58 offen offset:1024
    v_mfma_f32_16x16x32_bf16 v[96:99], v[148:151], a[212:215], v[96:99]
    v_mfma_f32_16x16x32_bf16 v[92:95], v[148:151], a[208:211], v[92:95]
    s_waitcnt vmcnt(17)
    v_mfma_f32_16x16x32_bf16 v[76:79], v[152:155], a[224:227], v[76:79]
    v_mfma_f32_16x16x32_bf16 v[80:83], v[152:155], a[228:231], v[80:83]
    buffer_load_dwordx4 v[224:227], v3, s[20:23], s32 offen offset:2048
    v_mfma_f32_16x16x32_bf16 v[84:87], v[152:155], a[232:235], v[84:87]
    v_mfma_f32_16x16x32_bf16 v[88:91], v[152:155], a[236:239], v[88:91]
    s_waitcnt vmcnt(17)
    v_mfma_f32_16x16x32_bf16 v[104:107], v[156:159], a[236:239], v[104:107]
    v_mfma_f32_16x16x32_bf16 v[100:103], v[156:159], a[232:235], v[100:103]
    buffer_load_dwordx4 v[228:231], v3, s[20:23], s58 offen offset:2048
    v_mfma_f32_16x16x32_bf16 v[96:99], v[156:159], a[228:231], v[96:99]
    v_mfma_f32_16x16x32_bf16 v[92:95], v[156:159], a[224:227], v[92:95]
    s_waitcnt vmcnt(17)
    v_mfma_f32_16x16x32_bf16 v[76:79], v[160:163], a[240:243], v[76:79]
    s_add_u32 s32, s58, s54
    v_mfma_f32_16x16x32_bf16 v[80:83], v[160:163], a[244:247], v[80:83]
    buffer_load_dwordx4 v[232:235], v3, s[20:23], s32 offen offset:0
    v_mfma_f32_16x16x32_bf16 v[84:87], v[160:163], a[248:251], v[84:87]
    v_mfma_f32_16x16x32_bf16 v[88:91], v[160:163], a[252:255], v[88:91]
    s_waitcnt vmcnt(17)
    v_mfma_f32_16x16x32_bf16 v[104:107], v[164:167], a[252:255], v[104:107]
    s_add_u32 s58, s32, 12288
    v_mfma_f32_16x16x32_bf16 v[100:103], v[164:167], a[248:251], v[100:103]
    buffer_load_dwordx4 v[236:239], v3, s[20:23], s58 offen offset:0
    v_mfma_f32_16x16x32_bf16 v[96:99], v[164:167], a[244:247], v[96:99]
    v_mfma_f32_16x16x32_bf16 v[92:95], v[164:167], a[240:243], v[92:95]
    s_waitcnt vmcnt(17)
    v_mfma_f32_16x16x32_bf16 v[76:79], v[168:171], v[12:15], v[76:79]
    v_mfma_f32_16x16x32_bf16 v[80:83], v[168:171], v[16:19], v[80:83]
    buffer_load_dwordx4 v[240:243], v3, s[20:23], s32 offen offset:1024
    v_mfma_f32_16x16x32_bf16 v[84:87], v[168:171], v[20:23], v[84:87]
    v_mfma_f32_16x16x32_bf16 v[88:91], v[168:171], v[24:27], v[88:91]
    s_waitcnt vmcnt(17)
    v_mfma_f32_16x16x32_bf16 v[104:107], v[172:175], v[24:27], v[104:107]
    v_mfma_f32_16x16x32_bf16 v[100:103], v[172:175], v[20:23], v[100:103]
    buffer_load_dwordx4 v[244:247], v3, s[20:23], s58 offen offset:1024
    v_mfma_f32_16x16x32_bf16 v[96:99], v[172:175], v[16:19], v[96:99]
    v_mfma_f32_16x16x32_bf16 v[92:95], v[172:175], v[12:15], v[92:95]
    s_waitcnt vmcnt(17)
    v_mfma_f32_16x16x32_bf16 v[76:79], v[176:179], v[28:31], v[76:79]
    v_mfma_f32_16x16x32_bf16 v[80:83], v[176:179], v[32:35], v[80:83]
    buffer_load_dwordx4 v[248:251], v3, s[20:23], s32 offen offset:2048
    v_mfma_f32_16x16x32_bf16 v[84:87], v[176:179], v[36:39], v[84:87]
    v_mfma_f32_16x16x32_bf16 v[88:91], v[176:179], v[40:43], v[88:91]
    s_waitcnt vmcnt(17)
    v_mfma_f32_16x16x32_bf16 v[104:107], v[180:183], v[40:43], v[104:107]
    v_mfma_f32_16x16x32_bf16 v[100:103], v[180:183], v[36:39], v[100:103]
    buffer_load_dwordx4 v[252:255], v3, s[20:23], s58 offen offset:2048
    v_mfma_f32_16x16x32_bf16 v[96:99], v[180:183], v[32:35], v[96:99]
    v_mfma_f32_16x16x32_bf16 v[92:95], v[180:183], v[28:31], v[92:95]
    s_waitcnt vmcnt(17)
    v_mfma_f32_16x16x32_bf16 v[108:111], v[184:187], a[0:3], 0
    s_add_u32 s32, s58, s55
    v_mfma_f32_16x16x32_bf16 v[112:115], v[184:187], a[4:7], 0
    buffer_load_dwordx4 v[148:151], v3, s[20:23], s32 offen offset:0
    v_mfma_f32_16x16x32_bf16 v[116:119], v[184:187], a[8:11], 0
    v_mfma_f32_16x16x32_bf16 v[120:123], v[184:187], a[12:15], 0
    s_waitcnt vmcnt(17)
    v_mfma_f32_16x16x32_bf16 v[136:139], v[188:191], a[12:15], 0
    s_add_u32 s58, s32, 12288
    v_mul_f32 v10, v76, v76
    v_fma_f32 v10, v10, s35, v7
    v_mfma_f32_16x16x32_bf16 v[132:135], v[188:191], a[8:11], 0
    buffer_load_dwordx4 v[152:155], v3, s[20:23], s58 offen offset:0
    v_mfma_f32_16x16x32_bf16 v[128:131], v[188:191], a[4:7], 0
    v_mul_f32 v10, v10, v76
    v_mfma_f32_16x16x32_bf16 v[124:127], v[188:191], a[0:3], 0
    s_waitcnt vmcnt(17)
    v_exp_f32 v10, v10
    v_mfma_f32_16x16x32_bf16 v[108:111], v[192:195], a[16:19], v[108:111]
    v_mul_f32 v92, v92, v76
    v_add_f32 v10, 1.0, v10
    v_mfma_f32_16x16x32_bf16 v[112:115], v[192:195], a[20:23], v[112:115]
    buffer_load_dwordx4 v[156:159], v3, s[20:23], s32 offen offset:1024
    v_mfma_f32_16x16x32_bf16 v[116:119], v[192:195], a[24:27], v[116:119]
    v_rcp_f32 v10, v10
    v_mfma_f32_16x16x32_bf16 v[120:123], v[192:195], a[28:31], v[120:123]
    s_waitcnt vmcnt(17)
    v_mul_f32 v11, v77, v77
    v_mfma_f32_16x16x32_bf16 v[136:139], v[196:199], a[28:31], v[136:139]
    v_fma_f32 v11, v11, s35, v7
    v_mul_f32 v11, v11, v77
    v_mfma_f32_16x16x32_bf16 v[132:135], v[196:199], a[24:27], v[132:135]
    buffer_load_dwordx4 v[160:163], v3, s[20:23], s58 offen offset:1024
    v_mfma_f32_16x16x32_bf16 v[128:131], v[196:199], a[20:23], v[128:131]
    v_exp_f32 v11, v11
    v_mfma_f32_16x16x32_bf16 v[124:127], v[196:199], a[16:19], v[124:127]
    s_waitcnt vmcnt(17)
    v_mul_f32 v93, v93, v77
    v_mfma_f32_16x16x32_bf16 v[108:111], v[200:203], a[32:35], v[108:111]
    v_mul_f32 v92, v92, v10
    v_add_f32 v11, 1.0, v11
    v_mfma_f32_16x16x32_bf16 v[112:115], v[200:203], a[36:39], v[112:115]
    buffer_load_dwordx4 v[164:167], v3, s[20:23], s32 offen offset:2048
    v_mfma_f32_16x16x32_bf16 v[116:119], v[200:203], a[40:43], v[116:119]
    v_rcp_f32 v11, v11
    v_mfma_f32_16x16x32_bf16 v[120:123], v[200:203], a[44:47], v[120:123]
    s_waitcnt vmcnt(17)
    v_mul_f32 v10, v78, v78
    v_mfma_f32_16x16x32_bf16 v[136:139], v[204:207], a[44:47], v[136:139]
    v_fma_f32 v10, v10, s35, v7
    v_mul_f32 v10, v10, v78
    v_mfma_f32_16x16x32_bf16 v[132:135], v[204:207], a[40:43], v[132:135]
    buffer_load_dwordx4 v[168:171], v3, s[20:23], s58 offen offset:2048
    v_mfma_f32_16x16x32_bf16 v[128:131], v[204:207], a[36:39], v[128:131]
    v_exp_f32 v10, v10
    v_mfma_f32_16x16x32_bf16 v[124:127], v[204:207], a[32:35], v[124:127]
    s_waitcnt vmcnt(17)
    v_mul_f32 v94, v94, v78
    v_mfma_f32_16x16x32_bf16 v[108:111], v[208:211], a[48:51], v[108:111]
    s_add_u32 s32, s58, s56
    v_mul_f32 v93, v93, v11
    v_add_f32 v10, 1.0, v10
    v_mfma_f32_16x16x32_bf16 v[112:115], v[208:211], a[52:55], v[112:115]
    buffer_load_dwordx4 v[172:175], v3, s[20:23], s32 offen offset:0
    v_mfma_f32_16x16x32_bf16 v[116:119], v[208:211], a[56:59], v[116:119]
    v_cvt_pk_bf16_f32 v140, v92, v93
    v_mfma_f32_16x16x32_bf16 v[120:123], v[208:211], a[60:63], v[120:123]
    s_waitcnt vmcnt(17)
    v_rcp_f32 v10, v10
    v_mfma_f32_16x16x32_bf16 v[136:139], v[212:215], a[60:63], v[136:139]
    s_add_u32 s58, s32, 12288
    v_mul_f32 v11, v79, v79
    v_fma_f32 v11, v11, s35, v7
    v_mfma_f32_16x16x32_bf16 v[132:135], v[212:215], a[56:59], v[132:135]
    buffer_load_dwordx4 v[176:179], v3, s[20:23], s58 offen offset:0
    v_mfma_f32_16x16x32_bf16 v[128:131], v[212:215], a[52:55], v[128:131]
    v_mul_f32 v11, v11, v79
    v_mfma_f32_16x16x32_bf16 v[124:127], v[212:215], a[48:51], v[124:127]
    s_waitcnt vmcnt(17)
    v_exp_f32 v11, v11
    v_mfma_f32_16x16x32_bf16 v[108:111], v[216:219], a[64:67], v[108:111]
    v_mul_f32 v95, v95, v79
    v_mul_f32 v94, v94, v10
    v_mfma_f32_16x16x32_bf16 v[112:115], v[216:219], a[68:71], v[112:115]
    buffer_load_dwordx4 v[180:183], v3, s[20:23], s32 offen offset:1024
    v_mfma_f32_16x16x32_bf16 v[116:119], v[216:219], a[72:75], v[116:119]
    v_add_f32 v11, 1.0, v11
    v_mfma_f32_16x16x32_bf16 v[120:123], v[216:219], a[76:79], v[120:123]
    s_waitcnt vmcnt(17)
    v_rcp_f32 v11, v11
    v_mfma_f32_16x16x32_bf16 v[136:139], v[220:223], a[76:79], v[136:139]
    v_mul_f32 v10, v80, v80
    v_fma_f32 v10, v10, s35, v7
    v_mfma_f32_16x16x32_bf16 v[132:135], v[220:223], a[72:75], v[132:135]
    buffer_load_dwordx4 v[184:187], v3, s[20:23], s58 offen offset:1024
    v_mfma_f32_16x16x32_bf16 v[128:131], v[220:223], a[68:71], v[128:131]
    v_mul_f32 v10, v10, v80
    v_mfma_f32_16x16x32_bf16 v[124:127], v[220:223], a[64:67], v[124:127]
    s_waitcnt vmcnt(17)
    v_exp_f32 v10, v10
    v_mfma_f32_16x16x32_bf16 v[108:111], v[224:227], a[80:83], v[108:111]
    v_mul_f32 v96, v96, v80
    v_mul_f32 v95, v95, v11
    v_mfma_f32_16x16x32_bf16 v[112:115], v[224:227], a[84:87], v[112:115]
    buffer_load_dwordx4 v[188:191], v3, s[20:23], s32 offen offset:2048
    v_mfma_f32_16x16x32_bf16 v[116:119], v[224:227], a[88:91], v[116:119]
    v_add_f32 v10, 1.0, v10
    v_cvt_pk_bf16_f32 v141, v94, v95
    v_mfma_f32_16x16x32_bf16 v[120:123], v[224:227], a[92:95], v[120:123]
    s_waitcnt vmcnt(17)
    v_rcp_f32 v10, v10
    v_mfma_f32_16x16x32_bf16 v[136:139], v[228:231], a[92:95], v[136:139]
    v_mul_f32 v11, v81, v81
    v_mfma_f32_16x16x32_bf16 v[132:135], v[228:231], a[88:91], v[132:135]
    buffer_load_dwordx4 v[192:195], v3, s[20:23], s58 offen offset:2048
    v_mfma_f32_16x16x32_bf16 v[128:131], v[228:231], a[84:87], v[128:131]
    v_fma_f32 v11, v11, s35, v7
    v_mul_f32 v11, v11, v81
    v_mfma_f32_16x16x32_bf16 v[124:127], v[228:231], a[80:83], v[124:127]
    s_waitcnt vmcnt(17)
    v_exp_f32 v11, v11
    v_mfma_f32_16x16x32_bf16 v[108:111], v[232:235], a[96:99], v[108:111]
    s_add_u32 s32, s58, s57
    v_mul_f32 v97, v97, v81
    v_mfma_f32_16x16x32_bf16 v[112:115], v[232:235], a[100:103], v[112:115]
    buffer_load_dwordx4 v[196:199], v3, s[20:23], s32 offen offset:0
    v_mfma_f32_16x16x32_bf16 v[116:119], v[232:235], a[104:107], v[116:119]
    v_mul_f32 v96, v96, v10
    v_add_f32 v11, 1.0, v11
    v_mfma_f32_16x16x32_bf16 v[120:123], v[232:235], a[108:111], v[120:123]
    s_waitcnt vmcnt(17)
    v_rcp_f32 v11, v11
    v_mfma_f32_16x16x32_bf16 v[136:139], v[236:239], a[108:111], v[136:139]
    s_add_u32 s58, s32, 12288
    ds_write_b64 v4, v[140:141] offset:0
    v_mfma_f32_16x16x32_bf16 v[132:135], v[236:239], a[104:107], v[132:135]
    buffer_load_dwordx4 v[200:203], v3, s[20:23], s58 offen offset:0
    v_mfma_f32_16x16x32_bf16 v[128:131], v[236:239], a[100:103], v[128:131]
    v_mul_f32 v10, v82, v82
    v_fma_f32 v10, v10, s35, v7
    v_mfma_f32_16x16x32_bf16 v[124:127], v[236:239], a[96:99], v[124:127]
    s_waitcnt vmcnt(17)
    v_mul_f32 v10, v10, v82
    v_mfma_f32_16x16x32_bf16 v[108:111], v[240:243], a[112:115], v[108:111]
    v_exp_f32 v10, v10
    v_mfma_f32_16x16x32_bf16 v[112:115], v[240:243], a[116:119], v[112:115]
    buffer_load_dwordx4 v[204:207], v3, s[20:23], s32 offen offset:1024
    v_mfma_f32_16x16x32_bf16 v[116:119], v[240:243], a[120:123], v[116:119]
    v_mul_f32 v98, v98, v82
    v_mul_f32 v97, v97, v11
    v_mfma_f32_16x16x32_bf16 v[120:123], v[240:243], a[124:127], v[120:123]
    s_waitcnt vmcnt(17)
    v_add_f32 v10, 1.0, v10
    v_mfma_f32_16x16x32_bf16 v[136:139], v[244:247], a[124:127], v[136:139]
    v_cvt_pk_bf16_f32 v142, v96, v97
    v_mfma_f32_16x16x32_bf16 v[132:135], v[244:247], a[120:123], v[132:135]
    buffer_load_dwordx4 v[208:211], v3, s[20:23], s58 offen offset:1024
    v_mfma_f32_16x16x32_bf16 v[128:131], v[244:247], a[116:119], v[128:131]
    v_rcp_f32 v10, v10
    v_mfma_f32_16x16x32_bf16 v[124:127], v[244:247], a[112:115], v[124:127]
    s_waitcnt vmcnt(17)
    v_mul_f32 v11, v83, v83
    v_fma_f32 v11, v11, s35, v7
    v_mfma_f32_16x16x32_bf16 v[108:111], v[248:251], a[128:131], v[108:111]
    v_mul_f32 v11, v11, v83
    v_mfma_f32_16x16x32_bf16 v[112:115], v[248:251], a[132:135], v[112:115]
    buffer_load_dwordx4 v[212:215], v3, s[20:23], s32 offen offset:2048
    v_mfma_f32_16x16x32_bf16 v[116:119], v[248:251], a[136:139], v[116:119]
    v_exp_f32 v11, v11
    v_mfma_f32_16x16x32_bf16 v[120:123], v[248:251], a[140:143], v[120:123]
    s_waitcnt vmcnt(17)
    v_mul_f32 v99, v99, v83
    v_mul_f32 v98, v98, v10
    v_mfma_f32_16x16x32_bf16 v[136:139], v[252:255], a[140:143], v[136:139]
    v_add_f32 v11, 1.0, v11
    v_mfma_f32_16x16x32_bf16 v[132:135], v[252:255], a[136:139], v[132:135]
    buffer_load_dwordx4 v[216:219], v3, s[20:23], s58 offen offset:2048
    v_mfma_f32_16x16x32_bf16 v[128:131], v[252:255], a[132:135], v[128:131]
    v_rcp_f32 v11, v11
    v_mfma_f32_16x16x32_bf16 v[124:127], v[252:255], a[128:131], v[124:127]
    s_waitcnt vmcnt(17)
    v_mul_f32 v10, v84, v84
    v_fma_f32 v10, v10, s35, v7
    v_mfma_f32_16x16x32_bf16 v[108:111], v[148:151], a[144:147], v[108:111]
    s_add_u32 s32, s58, s52
    v_mul_f32 v10, v10, v84
    v_mfma_f32_16x16x32_bf16 v[112:115], v[148:151], a[148:151], v[112:115]
    buffer_load_dwordx4 v[220:223], v3, s[20:23], s32 offen offset:0
    v_mfma_f32_16x16x32_bf16 v[116:119], v[148:151], a[152:155], v[116:119]
    v_exp_f32 v10, v10
    v_mfma_f32_16x16x32_bf16 v[120:123], v[148:151], a[156:159], v[120:123]
    s_waitcnt vmcnt(17)
    v_mul_f32 v100, v100, v84
    v_mul_f32 v99, v99, v11
    v_mfma_f32_16x16x32_bf16 v[136:139], v[152:155], a[156:159], v[136:139]
    s_add_u32 s58, s32, 12288
    v_add_f32 v10, 1.0, v10
    v_cvt_pk_bf16_f32 v143, v98, v99
    v_mfma_f32_16x16x32_bf16 v[132:135], v[152:155], a[152:155], v[132:135]
    buffer_load_dwordx4 v[224:227], v3, s[20:23], s58 offen offset:0
    v_mfma_f32_16x16x32_bf16 v[128:131], v[152:155], a[148:151], v[128:131]
    v_rcp_f32 v10, v10
    v_mfma_f32_16x16x32_bf16 v[124:127], v[152:155], a[144:147], v[124:127]
    s_waitcnt vmcnt(17)
    v_mul_f32 v11, v85, v85
    v_mfma_f32_16x16x32_bf16 v[108:111], v[156:159], a[160:163], v[108:111]
    v_fma_f32 v11, v11, s35, v7
    v_mul_f32 v11, v11, v85
    v_mfma_f32_16x16x32_bf16 v[112:115], v[156:159], a[164:167], v[112:115]
    buffer_load_dwordx4 v[228:231], v3, s[20:23], s32 offen offset:1024
    v_mfma_f32_16x16x32_bf16 v[116:119], v[156:159], a[168:171], v[116:119]
    v_exp_f32 v11, v11
    v_mfma_f32_16x16x32_bf16 v[120:123], v[156:159], a[172:175], v[120:123]
    s_waitcnt vmcnt(17)
    v_mul_f32 v101, v101, v85
    v_mfma_f32_16x16x32_bf16 v[136:139], v[160:163], a[172:175], v[136:139]
    v_mul_f32 v100, v100, v10
    v_add_f32 v11, 1.0, v11
    v_mfma_f32_16x16x32_bf16 v[132:135], v[160:163], a[168:171], v[132:135]
    buffer_load_dwordx4 v[232:235], v3, s[20:23], s58 offen offset:1024
    v_mfma_f32_16x16x32_bf16 v[128:131], v[160:163], a[164:167], v[128:131]
    v_rcp_f32 v11, v11
    v_mfma_f32_16x16x32_bf16 v[124:127], v[160:163], a[160:163], v[124:127]
    s_waitcnt vmcnt(17)
    ds_write_b64 v4, v[142:143] offset:1024
    v_mfma_f32_16x16x32_bf16 v[108:111], v[164:167], a[176:179], v[108:111]
    v_mul_f32 v10, v86, v86
    v_fma_f32 v10, v10, s35, v7
    v_mfma_f32_16x16x32_bf16 v[112:115], v[164:167], a[180:183], v[112:115]
    buffer_load_dwordx4 v[236:239], v3, s[20:23], s32 offen offset:2048
    v_mfma_f32_16x16x32_bf16 v[116:119], v[164:167], a[184:187], v[116:119]
    v_mul_f32 v10, v10, v86
    v_mfma_f32_16x16x32_bf16 v[120:123], v[164:167], a[188:191], v[120:123]
    s_waitcnt vmcnt(17)
    v_exp_f32 v10, v10
    v_mfma_f32_16x16x32_bf16 v[136:139], v[168:171], a[188:191], v[136:139]
    v_mul_f32 v102, v102, v86
    v_mul_f32 v101, v101, v11
    v_mfma_f32_16x16x32_bf16 v[132:135], v[168:171], a[184:187], v[132:135]
    buffer_load_dwordx4 v[240:243], v3, s[20:23], s58 offen offset:2048
    v_mfma_f32_16x16x32_bf16 v[128:131], v[168:171], a[180:183], v[128:131]
    v_add_f32 v10, 1.0, v10
    v_cvt_pk_bf16_f32 v144, v100, v101
    v_mfma_f32_16x16x32_bf16 v[124:127], v[168:171], a[176:179], v[124:127]
    s_waitcnt vmcnt(17)
    v_rcp_f32 v10, v10
    v_mfma_f32_16x16x32_bf16 v[108:111], v[172:175], a[192:195], v[108:111]
    s_add_u32 s32, s58, s53
    v_mul_f32 v11, v87, v87
    v_mfma_f32_16x16x32_bf16 v[112:115], v[172:175], a[196:199], v[112:115]
    buffer_load_dwordx4 v[244:247], v3, s[20:23], s32 offen offset:0
    v_mfma_f32_16x16x32_bf16 v[116:119], v[172:175], a[200:203], v[116:119]
    v_fma_f32 v11, v11, s35, v7
    v_mul_f32 v11, v11, v87
    v_mfma_f32_16x16x32_bf16 v[120:123], v[172:175], a[204:207], v[120:123]
    s_waitcnt vmcnt(17)
    v_exp_f32 v11, v11
    v_mfma_f32_16x16x32_bf16 v[136:139], v[176:179], a[204:207], v[136:139]
    s_add_u32 s58, s32, 12288
    v_mul_f32 v103, v103, v87
    v_mfma_f32_16x16x32_bf16 v[132:135], v[176:179], a[200:203], v[132:135]
    buffer_load_dwordx4 v[248:251], v3, s[20:23], s58 offen offset:0
    v_mfma_f32_16x16x32_bf16 v[128:131], v[176:179], a[196:199], v[128:131]
    v_mul_f32 v102, v102, v10
    v_add_f32 v11, 1.0, v11
    v_mfma_f32_16x16x32_bf16 v[124:127], v[176:179], a[192:195], v[124:127]
    s_waitcnt vmcnt(17)
    v_rcp_f32 v11, v11
    v_mfma_f32_16x16x32_bf16 v[108:111], v[180:183], a[208:211], v[108:111]
    v_mul_f32 v10, v88, v88
    v_mfma_f32_16x16x32_bf16 v[112:115], v[180:183], a[212:215], v[112:115]
    buffer_load_dwordx4 v[252:255], v3, s[20:23], s32 offen offset:1024
    v_mfma_f32_16x16x32_bf16 v[116:119], v[180:183], a[216:219], v[116:119]
    v_fma_f32 v10, v10, s35, v7
    v_mul_f32 v10, v10, v88
    v_mfma_f32_16x16x32_bf16 v[120:123], v[180:183], a[220:223], v[120:123]
    s_waitcnt vmcnt(17)
    v_exp_f32 v10, v10
    v_mfma_f32_16x16x32_bf16 v[136:139], v[184:187], a[220:223], v[136:139]
    v_mul_f32 v104, v104, v88
    v_mfma_f32_16x16x32_bf16 v[132:135], v[184:187], a[216:219], v[132:135]
    buffer_load_dwordx4 v[148:151], v3, s[20:23], s58 offen offset:1024
    v_mfma_f32_16x16x32_bf16 v[128:131], v[184:187], a[212:215], v[128:131]
    v_mul_f32 v103, v103, v11
    v_add_f32 v10, 1.0, v10
    v_mfma_f32_16x16x32_bf16 v[124:127], v[184:187], a[208:211], v[124:127]
    s_waitcnt vmcnt(17)
    v_cvt_pk_bf16_f32 v145, v102, v103
    v_mfma_f32_16x16x32_bf16 v[108:111], v[188:191], a[224:227], v[108:111]
    v_rcp_f32 v10, v10
    v_mfma_f32_16x16x32_bf16 v[112:115], v[188:191], a[228:231], v[112:115]
    buffer_load_dwordx4 v[152:155], v3, s[20:23], s32 offen offset:2048
    v_mfma_f32_16x16x32_bf16 v[116:119], v[188:191], a[232:235], v[116:119]
    v_mul_f32 v11, v89, v89
    v_fma_f32 v11, v11, s35, v7
    v_mfma_f32_16x16x32_bf16 v[120:123], v[188:191], a[236:239], v[120:123]
    s_waitcnt vmcnt(17)
    v_mul_f32 v11, v11, v89
    v_mfma_f32_16x16x32_bf16 v[136:139], v[192:195], a[236:239], v[136:139]
    v_exp_f32 v11, v11
    v_mfma_f32_16x16x32_bf16 v[132:135], v[192:195], a[232:235], v[132:135]
    buffer_load_dwordx4 v[156:159], v3, s[20:23], s58 offen offset:2048
    v_mfma_f32_16x16x32_bf16 v[128:131], v[192:195], a[228:231], v[128:131]
    v_mul_f32 v105, v105, v89
    v_mul_f32 v104, v104, v10
    v_mfma_f32_16x16x32_bf16 v[124:127], v[192:195], a[224:227], v[124:127]
    s_waitcnt vmcnt(17)
    v_add_f32 v11, 1.0, v11
    v_mfma_f32_16x16x32_bf16 v[108:111], v[196:199], a[240:243], v[108:111]
    s_add_u32 s32, s58, s54
    v_rcp_f32 v11, v11
    v_mfma_f32_16x16x32_bf16 v[112:115], v[196:199], a[244:247], v[112:115]
    buffer_load_dwordx4 v[160:163], v3, s[20:23], s32 offen offset:0
    v_mfma_f32_16x16x32_bf16 v[116:119], v[196:199], a[248:251], v[116:119]
    ds_write_b64 v4, v[144:145] offset:2048
    v_mul_f32 v10, v90, v90
    v_mfma_f32_16x16x32_bf16 v[120:123], v[196:199], a[252:255], v[120:123]
    s_waitcnt vmcnt(17)
    v_fma_f32 v10, v10, s35, v7
    v_mul_f32 v10, v10, v90
    v_mfma_f32_16x16x32_bf16 v[136:139], v[200:203], a[252:255], v[136:139]
    s_add_u32 s58, s32, 12288
    v_exp_f32 v10, v10
    v_mfma_f32_16x16x32_bf16 v[132:135], v[200:203], a[248:251], v[132:135]
    buffer_load_dwordx4 v[164:167], v3, s[20:23], s58 offen offset:0
    v_mfma_f32_16x16x32_bf16 v[128:131], v[200:203], a[244:247], v[128:131]
    v_mul_f32 v106, v106, v90
    v_mfma_f32_16x16x32_bf16 v[124:127], v[200:203], a[240:243], v[124:127]
    s_waitcnt vmcnt(17)
    v_mul_f32 v105, v105, v11
    v_add_f32 v10, 1.0, v10
    v_mfma_f32_16x16x32_bf16 v[108:111], v[204:207], v[12:15], v[108:111]
    v_cvt_pk_bf16_f32 v146, v104, v105
    v_mfma_f32_16x16x32_bf16 v[112:115], v[204:207], v[16:19], v[112:115]
    buffer_load_dwordx4 v[168:171], v3, s[20:23], s32 offen offset:1024
    v_mfma_f32_16x16x32_bf16 v[116:119], v[204:207], v[20:23], v[116:119]
    v_rcp_f32 v10, v10
    v_mfma_f32_16x16x32_bf16 v[120:123], v[204:207], v[24:27], v[120:123]
    s_waitcnt vmcnt(17)
    v_mul_f32 v11, v91, v91
    v_fma_f32 v11, v11, s35, v7
    v_mfma_f32_16x16x32_bf16 v[136:139], v[208:211], v[24:27], v[136:139]
    v_mul_f32 v11, v11, v91
    v_mfma_f32_16x16x32_bf16 v[132:135], v[208:211], v[20:23], v[132:135]
    buffer_load_dwordx4 v[172:175], v3, s[20:23], s58 offen offset:1024
    v_mfma_f32_16x16x32_bf16 v[128:131], v[208:211], v[16:19], v[128:131]
    v_exp_f32 v11, v11
    v_mfma_f32_16x16x32_bf16 v[124:127], v[208:211], v[12:15], v[124:127]
    s_waitcnt vmcnt(17)
    v_mul_f32 v107, v107, v91
    v_mul_f32 v106, v106, v10
    v_mfma_f32_16x16x32_bf16 v[108:111], v[212:215], v[28:31], v[108:111]
    v_add_f32 v11, 1.0, v11
    v_mfma_f32_16x16x32_bf16 v[112:115], v[212:215], v[32:35], v[112:115]
    buffer_load_dwordx4 v[176:179], v3, s[20:23], s32 offen offset:2048
    v_mfma_f32_16x16x32_bf16 v[116:119], v[212:215], v[36:39], v[116:119]
    v_rcp_f32 v11, v11
    v_mfma_f32_16x16x32_bf16 v[120:123], v[212:215], v[40:43], v[120:123]
    s_waitcnt vmcnt(17)
    v_nop
    v_mul_f32 v107, v107, v11
    v_mfma_f32_16x16x32_bf16 v[136:139], v[216:219], v[40:43], v[136:139]
    v_cvt_pk_bf16_f32 v147, v106, v107
    v_mfma_f32_16x16x32_bf16 v[132:135], v[216:219], v[36:39], v[132:135]
    buffer_load_dwordx4 v[180:183], v3, s[20:23], s58 offen offset:2048
    v_mfma_f32_16x16x32_bf16 v[128:131], v[216:219], v[32:35], v[128:131]
    ds_write_b64 v4, v[146:147] offset:3072
    v_nop
    v_mfma_f32_16x16x32_bf16 v[124:127], v[216:219], v[28:31], v[124:127]
    s_waitcnt vmcnt(17)
    v_mfma_f32_16x16x32_bf16 v[76:79], v[220:223], a[0:3], 0
    s_add_u32 s32, s58, s55
    v_mfma_f32_16x16x32_bf16 v[80:83], v[220:223], a[4:7], 0
    buffer_load_dwordx4 v[184:187], v3, s[20:23], s32 offen offset:0
    v_mfma_f32_16x16x32_bf16 v[84:87], v[220:223], a[8:11], 0
    v_mfma_f32_16x16x32_bf16 v[88:91], v[220:223], a[12:15], 0
    s_waitcnt vmcnt(17)
    v_mfma_f32_16x16x32_bf16 v[104:107], v[224:227], a[12:15], 0
    s_add_u32 s58, s32, 12288
    v_mul_f32 v10, v108, v108
    v_fma_f32 v10, v10, s35, v7
    v_mfma_f32_16x16x32_bf16 v[100:103], v[224:227], a[8:11], 0
    buffer_load_dwordx4 v[188:191], v3, s[20:23], s58 offen offset:0
    v_mfma_f32_16x16x32_bf16 v[96:99], v[224:227], a[4:7], 0
    v_mul_f32 v10, v10, v108
    v_mfma_f32_16x16x32_bf16 v[92:95], v[224:227], a[0:3], 0
    s_waitcnt vmcnt(17)
    v_exp_f32 v10, v10
    v_mfma_f32_16x16x32_bf16 v[76:79], v[228:231], a[16:19], v[76:79]
    v_mul_f32 v124, v124, v108
    v_add_f32 v10, 1.0, v10
    v_mfma_f32_16x16x32_bf16 v[80:83], v[228:231], a[20:23], v[80:83]
    buffer_load_dwordx4 v[192:195], v3, s[20:23], s32 offen offset:1024
    v_mfma_f32_16x16x32_bf16 v[84:87], v[228:231], a[24:27], v[84:87]
    v_rcp_f32 v10, v10
    v_mfma_f32_16x16x32_bf16 v[88:91], v[228:231], a[28:31], v[88:91]
    s_waitcnt vmcnt(17)
    v_mul_f32 v11, v109, v109
    v_mfma_f32_16x16x32_bf16 v[104:107], v[232:235], a[28:31], v[104:107]
    v_fma_f32 v11, v11, s35, v7
    v_mul_f32 v11, v11, v109
    v_mfma_f32_16x16x32_bf16 v[100:103], v[232:235], a[24:27], v[100:103]
    buffer_load_dwordx4 v[196:199], v3, s[20:23], s58 offen offset:1024
    v_mfma_f32_16x16x32_bf16 v[96:99], v[232:235], a[20:23], v[96:99]
    v_exp_f32 v11, v11
    v_mfma_f32_16x16x32_bf16 v[92:95], v[232:235], a[16:19], v[92:95]
    s_waitcnt vmcnt(17)
    v_mul_f32 v125, v125, v109
    v_mfma_f32_16x16x32_bf16 v[76:79], v[236:239], a[32:35], v[76:79]
    v_mul_f32 v124, v124, v10
    v_add_f32 v11, 1.0, v11
    v_mfma_f32_16x16x32_bf16 v[80:83], v[236:239], a[36:39], v[80:83]
    buffer_load_dwordx4 v[200:203], v3, s[20:23], s32 offen offset:2048
    v_mfma_f32_16x16x32_bf16 v[84:87], v[236:239], a[40:43], v[84:87]
    v_rcp_f32 v11, v11
    v_mfma_f32_16x16x32_bf16 v[88:91], v[236:239], a[44:47], v[88:91]
    s_waitcnt vmcnt(17)
    v_mul_f32 v10, v110, v110
    v_mfma_f32_16x16x32_bf16 v[104:107], v[240:243], a[44:47], v[104:107]
    v_fma_f32 v10, v10, s35, v7
    v_mul_f32 v10, v10, v110
    v_mfma_f32_16x16x32_bf16 v[100:103], v[240:243], a[40:43], v[100:103]
    buffer_load_dwordx4 v[204:207], v3, s[20:23], s58 offen offset:2048
    v_mfma_f32_16x16x32_bf16 v[96:99], v[240:243], a[36:39], v[96:99]
    v_exp_f32 v10, v10
    v_mfma_f32_16x16x32_bf16 v[92:95], v[240:243], a[32:35], v[92:95]
    s_waitcnt vmcnt(17)
    v_mul_f32 v126, v126, v110
    v_mfma_f32_16x16x32_bf16 v[76:79], v[244:247], a[48:51], v[76:79]
    s_add_u32 s32, s58, s56
    v_mul_f32 v125, v125, v11
    v_add_f32 v10, 1.0, v10
    v_mfma_f32_16x16x32_bf16 v[80:83], v[244:247], a[52:55], v[80:83]
    buffer_load_dwordx4 v[208:211], v3, s[20:23], s32 offen offset:0
    v_mfma_f32_16x16x32_bf16 v[84:87], v[244:247], a[56:59], v[84:87]
    v_cvt_pk_bf16_f32 v140, v124, v125
    v_mfma_f32_16x16x32_bf16 v[88:91], v[244:247], a[60:63], v[88:91]
    s_waitcnt vmcnt(17)
    v_rcp_f32 v10, v10
    v_mfma_f32_16x16x32_bf16 v[104:107], v[248:251], a[60:63], v[104:107]
    s_add_u32 s58, s32, 12288
    v_mul_f32 v11, v111, v111
    v_fma_f32 v11, v11, s35, v7
    v_mfma_f32_16x16x32_bf16 v[100:103], v[248:251], a[56:59], v[100:103]
    buffer_load_dwordx4 v[212:215], v3, s[20:23], s58 offen offset:0
    v_mfma_f32_16x16x32_bf16 v[96:99], v[248:251], a[52:55], v[96:99]
    v_mul_f32 v11, v11, v111
    v_mfma_f32_16x16x32_bf16 v[92:95], v[248:251], a[48:51], v[92:95]
    s_waitcnt vmcnt(17)
    v_exp_f32 v11, v11
    v_mfma_f32_16x16x32_bf16 v[76:79], v[252:255], a[64:67], v[76:79]
    v_mul_f32 v127, v127, v111
    v_mul_f32 v126, v126, v10
    v_mfma_f32_16x16x32_bf16 v[80:83], v[252:255], a[68:71], v[80:83]
    buffer_load_dwordx4 v[216:219], v3, s[20:23], s32 offen offset:1024
    v_mfma_f32_16x16x32_bf16 v[84:87], v[252:255], a[72:75], v[84:87]
    v_add_f32 v11, 1.0, v11
    v_mfma_f32_16x16x32_bf16 v[88:91], v[252:255], a[76:79], v[88:91]
    s_waitcnt vmcnt(17)
    v_rcp_f32 v11, v11
    v_mfma_f32_16x16x32_bf16 v[104:107], v[148:151], a[76:79], v[104:107]
    v_mul_f32 v10, v112, v112
    v_fma_f32 v10, v10, s35, v7
    v_mfma_f32_16x16x32_bf16 v[100:103], v[148:151], a[72:75], v[100:103]
    buffer_load_dwordx4 v[220:223], v3, s[20:23], s58 offen offset:1024
    v_mfma_f32_16x16x32_bf16 v[96:99], v[148:151], a[68:71], v[96:99]
    v_mul_f32 v10, v10, v112
    v_mfma_f32_16x16x32_bf16 v[92:95], v[148:151], a[64:67], v[92:95]
    s_waitcnt vmcnt(17)
    v_exp_f32 v10, v10
    v_mfma_f32_16x16x32_bf16 v[76:79], v[152:155], a[80:83], v[76:79]
    v_mul_f32 v128, v128, v112
    v_mul_f32 v127, v127, v11
    v_mfma_f32_16x16x32_bf16 v[80:83], v[152:155], a[84:87], v[80:83]
    buffer_load_dwordx4 v[224:227], v3, s[20:23], s32 offen offset:2048
    v_mfma_f32_16x16x32_bf16 v[84:87], v[152:155], a[88:91], v[84:87]
    v_add_f32 v10, 1.0, v10
    v_cvt_pk_bf16_f32 v141, v126, v127
    v_mfma_f32_16x16x32_bf16 v[88:91], v[152:155], a[92:95], v[88:91]
    s_waitcnt vmcnt(17)
    v_rcp_f32 v10, v10
    v_mfma_f32_16x16x32_bf16 v[104:107], v[156:159], a[92:95], v[104:107]
    v_mul_f32 v11, v113, v113
    v_mfma_f32_16x16x32_bf16 v[100:103], v[156:159], a[88:91], v[100:103]
    buffer_load_dwordx4 v[228:231], v3, s[20:23], s58 offen offset:2048
    v_mfma_f32_16x16x32_bf16 v[96:99], v[156:159], a[84:87], v[96:99]
    v_fma_f32 v11, v11, s35, v7
    v_mul_f32 v11, v11, v113
    v_mfma_f32_16x16x32_bf16 v[92:95], v[156:159], a[80:83], v[92:95]
    s_waitcnt vmcnt(17)
    v_exp_f32 v11, v11
    v_mfma_f32_16x16x32_bf16 v[76:79], v[160:163], a[96:99], v[76:79]
    s_add_u32 s32, s58, s57
    v_mul_f32 v129, v129, v113
    v_mfma_f32_16x16x32_bf16 v[80:83], v[160:163], a[100:103], v[80:83]
    buffer_load_dwordx4 v[232:235], v3, s[20:23], s32 offen offset:0
    v_mfma_f32_16x16x32_bf16 v[84:87], v[160:163], a[104:107], v[84:87]
    v_mul_f32 v128, v128, v10
    v_add_f32 v11, 1.0, v11
    v_mfma_f32_16x16x32_bf16 v[88:91], v[160:163], a[108:111], v[88:91]
    s_waitcnt vmcnt(17)
    v_rcp_f32 v11, v11
    v_mfma_f32_16x16x32_bf16 v[104:107], v[164:167], a[108:111], v[104:107]
    s_add_u32 s58, s32, 12288
    ds_write_b64 v4, v[140:141] offset:8192
    v_mfma_f32_16x16x32_bf16 v[100:103], v[164:167], a[104:107], v[100:103]
    buffer_load_dwordx4 v[236:239], v3, s[20:23], s58 offen offset:0
    v_mfma_f32_16x16x32_bf16 v[96:99], v[164:167], a[100:103], v[96:99]
    v_mul_f32 v10, v114, v114
    v_fma_f32 v10, v10, s35, v7
    v_mfma_f32_16x16x32_bf16 v[92:95], v[164:167], a[96:99], v[92:95]
    s_waitcnt vmcnt(17)
    v_mul_f32 v10, v10, v114
    v_mfma_f32_16x16x32_bf16 v[76:79], v[168:171], a[112:115], v[76:79]
    v_exp_f32 v10, v10
    v_mfma_f32_16x16x32_bf16 v[80:83], v[168:171], a[116:119], v[80:83]
    buffer_load_dwordx4 v[240:243], v3, s[20:23], s32 offen offset:1024
    v_mfma_f32_16x16x32_bf16 v[84:87], v[168:171], a[120:123], v[84:87]
    v_mul_f32 v130, v130, v114
    v_mul_f32 v129, v129, v11
    v_mfma_f32_16x16x32_bf16 v[88:91], v[168:171], a[124:127], v[88:91]
    s_waitcnt vmcnt(17)
    v_add_f32 v10, 1.0, v10
    v_mfma_f32_16x16x32_bf16 v[104:107], v[172:175], a[124:127], v[104:107]
    v_cvt_pk_bf16_f32 v142, v128, v129
    v_mfma_f32_16x16x32_bf16 v[100:103], v[172:175], a[120:123], v[100:103]
    buffer_load_dwordx4 v[244:247], v3, s[20:23], s58 offen offset:1024
    v_mfma_f32_16x16x32_bf16 v[96:99], v[172:175], a[116:119], v[96:99]
    v_rcp_f32 v10, v10
    v_mfma_f32_16x16x32_bf16 v[92:95], v[172:175], a[112:115], v[92:95]
    s_waitcnt vmcnt(17)
    v_mul_f32 v11, v115, v115
    v_fma_f32 v11, v11, s35, v7
    v_mfma_f32_16x16x32_bf16 v[76:79], v[176:179], a[128:131], v[76:79]
    v_mul_f32 v11, v11, v115
    v_mfma_f32_16x16x32_bf16 v[80:83], v[176:179], a[132:135], v[80:83]
    buffer_load_dwordx4 v[248:251], v3, s[20:23], s32 offen offset:2048
    v_mfma_f32_16x16x32_bf16 v[84:87], v[176:179], a[136:139], v[84:87]
    v_exp_f32 v11, v11
    v_mfma_f32_16x16x32_bf16 v[88:91], v[176:179], a[140:143], v[88:91]
    s_waitcnt vmcnt(17)
    v_mul_f32 v131, v131, v115
    v_mul_f32 v130, v130, v10
    v_mfma_f32_16x16x32_bf16 v[104:107], v[180:183], a[140:143], v[104:107]
    v_add_f32 v11, 1.0, v11
    v_mfma_f32_16x16x32_bf16 v[100:103], v[180:183], a[136:139], v[100:103]
    buffer_load_dwordx4 v[252:255], v3, s[20:23], s58 offen offset:2048
    v_mfma_f32_16x16x32_bf16 v[96:99], v[180:183], a[132:135], v[96:99]
    v_rcp_f32 v11, v11
    v_mfma_f32_16x16x32_bf16 v[92:95], v[180:183], a[128:131], v[92:95]
    s_waitcnt vmcnt(17)
    v_mul_f32 v10, v116, v116
    v_fma_f32 v10, v10, s35, v7
    v_mfma_f32_16x16x32_bf16 v[76:79], v[184:187], a[144:147], v[76:79]
    s_add_u32 s32, s58, s52
    v_mul_f32 v10, v10, v116
    v_mfma_f32_16x16x32_bf16 v[80:83], v[184:187], a[148:151], v[80:83]
    buffer_load_dwordx4 v[148:151], v3, s[20:23], s32 offen offset:0
    v_mfma_f32_16x16x32_bf16 v[84:87], v[184:187], a[152:155], v[84:87]
    v_exp_f32 v10, v10
    v_mfma_f32_16x16x32_bf16 v[88:91], v[184:187], a[156:159], v[88:91]
    s_waitcnt vmcnt(17)
    v_mul_f32 v132, v132, v116
    v_mul_f32 v131, v131, v11
    v_mfma_f32_16x16x32_bf16 v[104:107], v[188:191], a[156:159], v[104:107]
    s_add_u32 s58, s32, 12288
    v_add_f32 v10, 1.0, v10
    v_cvt_pk_bf16_f32 v143, v130, v131
    v_mfma_f32_16x16x32_bf16 v[100:103], v[188:191], a[152:155], v[100:103]
    buffer_load_dwordx4 v[152:155], v3, s[20:23], s58 offen offset:0
    v_mfma_f32_16x16x32_bf16 v[96:99], v[188:191], a[148:151], v[96:99]
    v_rcp_f32 v10, v10
    v_mfma_f32_16x16x32_bf16 v[92:95], v[188:191], a[144:147], v[92:95]
    s_waitcnt vmcnt(17)
    v_mul_f32 v11, v117, v117
    v_mfma_f32_16x16x32_bf16 v[76:79], v[192:195], a[160:163], v[76:79]
    v_fma_f32 v11, v11, s35, v7
    v_mul_f32 v11, v11, v117
    v_mfma_f32_16x16x32_bf16 v[80:83], v[192:195], a[164:167], v[80:83]
    buffer_load_dwordx4 v[156:159], v3, s[20:23], s32 offen offset:1024
    v_mfma_f32_16x16x32_bf16 v[84:87], v[192:195], a[168:171], v[84:87]
    v_exp_f32 v11, v11
    v_mfma_f32_16x16x32_bf16 v[88:91], v[192:195], a[172:175], v[88:91]
    s_waitcnt vmcnt(17)
    v_mul_f32 v133, v133, v117
    v_mfma_f32_16x16x32_bf16 v[104:107], v[196:199], a[172:175], v[104:107]
    v_mul_f32 v132, v132, v10
    v_add_f32 v11, 1.0, v11
    v_mfma_f32_16x16x32_bf16 v[100:103], v[196:199], a[168:171], v[100:103]
    buffer_load_dwordx4 v[160:163], v3, s[20:23], s58 offen offset:1024
    v_mfma_f32_16x16x32_bf16 v[96:99], v[196:199], a[164:167], v[96:99]
    v_rcp_f32 v11, v11
    v_mfma_f32_16x16x32_bf16 v[92:95], v[196:199], a[160:163], v[92:95]
    s_waitcnt vmcnt(17)
    ds_write_b64 v4, v[142:143] offset:9216
    v_mfma_f32_16x16x32_bf16 v[76:79], v[200:203], a[176:179], v[76:79]
    v_mul_f32 v10, v118, v118
    v_fma_f32 v10, v10, s35, v7
    v_mfma_f32_16x16x32_bf16 v[80:83], v[200:203], a[180:183], v[80:83]
    buffer_load_dwordx4 v[164:167], v3, s[20:23], s32 offen offset:2048
    v_mfma_f32_16x16x32_bf16 v[84:87], v[200:203], a[184:187], v[84:87]
    v_mul_f32 v10, v10, v118
    v_mfma_f32_16x16x32_bf16 v[88:91], v[200:203], a[188:191], v[88:91]
    s_waitcnt vmcnt(17)
    v_exp_f32 v10, v10
    v_mfma_f32_16x16x32_bf16 v[104:107], v[204:207], a[188:191], v[104:107]
    v_mul_f32 v134, v134, v118
    v_mul_f32 v133, v133, v11
    v_mfma_f32_16x16x32_bf16 v[100:103], v[204:207], a[184:187], v[100:103]
    buffer_load_dwordx4 v[168:171], v3, s[20:23], s58 offen offset:2048
    v_mfma_f32_16x16x32_bf16 v[96:99], v[204:207], a[180:183], v[96:99]
    v_add_f32 v10, 1.0, v10
    v_cvt_pk_bf16_f32 v144, v132, v133
    v_mfma_f32_16x16x32_bf16 v[92:95], v[204:207], a[176:179], v[92:95]
    s_waitcnt vmcnt(17)
    v_rcp_f32 v10, v10
    v_mfma_f32_16x16x32_bf16 v[76:79], v[208:211], a[192:195], v[76:79]
    s_add_u32 s32, s58, s53
    v_mul_f32 v11, v119, v119
    v_mfma_f32_16x16x32_bf16 v[80:83], v[208:211], a[196:199], v[80:83]
    buffer_load_dwordx4 v[172:175], v3, s[20:23], s32 offen offset:0
    v_mfma_f32_16x16x32_bf16 v[84:87], v[208:211], a[200:203], v[84:87]
    v_fma_f32 v11, v11, s35, v7
    v_mul_f32 v11, v11, v119
    v_mfma_f32_16x16x32_bf16 v[88:91], v[208:211], a[204:207], v[88:91]
    s_waitcnt vmcnt(17)
    v_exp_f32 v11, v11
    v_mfma_f32_16x16x32_bf16 v[104:107], v[212:215], a[204:207], v[104:107]
    s_add_u32 s58, s32, 12288
    v_mul_f32 v135, v135, v119
    v_mfma_f32_16x16x32_bf16 v[100:103], v[212:215], a[200:203], v[100:103]
    buffer_load_dwordx4 v[176:179], v3, s[20:23], s58 offen offset:0
    v_mfma_f32_16x16x32_bf16 v[96:99], v[212:215], a[196:199], v[96:99]
    v_mul_f32 v134, v134, v10
    v_add_f32 v11, 1.0, v11
    v_mfma_f32_16x16x32_bf16 v[92:95], v[212:215], a[192:195], v[92:95]
    s_waitcnt vmcnt(17)
    v_rcp_f32 v11, v11
    v_mfma_f32_16x16x32_bf16 v[76:79], v[216:219], a[208:211], v[76:79]
    v_mul_f32 v10, v120, v120
    v_mfma_f32_16x16x32_bf16 v[80:83], v[216:219], a[212:215], v[80:83]
    buffer_load_dwordx4 v[180:183], v3, s[20:23], s32 offen offset:1024
    v_mfma_f32_16x16x32_bf16 v[84:87], v[216:219], a[216:219], v[84:87]
    v_fma_f32 v10, v10, s35, v7
    v_mul_f32 v10, v10, v120
    v_mfma_f32_16x16x32_bf16 v[88:91], v[216:219], a[220:223], v[88:91]
    s_waitcnt vmcnt(17)
    v_exp_f32 v10, v10
    v_mfma_f32_16x16x32_bf16 v[104:107], v[220:223], a[220:223], v[104:107]
    v_mul_f32 v136, v136, v120
    v_mfma_f32_16x16x32_bf16 v[100:103], v[220:223], a[216:219], v[100:103]
    buffer_load_dwordx4 v[184:187], v3, s[20:23], s58 offen offset:1024
    v_mfma_f32_16x16x32_bf16 v[96:99], v[220:223], a[212:215], v[96:99]
    v_mul_f32 v135, v135, v11
    v_add_f32 v10, 1.0, v10
    v_mfma_f32_16x16x32_bf16 v[92:95], v[220:223], a[208:211], v[92:95]
    s_waitcnt vmcnt(17)
    v_cvt_pk_bf16_f32 v145, v134, v135
    v_mfma_f32_16x16x32_bf16 v[76:79], v[224:227], a[224:227], v[76:79]
    v_rcp_f32 v10, v10
    v_mfma_f32_16x16x32_bf16 v[80:83], v[224:227], a[228:231], v[80:83]
    buffer_load_dwordx4 v[188:191], v3, s[20:23], s32 offen offset:2048
    v_mfma_f32_16x16x32_bf16 v[84:87], v[224:227], a[232:235], v[84:87]
    v_mul_f32 v11, v121, v121
    v_fma_f32 v11, v11, s35, v7
    v_mfma_f32_16x16x32_bf16 v[88:91], v[224:227], a[236:239], v[88:91]
    s_waitcnt vmcnt(17)
    v_mul_f32 v11, v11, v121
    v_mfma_f32_16x16x32_bf16 v[104:107], v[228:231], a[236:239], v[104:107]
    v_exp_f32 v11, v11
    v_mfma_f32_16x16x32_bf16 v[100:103], v[228:231], a[232:235], v[100:103]
    buffer_load_dwordx4 v[192:195], v3, s[20:23], s58 offen offset:2048
    v_mfma_f32_16x16x32_bf16 v[96:99], v[228:231], a[228:231], v[96:99]
    v_mul_f32 v137, v137, v121
    v_mul_f32 v136, v136, v10
    v_mfma_f32_16x16x32_bf16 v[92:95], v[228:231], a[224:227], v[92:95]
    s_waitcnt vmcnt(17)
    v_add_f32 v11, 1.0, v11
    v_mfma_f32_16x16x32_bf16 v[76:79], v[232:235], a[240:243], v[76:79]
    s_add_u32 s32, s58, s54
    v_rcp_f32 v11, v11
    v_mfma_f32_16x16x32_bf16 v[80:83], v[232:235], a[244:247], v[80:83]
    buffer_load_dwordx4 v[196:199], v3, s[20:23], s32 offen offset:0
    v_mfma_f32_16x16x32_bf16 v[84:87], v[232:235], a[248:251], v[84:87]
    ds_write_b64 v4, v[144:145] offset:10240
    v_mul_f32 v10, v122, v122
    v_mfma_f32_16x16x32_bf16 v[88:91], v[232:235], a[252:255], v[88:91]
    s_waitcnt vmcnt(17)
    v_fma_f32 v10, v10, s35, v7
    v_mul_f32 v10, v10, v122
    v_mfma_f32_16x16x32_bf16 v[104:107], v[236:239], a[252:255], v[104:107]
    s_add_u32 s58, s32, 12288
    v_exp_f32 v10, v10
    v_mfma_f32_16x16x32_bf16 v[100:103], v[236:239], a[248:251], v[100:103]
    buffer_load_dwordx4 v[200:203], v3, s[20:23], s58 offen offset:0
    v_mfma_f32_16x16x32_bf16 v[96:99], v[236:239], a[244:247], v[96:99]
    v_mul_f32 v138, v138, v122
    v_mfma_f32_16x16x32_bf16 v[92:95], v[236:239], a[240:243], v[92:95]
    s_waitcnt vmcnt(17)
    v_mul_f32 v137, v137, v11
    v_add_f32 v10, 1.0, v10
    v_mfma_f32_16x16x32_bf16 v[76:79], v[240:243], v[12:15], v[76:79]
    v_cvt_pk_bf16_f32 v146, v136, v137
    v_mfma_f32_16x16x32_bf16 v[80:83], v[240:243], v[16:19], v[80:83]
    buffer_load_dwordx4 v[204:207], v3, s[20:23], s32 offen offset:1024
    v_mfma_f32_16x16x32_bf16 v[84:87], v[240:243], v[20:23], v[84:87]
    v_rcp_f32 v10, v10
    v_mfma_f32_16x16x32_bf16 v[88:91], v[240:243], v[24:27], v[88:91]
    s_waitcnt vmcnt(17)
    v_mul_f32 v11, v123, v123
    v_fma_f32 v11, v11, s35, v7
    v_mfma_f32_16x16x32_bf16 v[104:107], v[244:247], v[24:27], v[104:107]
    v_mul_f32 v11, v11, v123
    v_mfma_f32_16x16x32_bf16 v[100:103], v[244:247], v[20:23], v[100:103]
    buffer_load_dwordx4 v[208:211], v3, s[20:23], s58 offen offset:1024
    v_mfma_f32_16x16x32_bf16 v[96:99], v[244:247], v[16:19], v[96:99]
    v_exp_f32 v11, v11
    v_mfma_f32_16x16x32_bf16 v[92:95], v[244:247], v[12:15], v[92:95]
    s_waitcnt vmcnt(17)
    v_mul_f32 v139, v139, v123
    v_mul_f32 v138, v138, v10
    v_mfma_f32_16x16x32_bf16 v[76:79], v[248:251], v[28:31], v[76:79]
    v_add_f32 v11, 1.0, v11
    v_mfma_f32_16x16x32_bf16 v[80:83], v[248:251], v[32:35], v[80:83]
    buffer_load_dwordx4 v[212:215], v3, s[20:23], s32 offen offset:2048
    v_mfma_f32_16x16x32_bf16 v[84:87], v[248:251], v[36:39], v[84:87]
    v_rcp_f32 v11, v11
    v_mfma_f32_16x16x32_bf16 v[88:91], v[248:251], v[40:43], v[88:91]
    s_waitcnt vmcnt(17)
    v_nop
    v_mul_f32 v139, v139, v11
    v_mfma_f32_16x16x32_bf16 v[104:107], v[252:255], v[40:43], v[104:107]
    v_cvt_pk_bf16_f32 v147, v138, v139
    v_mfma_f32_16x16x32_bf16 v[100:103], v[252:255], v[36:39], v[100:103]
    buffer_load_dwordx4 v[216:219], v3, s[20:23], s58 offen offset:2048
    v_mfma_f32_16x16x32_bf16 v[96:99], v[252:255], v[32:35], v[96:99]
    ds_write_b64 v4, v[146:147] offset:11264
    v_nop
    v_mfma_f32_16x16x32_bf16 v[92:95], v[252:255], v[28:31], v[92:95]
    s_waitcnt vmcnt(17)
    v_mfma_f32_16x16x32_bf16 v[108:111], v[148:151], a[0:3], 0
    s_add_u32 s32, s58, s55
    v_mfma_f32_16x16x32_bf16 v[112:115], v[148:151], a[4:7], 0
    buffer_load_dwordx4 v[220:223], v3, s[20:23], s32 offen offset:0
    v_mfma_f32_16x16x32_bf16 v[116:119], v[148:151], a[8:11], 0
    v_mfma_f32_16x16x32_bf16 v[120:123], v[148:151], a[12:15], 0
    s_waitcnt vmcnt(17)
    v_mfma_f32_16x16x32_bf16 v[136:139], v[152:155], a[12:15], 0
    s_add_u32 s58, s32, 12288
    v_mul_f32 v10, v76, v76
    v_fma_f32 v10, v10, s35, v7
    v_mfma_f32_16x16x32_bf16 v[132:135], v[152:155], a[8:11], 0
    buffer_load_dwordx4 v[224:227], v3, s[20:23], s58 offen offset:0
    v_mfma_f32_16x16x32_bf16 v[128:131], v[152:155], a[4:7], 0
    v_mul_f32 v10, v10, v76
    v_mfma_f32_16x16x32_bf16 v[124:127], v[152:155], a[0:3], 0
    s_waitcnt vmcnt(17)
    v_exp_f32 v10, v10
    v_mfma_f32_16x16x32_bf16 v[108:111], v[156:159], a[16:19], v[108:111]
    v_mul_f32 v92, v92, v76
    v_add_f32 v10, 1.0, v10
    v_mfma_f32_16x16x32_bf16 v[112:115], v[156:159], a[20:23], v[112:115]
    buffer_load_dwordx4 v[228:231], v3, s[20:23], s32 offen offset:1024
    v_mfma_f32_16x16x32_bf16 v[116:119], v[156:159], a[24:27], v[116:119]
    v_rcp_f32 v10, v10
    v_mfma_f32_16x16x32_bf16 v[120:123], v[156:159], a[28:31], v[120:123]
    s_waitcnt vmcnt(17)
    v_mul_f32 v11, v77, v77
    v_mfma_f32_16x16x32_bf16 v[136:139], v[160:163], a[28:31], v[136:139]
    v_fma_f32 v11, v11, s35, v7
    v_mul_f32 v11, v11, v77
    v_mfma_f32_16x16x32_bf16 v[132:135], v[160:163], a[24:27], v[132:135]
    buffer_load_dwordx4 v[232:235], v3, s[20:23], s58 offen offset:1024
    v_mfma_f32_16x16x32_bf16 v[128:131], v[160:163], a[20:23], v[128:131]
    v_exp_f32 v11, v11
    v_mfma_f32_16x16x32_bf16 v[124:127], v[160:163], a[16:19], v[124:127]
    s_waitcnt vmcnt(17)
    v_mul_f32 v93, v93, v77
    v_mfma_f32_16x16x32_bf16 v[108:111], v[164:167], a[32:35], v[108:111]
    v_mul_f32 v92, v92, v10
    v_add_f32 v11, 1.0, v11
    v_mfma_f32_16x16x32_bf16 v[112:115], v[164:167], a[36:39], v[112:115]
    buffer_load_dwordx4 v[236:239], v3, s[20:23], s32 offen offset:2048
    v_mfma_f32_16x16x32_bf16 v[116:119], v[164:167], a[40:43], v[116:119]
    v_rcp_f32 v11, v11
    v_mfma_f32_16x16x32_bf16 v[120:123], v[164:167], a[44:47], v[120:123]
    s_waitcnt vmcnt(17)
    v_mul_f32 v10, v78, v78
    v_mfma_f32_16x16x32_bf16 v[136:139], v[168:171], a[44:47], v[136:139]
    v_fma_f32 v10, v10, s35, v7
    v_mul_f32 v10, v10, v78
    v_mfma_f32_16x16x32_bf16 v[132:135], v[168:171], a[40:43], v[132:135]
    buffer_load_dwordx4 v[240:243], v3, s[20:23], s58 offen offset:2048
    v_mfma_f32_16x16x32_bf16 v[128:131], v[168:171], a[36:39], v[128:131]
    v_exp_f32 v10, v10
    v_mfma_f32_16x16x32_bf16 v[124:127], v[168:171], a[32:35], v[124:127]
    s_waitcnt vmcnt(17)
    v_mul_f32 v94, v94, v78
    v_mfma_f32_16x16x32_bf16 v[108:111], v[172:175], a[48:51], v[108:111]
    s_add_u32 s32, s58, s56
    v_mul_f32 v93, v93, v11
    v_add_f32 v10, 1.0, v10
    v_mfma_f32_16x16x32_bf16 v[112:115], v[172:175], a[52:55], v[112:115]
    buffer_load_dwordx4 v[244:247], v3, s[20:23], s32 offen offset:0
    v_mfma_f32_16x16x32_bf16 v[116:119], v[172:175], a[56:59], v[116:119]
    v_cvt_pk_bf16_f32 v140, v92, v93
    v_mfma_f32_16x16x32_bf16 v[120:123], v[172:175], a[60:63], v[120:123]
    s_waitcnt vmcnt(17)
    v_rcp_f32 v10, v10
    v_mfma_f32_16x16x32_bf16 v[136:139], v[176:179], a[60:63], v[136:139]
    s_add_u32 s58, s32, 12288
    v_mul_f32 v11, v79, v79
    v_fma_f32 v11, v11, s35, v7
    v_mfma_f32_16x16x32_bf16 v[132:135], v[176:179], a[56:59], v[132:135]
    buffer_load_dwordx4 v[248:251], v3, s[20:23], s58 offen offset:0
    v_mfma_f32_16x16x32_bf16 v[128:131], v[176:179], a[52:55], v[128:131]
    v_mul_f32 v11, v11, v79
    v_mfma_f32_16x16x32_bf16 v[124:127], v[176:179], a[48:51], v[124:127]
    s_waitcnt vmcnt(17)
    v_exp_f32 v11, v11
    v_mfma_f32_16x16x32_bf16 v[108:111], v[180:183], a[64:67], v[108:111]
    v_mul_f32 v95, v95, v79
    v_mul_f32 v94, v94, v10
    v_mfma_f32_16x16x32_bf16 v[112:115], v[180:183], a[68:71], v[112:115]
    buffer_load_dwordx4 v[252:255], v3, s[20:23], s32 offen offset:1024
    v_mfma_f32_16x16x32_bf16 v[116:119], v[180:183], a[72:75], v[116:119]
    v_add_f32 v11, 1.0, v11
    v_mfma_f32_16x16x32_bf16 v[120:123], v[180:183], a[76:79], v[120:123]
    s_waitcnt vmcnt(17)
    v_rcp_f32 v11, v11
    v_mfma_f32_16x16x32_bf16 v[136:139], v[184:187], a[76:79], v[136:139]
    v_mul_f32 v10, v80, v80
    v_fma_f32 v10, v10, s35, v7
    v_mfma_f32_16x16x32_bf16 v[132:135], v[184:187], a[72:75], v[132:135]
    buffer_load_dwordx4 v[148:151], v3, s[20:23], s58 offen offset:1024
    v_mfma_f32_16x16x32_bf16 v[128:131], v[184:187], a[68:71], v[128:131]
    v_mul_f32 v10, v10, v80
    v_mfma_f32_16x16x32_bf16 v[124:127], v[184:187], a[64:67], v[124:127]
    s_waitcnt vmcnt(17)
    v_exp_f32 v10, v10
    v_mfma_f32_16x16x32_bf16 v[108:111], v[188:191], a[80:83], v[108:111]
    v_mul_f32 v96, v96, v80
    v_mul_f32 v95, v95, v11
    v_mfma_f32_16x16x32_bf16 v[112:115], v[188:191], a[84:87], v[112:115]
    buffer_load_dwordx4 v[152:155], v3, s[20:23], s32 offen offset:2048
    v_mfma_f32_16x16x32_bf16 v[116:119], v[188:191], a[88:91], v[116:119]
    v_add_f32 v10, 1.0, v10
    v_cvt_pk_bf16_f32 v141, v94, v95
    v_mfma_f32_16x16x32_bf16 v[120:123], v[188:191], a[92:95], v[120:123]
    s_waitcnt vmcnt(17)
    v_rcp_f32 v10, v10
    v_mfma_f32_16x16x32_bf16 v[136:139], v[192:195], a[92:95], v[136:139]
    v_mul_f32 v11, v81, v81
    v_mfma_f32_16x16x32_bf16 v[132:135], v[192:195], a[88:91], v[132:135]
    buffer_load_dwordx4 v[156:159], v3, s[20:23], s58 offen offset:2048
    v_mfma_f32_16x16x32_bf16 v[128:131], v[192:195], a[84:87], v[128:131]
    v_fma_f32 v11, v11, s35, v7
    v_mul_f32 v11, v11, v81
    v_mfma_f32_16x16x32_bf16 v[124:127], v[192:195], a[80:83], v[124:127]
    s_waitcnt vmcnt(17)
    v_exp_f32 v11, v11
    v_mfma_f32_16x16x32_bf16 v[108:111], v[196:199], a[96:99], v[108:111]
    s_add_u32 s32, s58, s57
    v_mul_f32 v97, v97, v81
    v_mfma_f32_16x16x32_bf16 v[112:115], v[196:199], a[100:103], v[112:115]
    buffer_load_dwordx4 v[160:163], v3, s[20:23], s32 offen offset:0
    v_mfma_f32_16x16x32_bf16 v[116:119], v[196:199], a[104:107], v[116:119]
    v_mul_f32 v96, v96, v10
    v_add_f32 v11, 1.0, v11
    v_mfma_f32_16x16x32_bf16 v[120:123], v[196:199], a[108:111], v[120:123]
    s_waitcnt vmcnt(17)
    v_rcp_f32 v11, v11
    v_mfma_f32_16x16x32_bf16 v[136:139], v[200:203], a[108:111], v[136:139]
    s_add_u32 s58, s32, 12288
    ds_write_b64 v4, v[140:141] offset:16384
    v_mfma_f32_16x16x32_bf16 v[132:135], v[200:203], a[104:107], v[132:135]
    buffer_load_dwordx4 v[164:167], v3, s[20:23], s58 offen offset:0
    v_mfma_f32_16x16x32_bf16 v[128:131], v[200:203], a[100:103], v[128:131]
    v_mul_f32 v10, v82, v82
    v_fma_f32 v10, v10, s35, v7
    v_mfma_f32_16x16x32_bf16 v[124:127], v[200:203], a[96:99], v[124:127]
    s_waitcnt vmcnt(17)
    v_mul_f32 v10, v10, v82
    v_mfma_f32_16x16x32_bf16 v[108:111], v[204:207], a[112:115], v[108:111]
    v_exp_f32 v10, v10
    v_mfma_f32_16x16x32_bf16 v[112:115], v[204:207], a[116:119], v[112:115]
    buffer_load_dwordx4 v[168:171], v3, s[20:23], s32 offen offset:1024
    v_mfma_f32_16x16x32_bf16 v[116:119], v[204:207], a[120:123], v[116:119]
    v_mul_f32 v98, v98, v82
    v_mul_f32 v97, v97, v11
    v_mfma_f32_16x16x32_bf16 v[120:123], v[204:207], a[124:127], v[120:123]
    s_waitcnt vmcnt(17)
    v_add_f32 v10, 1.0, v10
    v_mfma_f32_16x16x32_bf16 v[136:139], v[208:211], a[124:127], v[136:139]
    v_cvt_pk_bf16_f32 v142, v96, v97
    v_mfma_f32_16x16x32_bf16 v[132:135], v[208:211], a[120:123], v[132:135]
    buffer_load_dwordx4 v[172:175], v3, s[20:23], s58 offen offset:1024
    v_mfma_f32_16x16x32_bf16 v[128:131], v[208:211], a[116:119], v[128:131]
    v_rcp_f32 v10, v10
    v_mfma_f32_16x16x32_bf16 v[124:127], v[208:211], a[112:115], v[124:127]
    s_waitcnt vmcnt(17)
    v_mul_f32 v11, v83, v83
    v_fma_f32 v11, v11, s35, v7
    v_mfma_f32_16x16x32_bf16 v[108:111], v[212:215], a[128:131], v[108:111]
    v_mul_f32 v11, v11, v83
    v_mfma_f32_16x16x32_bf16 v[112:115], v[212:215], a[132:135], v[112:115]
    buffer_load_dwordx4 v[176:179], v3, s[20:23], s32 offen offset:2048
    v_mfma_f32_16x16x32_bf16 v[116:119], v[212:215], a[136:139], v[116:119]
    v_exp_f32 v11, v11
    v_mfma_f32_16x16x32_bf16 v[120:123], v[212:215], a[140:143], v[120:123]
    s_waitcnt vmcnt(17)
    v_mul_f32 v99, v99, v83
    v_mul_f32 v98, v98, v10
    v_mfma_f32_16x16x32_bf16 v[136:139], v[216:219], a[140:143], v[136:139]
    v_add_f32 v11, 1.0, v11
    v_mfma_f32_16x16x32_bf16 v[132:135], v[216:219], a[136:139], v[132:135]
    buffer_load_dwordx4 v[180:183], v3, s[20:23], s58 offen offset:2048
    v_mfma_f32_16x16x32_bf16 v[128:131], v[216:219], a[132:135], v[128:131]
    v_rcp_f32 v11, v11
    v_mfma_f32_16x16x32_bf16 v[124:127], v[216:219], a[128:131], v[124:127]
    s_waitcnt vmcnt(17)
    v_mul_f32 v10, v84, v84
    v_fma_f32 v10, v10, s35, v7
    v_mfma_f32_16x16x32_bf16 v[108:111], v[220:223], a[144:147], v[108:111]
    s_add_u32 s32, s58, s52
    v_mul_f32 v10, v10, v84
    v_mfma_f32_16x16x32_bf16 v[112:115], v[220:223], a[148:151], v[112:115]
    buffer_load_dwordx4 v[184:187], v3, s[20:23], s32 offen offset:0
    v_mfma_f32_16x16x32_bf16 v[116:119], v[220:223], a[152:155], v[116:119]
    v_exp_f32 v10, v10
    v_mfma_f32_16x16x32_bf16 v[120:123], v[220:223], a[156:159], v[120:123]
    s_waitcnt vmcnt(17)
    v_mul_f32 v100, v100, v84
    v_mul_f32 v99, v99, v11
    v_mfma_f32_16x16x32_bf16 v[136:139], v[224:227], a[156:159], v[136:139]
    s_add_u32 s58, s32, 12288
    v_add_f32 v10, 1.0, v10
    v_cvt_pk_bf16_f32 v143, v98, v99
    v_mfma_f32_16x16x32_bf16 v[132:135], v[224:227], a[152:155], v[132:135]
    buffer_load_dwordx4 v[188:191], v3, s[20:23], s58 offen offset:0
    v_mfma_f32_16x16x32_bf16 v[128:131], v[224:227], a[148:151], v[128:131]
    v_rcp_f32 v10, v10
    v_mfma_f32_16x16x32_bf16 v[124:127], v[224:227], a[144:147], v[124:127]
    s_waitcnt vmcnt(17)
    v_mul_f32 v11, v85, v85
    v_mfma_f32_16x16x32_bf16 v[108:111], v[228:231], a[160:163], v[108:111]
    v_fma_f32 v11, v11, s35, v7
    v_mul_f32 v11, v11, v85
    v_mfma_f32_16x16x32_bf16 v[112:115], v[228:231], a[164:167], v[112:115]
    buffer_load_dwordx4 v[192:195], v3, s[20:23], s32 offen offset:1024
    v_mfma_f32_16x16x32_bf16 v[116:119], v[228:231], a[168:171], v[116:119]
    v_exp_f32 v11, v11
    v_mfma_f32_16x16x32_bf16 v[120:123], v[228:231], a[172:175], v[120:123]
    s_waitcnt vmcnt(17)
    v_mul_f32 v101, v101, v85
    v_mfma_f32_16x16x32_bf16 v[136:139], v[232:235], a[172:175], v[136:139]
    v_mul_f32 v100, v100, v10
    v_add_f32 v11, 1.0, v11
    v_mfma_f32_16x16x32_bf16 v[132:135], v[232:235], a[168:171], v[132:135]
    buffer_load_dwordx4 v[196:199], v3, s[20:23], s58 offen offset:1024
    v_mfma_f32_16x16x32_bf16 v[128:131], v[232:235], a[164:167], v[128:131]
    v_rcp_f32 v11, v11
    v_mfma_f32_16x16x32_bf16 v[124:127], v[232:235], a[160:163], v[124:127]
    s_waitcnt vmcnt(17)
    ds_write_b64 v4, v[142:143] offset:17408
    v_mfma_f32_16x16x32_bf16 v[108:111], v[236:239], a[176:179], v[108:111]
    v_mul_f32 v10, v86, v86
    v_fma_f32 v10, v10, s35, v7
    v_mfma_f32_16x16x32_bf16 v[112:115], v[236:239], a[180:183], v[112:115]
    buffer_load_dwordx4 v[200:203], v3, s[20:23], s32 offen offset:2048
    v_mfma_f32_16x16x32_bf16 v[116:119], v[236:239], a[184:187], v[116:119]
    v_mul_f32 v10, v10, v86
    v_mfma_f32_16x16x32_bf16 v[120:123], v[236:239], a[188:191], v[120:123]
    s_waitcnt vmcnt(17)
    v_exp_f32 v10, v10
    v_mfma_f32_16x16x32_bf16 v[136:139], v[240:243], a[188:191], v[136:139]
    v_mul_f32 v102, v102, v86
    v_mul_f32 v101, v101, v11
    v_mfma_f32_16x16x32_bf16 v[132:135], v[240:243], a[184:187], v[132:135]
    buffer_load_dwordx4 v[204:207], v3, s[20:23], s58 offen offset:2048
    v_mfma_f32_16x16x32_bf16 v[128:131], v[240:243], a[180:183], v[128:131]
    v_add_f32 v10, 1.0, v10
    v_cvt_pk_bf16_f32 v144, v100, v101
    v_mfma_f32_16x16x32_bf16 v[124:127], v[240:243], a[176:179], v[124:127]
    s_waitcnt vmcnt(17)
    v_rcp_f32 v10, v10
    v_mfma_f32_16x16x32_bf16 v[108:111], v[244:247], a[192:195], v[108:111]
    s_add_u32 s32, s58, s53
    v_mul_f32 v11, v87, v87
    v_mfma_f32_16x16x32_bf16 v[112:115], v[244:247], a[196:199], v[112:115]
    buffer_load_dwordx4 v[208:211], v3, s[20:23], s32 offen offset:0
    v_mfma_f32_16x16x32_bf16 v[116:119], v[244:247], a[200:203], v[116:119]
    v_fma_f32 v11, v11, s35, v7
    v_mul_f32 v11, v11, v87
    v_mfma_f32_16x16x32_bf16 v[120:123], v[244:247], a[204:207], v[120:123]
    s_waitcnt vmcnt(17)
    v_exp_f32 v11, v11
    v_mfma_f32_16x16x32_bf16 v[136:139], v[248:251], a[204:207], v[136:139]
    s_add_u32 s58, s32, 12288
    v_mul_f32 v103, v103, v87
    v_mfma_f32_16x16x32_bf16 v[132:135], v[248:251], a[200:203], v[132:135]
    buffer_load_dwordx4 v[212:215], v3, s[20:23], s58 offen offset:0
    v_mfma_f32_16x16x32_bf16 v[128:131], v[248:251], a[196:199], v[128:131]
    v_mul_f32 v102, v102, v10
    v_add_f32 v11, 1.0, v11
    v_mfma_f32_16x16x32_bf16 v[124:127], v[248:251], a[192:195], v[124:127]
    s_waitcnt vmcnt(17)
    v_rcp_f32 v11, v11
    v_mfma_f32_16x16x32_bf16 v[108:111], v[252:255], a[208:211], v[108:111]
    v_mul_f32 v10, v88, v88
    v_mfma_f32_16x16x32_bf16 v[112:115], v[252:255], a[212:215], v[112:115]
    buffer_load_dwordx4 v[216:219], v3, s[20:23], s32 offen offset:1024
    v_mfma_f32_16x16x32_bf16 v[116:119], v[252:255], a[216:219], v[116:119]
    v_fma_f32 v10, v10, s35, v7
    v_mul_f32 v10, v10, v88
    v_mfma_f32_16x16x32_bf16 v[120:123], v[252:255], a[220:223], v[120:123]
    s_waitcnt vmcnt(17)
    v_exp_f32 v10, v10
    v_mfma_f32_16x16x32_bf16 v[136:139], v[148:151], a[220:223], v[136:139]
    v_mul_f32 v104, v104, v88
    v_mfma_f32_16x16x32_bf16 v[132:135], v[148:151], a[216:219], v[132:135]
    buffer_load_dwordx4 v[220:223], v3, s[20:23], s58 offen offset:1024
    v_mfma_f32_16x16x32_bf16 v[128:131], v[148:151], a[212:215], v[128:131]
    v_mul_f32 v103, v103, v11
    v_add_f32 v10, 1.0, v10
    v_mfma_f32_16x16x32_bf16 v[124:127], v[148:151], a[208:211], v[124:127]
    s_waitcnt vmcnt(17)
    v_cvt_pk_bf16_f32 v145, v102, v103
    v_mfma_f32_16x16x32_bf16 v[108:111], v[152:155], a[224:227], v[108:111]
    v_rcp_f32 v10, v10
    v_mfma_f32_16x16x32_bf16 v[112:115], v[152:155], a[228:231], v[112:115]
    buffer_load_dwordx4 v[224:227], v3, s[20:23], s32 offen offset:2048
    v_mfma_f32_16x16x32_bf16 v[116:119], v[152:155], a[232:235], v[116:119]
    v_mul_f32 v11, v89, v89
    v_fma_f32 v11, v11, s35, v7
    v_mfma_f32_16x16x32_bf16 v[120:123], v[152:155], a[236:239], v[120:123]
    s_waitcnt vmcnt(17)
    v_mul_f32 v11, v11, v89
    v_mfma_f32_16x16x32_bf16 v[136:139], v[156:159], a[236:239], v[136:139]
    v_exp_f32 v11, v11
    v_mfma_f32_16x16x32_bf16 v[132:135], v[156:159], a[232:235], v[132:135]
    buffer_load_dwordx4 v[228:231], v3, s[20:23], s58 offen offset:2048
    v_mfma_f32_16x16x32_bf16 v[128:131], v[156:159], a[228:231], v[128:131]
    v_mul_f32 v105, v105, v89
    v_mul_f32 v104, v104, v10
    v_mfma_f32_16x16x32_bf16 v[124:127], v[156:159], a[224:227], v[124:127]
    s_waitcnt vmcnt(17)
    v_add_f32 v11, 1.0, v11
    v_mfma_f32_16x16x32_bf16 v[108:111], v[160:163], a[240:243], v[108:111]
    s_add_u32 s32, s58, s54
    v_rcp_f32 v11, v11
    v_mfma_f32_16x16x32_bf16 v[112:115], v[160:163], a[244:247], v[112:115]
    buffer_load_dwordx4 v[232:235], v3, s[20:23], s32 offen offset:0
    v_mfma_f32_16x16x32_bf16 v[116:119], v[160:163], a[248:251], v[116:119]
    ds_write_b64 v4, v[144:145] offset:18432
    v_mul_f32 v10, v90, v90
    v_mfma_f32_16x16x32_bf16 v[120:123], v[160:163], a[252:255], v[120:123]
    s_waitcnt vmcnt(17)
    v_fma_f32 v10, v10, s35, v7
    v_mul_f32 v10, v10, v90
    v_mfma_f32_16x16x32_bf16 v[136:139], v[164:167], a[252:255], v[136:139]
    s_add_u32 s58, s32, 12288
    v_exp_f32 v10, v10
    v_mfma_f32_16x16x32_bf16 v[132:135], v[164:167], a[248:251], v[132:135]
    buffer_load_dwordx4 v[236:239], v3, s[20:23], s58 offen offset:0
    v_mfma_f32_16x16x32_bf16 v[128:131], v[164:167], a[244:247], v[128:131]
    v_mul_f32 v106, v106, v90
    v_mfma_f32_16x16x32_bf16 v[124:127], v[164:167], a[240:243], v[124:127]
    s_waitcnt vmcnt(17)
    v_mul_f32 v105, v105, v11
    v_add_f32 v10, 1.0, v10
    v_mfma_f32_16x16x32_bf16 v[108:111], v[168:171], v[12:15], v[108:111]
    v_cvt_pk_bf16_f32 v146, v104, v105
    v_mfma_f32_16x16x32_bf16 v[112:115], v[168:171], v[16:19], v[112:115]
    buffer_load_dwordx4 v[240:243], v3, s[20:23], s32 offen offset:1024
    v_mfma_f32_16x16x32_bf16 v[116:119], v[168:171], v[20:23], v[116:119]
    v_rcp_f32 v10, v10
    v_mfma_f32_16x16x32_bf16 v[120:123], v[168:171], v[24:27], v[120:123]
    s_waitcnt vmcnt(17)
    v_mul_f32 v11, v91, v91
    v_fma_f32 v11, v11, s35, v7
    v_mfma_f32_16x16x32_bf16 v[136:139], v[172:175], v[24:27], v[136:139]
    v_mul_f32 v11, v11, v91
    v_mfma_f32_16x16x32_bf16 v[132:135], v[172:175], v[20:23], v[132:135]
    buffer_load_dwordx4 v[244:247], v3, s[20:23], s58 offen offset:1024
    v_mfma_f32_16x16x32_bf16 v[128:131], v[172:175], v[16:19], v[128:131]
    v_exp_f32 v11, v11
    v_mfma_f32_16x16x32_bf16 v[124:127], v[172:175], v[12:15], v[124:127]
    s_waitcnt vmcnt(17)
    v_mul_f32 v107, v107, v91
    v_mul_f32 v106, v106, v10
    v_mfma_f32_16x16x32_bf16 v[108:111], v[176:179], v[28:31], v[108:111]
    v_add_f32 v11, 1.0, v11
    v_mfma_f32_16x16x32_bf16 v[112:115], v[176:179], v[32:35], v[112:115]
    buffer_load_dwordx4 v[248:251], v3, s[20:23], s32 offen offset:2048
    v_mfma_f32_16x16x32_bf16 v[116:119], v[176:179], v[36:39], v[116:119]
    v_rcp_f32 v11, v11
    v_mfma_f32_16x16x32_bf16 v[120:123], v[176:179], v[40:43], v[120:123]
    s_waitcnt vmcnt(17)
    v_nop
    v_mul_f32 v107, v107, v11
    v_mfma_f32_16x16x32_bf16 v[136:139], v[180:183], v[40:43], v[136:139]
    v_cvt_pk_bf16_f32 v147, v106, v107
    v_mfma_f32_16x16x32_bf16 v[132:135], v[180:183], v[36:39], v[132:135]
    buffer_load_dwordx4 v[252:255], v3, s[20:23], s58 offen offset:2048
    v_mfma_f32_16x16x32_bf16 v[128:131], v[180:183], v[32:35], v[128:131]
    ds_write_b64 v4, v[146:147] offset:19456
    v_nop
    v_mfma_f32_16x16x32_bf16 v[124:127], v[180:183], v[28:31], v[124:127]
    s_waitcnt vmcnt(17)
    v_mfma_f32_16x16x32_bf16 v[76:79], v[184:187], a[0:3], 0
    s_add_u32 s32, s58, s55
    v_mfma_f32_16x16x32_bf16 v[80:83], v[184:187], a[4:7], 0
    buffer_load_dwordx4 v[148:151], v3, s[20:23], s32 offen offset:0
    v_mfma_f32_16x16x32_bf16 v[84:87], v[184:187], a[8:11], 0
    v_mfma_f32_16x16x32_bf16 v[88:91], v[184:187], a[12:15], 0
    s_waitcnt vmcnt(17)
    v_mfma_f32_16x16x32_bf16 v[104:107], v[188:191], a[12:15], 0
    s_add_u32 s58, s32, 12288
    v_mul_f32 v10, v108, v108
    v_fma_f32 v10, v10, s35, v7
    v_mfma_f32_16x16x32_bf16 v[100:103], v[188:191], a[8:11], 0
    buffer_load_dwordx4 v[152:155], v3, s[20:23], s58 offen offset:0
    v_mfma_f32_16x16x32_bf16 v[96:99], v[188:191], a[4:7], 0
    v_mul_f32 v10, v10, v108
    v_mfma_f32_16x16x32_bf16 v[92:95], v[188:191], a[0:3], 0
    s_waitcnt vmcnt(17)
    v_exp_f32 v10, v10
    v_mfma_f32_16x16x32_bf16 v[76:79], v[192:195], a[16:19], v[76:79]
    v_mul_f32 v124, v124, v108
    v_add_f32 v10, 1.0, v10
    v_mfma_f32_16x16x32_bf16 v[80:83], v[192:195], a[20:23], v[80:83]
    buffer_load_dwordx4 v[156:159], v3, s[20:23], s32 offen offset:1024
    v_mfma_f32_16x16x32_bf16 v[84:87], v[192:195], a[24:27], v[84:87]
    v_rcp_f32 v10, v10
    v_mfma_f32_16x16x32_bf16 v[88:91], v[192:195], a[28:31], v[88:91]
    s_waitcnt vmcnt(17)
    v_mul_f32 v11, v109, v109
    v_mfma_f32_16x16x32_bf16 v[104:107], v[196:199], a[28:31], v[104:107]
    v_fma_f32 v11, v11, s35, v7
    v_mul_f32 v11, v11, v109
    v_mfma_f32_16x16x32_bf16 v[100:103], v[196:199], a[24:27], v[100:103]
    buffer_load_dwordx4 v[160:163], v3, s[20:23], s58 offen offset:1024
    v_mfma_f32_16x16x32_bf16 v[96:99], v[196:199], a[20:23], v[96:99]
    v_exp_f32 v11, v11
    v_mfma_f32_16x16x32_bf16 v[92:95], v[196:199], a[16:19], v[92:95]
    s_waitcnt vmcnt(17)
    v_mul_f32 v125, v125, v109
    v_mfma_f32_16x16x32_bf16 v[76:79], v[200:203], a[32:35], v[76:79]
    v_mul_f32 v124, v124, v10
    v_add_f32 v11, 1.0, v11
    v_mfma_f32_16x16x32_bf16 v[80:83], v[200:203], a[36:39], v[80:83]
    buffer_load_dwordx4 v[164:167], v3, s[20:23], s32 offen offset:2048
    v_mfma_f32_16x16x32_bf16 v[84:87], v[200:203], a[40:43], v[84:87]
    v_rcp_f32 v11, v11
    v_mfma_f32_16x16x32_bf16 v[88:91], v[200:203], a[44:47], v[88:91]
    s_waitcnt vmcnt(17)
    v_mul_f32 v10, v110, v110
    v_mfma_f32_16x16x32_bf16 v[104:107], v[204:207], a[44:47], v[104:107]
    v_fma_f32 v10, v10, s35, v7
    v_mul_f32 v10, v10, v110
    v_mfma_f32_16x16x32_bf16 v[100:103], v[204:207], a[40:43], v[100:103]
    buffer_load_dwordx4 v[168:171], v3, s[20:23], s58 offen offset:2048
    v_mfma_f32_16x16x32_bf16 v[96:99], v[204:207], a[36:39], v[96:99]
    v_exp_f32 v10, v10
    v_mfma_f32_16x16x32_bf16 v[92:95], v[204:207], a[32:35], v[92:95]
    s_waitcnt vmcnt(17)
    v_mul_f32 v126, v126, v110
    v_mfma_f32_16x16x32_bf16 v[76:79], v[208:211], a[48:51], v[76:79]
    s_add_u32 s32, s58, s56
    v_mul_f32 v125, v125, v11
    v_add_f32 v10, 1.0, v10
    v_mfma_f32_16x16x32_bf16 v[80:83], v[208:211], a[52:55], v[80:83]
    buffer_load_dwordx4 v[172:175], v3, s[20:23], s32 offen offset:0
    v_mfma_f32_16x16x32_bf16 v[84:87], v[208:211], a[56:59], v[84:87]
    v_cvt_pk_bf16_f32 v140, v124, v125
    v_mfma_f32_16x16x32_bf16 v[88:91], v[208:211], a[60:63], v[88:91]
    s_waitcnt vmcnt(17)
    v_rcp_f32 v10, v10
    v_mfma_f32_16x16x32_bf16 v[104:107], v[212:215], a[60:63], v[104:107]
    s_add_u32 s58, s32, 12288
    v_mul_f32 v11, v111, v111
    v_fma_f32 v11, v11, s35, v7
    v_mfma_f32_16x16x32_bf16 v[100:103], v[212:215], a[56:59], v[100:103]
    buffer_load_dwordx4 v[176:179], v3, s[20:23], s58 offen offset:0
    v_mfma_f32_16x16x32_bf16 v[96:99], v[212:215], a[52:55], v[96:99]
    v_mul_f32 v11, v11, v111
    v_mfma_f32_16x16x32_bf16 v[92:95], v[212:215], a[48:51], v[92:95]
    s_waitcnt vmcnt(17)
    v_exp_f32 v11, v11
    v_mfma_f32_16x16x32_bf16 v[76:79], v[216:219], a[64:67], v[76:79]
    v_mul_f32 v127, v127, v111
    v_mul_f32 v126, v126, v10
    v_mfma_f32_16x16x32_bf16 v[80:83], v[216:219], a[68:71], v[80:83]
    buffer_load_dwordx4 v[180:183], v3, s[20:23], s32 offen offset:1024
    v_mfma_f32_16x16x32_bf16 v[84:87], v[216:219], a[72:75], v[84:87]
    v_add_f32 v11, 1.0, v11
    v_mfma_f32_16x16x32_bf16 v[88:91], v[216:219], a[76:79], v[88:91]
    s_waitcnt vmcnt(17)
    v_rcp_f32 v11, v11
    v_mfma_f32_16x16x32_bf16 v[104:107], v[220:223], a[76:79], v[104:107]
    v_mul_f32 v10, v112, v112
    v_fma_f32 v10, v10, s35, v7
    v_mfma_f32_16x16x32_bf16 v[100:103], v[220:223], a[72:75], v[100:103]
    buffer_load_dwordx4 v[184:187], v3, s[20:23], s58 offen offset:1024
    v_mfma_f32_16x16x32_bf16 v[96:99], v[220:223], a[68:71], v[96:99]
    v_mul_f32 v10, v10, v112
    v_mfma_f32_16x16x32_bf16 v[92:95], v[220:223], a[64:67], v[92:95]
    s_waitcnt vmcnt(17)
    v_exp_f32 v10, v10
    v_mfma_f32_16x16x32_bf16 v[76:79], v[224:227], a[80:83], v[76:79]
    v_mul_f32 v128, v128, v112
    v_mul_f32 v127, v127, v11
    v_mfma_f32_16x16x32_bf16 v[80:83], v[224:227], a[84:87], v[80:83]
    buffer_load_dwordx4 v[188:191], v3, s[20:23], s32 offen offset:2048
    v_mfma_f32_16x16x32_bf16 v[84:87], v[224:227], a[88:91], v[84:87]
    v_add_f32 v10, 1.0, v10
    v_cvt_pk_bf16_f32 v141, v126, v127
    v_mfma_f32_16x16x32_bf16 v[88:91], v[224:227], a[92:95], v[88:91]
    s_waitcnt vmcnt(17)
    v_rcp_f32 v10, v10
    v_mfma_f32_16x16x32_bf16 v[104:107], v[228:231], a[92:95], v[104:107]
    v_mul_f32 v11, v113, v113
    v_mfma_f32_16x16x32_bf16 v[100:103], v[228:231], a[88:91], v[100:103]
    buffer_load_dwordx4 v[192:195], v3, s[20:23], s58 offen offset:2048
    v_mfma_f32_16x16x32_bf16 v[96:99], v[228:231], a[84:87], v[96:99]
    v_fma_f32 v11, v11, s35, v7
    v_mul_f32 v11, v11, v113
    v_mfma_f32_16x16x32_bf16 v[92:95], v[228:231], a[80:83], v[92:95]
    s_waitcnt vmcnt(17)
    v_exp_f32 v11, v11
    v_mfma_f32_16x16x32_bf16 v[76:79], v[232:235], a[96:99], v[76:79]
    s_add_u32 s32, s58, s57
    v_mul_f32 v129, v129, v113
    v_mfma_f32_16x16x32_bf16 v[80:83], v[232:235], a[100:103], v[80:83]
    buffer_load_dwordx4 v[196:199], v3, s[20:23], s32 offen offset:0
    v_mfma_f32_16x16x32_bf16 v[84:87], v[232:235], a[104:107], v[84:87]
    v_mul_f32 v128, v128, v10
    v_add_f32 v11, 1.0, v11
    v_mfma_f32_16x16x32_bf16 v[88:91], v[232:235], a[108:111], v[88:91]
    s_waitcnt vmcnt(17)
    v_rcp_f32 v11, v11
    v_mfma_f32_16x16x32_bf16 v[104:107], v[236:239], a[108:111], v[104:107]
    s_add_u32 s58, s32, 12288
    ds_write_b64 v4, v[140:141] offset:24576
    v_mfma_f32_16x16x32_bf16 v[100:103], v[236:239], a[104:107], v[100:103]
    buffer_load_dwordx4 v[200:203], v3, s[20:23], s58 offen offset:0
    v_mfma_f32_16x16x32_bf16 v[96:99], v[236:239], a[100:103], v[96:99]
    v_mul_f32 v10, v114, v114
    v_fma_f32 v10, v10, s35, v7
    v_mfma_f32_16x16x32_bf16 v[92:95], v[236:239], a[96:99], v[92:95]
    s_waitcnt vmcnt(17)
    v_mul_f32 v10, v10, v114
    v_mfma_f32_16x16x32_bf16 v[76:79], v[240:243], a[112:115], v[76:79]
    v_exp_f32 v10, v10
    v_mfma_f32_16x16x32_bf16 v[80:83], v[240:243], a[116:119], v[80:83]
    buffer_load_dwordx4 v[204:207], v3, s[20:23], s32 offen offset:1024
    v_mfma_f32_16x16x32_bf16 v[84:87], v[240:243], a[120:123], v[84:87]
    v_mul_f32 v130, v130, v114
    v_mul_f32 v129, v129, v11
    v_mfma_f32_16x16x32_bf16 v[88:91], v[240:243], a[124:127], v[88:91]
    s_waitcnt vmcnt(17)
    v_add_f32 v10, 1.0, v10
    v_mfma_f32_16x16x32_bf16 v[104:107], v[244:247], a[124:127], v[104:107]
    v_cvt_pk_bf16_f32 v142, v128, v129
    v_mfma_f32_16x16x32_bf16 v[100:103], v[244:247], a[120:123], v[100:103]
    buffer_load_dwordx4 v[208:211], v3, s[20:23], s58 offen offset:1024
    v_mfma_f32_16x16x32_bf16 v[96:99], v[244:247], a[116:119], v[96:99]
    v_rcp_f32 v10, v10
    v_mfma_f32_16x16x32_bf16 v[92:95], v[244:247], a[112:115], v[92:95]
    s_waitcnt vmcnt(17)
    v_mul_f32 v11, v115, v115
    v_fma_f32 v11, v11, s35, v7
    v_mfma_f32_16x16x32_bf16 v[76:79], v[248:251], a[128:131], v[76:79]
    v_mul_f32 v11, v11, v115
    v_mfma_f32_16x16x32_bf16 v[80:83], v[248:251], a[132:135], v[80:83]
    buffer_load_dwordx4 v[212:215], v3, s[20:23], s32 offen offset:2048
    v_mfma_f32_16x16x32_bf16 v[84:87], v[248:251], a[136:139], v[84:87]
    v_exp_f32 v11, v11
    v_mfma_f32_16x16x32_bf16 v[88:91], v[248:251], a[140:143], v[88:91]
    s_waitcnt vmcnt(17)
    v_mul_f32 v131, v131, v115
    v_mul_f32 v130, v130, v10
    v_mfma_f32_16x16x32_bf16 v[104:107], v[252:255], a[140:143], v[104:107]
    v_add_f32 v11, 1.0, v11
    v_mfma_f32_16x16x32_bf16 v[100:103], v[252:255], a[136:139], v[100:103]
    buffer_load_dwordx4 v[216:219], v3, s[20:23], s58 offen offset:2048
    v_mfma_f32_16x16x32_bf16 v[96:99], v[252:255], a[132:135], v[96:99]
    v_rcp_f32 v11, v11
    v_mfma_f32_16x16x32_bf16 v[92:95], v[252:255], a[128:131], v[92:95]
    s_waitcnt vmcnt(17)
    v_mul_f32 v10, v116, v116
    v_fma_f32 v10, v10, s35, v7
    v_mfma_f32_16x16x32_bf16 v[76:79], v[148:151], a[144:147], v[76:79]
    s_add_u32 s32, s58, s52
    v_mul_f32 v10, v10, v116
    v_mfma_f32_16x16x32_bf16 v[80:83], v[148:151], a[148:151], v[80:83]
    buffer_load_dwordx4 v[220:223], v3, s[20:23], s32 offen offset:0
    v_mfma_f32_16x16x32_bf16 v[84:87], v[148:151], a[152:155], v[84:87]
    v_exp_f32 v10, v10
    v_mfma_f32_16x16x32_bf16 v[88:91], v[148:151], a[156:159], v[88:91]
    s_waitcnt vmcnt(17)
    v_mul_f32 v132, v132, v116
    v_mul_f32 v131, v131, v11
    v_mfma_f32_16x16x32_bf16 v[104:107], v[152:155], a[156:159], v[104:107]
    s_add_u32 s58, s32, 12288
    v_add_f32 v10, 1.0, v10
    v_cvt_pk_bf16_f32 v143, v130, v131
    v_mfma_f32_16x16x32_bf16 v[100:103], v[152:155], a[152:155], v[100:103]
    buffer_load_dwordx4 v[224:227], v3, s[20:23], s58 offen offset:0
    v_mfma_f32_16x16x32_bf16 v[96:99], v[152:155], a[148:151], v[96:99]
    v_rcp_f32 v10, v10
    v_mfma_f32_16x16x32_bf16 v[92:95], v[152:155], a[144:147], v[92:95]
    s_waitcnt vmcnt(17)
    v_mul_f32 v11, v117, v117
    v_mfma_f32_16x16x32_bf16 v[76:79], v[156:159], a[160:163], v[76:79]
    v_fma_f32 v11, v11, s35, v7
    v_mul_f32 v11, v11, v117
    v_mfma_f32_16x16x32_bf16 v[80:83], v[156:159], a[164:167], v[80:83]
    buffer_load_dwordx4 v[228:231], v3, s[20:23], s32 offen offset:1024
    v_mfma_f32_16x16x32_bf16 v[84:87], v[156:159], a[168:171], v[84:87]
    v_exp_f32 v11, v11
    v_mfma_f32_16x16x32_bf16 v[88:91], v[156:159], a[172:175], v[88:91]
    s_waitcnt vmcnt(17)
    v_mul_f32 v133, v133, v117
    v_mfma_f32_16x16x32_bf16 v[104:107], v[160:163], a[172:175], v[104:107]
    v_mul_f32 v132, v132, v10
    v_add_f32 v11, 1.0, v11
    v_mfma_f32_16x16x32_bf16 v[100:103], v[160:163], a[168:171], v[100:103]
    buffer_load_dwordx4 v[232:235], v3, s[20:23], s58 offen offset:1024
    v_mfma_f32_16x16x32_bf16 v[96:99], v[160:163], a[164:167], v[96:99]
    v_rcp_f32 v11, v11
    v_mfma_f32_16x16x32_bf16 v[92:95], v[160:163], a[160:163], v[92:95]
    s_waitcnt vmcnt(17)
    ds_write_b64 v4, v[142:143] offset:25600
    v_mfma_f32_16x16x32_bf16 v[76:79], v[164:167], a[176:179], v[76:79]
    v_mul_f32 v10, v118, v118
    v_fma_f32 v10, v10, s35, v7
    v_mfma_f32_16x16x32_bf16 v[80:83], v[164:167], a[180:183], v[80:83]
    buffer_load_dwordx4 v[236:239], v3, s[20:23], s32 offen offset:2048
    v_mfma_f32_16x16x32_bf16 v[84:87], v[164:167], a[184:187], v[84:87]
    v_mul_f32 v10, v10, v118
    v_mfma_f32_16x16x32_bf16 v[88:91], v[164:167], a[188:191], v[88:91]
    s_waitcnt vmcnt(17)
    v_exp_f32 v10, v10
    v_mfma_f32_16x16x32_bf16 v[104:107], v[168:171], a[188:191], v[104:107]
    v_mul_f32 v134, v134, v118
    v_mul_f32 v133, v133, v11
    v_mfma_f32_16x16x32_bf16 v[100:103], v[168:171], a[184:187], v[100:103]
    buffer_load_dwordx4 v[240:243], v3, s[20:23], s58 offen offset:2048
    v_mfma_f32_16x16x32_bf16 v[96:99], v[168:171], a[180:183], v[96:99]
    v_add_f32 v10, 1.0, v10
    v_cvt_pk_bf16_f32 v144, v132, v133
    v_mfma_f32_16x16x32_bf16 v[92:95], v[168:171], a[176:179], v[92:95]
    s_waitcnt vmcnt(17)
    v_rcp_f32 v10, v10
    v_mfma_f32_16x16x32_bf16 v[76:79], v[172:175], a[192:195], v[76:79]
    s_add_u32 s32, s58, s53
    v_mul_f32 v11, v119, v119
    v_mfma_f32_16x16x32_bf16 v[80:83], v[172:175], a[196:199], v[80:83]
    buffer_load_dwordx4 v[244:247], v3, s[20:23], s32 offen offset:0
    v_mfma_f32_16x16x32_bf16 v[84:87], v[172:175], a[200:203], v[84:87]
    v_fma_f32 v11, v11, s35, v7
    v_mul_f32 v11, v11, v119
    v_mfma_f32_16x16x32_bf16 v[88:91], v[172:175], a[204:207], v[88:91]
    s_waitcnt vmcnt(17)
    v_exp_f32 v11, v11
    v_mfma_f32_16x16x32_bf16 v[104:107], v[176:179], a[204:207], v[104:107]
    s_add_u32 s58, s32, 12288
    v_mul_f32 v135, v135, v119
    v_mfma_f32_16x16x32_bf16 v[100:103], v[176:179], a[200:203], v[100:103]
    buffer_load_dwordx4 v[248:251], v3, s[20:23], s58 offen offset:0
    v_mfma_f32_16x16x32_bf16 v[96:99], v[176:179], a[196:199], v[96:99]
    v_mul_f32 v134, v134, v10
    v_add_f32 v11, 1.0, v11
    v_mfma_f32_16x16x32_bf16 v[92:95], v[176:179], a[192:195], v[92:95]
    s_waitcnt vmcnt(17)
    v_rcp_f32 v11, v11
    v_mfma_f32_16x16x32_bf16 v[76:79], v[180:183], a[208:211], v[76:79]
    v_mul_f32 v10, v120, v120
    v_mfma_f32_16x16x32_bf16 v[80:83], v[180:183], a[212:215], v[80:83]
    buffer_load_dwordx4 v[252:255], v3, s[20:23], s32 offen offset:1024
    v_mfma_f32_16x16x32_bf16 v[84:87], v[180:183], a[216:219], v[84:87]
    v_fma_f32 v10, v10, s35, v7
    v_mul_f32 v10, v10, v120
    v_mfma_f32_16x16x32_bf16 v[88:91], v[180:183], a[220:223], v[88:91]
    s_waitcnt vmcnt(17)
    v_exp_f32 v10, v10
    v_mfma_f32_16x16x32_bf16 v[104:107], v[184:187], a[220:223], v[104:107]
    v_mul_f32 v136, v136, v120
    v_mfma_f32_16x16x32_bf16 v[100:103], v[184:187], a[216:219], v[100:103]
    buffer_load_dwordx4 v[148:151], v3, s[20:23], s58 offen offset:1024
    v_mfma_f32_16x16x32_bf16 v[96:99], v[184:187], a[212:215], v[96:99]
    v_mul_f32 v135, v135, v11
    v_add_f32 v10, 1.0, v10
    v_mfma_f32_16x16x32_bf16 v[92:95], v[184:187], a[208:211], v[92:95]
    s_waitcnt vmcnt(17)
    v_cvt_pk_bf16_f32 v145, v134, v135
    v_mfma_f32_16x16x32_bf16 v[76:79], v[188:191], a[224:227], v[76:79]
    v_rcp_f32 v10, v10
    v_mfma_f32_16x16x32_bf16 v[80:83], v[188:191], a[228:231], v[80:83]
    buffer_load_dwordx4 v[152:155], v3, s[20:23], s32 offen offset:2048
    v_mfma_f32_16x16x32_bf16 v[84:87], v[188:191], a[232:235], v[84:87]
    v_mul_f32 v11, v121, v121
    v_fma_f32 v11, v11, s35, v7
    v_mfma_f32_16x16x32_bf16 v[88:91], v[188:191], a[236:239], v[88:91]
    s_waitcnt vmcnt(17)
    v_mul_f32 v11, v11, v121
    v_mfma_f32_16x16x32_bf16 v[104:107], v[192:195], a[236:239], v[104:107]
    v_exp_f32 v11, v11
    v_mfma_f32_16x16x32_bf16 v[100:103], v[192:195], a[232:235], v[100:103]
    buffer_load_dwordx4 v[156:159], v3, s[20:23], s58 offen offset:2048
    v_mfma_f32_16x16x32_bf16 v[96:99], v[192:195], a[228:231], v[96:99]
    v_mul_f32 v137, v137, v121
    v_mul_f32 v136, v136, v10
    v_mfma_f32_16x16x32_bf16 v[92:95], v[192:195], a[224:227], v[92:95]
    s_waitcnt vmcnt(17)
    v_add_f32 v11, 1.0, v11
    v_mfma_f32_16x16x32_bf16 v[76:79], v[196:199], a[240:243], v[76:79]
    s_add_u32 s32, s58, s54
    v_rcp_f32 v11, v11
    v_mfma_f32_16x16x32_bf16 v[80:83], v[196:199], a[244:247], v[80:83]
    buffer_load_dwordx4 v[160:163], v3, s[20:23], s32 offen offset:0
    v_mfma_f32_16x16x32_bf16 v[84:87], v[196:199], a[248:251], v[84:87]
    ds_write_b64 v4, v[144:145] offset:26624
    v_mul_f32 v10, v122, v122
    v_mfma_f32_16x16x32_bf16 v[88:91], v[196:199], a[252:255], v[88:91]
    s_waitcnt vmcnt(17)
    v_fma_f32 v10, v10, s35, v7
    v_mul_f32 v10, v10, v122
    v_mfma_f32_16x16x32_bf16 v[104:107], v[200:203], a[252:255], v[104:107]
    s_add_u32 s58, s32, 12288
    v_exp_f32 v10, v10
    v_mfma_f32_16x16x32_bf16 v[100:103], v[200:203], a[248:251], v[100:103]
    buffer_load_dwordx4 v[164:167], v3, s[20:23], s58 offen offset:0
    v_mfma_f32_16x16x32_bf16 v[96:99], v[200:203], a[244:247], v[96:99]
    v_mul_f32 v138, v138, v122
    v_mfma_f32_16x16x32_bf16 v[92:95], v[200:203], a[240:243], v[92:95]
    s_waitcnt vmcnt(17)
    v_mul_f32 v137, v137, v11
    v_add_f32 v10, 1.0, v10
    v_mfma_f32_16x16x32_bf16 v[76:79], v[204:207], v[12:15], v[76:79]
    v_cvt_pk_bf16_f32 v146, v136, v137
    v_mfma_f32_16x16x32_bf16 v[80:83], v[204:207], v[16:19], v[80:83]
    buffer_load_dwordx4 v[168:171], v3, s[20:23], s32 offen offset:1024
    v_mfma_f32_16x16x32_bf16 v[84:87], v[204:207], v[20:23], v[84:87]
    v_rcp_f32 v10, v10
    v_mfma_f32_16x16x32_bf16 v[88:91], v[204:207], v[24:27], v[88:91]
    s_waitcnt vmcnt(17)
    v_mul_f32 v11, v123, v123
    v_fma_f32 v11, v11, s35, v7
    v_mfma_f32_16x16x32_bf16 v[104:107], v[208:211], v[24:27], v[104:107]
    v_mul_f32 v11, v11, v123
    v_mfma_f32_16x16x32_bf16 v[100:103], v[208:211], v[20:23], v[100:103]
    buffer_load_dwordx4 v[172:175], v3, s[20:23], s58 offen offset:1024
    v_mfma_f32_16x16x32_bf16 v[96:99], v[208:211], v[16:19], v[96:99]
    v_exp_f32 v11, v11
    v_mfma_f32_16x16x32_bf16 v[92:95], v[208:211], v[12:15], v[92:95]
    s_waitcnt vmcnt(17)
    v_mul_f32 v139, v139, v123
    v_mul_f32 v138, v138, v10
    v_mfma_f32_16x16x32_bf16 v[76:79], v[212:215], v[28:31], v[76:79]
    v_add_f32 v11, 1.0, v11
    v_mfma_f32_16x16x32_bf16 v[80:83], v[212:215], v[32:35], v[80:83]
    buffer_load_dwordx4 v[176:179], v3, s[20:23], s32 offen offset:2048
    v_mfma_f32_16x16x32_bf16 v[84:87], v[212:215], v[36:39], v[84:87]
    v_rcp_f32 v11, v11
    v_mfma_f32_16x16x32_bf16 v[88:91], v[212:215], v[40:43], v[88:91]
    s_waitcnt vmcnt(17)
    v_nop
    v_mul_f32 v139, v139, v11
    v_mfma_f32_16x16x32_bf16 v[104:107], v[216:219], v[40:43], v[104:107]
    v_cvt_pk_bf16_f32 v147, v138, v139
    v_mfma_f32_16x16x32_bf16 v[100:103], v[216:219], v[36:39], v[100:103]
    buffer_load_dwordx4 v[180:183], v3, s[20:23], s58 offen offset:2048
    v_mfma_f32_16x16x32_bf16 v[96:99], v[216:219], v[32:35], v[96:99]
    ds_write_b64 v4, v[146:147] offset:27648
    v_nop
    v_mfma_f32_16x16x32_bf16 v[92:95], v[216:219], v[28:31], v[92:95]
    s_waitcnt vmcnt(17)
    v_mfma_f32_16x16x32_bf16 v[108:111], v[220:223], a[0:3], 0
    s_add_u32 s32, s58, s55
    v_mfma_f32_16x16x32_bf16 v[112:115], v[220:223], a[4:7], 0
    buffer_load_dwordx4 v[184:187], v3, s[20:23], s32 offen offset:0
    v_mfma_f32_16x16x32_bf16 v[116:119], v[220:223], a[8:11], 0
    v_mfma_f32_16x16x32_bf16 v[120:123], v[220:223], a[12:15], 0
    s_waitcnt vmcnt(17)
    v_mfma_f32_16x16x32_bf16 v[136:139], v[224:227], a[12:15], 0
    s_add_u32 s58, s32, 12288
    v_mul_f32 v10, v76, v76
    v_fma_f32 v10, v10, s35, v7
    v_mfma_f32_16x16x32_bf16 v[132:135], v[224:227], a[8:11], 0
    buffer_load_dwordx4 v[188:191], v3, s[20:23], s58 offen offset:0
    v_mfma_f32_16x16x32_bf16 v[128:131], v[224:227], a[4:7], 0
    v_mul_f32 v10, v10, v76
    v_mfma_f32_16x16x32_bf16 v[124:127], v[224:227], a[0:3], 0
    s_waitcnt vmcnt(17)
    v_exp_f32 v10, v10
    v_mfma_f32_16x16x32_bf16 v[108:111], v[228:231], a[16:19], v[108:111]
    v_mul_f32 v92, v92, v76
    v_add_f32 v10, 1.0, v10
    v_mfma_f32_16x16x32_bf16 v[112:115], v[228:231], a[20:23], v[112:115]
    buffer_load_dwordx4 v[192:195], v3, s[20:23], s32 offen offset:1024
    v_mfma_f32_16x16x32_bf16 v[116:119], v[228:231], a[24:27], v[116:119]
    v_rcp_f32 v10, v10
    v_mfma_f32_16x16x32_bf16 v[120:123], v[228:231], a[28:31], v[120:123]
    s_waitcnt vmcnt(17)
    v_mul_f32 v11, v77, v77
    v_mfma_f32_16x16x32_bf16 v[136:139], v[232:235], a[28:31], v[136:139]
    v_fma_f32 v11, v11, s35, v7
    v_mul_f32 v11, v11, v77
    v_mfma_f32_16x16x32_bf16 v[132:135], v[232:235], a[24:27], v[132:135]
    buffer_load_dwordx4 v[196:199], v3, s[20:23], s58 offen offset:1024
    v_mfma_f32_16x16x32_bf16 v[128:131], v[232:235], a[20:23], v[128:131]
    v_exp_f32 v11, v11
    v_mfma_f32_16x16x32_bf16 v[124:127], v[232:235], a[16:19], v[124:127]
    s_waitcnt vmcnt(17)
    v_mul_f32 v93, v93, v77
    v_mfma_f32_16x16x32_bf16 v[108:111], v[236:239], a[32:35], v[108:111]
    v_mul_f32 v92, v92, v10
    v_add_f32 v11, 1.0, v11
    v_mfma_f32_16x16x32_bf16 v[112:115], v[236:239], a[36:39], v[112:115]
    buffer_load_dwordx4 v[200:203], v3, s[20:23], s32 offen offset:2048
    v_mfma_f32_16x16x32_bf16 v[116:119], v[236:239], a[40:43], v[116:119]
    v_rcp_f32 v11, v11
    v_mfma_f32_16x16x32_bf16 v[120:123], v[236:239], a[44:47], v[120:123]
    s_waitcnt vmcnt(17)
    v_mul_f32 v10, v78, v78
    v_mfma_f32_16x16x32_bf16 v[136:139], v[240:243], a[44:47], v[136:139]
    v_fma_f32 v10, v10, s35, v7
    v_mul_f32 v10, v10, v78
    v_mfma_f32_16x16x32_bf16 v[132:135], v[240:243], a[40:43], v[132:135]
    buffer_load_dwordx4 v[204:207], v3, s[20:23], s58 offen offset:2048
    v_mfma_f32_16x16x32_bf16 v[128:131], v[240:243], a[36:39], v[128:131]
    v_exp_f32 v10, v10
    v_mfma_f32_16x16x32_bf16 v[124:127], v[240:243], a[32:35], v[124:127]
    s_waitcnt vmcnt(17)
    v_mul_f32 v94, v94, v78
    v_mfma_f32_16x16x32_bf16 v[108:111], v[244:247], a[48:51], v[108:111]
    s_add_u32 s32, s58, s56
    v_mul_f32 v93, v93, v11
    v_add_f32 v10, 1.0, v10
    v_mfma_f32_16x16x32_bf16 v[112:115], v[244:247], a[52:55], v[112:115]
    buffer_load_dwordx4 v[208:211], v3, s[20:23], s32 offen offset:0
    v_mfma_f32_16x16x32_bf16 v[116:119], v[244:247], a[56:59], v[116:119]
    v_cvt_pk_bf16_f32 v140, v92, v93
    v_mfma_f32_16x16x32_bf16 v[120:123], v[244:247], a[60:63], v[120:123]
    s_waitcnt vmcnt(17)
    v_rcp_f32 v10, v10
    v_mfma_f32_16x16x32_bf16 v[136:139], v[248:251], a[60:63], v[136:139]
    s_add_u32 s58, s32, 12288
    v_mul_f32 v11, v79, v79
    v_fma_f32 v11, v11, s35, v7
    v_mfma_f32_16x16x32_bf16 v[132:135], v[248:251], a[56:59], v[132:135]
    buffer_load_dwordx4 v[212:215], v3, s[20:23], s58 offen offset:0
    v_mfma_f32_16x16x32_bf16 v[128:131], v[248:251], a[52:55], v[128:131]
    v_mul_f32 v11, v11, v79
    v_mfma_f32_16x16x32_bf16 v[124:127], v[248:251], a[48:51], v[124:127]
    s_waitcnt vmcnt(17)
    v_exp_f32 v11, v11
    v_mfma_f32_16x16x32_bf16 v[108:111], v[252:255], a[64:67], v[108:111]
    v_mul_f32 v95, v95, v79
    v_mul_f32 v94, v94, v10
    v_mfma_f32_16x16x32_bf16 v[112:115], v[252:255], a[68:71], v[112:115]
    buffer_load_dwordx4 v[216:219], v3, s[20:23], s32 offen offset:1024
    v_mfma_f32_16x16x32_bf16 v[116:119], v[252:255], a[72:75], v[116:119]
    v_add_f32 v11, 1.0, v11
    v_mfma_f32_16x16x32_bf16 v[120:123], v[252:255], a[76:79], v[120:123]
    s_waitcnt vmcnt(17)
    v_rcp_f32 v11, v11
    v_mfma_f32_16x16x32_bf16 v[136:139], v[148:151], a[76:79], v[136:139]
    v_mul_f32 v10, v80, v80
    v_fma_f32 v10, v10, s35, v7
    v_mfma_f32_16x16x32_bf16 v[132:135], v[148:151], a[72:75], v[132:135]
    buffer_load_dwordx4 v[220:223], v3, s[20:23], s58 offen offset:1024
    v_mfma_f32_16x16x32_bf16 v[128:131], v[148:151], a[68:71], v[128:131]
    v_mul_f32 v10, v10, v80
    v_mfma_f32_16x16x32_bf16 v[124:127], v[148:151], a[64:67], v[124:127]
    s_waitcnt vmcnt(17)
    v_exp_f32 v10, v10
    v_mfma_f32_16x16x32_bf16 v[108:111], v[152:155], a[80:83], v[108:111]
    v_mul_f32 v96, v96, v80
    v_mul_f32 v95, v95, v11
    v_mfma_f32_16x16x32_bf16 v[112:115], v[152:155], a[84:87], v[112:115]
    buffer_load_dwordx4 v[224:227], v3, s[20:23], s32 offen offset:2048
    v_mfma_f32_16x16x32_bf16 v[116:119], v[152:155], a[88:91], v[116:119]
    v_add_f32 v10, 1.0, v10
    v_cvt_pk_bf16_f32 v141, v94, v95
    v_mfma_f32_16x16x32_bf16 v[120:123], v[152:155], a[92:95], v[120:123]
    s_waitcnt vmcnt(17)
    v_rcp_f32 v10, v10
    v_mfma_f32_16x16x32_bf16 v[136:139], v[156:159], a[92:95], v[136:139]
    v_mul_f32 v11, v81, v81
    v_mfma_f32_16x16x32_bf16 v[132:135], v[156:159], a[88:91], v[132:135]
    buffer_load_dwordx4 v[228:231], v3, s[20:23], s58 offen offset:2048
    v_mfma_f32_16x16x32_bf16 v[128:131], v[156:159], a[84:87], v[128:131]
    v_fma_f32 v11, v11, s35, v7
    v_mul_f32 v11, v11, v81
    v_mfma_f32_16x16x32_bf16 v[124:127], v[156:159], a[80:83], v[124:127]
    s_waitcnt vmcnt(17)
    v_exp_f32 v11, v11
    v_mfma_f32_16x16x32_bf16 v[108:111], v[160:163], a[96:99], v[108:111]
    s_add_u32 s32, s58, s57
    v_mul_f32 v97, v97, v81
    v_mfma_f32_16x16x32_bf16 v[112:115], v[160:163], a[100:103], v[112:115]
    buffer_load_dwordx4 v[232:235], v3, s[20:23], s32 offen offset:0
    v_mfma_f32_16x16x32_bf16 v[116:119], v[160:163], a[104:107], v[116:119]
    v_mul_f32 v96, v96, v10
    v_add_f32 v11, 1.0, v11
    v_mfma_f32_16x16x32_bf16 v[120:123], v[160:163], a[108:111], v[120:123]
    s_waitcnt vmcnt(17)
    v_rcp_f32 v11, v11
    v_mfma_f32_16x16x32_bf16 v[136:139], v[164:167], a[108:111], v[136:139]
    s_add_u32 s58, s32, 12288
    ds_write_b64 v4, v[140:141] offset:32768
    v_mfma_f32_16x16x32_bf16 v[132:135], v[164:167], a[104:107], v[132:135]
    buffer_load_dwordx4 v[236:239], v3, s[20:23], s58 offen offset:0
    v_mfma_f32_16x16x32_bf16 v[128:131], v[164:167], a[100:103], v[128:131]
    v_mul_f32 v10, v82, v82
    v_fma_f32 v10, v10, s35, v7
    v_mfma_f32_16x16x32_bf16 v[124:127], v[164:167], a[96:99], v[124:127]
    s_waitcnt vmcnt(17)
    v_mul_f32 v10, v10, v82
    v_mfma_f32_16x16x32_bf16 v[108:111], v[168:171], a[112:115], v[108:111]
    v_exp_f32 v10, v10
    v_mfma_f32_16x16x32_bf16 v[112:115], v[168:171], a[116:119], v[112:115]
    buffer_load_dwordx4 v[240:243], v3, s[20:23], s32 offen offset:1024
    v_mfma_f32_16x16x32_bf16 v[116:119], v[168:171], a[120:123], v[116:119]
    v_mul_f32 v98, v98, v82
    v_mul_f32 v97, v97, v11
    v_mfma_f32_16x16x32_bf16 v[120:123], v[168:171], a[124:127], v[120:123]
    s_waitcnt vmcnt(17)
    v_add_f32 v10, 1.0, v10
    v_mfma_f32_16x16x32_bf16 v[136:139], v[172:175], a[124:127], v[136:139]
    v_cvt_pk_bf16_f32 v142, v96, v97
    v_mfma_f32_16x16x32_bf16 v[132:135], v[172:175], a[120:123], v[132:135]
    buffer_load_dwordx4 v[244:247], v3, s[20:23], s58 offen offset:1024
    v_mfma_f32_16x16x32_bf16 v[128:131], v[172:175], a[116:119], v[128:131]
    v_rcp_f32 v10, v10
    v_mfma_f32_16x16x32_bf16 v[124:127], v[172:175], a[112:115], v[124:127]
    s_waitcnt vmcnt(17)
    v_mul_f32 v11, v83, v83
    v_fma_f32 v11, v11, s35, v7
    v_mfma_f32_16x16x32_bf16 v[108:111], v[176:179], a[128:131], v[108:111]
    v_mul_f32 v11, v11, v83
    v_mfma_f32_16x16x32_bf16 v[112:115], v[176:179], a[132:135], v[112:115]
    buffer_load_dwordx4 v[248:251], v3, s[20:23], s32 offen offset:2048
    v_mfma_f32_16x16x32_bf16 v[116:119], v[176:179], a[136:139], v[116:119]
    v_exp_f32 v11, v11
    v_mfma_f32_16x16x32_bf16 v[120:123], v[176:179], a[140:143], v[120:123]
    s_waitcnt vmcnt(17)
    v_mul_f32 v99, v99, v83
    v_mul_f32 v98, v98, v10
    v_mfma_f32_16x16x32_bf16 v[136:139], v[180:183], a[140:143], v[136:139]
    v_add_f32 v11, 1.0, v11
    v_mfma_f32_16x16x32_bf16 v[132:135], v[180:183], a[136:139], v[132:135]
    buffer_load_dwordx4 v[252:255], v3, s[20:23], s58 offen offset:2048
    v_mfma_f32_16x16x32_bf16 v[128:131], v[180:183], a[132:135], v[128:131]
    v_rcp_f32 v11, v11
    v_mfma_f32_16x16x32_bf16 v[124:127], v[180:183], a[128:131], v[124:127]
    s_waitcnt vmcnt(17)
    v_mul_f32 v10, v84, v84
    v_fma_f32 v10, v10, s35, v7
    v_mfma_f32_16x16x32_bf16 v[108:111], v[184:187], a[144:147], v[108:111]
    s_add_u32 s32, s58, s52
    v_mul_f32 v10, v10, v84
    v_mfma_f32_16x16x32_bf16 v[112:115], v[184:187], a[148:151], v[112:115]
    buffer_load_dwordx4 v[148:151], v3, s[20:23], s32 offen offset:0
    v_mfma_f32_16x16x32_bf16 v[116:119], v[184:187], a[152:155], v[116:119]
    v_exp_f32 v10, v10
    v_mfma_f32_16x16x32_bf16 v[120:123], v[184:187], a[156:159], v[120:123]
    s_waitcnt vmcnt(17)
    v_mul_f32 v100, v100, v84
    v_mul_f32 v99, v99, v11
    v_mfma_f32_16x16x32_bf16 v[136:139], v[188:191], a[156:159], v[136:139]
    s_add_u32 s58, s32, 12288
    v_add_f32 v10, 1.0, v10
    v_cvt_pk_bf16_f32 v143, v98, v99
    v_mfma_f32_16x16x32_bf16 v[132:135], v[188:191], a[152:155], v[132:135]
    buffer_load_dwordx4 v[152:155], v3, s[20:23], s58 offen offset:0
    v_mfma_f32_16x16x32_bf16 v[128:131], v[188:191], a[148:151], v[128:131]
    v_rcp_f32 v10, v10
    v_mfma_f32_16x16x32_bf16 v[124:127], v[188:191], a[144:147], v[124:127]
    s_waitcnt vmcnt(17)
    v_mul_f32 v11, v85, v85
    v_mfma_f32_16x16x32_bf16 v[108:111], v[192:195], a[160:163], v[108:111]
    v_fma_f32 v11, v11, s35, v7
    v_mul_f32 v11, v11, v85
    v_mfma_f32_16x16x32_bf16 v[112:115], v[192:195], a[164:167], v[112:115]
    buffer_load_dwordx4 v[156:159], v3, s[20:23], s32 offen offset:1024
    v_mfma_f32_16x16x32_bf16 v[116:119], v[192:195], a[168:171], v[116:119]
    v_exp_f32 v11, v11
    v_mfma_f32_16x16x32_bf16 v[120:123], v[192:195], a[172:175], v[120:123]
    s_waitcnt vmcnt(17)
    v_mul_f32 v101, v101, v85
    v_mfma_f32_16x16x32_bf16 v[136:139], v[196:199], a[172:175], v[136:139]
    v_mul_f32 v100, v100, v10
    v_add_f32 v11, 1.0, v11
    v_mfma_f32_16x16x32_bf16 v[132:135], v[196:199], a[168:171], v[132:135]
    buffer_load_dwordx4 v[160:163], v3, s[20:23], s58 offen offset:1024
    v_mfma_f32_16x16x32_bf16 v[128:131], v[196:199], a[164:167], v[128:131]
    v_rcp_f32 v11, v11
    v_mfma_f32_16x16x32_bf16 v[124:127], v[196:199], a[160:163], v[124:127]
    s_waitcnt vmcnt(17)
    ds_write_b64 v4, v[142:143] offset:33792
    v_mfma_f32_16x16x32_bf16 v[108:111], v[200:203], a[176:179], v[108:111]
    v_mul_f32 v10, v86, v86
    v_fma_f32 v10, v10, s35, v7
    v_mfma_f32_16x16x32_bf16 v[112:115], v[200:203], a[180:183], v[112:115]
    buffer_load_dwordx4 v[164:167], v3, s[20:23], s32 offen offset:2048
    v_mfma_f32_16x16x32_bf16 v[116:119], v[200:203], a[184:187], v[116:119]
    v_mul_f32 v10, v10, v86
    v_mfma_f32_16x16x32_bf16 v[120:123], v[200:203], a[188:191], v[120:123]
    s_waitcnt vmcnt(17)
    v_exp_f32 v10, v10
    v_mfma_f32_16x16x32_bf16 v[136:139], v[204:207], a[188:191], v[136:139]
    v_mul_f32 v102, v102, v86
    v_mul_f32 v101, v101, v11
    v_mfma_f32_16x16x32_bf16 v[132:135], v[204:207], a[184:187], v[132:135]
    buffer_load_dwordx4 v[168:171], v3, s[20:23], s58 offen offset:2048
    v_mfma_f32_16x16x32_bf16 v[128:131], v[204:207], a[180:183], v[128:131]
    v_add_f32 v10, 1.0, v10
    v_cvt_pk_bf16_f32 v144, v100, v101
    v_mfma_f32_16x16x32_bf16 v[124:127], v[204:207], a[176:179], v[124:127]
    s_waitcnt vmcnt(17)
    v_rcp_f32 v10, v10
    v_mfma_f32_16x16x32_bf16 v[108:111], v[208:211], a[192:195], v[108:111]
    s_add_u32 s32, s58, s53
    v_mul_f32 v11, v87, v87
    v_mfma_f32_16x16x32_bf16 v[112:115], v[208:211], a[196:199], v[112:115]
    buffer_load_dwordx4 v[172:175], v3, s[20:23], s32 offen offset:0
    v_mfma_f32_16x16x32_bf16 v[116:119], v[208:211], a[200:203], v[116:119]
    v_fma_f32 v11, v11, s35, v7
    v_mul_f32 v11, v11, v87
    v_mfma_f32_16x16x32_bf16 v[120:123], v[208:211], a[204:207], v[120:123]
    s_waitcnt vmcnt(17)
    v_exp_f32 v11, v11
    v_mfma_f32_16x16x32_bf16 v[136:139], v[212:215], a[204:207], v[136:139]
    s_add_u32 s58, s32, 12288
    v_mul_f32 v103, v103, v87
    v_mfma_f32_16x16x32_bf16 v[132:135], v[212:215], a[200:203], v[132:135]
    buffer_load_dwordx4 v[176:179], v3, s[20:23], s58 offen offset:0
    v_mfma_f32_16x16x32_bf16 v[128:131], v[212:215], a[196:199], v[128:131]
    v_mul_f32 v102, v102, v10
    v_add_f32 v11, 1.0, v11
    v_mfma_f32_16x16x32_bf16 v[124:127], v[212:215], a[192:195], v[124:127]
    s_waitcnt vmcnt(17)
    v_rcp_f32 v11, v11
    v_mfma_f32_16x16x32_bf16 v[108:111], v[216:219], a[208:211], v[108:111]
    v_mul_f32 v10, v88, v88
    v_mfma_f32_16x16x32_bf16 v[112:115], v[216:219], a[212:215], v[112:115]
    buffer_load_dwordx4 v[180:183], v3, s[20:23], s32 offen offset:1024
    v_mfma_f32_16x16x32_bf16 v[116:119], v[216:219], a[216:219], v[116:119]
    v_fma_f32 v10, v10, s35, v7
    v_mul_f32 v10, v10, v88
    v_mfma_f32_16x16x32_bf16 v[120:123], v[216:219], a[220:223], v[120:123]
    s_waitcnt vmcnt(17)
    v_exp_f32 v10, v10
    v_mfma_f32_16x16x32_bf16 v[136:139], v[220:223], a[220:223], v[136:139]
    v_mul_f32 v104, v104, v88
    v_mfma_f32_16x16x32_bf16 v[132:135], v[220:223], a[216:219], v[132:135]
    buffer_load_dwordx4 v[184:187], v3, s[20:23], s58 offen offset:1024
    v_mfma_f32_16x16x32_bf16 v[128:131], v[220:223], a[212:215], v[128:131]
    v_mul_f32 v103, v103, v11
    v_add_f32 v10, 1.0, v10
    v_mfma_f32_16x16x32_bf16 v[124:127], v[220:223], a[208:211], v[124:127]
    s_waitcnt vmcnt(17)
    v_cvt_pk_bf16_f32 v145, v102, v103
    v_mfma_f32_16x16x32_bf16 v[108:111], v[224:227], a[224:227], v[108:111]
    v_rcp_f32 v10, v10
    v_mfma_f32_16x16x32_bf16 v[112:115], v[224:227], a[228:231], v[112:115]
    buffer_load_dwordx4 v[188:191], v3, s[20:23], s32 offen offset:2048
    v_mfma_f32_16x16x32_bf16 v[116:119], v[224:227], a[232:235], v[116:119]
    v_mul_f32 v11, v89, v89
    v_fma_f32 v11, v11, s35, v7
    v_mfma_f32_16x16x32_bf16 v[120:123], v[224:227], a[236:239], v[120:123]
    s_waitcnt vmcnt(17)
    v_mul_f32 v11, v11, v89
    v_mfma_f32_16x16x32_bf16 v[136:139], v[228:231], a[236:239], v[136:139]
    v_exp_f32 v11, v11
    v_mfma_f32_16x16x32_bf16 v[132:135], v[228:231], a[232:235], v[132:135]
    buffer_load_dwordx4 v[192:195], v3, s[20:23], s58 offen offset:2048
    v_mfma_f32_16x16x32_bf16 v[128:131], v[228:231], a[228:231], v[128:131]
    v_mul_f32 v105, v105, v89
    v_mul_f32 v104, v104, v10
    v_mfma_f32_16x16x32_bf16 v[124:127], v[228:231], a[224:227], v[124:127]
    s_waitcnt vmcnt(17)
    v_add_f32 v11, 1.0, v11
    v_mfma_f32_16x16x32_bf16 v[108:111], v[232:235], a[240:243], v[108:111]
    s_add_u32 s32, s58, s54
    v_rcp_f32 v11, v11
    v_mfma_f32_16x16x32_bf16 v[112:115], v[232:235], a[244:247], v[112:115]
    buffer_load_dwordx4 v[196:199], v3, s[20:23], s32 offen offset:0
    v_mfma_f32_16x16x32_bf16 v[116:119], v[232:235], a[248:251], v[116:119]
    ds_write_b64 v4, v[144:145] offset:34816
    v_mul_f32 v10, v90, v90
    v_mfma_f32_16x16x32_bf16 v[120:123], v[232:235], a[252:255], v[120:123]
    s_waitcnt vmcnt(17)
    v_fma_f32 v10, v10, s35, v7
    v_mul_f32 v10, v10, v90
    v_mfma_f32_16x16x32_bf16 v[136:139], v[236:239], a[252:255], v[136:139]
    s_add_u32 s58, s32, 12288
    v_exp_f32 v10, v10
    v_mfma_f32_16x16x32_bf16 v[132:135], v[236:239], a[248:251], v[132:135]
    buffer_load_dwordx4 v[200:203], v3, s[20:23], s58 offen offset:0
    v_mfma_f32_16x16x32_bf16 v[128:131], v[236:239], a[244:247], v[128:131]
    v_mul_f32 v106, v106, v90
    v_mfma_f32_16x16x32_bf16 v[124:127], v[236:239], a[240:243], v[124:127]
    s_waitcnt vmcnt(17)
    v_mul_f32 v105, v105, v11
    v_add_f32 v10, 1.0, v10
    v_mfma_f32_16x16x32_bf16 v[108:111], v[240:243], v[12:15], v[108:111]
    v_cvt_pk_bf16_f32 v146, v104, v105
    v_mfma_f32_16x16x32_bf16 v[112:115], v[240:243], v[16:19], v[112:115]
    buffer_load_dwordx4 v[204:207], v3, s[20:23], s32 offen offset:1024
    v_mfma_f32_16x16x32_bf16 v[116:119], v[240:243], v[20:23], v[116:119]
    v_rcp_f32 v10, v10
    v_mfma_f32_16x16x32_bf16 v[120:123], v[240:243], v[24:27], v[120:123]
    s_waitcnt vmcnt(17)
    v_mul_f32 v11, v91, v91
    v_fma_f32 v11, v11, s35, v7
    v_mfma_f32_16x16x32_bf16 v[136:139], v[244:247], v[24:27], v[136:139]
    v_mul_f32 v11, v11, v91
    v_mfma_f32_16x16x32_bf16 v[132:135], v[244:247], v[20:23], v[132:135]
    buffer_load_dwordx4 v[208:211], v3, s[20:23], s58 offen offset:1024
    v_mfma_f32_16x16x32_bf16 v[128:131], v[244:247], v[16:19], v[128:131]
    v_exp_f32 v11, v11
    v_mfma_f32_16x16x32_bf16 v[124:127], v[244:247], v[12:15], v[124:127]
    s_waitcnt vmcnt(17)
    v_mul_f32 v107, v107, v91
    v_mul_f32 v106, v106, v10
    v_mfma_f32_16x16x32_bf16 v[108:111], v[248:251], v[28:31], v[108:111]
    v_add_f32 v11, 1.0, v11
    v_mfma_f32_16x16x32_bf16 v[112:115], v[248:251], v[32:35], v[112:115]
    buffer_load_dwordx4 v[212:215], v3, s[20:23], s32 offen offset:2048
    v_mfma_f32_16x16x32_bf16 v[116:119], v[248:251], v[36:39], v[116:119]
    v_rcp_f32 v11, v11
    v_mfma_f32_16x16x32_bf16 v[120:123], v[248:251], v[40:43], v[120:123]
    s_waitcnt vmcnt(17)
    v_nop
    v_mul_f32 v107, v107, v11
    v_mfma_f32_16x16x32_bf16 v[136:139], v[252:255], v[40:43], v[136:139]
    v_cvt_pk_bf16_f32 v147, v106, v107
    v_mfma_f32_16x16x32_bf16 v[132:135], v[252:255], v[36:39], v[132:135]
    buffer_load_dwordx4 v[216:219], v3, s[20:23], s58 offen offset:2048
    v_mfma_f32_16x16x32_bf16 v[128:131], v[252:255], v[32:35], v[128:131]
    ds_write_b64 v4, v[146:147] offset:35840
    v_nop
    v_mfma_f32_16x16x32_bf16 v[124:127], v[252:255], v[28:31], v[124:127]
    s_waitcnt vmcnt(17)
    v_mfma_f32_16x16x32_bf16 v[76:79], v[148:151], a[0:3], 0
    s_add_u32 s32, s58, s55
    v_mfma_f32_16x16x32_bf16 v[80:83], v[148:151], a[4:7], 0
    buffer_load_dwordx4 v[220:223], v3, s[20:23], s32 offen offset:0
    v_mfma_f32_16x16x32_bf16 v[84:87], v[148:151], a[8:11], 0
    v_mfma_f32_16x16x32_bf16 v[88:91], v[148:151], a[12:15], 0
    s_waitcnt vmcnt(17)
    v_mfma_f32_16x16x32_bf16 v[104:107], v[152:155], a[12:15], 0
    s_add_u32 s58, s32, 12288
    v_mul_f32 v10, v108, v108
    v_fma_f32 v10, v10, s35, v7
    v_mfma_f32_16x16x32_bf16 v[100:103], v[152:155], a[8:11], 0
    buffer_load_dwordx4 v[224:227], v3, s[20:23], s58 offen offset:0
    v_mfma_f32_16x16x32_bf16 v[96:99], v[152:155], a[4:7], 0
    v_mul_f32 v10, v10, v108
    v_mfma_f32_16x16x32_bf16 v[92:95], v[152:155], a[0:3], 0
    s_waitcnt vmcnt(17)
    v_exp_f32 v10, v10
    v_mfma_f32_16x16x32_bf16 v[76:79], v[156:159], a[16:19], v[76:79]
    v_mul_f32 v124, v124, v108
    v_add_f32 v10, 1.0, v10
    v_mfma_f32_16x16x32_bf16 v[80:83], v[156:159], a[20:23], v[80:83]
    buffer_load_dwordx4 v[228:231], v3, s[20:23], s32 offen offset:1024
    v_mfma_f32_16x16x32_bf16 v[84:87], v[156:159], a[24:27], v[84:87]
    v_rcp_f32 v10, v10
    v_mfma_f32_16x16x32_bf16 v[88:91], v[156:159], a[28:31], v[88:91]
    s_waitcnt vmcnt(17)
    v_mul_f32 v11, v109, v109
    v_mfma_f32_16x16x32_bf16 v[104:107], v[160:163], a[28:31], v[104:107]
    v_fma_f32 v11, v11, s35, v7
    v_mul_f32 v11, v11, v109
    v_mfma_f32_16x16x32_bf16 v[100:103], v[160:163], a[24:27], v[100:103]
    buffer_load_dwordx4 v[232:235], v3, s[20:23], s58 offen offset:1024
    v_mfma_f32_16x16x32_bf16 v[96:99], v[160:163], a[20:23], v[96:99]
    v_exp_f32 v11, v11
    v_mfma_f32_16x16x32_bf16 v[92:95], v[160:163], a[16:19], v[92:95]
    s_waitcnt vmcnt(17)
    v_mul_f32 v125, v125, v109
    v_mfma_f32_16x16x32_bf16 v[76:79], v[164:167], a[32:35], v[76:79]
    v_mul_f32 v124, v124, v10
    v_add_f32 v11, 1.0, v11
    v_mfma_f32_16x16x32_bf16 v[80:83], v[164:167], a[36:39], v[80:83]
    buffer_load_dwordx4 v[236:239], v3, s[20:23], s32 offen offset:2048
    v_mfma_f32_16x16x32_bf16 v[84:87], v[164:167], a[40:43], v[84:87]
    v_rcp_f32 v11, v11
    v_mfma_f32_16x16x32_bf16 v[88:91], v[164:167], a[44:47], v[88:91]
    s_waitcnt vmcnt(17)
    v_mul_f32 v10, v110, v110
    v_mfma_f32_16x16x32_bf16 v[104:107], v[168:171], a[44:47], v[104:107]
    v_fma_f32 v10, v10, s35, v7
    v_mul_f32 v10, v10, v110
    v_mfma_f32_16x16x32_bf16 v[100:103], v[168:171], a[40:43], v[100:103]
    buffer_load_dwordx4 v[240:243], v3, s[20:23], s58 offen offset:2048
    v_mfma_f32_16x16x32_bf16 v[96:99], v[168:171], a[36:39], v[96:99]
    v_exp_f32 v10, v10
    v_mfma_f32_16x16x32_bf16 v[92:95], v[168:171], a[32:35], v[92:95]
    s_waitcnt vmcnt(17)
    v_mul_f32 v126, v126, v110
    v_mfma_f32_16x16x32_bf16 v[76:79], v[172:175], a[48:51], v[76:79]
    s_add_u32 s32, s58, s56
    v_mul_f32 v125, v125, v11
    v_add_f32 v10, 1.0, v10
    v_mfma_f32_16x16x32_bf16 v[80:83], v[172:175], a[52:55], v[80:83]
    buffer_load_dwordx4 v[244:247], v3, s[20:23], s32 offen offset:0
    v_mfma_f32_16x16x32_bf16 v[84:87], v[172:175], a[56:59], v[84:87]
    v_cvt_pk_bf16_f32 v140, v124, v125
    v_mfma_f32_16x16x32_bf16 v[88:91], v[172:175], a[60:63], v[88:91]
    s_waitcnt vmcnt(17)
    v_rcp_f32 v10, v10
    v_mfma_f32_16x16x32_bf16 v[104:107], v[176:179], a[60:63], v[104:107]
    s_add_u32 s58, s32, 12288
    v_mul_f32 v11, v111, v111
    v_fma_f32 v11, v11, s35, v7
    v_mfma_f32_16x16x32_bf16 v[100:103], v[176:179], a[56:59], v[100:103]
    buffer_load_dwordx4 v[248:251], v3, s[20:23], s58 offen offset:0
    v_mfma_f32_16x16x32_bf16 v[96:99], v[176:179], a[52:55], v[96:99]
    v_mul_f32 v11, v11, v111
    v_mfma_f32_16x16x32_bf16 v[92:95], v[176:179], a[48:51], v[92:95]
    s_waitcnt vmcnt(17)
    v_exp_f32 v11, v11
    v_mfma_f32_16x16x32_bf16 v[76:79], v[180:183], a[64:67], v[76:79]
    v_mul_f32 v127, v127, v111
    v_mul_f32 v126, v126, v10
    v_mfma_f32_16x16x32_bf16 v[80:83], v[180:183], a[68:71], v[80:83]
    buffer_load_dwordx4 v[252:255], v3, s[20:23], s32 offen offset:1024
    v_mfma_f32_16x16x32_bf16 v[84:87], v[180:183], a[72:75], v[84:87]
    v_add_f32 v11, 1.0, v11
    v_mfma_f32_16x16x32_bf16 v[88:91], v[180:183], a[76:79], v[88:91]
    s_waitcnt vmcnt(17)
    v_rcp_f32 v11, v11
    v_mfma_f32_16x16x32_bf16 v[104:107], v[184:187], a[76:79], v[104:107]
    v_mul_f32 v10, v112, v112
    v_fma_f32 v10, v10, s35, v7
    v_mfma_f32_16x16x32_bf16 v[100:103], v[184:187], a[72:75], v[100:103]
    buffer_load_dwordx4 v[148:151], v3, s[20:23], s58 offen offset:1024
    v_mfma_f32_16x16x32_bf16 v[96:99], v[184:187], a[68:71], v[96:99]
    v_mul_f32 v10, v10, v112
    v_mfma_f32_16x16x32_bf16 v[92:95], v[184:187], a[64:67], v[92:95]
    s_waitcnt vmcnt(17)
    v_exp_f32 v10, v10
    v_mfma_f32_16x16x32_bf16 v[76:79], v[188:191], a[80:83], v[76:79]
    v_mul_f32 v128, v128, v112
    v_mul_f32 v127, v127, v11
    v_mfma_f32_16x16x32_bf16 v[80:83], v[188:191], a[84:87], v[80:83]
    buffer_load_dwordx4 v[152:155], v3, s[20:23], s32 offen offset:2048
    v_mfma_f32_16x16x32_bf16 v[84:87], v[188:191], a[88:91], v[84:87]
    v_add_f32 v10, 1.0, v10
    v_cvt_pk_bf16_f32 v141, v126, v127
    v_mfma_f32_16x16x32_bf16 v[88:91], v[188:191], a[92:95], v[88:91]
    s_waitcnt vmcnt(17)
    v_rcp_f32 v10, v10
    v_mfma_f32_16x16x32_bf16 v[104:107], v[192:195], a[92:95], v[104:107]
    v_mul_f32 v11, v113, v113
    v_mfma_f32_16x16x32_bf16 v[100:103], v[192:195], a[88:91], v[100:103]
    buffer_load_dwordx4 v[156:159], v3, s[20:23], s58 offen offset:2048
    v_mfma_f32_16x16x32_bf16 v[96:99], v[192:195], a[84:87], v[96:99]
    v_fma_f32 v11, v11, s35, v7
    v_mul_f32 v11, v11, v113
    v_mfma_f32_16x16x32_bf16 v[92:95], v[192:195], a[80:83], v[92:95]
    s_waitcnt vmcnt(17)
    v_exp_f32 v11, v11
    v_mfma_f32_16x16x32_bf16 v[76:79], v[196:199], a[96:99], v[76:79]
    s_add_u32 s32, s58, s57
    v_mul_f32 v129, v129, v113
    v_mfma_f32_16x16x32_bf16 v[80:83], v[196:199], a[100:103], v[80:83]
    buffer_load_dwordx4 v[160:163], v3, s[20:23], s32 offen offset:0
    v_mfma_f32_16x16x32_bf16 v[84:87], v[196:199], a[104:107], v[84:87]
    v_mul_f32 v128, v128, v10
    v_add_f32 v11, 1.0, v11
    v_mfma_f32_16x16x32_bf16 v[88:91], v[196:199], a[108:111], v[88:91]
    s_waitcnt vmcnt(17)
    v_rcp_f32 v11, v11
    v_mfma_f32_16x16x32_bf16 v[104:107], v[200:203], a[108:111], v[104:107]
    s_add_u32 s58, s32, 12288
    ds_write_b64 v4, v[140:141] offset:40960
    v_mfma_f32_16x16x32_bf16 v[100:103], v[200:203], a[104:107], v[100:103]
    buffer_load_dwordx4 v[164:167], v3, s[20:23], s58 offen offset:0
    v_mfma_f32_16x16x32_bf16 v[96:99], v[200:203], a[100:103], v[96:99]
    v_mul_f32 v10, v114, v114
    v_fma_f32 v10, v10, s35, v7
    v_mfma_f32_16x16x32_bf16 v[92:95], v[200:203], a[96:99], v[92:95]
    s_waitcnt vmcnt(17)
    v_mul_f32 v10, v10, v114
    v_mfma_f32_16x16x32_bf16 v[76:79], v[204:207], a[112:115], v[76:79]
    v_exp_f32 v10, v10
    v_mfma_f32_16x16x32_bf16 v[80:83], v[204:207], a[116:119], v[80:83]
    buffer_load_dwordx4 v[168:171], v3, s[20:23], s32 offen offset:1024
    v_mfma_f32_16x16x32_bf16 v[84:87], v[204:207], a[120:123], v[84:87]
    v_mul_f32 v130, v130, v114
    v_mul_f32 v129, v129, v11
    v_mfma_f32_16x16x32_bf16 v[88:91], v[204:207], a[124:127], v[88:91]
    s_waitcnt vmcnt(17)
    v_add_f32 v10, 1.0, v10
    v_mfma_f32_16x16x32_bf16 v[104:107], v[208:211], a[124:127], v[104:107]
    v_cvt_pk_bf16_f32 v142, v128, v129
    v_mfma_f32_16x16x32_bf16 v[100:103], v[208:211], a[120:123], v[100:103]
    buffer_load_dwordx4 v[172:175], v3, s[20:23], s58 offen offset:1024
    v_mfma_f32_16x16x32_bf16 v[96:99], v[208:211], a[116:119], v[96:99]
    v_rcp_f32 v10, v10
    v_mfma_f32_16x16x32_bf16 v[92:95], v[208:211], a[112:115], v[92:95]
    s_waitcnt vmcnt(17)
    v_mul_f32 v11, v115, v115
    v_fma_f32 v11, v11, s35, v7
    v_mfma_f32_16x16x32_bf16 v[76:79], v[212:215], a[128:131], v[76:79]
    v_mul_f32 v11, v11, v115
    v_mfma_f32_16x16x32_bf16 v[80:83], v[212:215], a[132:135], v[80:83]
    buffer_load_dwordx4 v[176:179], v3, s[20:23], s32 offen offset:2048
    v_mfma_f32_16x16x32_bf16 v[84:87], v[212:215], a[136:139], v[84:87]
    v_exp_f32 v11, v11
    v_mfma_f32_16x16x32_bf16 v[88:91], v[212:215], a[140:143], v[88:91]
    s_waitcnt vmcnt(17)
    v_mul_f32 v131, v131, v115
    v_mul_f32 v130, v130, v10
    v_mfma_f32_16x16x32_bf16 v[104:107], v[216:219], a[140:143], v[104:107]
    v_add_f32 v11, 1.0, v11
    v_mfma_f32_16x16x32_bf16 v[100:103], v[216:219], a[136:139], v[100:103]
    buffer_load_dwordx4 v[180:183], v3, s[20:23], s58 offen offset:2048
    v_mfma_f32_16x16x32_bf16 v[96:99], v[216:219], a[132:135], v[96:99]
    v_rcp_f32 v11, v11
    v_mfma_f32_16x16x32_bf16 v[92:95], v[216:219], a[128:131], v[92:95]
    s_waitcnt vmcnt(17)
    v_mul_f32 v10, v116, v116
    v_fma_f32 v10, v10, s35, v7
    v_mfma_f32_16x16x32_bf16 v[76:79], v[220:223], a[144:147], v[76:79]
    s_add_u32 s32, s58, s52
    v_mul_f32 v10, v10, v116
    v_mfma_f32_16x16x32_bf16 v[80:83], v[220:223], a[148:151], v[80:83]
    buffer_load_dwordx4 v[184:187], v3, s[20:23], s32 offen offset:0
    v_mfma_f32_16x16x32_bf16 v[84:87], v[220:223], a[152:155], v[84:87]
    v_exp_f32 v10, v10
    v_mfma_f32_16x16x32_bf16 v[88:91], v[220:223], a[156:159], v[88:91]
    s_waitcnt vmcnt(17)
    v_mul_f32 v132, v132, v116
    v_mul_f32 v131, v131, v11
    v_mfma_f32_16x16x32_bf16 v[104:107], v[224:227], a[156:159], v[104:107]
    s_add_u32 s58, s32, 12288
    v_add_f32 v10, 1.0, v10
    v_cvt_pk_bf16_f32 v143, v130, v131
    v_mfma_f32_16x16x32_bf16 v[100:103], v[224:227], a[152:155], v[100:103]
    buffer_load_dwordx4 v[188:191], v3, s[20:23], s58 offen offset:0
    v_mfma_f32_16x16x32_bf16 v[96:99], v[224:227], a[148:151], v[96:99]
    v_rcp_f32 v10, v10
    v_mfma_f32_16x16x32_bf16 v[92:95], v[224:227], a[144:147], v[92:95]
    s_waitcnt vmcnt(17)
    v_mul_f32 v11, v117, v117
    v_mfma_f32_16x16x32_bf16 v[76:79], v[228:231], a[160:163], v[76:79]
    v_fma_f32 v11, v11, s35, v7
    v_mul_f32 v11, v11, v117
    v_mfma_f32_16x16x32_bf16 v[80:83], v[228:231], a[164:167], v[80:83]
    buffer_load_dwordx4 v[192:195], v3, s[20:23], s32 offen offset:1024
    v_mfma_f32_16x16x32_bf16 v[84:87], v[228:231], a[168:171], v[84:87]
    v_exp_f32 v11, v11
    v_mfma_f32_16x16x32_bf16 v[88:91], v[228:231], a[172:175], v[88:91]
    s_waitcnt vmcnt(17)
    v_mul_f32 v133, v133, v117
    v_mfma_f32_16x16x32_bf16 v[104:107], v[232:235], a[172:175], v[104:107]
    v_mul_f32 v132, v132, v10
    v_add_f32 v11, 1.0, v11
    v_mfma_f32_16x16x32_bf16 v[100:103], v[232:235], a[168:171], v[100:103]
    buffer_load_dwordx4 v[196:199], v3, s[20:23], s58 offen offset:1024
    v_mfma_f32_16x16x32_bf16 v[96:99], v[232:235], a[164:167], v[96:99]
    v_rcp_f32 v11, v11
    v_mfma_f32_16x16x32_bf16 v[92:95], v[232:235], a[160:163], v[92:95]
    s_waitcnt vmcnt(17)
    ds_write_b64 v4, v[142:143] offset:41984
    v_mfma_f32_16x16x32_bf16 v[76:79], v[236:239], a[176:179], v[76:79]
    v_mul_f32 v10, v118, v118
    v_fma_f32 v10, v10, s35, v7
    v_mfma_f32_16x16x32_bf16 v[80:83], v[236:239], a[180:183], v[80:83]
    buffer_load_dwordx4 v[200:203], v3, s[20:23], s32 offen offset:2048
    v_mfma_f32_16x16x32_bf16 v[84:87], v[236:239], a[184:187], v[84:87]
    v_mul_f32 v10, v10, v118
    v_mfma_f32_16x16x32_bf16 v[88:91], v[236:239], a[188:191], v[88:91]
    s_waitcnt vmcnt(17)
    v_exp_f32 v10, v10
    v_mfma_f32_16x16x32_bf16 v[104:107], v[240:243], a[188:191], v[104:107]
    v_mul_f32 v134, v134, v118
    v_mul_f32 v133, v133, v11
    v_mfma_f32_16x16x32_bf16 v[100:103], v[240:243], a[184:187], v[100:103]
    buffer_load_dwordx4 v[204:207], v3, s[20:23], s58 offen offset:2048
    v_mfma_f32_16x16x32_bf16 v[96:99], v[240:243], a[180:183], v[96:99]
    v_add_f32 v10, 1.0, v10
    v_cvt_pk_bf16_f32 v144, v132, v133
    v_mfma_f32_16x16x32_bf16 v[92:95], v[240:243], a[176:179], v[92:95]
    s_waitcnt vmcnt(17)
    v_rcp_f32 v10, v10
    v_mfma_f32_16x16x32_bf16 v[76:79], v[244:247], a[192:195], v[76:79]
    s_add_u32 s32, s58, s53
    v_mul_f32 v11, v119, v119
    v_mfma_f32_16x16x32_bf16 v[80:83], v[244:247], a[196:199], v[80:83]
    buffer_load_dwordx4 v[208:211], v3, s[20:23], s32 offen offset:0
    v_mfma_f32_16x16x32_bf16 v[84:87], v[244:247], a[200:203], v[84:87]
    v_fma_f32 v11, v11, s35, v7
    v_mul_f32 v11, v11, v119
    v_mfma_f32_16x16x32_bf16 v[88:91], v[244:247], a[204:207], v[88:91]
    s_waitcnt vmcnt(17)
    v_exp_f32 v11, v11
    v_mfma_f32_16x16x32_bf16 v[104:107], v[248:251], a[204:207], v[104:107]
    s_add_u32 s58, s32, 12288
    v_mul_f32 v135, v135, v119
    v_mfma_f32_16x16x32_bf16 v[100:103], v[248:251], a[200:203], v[100:103]
    buffer_load_dwordx4 v[212:215], v3, s[20:23], s58 offen offset:0
    v_mfma_f32_16x16x32_bf16 v[96:99], v[248:251], a[196:199], v[96:99]
    v_mul_f32 v134, v134, v10
    v_add_f32 v11, 1.0, v11
    v_mfma_f32_16x16x32_bf16 v[92:95], v[248:251], a[192:195], v[92:95]
    s_waitcnt vmcnt(17)
    v_rcp_f32 v11, v11
    v_mfma_f32_16x16x32_bf16 v[76:79], v[252:255], a[208:211], v[76:79]
    v_mul_f32 v10, v120, v120
    v_mfma_f32_16x16x32_bf16 v[80:83], v[252:255], a[212:215], v[80:83]
    buffer_load_dwordx4 v[216:219], v3, s[20:23], s32 offen offset:1024
    v_mfma_f32_16x16x32_bf16 v[84:87], v[252:255], a[216:219], v[84:87]
    v_fma_f32 v10, v10, s35, v7
    v_mul_f32 v10, v10, v120
    v_mfma_f32_16x16x32_bf16 v[88:91], v[252:255], a[220:223], v[88:91]
    s_waitcnt vmcnt(17)
    v_exp_f32 v10, v10
    v_mfma_f32_16x16x32_bf16 v[104:107], v[148:151], a[220:223], v[104:107]
    v_mul_f32 v136, v136, v120
    v_mfma_f32_16x16x32_bf16 v[100:103], v[148:151], a[216:219], v[100:103]
    buffer_load_dwordx4 v[220:223], v3, s[20:23], s58 offen offset:1024
    v_mfma_f32_16x16x32_bf16 v[96:99], v[148:151], a[212:215], v[96:99]
    v_mul_f32 v135, v135, v11
    v_add_f32 v10, 1.0, v10
    v_mfma_f32_16x16x32_bf16 v[92:95], v[148:151], a[208:211], v[92:95]
    s_waitcnt vmcnt(17)
    v_cvt_pk_bf16_f32 v145, v134, v135
    v_mfma_f32_16x16x32_bf16 v[76:79], v[152:155], a[224:227], v[76:79]
    v_rcp_f32 v10, v10
    v_mfma_f32_16x16x32_bf16 v[80:83], v[152:155], a[228:231], v[80:83]
    buffer_load_dwordx4 v[224:227], v3, s[20:23], s32 offen offset:2048
    v_mfma_f32_16x16x32_bf16 v[84:87], v[152:155], a[232:235], v[84:87]
    v_mul_f32 v11, v121, v121
    v_fma_f32 v11, v11, s35, v7
    v_mfma_f32_16x16x32_bf16 v[88:91], v[152:155], a[236:239], v[88:91]
    s_waitcnt vmcnt(17)
    v_mul_f32 v11, v11, v121
    v_mfma_f32_16x16x32_bf16 v[104:107], v[156:159], a[236:239], v[104:107]
    v_exp_f32 v11, v11
    v_mfma_f32_16x16x32_bf16 v[100:103], v[156:159], a[232:235], v[100:103]
    buffer_load_dwordx4 v[228:231], v3, s[20:23], s58 offen offset:2048
    v_mfma_f32_16x16x32_bf16 v[96:99], v[156:159], a[228:231], v[96:99]
    v_mul_f32 v137, v137, v121
    v_mul_f32 v136, v136, v10
    v_mfma_f32_16x16x32_bf16 v[92:95], v[156:159], a[224:227], v[92:95]
    s_waitcnt vmcnt(17)
    v_add_f32 v11, 1.0, v11
    v_mfma_f32_16x16x32_bf16 v[76:79], v[160:163], a[240:243], v[76:79]
    s_add_u32 s32, s58, s54
    v_rcp_f32 v11, v11
    v_mfma_f32_16x16x32_bf16 v[80:83], v[160:163], a[244:247], v[80:83]
    buffer_load_dwordx4 v[232:235], v3, s[20:23], s32 offen offset:0
    v_mfma_f32_16x16x32_bf16 v[84:87], v[160:163], a[248:251], v[84:87]
    ds_write_b64 v4, v[144:145] offset:43008
    v_mul_f32 v10, v122, v122
    v_mfma_f32_16x16x32_bf16 v[88:91], v[160:163], a[252:255], v[88:91]
    s_waitcnt vmcnt(17)
    v_fma_f32 v10, v10, s35, v7
    v_mul_f32 v10, v10, v122
    v_mfma_f32_16x16x32_bf16 v[104:107], v[164:167], a[252:255], v[104:107]
    s_add_u32 s58, s32, 12288
    v_exp_f32 v10, v10
    v_mfma_f32_16x16x32_bf16 v[100:103], v[164:167], a[248:251], v[100:103]
    buffer_load_dwordx4 v[236:239], v3, s[20:23], s58 offen offset:0
    v_mfma_f32_16x16x32_bf16 v[96:99], v[164:167], a[244:247], v[96:99]
    v_mul_f32 v138, v138, v122
    v_mfma_f32_16x16x32_bf16 v[92:95], v[164:167], a[240:243], v[92:95]
    s_waitcnt vmcnt(17)
    v_mul_f32 v137, v137, v11
    v_add_f32 v10, 1.0, v10
    v_mfma_f32_16x16x32_bf16 v[76:79], v[168:171], v[12:15], v[76:79]
    v_cvt_pk_bf16_f32 v146, v136, v137
    v_mfma_f32_16x16x32_bf16 v[80:83], v[168:171], v[16:19], v[80:83]
    buffer_load_dwordx4 v[240:243], v3, s[20:23], s32 offen offset:1024
    v_mfma_f32_16x16x32_bf16 v[84:87], v[168:171], v[20:23], v[84:87]
    v_rcp_f32 v10, v10
    v_mfma_f32_16x16x32_bf16 v[88:91], v[168:171], v[24:27], v[88:91]
    s_waitcnt vmcnt(17)
    v_mul_f32 v11, v123, v123
    v_fma_f32 v11, v11, s35, v7
    v_mfma_f32_16x16x32_bf16 v[104:107], v[172:175], v[24:27], v[104:107]
    v_mul_f32 v11, v11, v123
    v_mfma_f32_16x16x32_bf16 v[100:103], v[172:175], v[20:23], v[100:103]
    buffer_load_dwordx4 v[244:247], v3, s[20:23], s58 offen offset:1024
    v_mfma_f32_16x16x32_bf16 v[96:99], v[172:175], v[16:19], v[96:99]
    v_exp_f32 v11, v11
    v_mfma_f32_16x16x32_bf16 v[92:95], v[172:175], v[12:15], v[92:95]
    s_waitcnt vmcnt(17)
    v_mul_f32 v139, v139, v123
    v_mul_f32 v138, v138, v10
    v_mfma_f32_16x16x32_bf16 v[76:79], v[176:179], v[28:31], v[76:79]
    v_add_f32 v11, 1.0, v11
    v_mfma_f32_16x16x32_bf16 v[80:83], v[176:179], v[32:35], v[80:83]
    buffer_load_dwordx4 v[248:251], v3, s[20:23], s32 offen offset:2048
    v_mfma_f32_16x16x32_bf16 v[84:87], v[176:179], v[36:39], v[84:87]
    v_rcp_f32 v11, v11
    v_mfma_f32_16x16x32_bf16 v[88:91], v[176:179], v[40:43], v[88:91]
    s_waitcnt vmcnt(17)
    v_nop
    v_mul_f32 v139, v139, v11
    v_mfma_f32_16x16x32_bf16 v[104:107], v[180:183], v[40:43], v[104:107]
    v_cvt_pk_bf16_f32 v147, v138, v139
    v_mfma_f32_16x16x32_bf16 v[100:103], v[180:183], v[36:39], v[100:103]
    buffer_load_dwordx4 v[252:255], v3, s[20:23], s58 offen offset:2048
    v_mfma_f32_16x16x32_bf16 v[96:99], v[180:183], v[32:35], v[96:99]
    ds_write_b64 v4, v[146:147] offset:44032
    v_nop
    v_mfma_f32_16x16x32_bf16 v[92:95], v[180:183], v[28:31], v[92:95]
    s_waitcnt vmcnt(17)
    v_mfma_f32_16x16x32_bf16 v[108:111], v[184:187], a[0:3], 0
    s_add_u32 s32, s58, s55
    v_mfma_f32_16x16x32_bf16 v[112:115], v[184:187], a[4:7], 0
    buffer_load_dwordx4 v[148:151], v3, s[20:23], s32 offen offset:0
    v_mfma_f32_16x16x32_bf16 v[116:119], v[184:187], a[8:11], 0
    v_mfma_f32_16x16x32_bf16 v[120:123], v[184:187], a[12:15], 0
    s_waitcnt vmcnt(17)
    v_mfma_f32_16x16x32_bf16 v[136:139], v[188:191], a[12:15], 0
    s_add_u32 s58, s32, 12288
    v_mul_f32 v10, v76, v76
    v_fma_f32 v10, v10, s35, v7
    v_mfma_f32_16x16x32_bf16 v[132:135], v[188:191], a[8:11], 0
    buffer_load_dwordx4 v[152:155], v3, s[20:23], s58 offen offset:0
    v_mfma_f32_16x16x32_bf16 v[128:131], v[188:191], a[4:7], 0
    v_mul_f32 v10, v10, v76
    v_mfma_f32_16x16x32_bf16 v[124:127], v[188:191], a[0:3], 0
    s_waitcnt vmcnt(17)
    v_exp_f32 v10, v10
    v_mfma_f32_16x16x32_bf16 v[108:111], v[192:195], a[16:19], v[108:111]
    v_mul_f32 v92, v92, v76
    v_add_f32 v10, 1.0, v10
    v_mfma_f32_16x16x32_bf16 v[112:115], v[192:195], a[20:23], v[112:115]
    buffer_load_dwordx4 v[156:159], v3, s[20:23], s32 offen offset:1024
    v_mfma_f32_16x16x32_bf16 v[116:119], v[192:195], a[24:27], v[116:119]
    v_rcp_f32 v10, v10
    v_mfma_f32_16x16x32_bf16 v[120:123], v[192:195], a[28:31], v[120:123]
    s_waitcnt vmcnt(17)
    v_mul_f32 v11, v77, v77
    v_mfma_f32_16x16x32_bf16 v[136:139], v[196:199], a[28:31], v[136:139]
    v_fma_f32 v11, v11, s35, v7
    v_mul_f32 v11, v11, v77
    v_mfma_f32_16x16x32_bf16 v[132:135], v[196:199], a[24:27], v[132:135]
    buffer_load_dwordx4 v[160:163], v3, s[20:23], s58 offen offset:1024
    v_mfma_f32_16x16x32_bf16 v[128:131], v[196:199], a[20:23], v[128:131]
    v_exp_f32 v11, v11
    v_mfma_f32_16x16x32_bf16 v[124:127], v[196:199], a[16:19], v[124:127]
    s_waitcnt vmcnt(17)
    v_mul_f32 v93, v93, v77
    v_mfma_f32_16x16x32_bf16 v[108:111], v[200:203], a[32:35], v[108:111]
    v_mul_f32 v92, v92, v10
    v_add_f32 v11, 1.0, v11
    v_mfma_f32_16x16x32_bf16 v[112:115], v[200:203], a[36:39], v[112:115]
    buffer_load_dwordx4 v[164:167], v3, s[20:23], s32 offen offset:2048
    v_mfma_f32_16x16x32_bf16 v[116:119], v[200:203], a[40:43], v[116:119]
    v_rcp_f32 v11, v11
    v_mfma_f32_16x16x32_bf16 v[120:123], v[200:203], a[44:47], v[120:123]
    s_waitcnt vmcnt(17)
    v_mul_f32 v10, v78, v78
    v_mfma_f32_16x16x32_bf16 v[136:139], v[204:207], a[44:47], v[136:139]
    v_fma_f32 v10, v10, s35, v7
    v_mul_f32 v10, v10, v78
    v_mfma_f32_16x16x32_bf16 v[132:135], v[204:207], a[40:43], v[132:135]
    buffer_load_dwordx4 v[168:171], v3, s[20:23], s58 offen offset:2048
    v_mfma_f32_16x16x32_bf16 v[128:131], v[204:207], a[36:39], v[128:131]
    v_exp_f32 v10, v10
    v_mfma_f32_16x16x32_bf16 v[124:127], v[204:207], a[32:35], v[124:127]
    s_waitcnt vmcnt(17)
    v_mul_f32 v94, v94, v78
    v_mfma_f32_16x16x32_bf16 v[108:111], v[208:211], a[48:51], v[108:111]
    s_add_u32 s32, s58, s56
    v_mul_f32 v93, v93, v11
    v_add_f32 v10, 1.0, v10
    v_mfma_f32_16x16x32_bf16 v[112:115], v[208:211], a[52:55], v[112:115]
    buffer_load_dwordx4 v[172:175], v3, s[20:23], s32 offen offset:0
    v_mfma_f32_16x16x32_bf16 v[116:119], v[208:211], a[56:59], v[116:119]
    v_cvt_pk_bf16_f32 v140, v92, v93
    v_mfma_f32_16x16x32_bf16 v[120:123], v[208:211], a[60:63], v[120:123]
    s_waitcnt vmcnt(17)
    v_rcp_f32 v10, v10
    v_mfma_f32_16x16x32_bf16 v[136:139], v[212:215], a[60:63], v[136:139]
    s_add_u32 s58, s32, 12288
    v_mul_f32 v11, v79, v79
    v_fma_f32 v11, v11, s35, v7
    v_mfma_f32_16x16x32_bf16 v[132:135], v[212:215], a[56:59], v[132:135]
    buffer_load_dwordx4 v[176:179], v3, s[20:23], s58 offen offset:0
    v_mfma_f32_16x16x32_bf16 v[128:131], v[212:215], a[52:55], v[128:131]
    v_mul_f32 v11, v11, v79
    v_mfma_f32_16x16x32_bf16 v[124:127], v[212:215], a[48:51], v[124:127]
    s_waitcnt vmcnt(17)
    v_exp_f32 v11, v11
    v_mfma_f32_16x16x32_bf16 v[108:111], v[216:219], a[64:67], v[108:111]
    v_mul_f32 v95, v95, v79
    v_mul_f32 v94, v94, v10
    v_mfma_f32_16x16x32_bf16 v[112:115], v[216:219], a[68:71], v[112:115]
    buffer_load_dwordx4 v[180:183], v3, s[20:23], s32 offen offset:1024
    v_mfma_f32_16x16x32_bf16 v[116:119], v[216:219], a[72:75], v[116:119]
    v_add_f32 v11, 1.0, v11
    v_mfma_f32_16x16x32_bf16 v[120:123], v[216:219], a[76:79], v[120:123]
    s_waitcnt vmcnt(17)
    v_rcp_f32 v11, v11
    v_mfma_f32_16x16x32_bf16 v[136:139], v[220:223], a[76:79], v[136:139]
    v_mul_f32 v10, v80, v80
    v_fma_f32 v10, v10, s35, v7
    v_mfma_f32_16x16x32_bf16 v[132:135], v[220:223], a[72:75], v[132:135]
    buffer_load_dwordx4 v[184:187], v3, s[20:23], s58 offen offset:1024
    v_mfma_f32_16x16x32_bf16 v[128:131], v[220:223], a[68:71], v[128:131]
    v_mul_f32 v10, v10, v80
    v_mfma_f32_16x16x32_bf16 v[124:127], v[220:223], a[64:67], v[124:127]
    s_waitcnt vmcnt(17)
    v_exp_f32 v10, v10
    v_mfma_f32_16x16x32_bf16 v[108:111], v[224:227], a[80:83], v[108:111]
    v_mul_f32 v96, v96, v80
    v_mul_f32 v95, v95, v11
    v_mfma_f32_16x16x32_bf16 v[112:115], v[224:227], a[84:87], v[112:115]
    buffer_load_dwordx4 v[188:191], v3, s[20:23], s32 offen offset:2048
    v_mfma_f32_16x16x32_bf16 v[116:119], v[224:227], a[88:91], v[116:119]
    v_add_f32 v10, 1.0, v10
    v_cvt_pk_bf16_f32 v141, v94, v95
    v_mfma_f32_16x16x32_bf16 v[120:123], v[224:227], a[92:95], v[120:123]
    s_waitcnt vmcnt(17)
    v_rcp_f32 v10, v10
    v_mfma_f32_16x16x32_bf16 v[136:139], v[228:231], a[92:95], v[136:139]
    v_mul_f32 v11, v81, v81
    v_mfma_f32_16x16x32_bf16 v[132:135], v[228:231], a[88:91], v[132:135]
    buffer_load_dwordx4 v[192:195], v3, s[20:23], s58 offen offset:2048
    v_mfma_f32_16x16x32_bf16 v[128:131], v[228:231], a[84:87], v[128:131]
    v_fma_f32 v11, v11, s35, v7
    v_mul_f32 v11, v11, v81
    v_mfma_f32_16x16x32_bf16 v[124:127], v[228:231], a[80:83], v[124:127]
    s_waitcnt vmcnt(17)
    v_exp_f32 v11, v11
    v_mfma_f32_16x16x32_bf16 v[108:111], v[232:235], a[96:99], v[108:111]
    s_add_u32 s32, s58, s57
    v_mul_f32 v97, v97, v81
    v_mfma_f32_16x16x32_bf16 v[112:115], v[232:235], a[100:103], v[112:115]
    buffer_load_dwordx4 v[196:199], v3, s[20:23], s32 offen offset:0
    v_mfma_f32_16x16x32_bf16 v[116:119], v[232:235], a[104:107], v[116:119]
    v_mul_f32 v96, v96, v10
    v_add_f32 v11, 1.0, v11
    v_mfma_f32_16x16x32_bf16 v[120:123], v[232:235], a[108:111], v[120:123]
    s_waitcnt vmcnt(17)
    v_rcp_f32 v11, v11
    v_mfma_f32_16x16x32_bf16 v[136:139], v[236:239], a[108:111], v[136:139]
    s_add_u32 s58, s32, 12288
    ds_write_b64 v4, v[140:141] offset:49152
    v_mfma_f32_16x16x32_bf16 v[132:135], v[236:239], a[104:107], v[132:135]
    buffer_load_dwordx4 v[200:203], v3, s[20:23], s58 offen offset:0
    v_mfma_f32_16x16x32_bf16 v[128:131], v[236:239], a[100:103], v[128:131]
    v_mul_f32 v10, v82, v82
    v_fma_f32 v10, v10, s35, v7
    v_mfma_f32_16x16x32_bf16 v[124:127], v[236:239], a[96:99], v[124:127]
    s_waitcnt vmcnt(17)
    v_mul_f32 v10, v10, v82
    v_mfma_f32_16x16x32_bf16 v[108:111], v[240:243], a[112:115], v[108:111]
    v_exp_f32 v10, v10
    v_mfma_f32_16x16x32_bf16 v[112:115], v[240:243], a[116:119], v[112:115]
    buffer_load_dwordx4 v[204:207], v3, s[20:23], s32 offen offset:1024
    v_mfma_f32_16x16x32_bf16 v[116:119], v[240:243], a[120:123], v[116:119]
    v_mul_f32 v98, v98, v82
    v_mul_f32 v97, v97, v11
    v_mfma_f32_16x16x32_bf16 v[120:123], v[240:243], a[124:127], v[120:123]
    s_waitcnt vmcnt(17)
    v_add_f32 v10, 1.0, v10
    v_mfma_f32_16x16x32_bf16 v[136:139], v[244:247], a[124:127], v[136:139]
    v_cvt_pk_bf16_f32 v142, v96, v97
    v_mfma_f32_16x16x32_bf16 v[132:135], v[244:247], a[120:123], v[132:135]
    buffer_load_dwordx4 v[208:211], v3, s[20:23], s58 offen offset:1024
    v_mfma_f32_16x16x32_bf16 v[128:131], v[244:247], a[116:119], v[128:131]
    v_rcp_f32 v10, v10
    v_mfma_f32_16x16x32_bf16 v[124:127], v[244:247], a[112:115], v[124:127]
    s_waitcnt vmcnt(17)
    v_mul_f32 v11, v83, v83
    v_fma_f32 v11, v11, s35, v7
    v_mfma_f32_16x16x32_bf16 v[108:111], v[248:251], a[128:131], v[108:111]
    v_mul_f32 v11, v11, v83
    v_mfma_f32_16x16x32_bf16 v[112:115], v[248:251], a[132:135], v[112:115]
    buffer_load_dwordx4 v[212:215], v3, s[20:23], s32 offen offset:2048
    v_mfma_f32_16x16x32_bf16 v[116:119], v[248:251], a[136:139], v[116:119]
    v_exp_f32 v11, v11
    v_mfma_f32_16x16x32_bf16 v[120:123], v[248:251], a[140:143], v[120:123]
    s_waitcnt vmcnt(17)
    v_mul_f32 v99, v99, v83
    v_mul_f32 v98, v98, v10
    v_mfma_f32_16x16x32_bf16 v[136:139], v[252:255], a[140:143], v[136:139]
    v_add_f32 v11, 1.0, v11
    v_mfma_f32_16x16x32_bf16 v[132:135], v[252:255], a[136:139], v[132:135]
    buffer_load_dwordx4 v[216:219], v3, s[20:23], s58 offen offset:2048
    v_mfma_f32_16x16x32_bf16 v[128:131], v[252:255], a[132:135], v[128:131]
    v_rcp_f32 v11, v11
    v_mfma_f32_16x16x32_bf16 v[124:127], v[252:255], a[128:131], v[124:127]
    s_waitcnt vmcnt(17)
    v_mul_f32 v10, v84, v84
    v_fma_f32 v10, v10, s35, v7
    v_mfma_f32_16x16x32_bf16 v[108:111], v[148:151], a[144:147], v[108:111]
    s_add_u32 s32, s58, s52
    v_mul_f32 v10, v10, v84
    v_mfma_f32_16x16x32_bf16 v[112:115], v[148:151], a[148:151], v[112:115]
    buffer_load_dwordx4 v[220:223], v3, s[20:23], s32 offen offset:0
    v_mfma_f32_16x16x32_bf16 v[116:119], v[148:151], a[152:155], v[116:119]
    v_exp_f32 v10, v10
    v_mfma_f32_16x16x32_bf16 v[120:123], v[148:151], a[156:159], v[120:123]
    s_waitcnt vmcnt(17)
    v_mul_f32 v100, v100, v84
    v_mul_f32 v99, v99, v11
    v_mfma_f32_16x16x32_bf16 v[136:139], v[152:155], a[156:159], v[136:139]
    s_add_u32 s58, s32, 12288
    v_add_f32 v10, 1.0, v10
    v_cvt_pk_bf16_f32 v143, v98, v99
    v_mfma_f32_16x16x32_bf16 v[132:135], v[152:155], a[152:155], v[132:135]
    buffer_load_dwordx4 v[224:227], v3, s[20:23], s58 offen offset:0
    v_mfma_f32_16x16x32_bf16 v[128:131], v[152:155], a[148:151], v[128:131]
    v_rcp_f32 v10, v10
    v_mfma_f32_16x16x32_bf16 v[124:127], v[152:155], a[144:147], v[124:127]
    s_waitcnt vmcnt(17)
    v_mul_f32 v11, v85, v85
    v_mfma_f32_16x16x32_bf16 v[108:111], v[156:159], a[160:163], v[108:111]
    v_fma_f32 v11, v11, s35, v7
    v_mul_f32 v11, v11, v85
    v_mfma_f32_16x16x32_bf16 v[112:115], v[156:159], a[164:167], v[112:115]
    buffer_load_dwordx4 v[228:231], v3, s[20:23], s32 offen offset:1024
    v_mfma_f32_16x16x32_bf16 v[116:119], v[156:159], a[168:171], v[116:119]
    v_exp_f32 v11, v11
    v_mfma_f32_16x16x32_bf16 v[120:123], v[156:159], a[172:175], v[120:123]
    s_waitcnt vmcnt(17)
    v_mul_f32 v101, v101, v85
    v_mfma_f32_16x16x32_bf16 v[136:139], v[160:163], a[172:175], v[136:139]
    v_mul_f32 v100, v100, v10
    v_add_f32 v11, 1.0, v11
    v_mfma_f32_16x16x32_bf16 v[132:135], v[160:163], a[168:171], v[132:135]
    buffer_load_dwordx4 v[232:235], v3, s[20:23], s58 offen offset:1024
    v_mfma_f32_16x16x32_bf16 v[128:131], v[160:163], a[164:167], v[128:131]
    v_rcp_f32 v11, v11
    v_mfma_f32_16x16x32_bf16 v[124:127], v[160:163], a[160:163], v[124:127]
    s_waitcnt vmcnt(17)
    ds_write_b64 v4, v[142:143] offset:50176
    v_mfma_f32_16x16x32_bf16 v[108:111], v[164:167], a[176:179], v[108:111]
    v_mul_f32 v10, v86, v86
    v_fma_f32 v10, v10, s35, v7
    v_mfma_f32_16x16x32_bf16 v[112:115], v[164:167], a[180:183], v[112:115]
    buffer_load_dwordx4 v[236:239], v3, s[20:23], s32 offen offset:2048
    v_mfma_f32_16x16x32_bf16 v[116:119], v[164:167], a[184:187], v[116:119]
    v_mul_f32 v10, v10, v86
    v_mfma_f32_16x16x32_bf16 v[120:123], v[164:167], a[188:191], v[120:123]
    s_waitcnt vmcnt(17)
    v_exp_f32 v10, v10
    v_mfma_f32_16x16x32_bf16 v[136:139], v[168:171], a[188:191], v[136:139]
    v_mul_f32 v102, v102, v86
    v_mul_f32 v101, v101, v11
    v_mfma_f32_16x16x32_bf16 v[132:135], v[168:171], a[184:187], v[132:135]
    buffer_load_dwordx4 v[240:243], v3, s[20:23], s58 offen offset:2048
    v_mfma_f32_16x16x32_bf16 v[128:131], v[168:171], a[180:183], v[128:131]
    v_add_f32 v10, 1.0, v10
    v_cvt_pk_bf16_f32 v144, v100, v101
    v_mfma_f32_16x16x32_bf16 v[124:127], v[168:171], a[176:179], v[124:127]
    s_waitcnt vmcnt(17)
    v_rcp_f32 v10, v10
    v_mfma_f32_16x16x32_bf16 v[108:111], v[172:175], a[192:195], v[108:111]
    s_add_u32 s32, s58, s53
    v_mul_f32 v11, v87, v87
    v_mfma_f32_16x16x32_bf16 v[112:115], v[172:175], a[196:199], v[112:115]
    buffer_load_dwordx4 v[244:247], v3, s[20:23], s32 offen offset:0
    v_mfma_f32_16x16x32_bf16 v[116:119], v[172:175], a[200:203], v[116:119]
    v_fma_f32 v11, v11, s35, v7
    v_mul_f32 v11, v11, v87
    v_mfma_f32_16x16x32_bf16 v[120:123], v[172:175], a[204:207], v[120:123]
    s_waitcnt vmcnt(17)
    v_exp_f32 v11, v11
    v_mfma_f32_16x16x32_bf16 v[136:139], v[176:179], a[204:207], v[136:139]
    s_add_u32 s58, s32, 12288
    v_mul_f32 v103, v103, v87
    v_mfma_f32_16x16x32_bf16 v[132:135], v[176:179], a[200:203], v[132:135]
    buffer_load_dwordx4 v[248:251], v3, s[20:23], s58 offen offset:0
    v_mfma_f32_16x16x32_bf16 v[128:131], v[176:179], a[196:199], v[128:131]
    v_mul_f32 v102, v102, v10
    v_add_f32 v11, 1.0, v11
    v_mfma_f32_16x16x32_bf16 v[124:127], v[176:179], a[192:195], v[124:127]
    s_waitcnt vmcnt(17)
    v_rcp_f32 v11, v11
    v_mfma_f32_16x16x32_bf16 v[108:111], v[180:183], a[208:211], v[108:111]
    v_mul_f32 v10, v88, v88
    v_mfma_f32_16x16x32_bf16 v[112:115], v[180:183], a[212:215], v[112:115]
    buffer_load_dwordx4 v[252:255], v3, s[20:23], s32 offen offset:1024
    v_mfma_f32_16x16x32_bf16 v[116:119], v[180:183], a[216:219], v[116:119]
    v_fma_f32 v10, v10, s35, v7
    v_mul_f32 v10, v10, v88
    v_mfma_f32_16x16x32_bf16 v[120:123], v[180:183], a[220:223], v[120:123]
    s_waitcnt vmcnt(17)
    v_exp_f32 v10, v10
    v_mfma_f32_16x16x32_bf16 v[136:139], v[184:187], a[220:223], v[136:139]
    v_mul_f32 v104, v104, v88
    v_mfma_f32_16x16x32_bf16 v[132:135], v[184:187], a[216:219], v[132:135]
    buffer_load_dwordx4 v[148:151], v3, s[20:23], s58 offen offset:1024
    v_mfma_f32_16x16x32_bf16 v[128:131], v[184:187], a[212:215], v[128:131]
    v_mul_f32 v103, v103, v11
    v_add_f32 v10, 1.0, v10
    v_mfma_f32_16x16x32_bf16 v[124:127], v[184:187], a[208:211], v[124:127]
    s_waitcnt vmcnt(17)
    v_cvt_pk_bf16_f32 v145, v102, v103
    v_mfma_f32_16x16x32_bf16 v[108:111], v[188:191], a[224:227], v[108:111]
    v_rcp_f32 v10, v10
    v_mfma_f32_16x16x32_bf16 v[112:115], v[188:191], a[228:231], v[112:115]
    buffer_load_dwordx4 v[152:155], v3, s[20:23], s32 offen offset:2048
    v_mfma_f32_16x16x32_bf16 v[116:119], v[188:191], a[232:235], v[116:119]
    v_mul_f32 v11, v89, v89
    v_fma_f32 v11, v11, s35, v7
    v_mfma_f32_16x16x32_bf16 v[120:123], v[188:191], a[236:239], v[120:123]
    s_waitcnt vmcnt(17)
    v_mul_f32 v11, v11, v89
    v_mfma_f32_16x16x32_bf16 v[136:139], v[192:195], a[236:239], v[136:139]
    v_exp_f32 v11, v11
    v_mfma_f32_16x16x32_bf16 v[132:135], v[192:195], a[232:235], v[132:135]
    buffer_load_dwordx4 v[156:159], v3, s[20:23], s58 offen offset:2048
    v_mfma_f32_16x16x32_bf16 v[128:131], v[192:195], a[228:231], v[128:131]
    v_mul_f32 v105, v105, v89
    v_mul_f32 v104, v104, v10
    v_mfma_f32_16x16x32_bf16 v[124:127], v[192:195], a[224:227], v[124:127]
    s_waitcnt vmcnt(17)
    v_add_f32 v11, 1.0, v11
    v_mfma_f32_16x16x32_bf16 v[108:111], v[196:199], a[240:243], v[108:111]
    s_add_u32 s32, s58, s54
    v_rcp_f32 v11, v11
    v_mfma_f32_16x16x32_bf16 v[112:115], v[196:199], a[244:247], v[112:115]
    buffer_load_dwordx4 v[160:163], v3, s[20:23], s32 offen offset:0
    v_mfma_f32_16x16x32_bf16 v[116:119], v[196:199], a[248:251], v[116:119]
    ds_write_b64 v4, v[144:145] offset:51200
    v_mul_f32 v10, v90, v90
    v_mfma_f32_16x16x32_bf16 v[120:123], v[196:199], a[252:255], v[120:123]
    s_waitcnt vmcnt(17)
    v_fma_f32 v10, v10, s35, v7
    v_mul_f32 v10, v10, v90
    v_mfma_f32_16x16x32_bf16 v[136:139], v[200:203], a[252:255], v[136:139]
    s_add_u32 s58, s32, 12288
    v_exp_f32 v10, v10
    v_mfma_f32_16x16x32_bf16 v[132:135], v[200:203], a[248:251], v[132:135]
    buffer_load_dwordx4 v[164:167], v3, s[20:23], s58 offen offset:0
    v_mfma_f32_16x16x32_bf16 v[128:131], v[200:203], a[244:247], v[128:131]
    v_mul_f32 v106, v106, v90
    v_mfma_f32_16x16x32_bf16 v[124:127], v[200:203], a[240:243], v[124:127]
    s_waitcnt vmcnt(17)
    v_mul_f32 v105, v105, v11
    v_add_f32 v10, 1.0, v10
    v_mfma_f32_16x16x32_bf16 v[108:111], v[204:207], v[12:15], v[108:111]
    v_cvt_pk_bf16_f32 v146, v104, v105
    v_mfma_f32_16x16x32_bf16 v[112:115], v[204:207], v[16:19], v[112:115]
    buffer_load_dwordx4 v[168:171], v3, s[20:23], s32 offen offset:1024
    v_mfma_f32_16x16x32_bf16 v[116:119], v[204:207], v[20:23], v[116:119]
    v_rcp_f32 v10, v10
    v_mfma_f32_16x16x32_bf16 v[120:123], v[204:207], v[24:27], v[120:123]
    s_waitcnt vmcnt(17)
    v_mul_f32 v11, v91, v91
    v_fma_f32 v11, v11, s35, v7
    v_mfma_f32_16x16x32_bf16 v[136:139], v[208:211], v[24:27], v[136:139]
    v_mul_f32 v11, v11, v91
    v_mfma_f32_16x16x32_bf16 v[132:135], v[208:211], v[20:23], v[132:135]
    buffer_load_dwordx4 v[172:175], v3, s[20:23], s58 offen offset:1024
    v_mfma_f32_16x16x32_bf16 v[128:131], v[208:211], v[16:19], v[128:131]
    v_exp_f32 v11, v11
    v_mfma_f32_16x16x32_bf16 v[124:127], v[208:211], v[12:15], v[124:127]
    s_waitcnt vmcnt(17)
    v_mul_f32 v107, v107, v91
    v_mul_f32 v106, v106, v10
    v_mfma_f32_16x16x32_bf16 v[108:111], v[212:215], v[28:31], v[108:111]
    v_add_f32 v11, 1.0, v11
    v_mfma_f32_16x16x32_bf16 v[112:115], v[212:215], v[32:35], v[112:115]
    buffer_load_dwordx4 v[176:179], v3, s[20:23], s32 offen offset:2048
    v_mfma_f32_16x16x32_bf16 v[116:119], v[212:215], v[36:39], v[116:119]
    v_rcp_f32 v11, v11
    v_mfma_f32_16x16x32_bf16 v[120:123], v[212:215], v[40:43], v[120:123]
    s_waitcnt vmcnt(17)
    v_nop
    v_mul_f32 v107, v107, v11
    v_mfma_f32_16x16x32_bf16 v[136:139], v[216:219], v[40:43], v[136:139]
    v_cvt_pk_bf16_f32 v147, v106, v107
    v_mfma_f32_16x16x32_bf16 v[132:135], v[216:219], v[36:39], v[132:135]
    buffer_load_dwordx4 v[180:183], v3, s[20:23], s58 offen offset:2048
    v_mfma_f32_16x16x32_bf16 v[128:131], v[216:219], v[32:35], v[128:131]
    ds_write_b64 v4, v[146:147] offset:52224
    v_nop
    v_mfma_f32_16x16x32_bf16 v[124:127], v[216:219], v[28:31], v[124:127]
    s_waitcnt vmcnt(17)
    v_mfma_f32_16x16x32_bf16 v[76:79], v[220:223], a[0:3], 0
    s_add_u32 s32, s58, s55
    v_mfma_f32_16x16x32_bf16 v[80:83], v[220:223], a[4:7], 0
    buffer_load_dwordx4 v[184:187], v3, s[20:23], s32 offen offset:0
    v_mfma_f32_16x16x32_bf16 v[84:87], v[220:223], a[8:11], 0
    s_waitcnt vmcnt(17) lgkmcnt(0)
    v_mfma_f32_16x16x32_bf16 v[88:91], v[220:223], a[12:15], 0
    s_barrier
    v_mfma_f32_16x16x32_bf16 v[104:107], v[224:227], a[12:15], 0
    s_add_u32 s58, s32, 12288
    ds_read_b128 v[44:47], v5 offset:0
    v_mul_f32 v10, v108, v108
    v_mfma_f32_16x16x32_bf16 v[100:103], v[224:227], a[8:11], 0
    buffer_load_dwordx4 v[188:191], v3, s[20:23], s58 offen offset:0
    v_fma_f32 v10, v10, s35, v7
    v_mfma_f32_16x16x32_bf16 v[96:99], v[224:227], a[4:7], 0
    ds_read_b128 v[48:51], v5 offset:1024
    v_mul_f32 v10, v10, v108
    v_mfma_f32_16x16x32_bf16 v[92:95], v[224:227], a[0:3], 0
    s_waitcnt vmcnt(17)
    ds_read_b128 v[52:55], v5 offset:2048
    v_mfma_f32_16x16x32_bf16 v[76:79], v[228:231], a[16:19], v[76:79]
    ds_read_b128 v[56:59], v5 offset:3072
    v_mfma_f32_16x16x32_bf16 v[80:83], v[228:231], a[20:23], v[80:83]
    buffer_load_dwordx4 v[192:195], v3, s[20:23], s32 offen offset:1024
    v_mfma_f32_16x16x32_bf16 v[84:87], v[228:231], a[24:27], v[84:87]
    ds_read_b128 v[60:63], v5 offset:4096
    v_exp_f32 v10, v10
    v_mfma_f32_16x16x32_bf16 v[88:91], v[228:231], a[28:31], v[88:91]
    s_waitcnt vmcnt(17)
    ds_read_b128 v[64:67], v5 offset:5120
    v_mul_f32 v124, v124, v108
    v_mfma_f32_16x16x32_bf16 v[104:107], v[232:235], a[28:31], v[104:107]
    ds_read_b128 v[68:71], v5 offset:6144
    v_add_f32 v10, 1.0, v10
    v_mfma_f32_16x16x32_bf16 v[100:103], v[232:235], a[24:27], v[100:103]
    buffer_load_dwordx4 v[196:199], v3, s[20:23], s58 offen offset:1024
    v_mfma_f32_16x16x32_bf16 v[96:99], v[232:235], a[20:23], v[96:99]
    ds_read_b128 v[72:75], v5 offset:7168
    v_rcp_f32 v10, v10
    v_mfma_f32_16x16x32_bf16 v[92:95], v[232:235], a[16:19], v[92:95]
    s_waitcnt vmcnt(17)
    v_mul_f32 v11, v109, v109
    v_fma_f32 v11, v11, s35, v7
    v_mfma_f32_16x16x32_bf16 v[76:79], v[236:239], a[32:35], v[76:79]
    ds_read_b128 a[0:3], v5 offset:8192
    v_mul_f32 v11, v11, v109
    v_mfma_f32_16x16x32_bf16 v[80:83], v[236:239], a[36:39], v[80:83]
    buffer_load_dwordx4 v[200:203], v3, s[20:23], s32 offen offset:2048
    v_mfma_f32_16x16x32_bf16 v[84:87], v[236:239], a[40:43], v[84:87]
    ds_read_b128 a[4:7], v5 offset:9216
    v_exp_f32 v11, v11
    v_mfma_f32_16x16x32_bf16 v[88:91], v[236:239], a[44:47], v[88:91]
    s_waitcnt vmcnt(17)
    ds_read_b128 a[8:11], v5 offset:10240
    v_mul_f32 v125, v125, v109
    v_mfma_f32_16x16x32_bf16 v[104:107], v[240:243], a[44:47], v[104:107]
    ds_read_b128 a[12:15], v5 offset:11264
    v_mul_f32 v124, v124, v10
    v_add_f32 v11, 1.0, v11
    v_mfma_f32_16x16x32_bf16 v[100:103], v[240:243], a[40:43], v[100:103]
    buffer_load_dwordx4 v[204:207], v3, s[20:23], s58 offen offset:2048
    v_mfma_f32_16x16x32_bf16 v[96:99], v[240:243], a[36:39], v[96:99]
    ds_read_b128 a[16:19], v5 offset:12288
    v_mfma_f32_16x16x32_bf16 v[92:95], v[240:243], a[32:35], v[92:95]
    s_waitcnt vmcnt(17)
    ds_read_b128 a[20:23], v5 offset:13312
    v_rcp_f32 v11, v11
    v_mfma_f32_16x16x32_bf16 v[76:79], v[244:247], a[48:51], v[76:79]
    s_add_u32 s32, s58, s56
    ds_read_b128 a[24:27], v5 offset:14336
    v_mul_f32 v10, v110, v110
    v_mfma_f32_16x16x32_bf16 v[80:83], v[244:247], a[52:55], v[80:83]
    buffer_load_dwordx4 v[208:211], v3, s[20:23], s32 offen offset:0
    v_mfma_f32_16x16x32_bf16 v[84:87], v[244:247], a[56:59], v[84:87]
    ds_read_b128 a[28:31], v5 offset:15360
    v_fma_f32 v10, v10, s35, v7
    v_mfma_f32_16x16x32_bf16 v[88:91], v[244:247], a[60:63], v[88:91]
    s_waitcnt vmcnt(17)
    v_mul_f32 v10, v10, v110
    v_exp_f32 v10, v10
    v_mfma_f32_16x16x32_bf16 v[104:107], v[248:251], a[60:63], v[104:107]
    s_add_u32 s58, s32, 12288
    v_mul_f32 v126, v126, v110
    v_mul_f32 v125, v125, v11
    v_mfma_f32_16x16x32_bf16 v[100:103], v[248:251], a[56:59], v[100:103]
    buffer_load_dwordx4 v[212:215], v3, s[20:23], s58 offen offset:0
    v_mfma_f32_16x16x32_bf16 v[96:99], v[248:251], a[52:55], v[96:99]
    v_add_f32 v10, 1.0, v10
    v_cvt_pk_bf16_f32 v140, v124, v125
    v_mfma_f32_16x16x32_bf16 v[92:95], v[248:251], a[48:51], v[92:95]
    s_waitcnt vmcnt(17)
    v_rcp_f32 v10, v10
    v_mul_f32 v11, v111, v111
    v_mfma_f32_16x16x32_bf16 v[76:79], v[252:255], a[64:67], v[76:79]
    ds_read_b128 a[32:35], v5 offset:16384
    v_fma_f32 v11, v11, s35, v7
    v_mfma_f32_16x16x32_bf16 v[80:83], v[252:255], a[68:71], v[80:83]
    buffer_load_dwordx4 v[216:219], v3, s[20:23], s32 offen offset:1024
    v_mfma_f32_16x16x32_bf16 v[84:87], v[252:255], a[72:75], v[84:87]
    ds_read_b128 a[36:39], v5 offset:17408
    v_mul_f32 v11, v11, v111
    v_mfma_f32_16x16x32_bf16 v[88:91], v[252:255], a[76:79], v[88:91]
    s_waitcnt vmcnt(17)
    ds_read_b128 a[40:43], v5 offset:18432
    v_exp_f32 v11, v11
    v_mfma_f32_16x16x32_bf16 v[104:107], v[148:151], a[76:79], v[104:107]
    ds_read_b128 a[44:47], v5 offset:19456
    v_mul_f32 v127, v127, v111
    v_mfma_f32_16x16x32_bf16 v[100:103], v[148:151], a[72:75], v[100:103]
    buffer_load_dwordx4 v[220:223], v3, s[20:23], s58 offen offset:1024
    v_mul_f32 v126, v126, v10
    v_mfma_f32_16x16x32_bf16 v[96:99], v[148:151], a[68:71], v[96:99]
    ds_read_b128 a[48:51], v5 offset:20480
    v_add_f32 v11, 1.0, v11
    v_mfma_f32_16x16x32_bf16 v[92:95], v[148:151], a[64:67], v[92:95]
    s_waitcnt vmcnt(17)
    ds_read_b128 a[52:55], v5 offset:21504
    v_mfma_f32_16x16x32_bf16 v[76:79], v[152:155], a[80:83], v[76:79]
    ds_read_b128 a[56:59], v5 offset:22528
    v_mfma_f32_16x16x32_bf16 v[80:83], v[152:155], a[84:87], v[80:83]
    buffer_load_dwordx4 v[224:227], v3, s[20:23], s32 offen offset:2048
    v_mfma_f32_16x16x32_bf16 v[84:87], v[152:155], a[88:91], v[84:87]
    ds_read_b128 a[60:63], v5 offset:23552
    v_rcp_f32 v11, v11
    v_mfma_f32_16x16x32_bf16 v[88:91], v[152:155], a[92:95], v[88:91]
    s_waitcnt vmcnt(17)
    v_mul_f32 v10, v112, v112
    v_fma_f32 v10, v10, s35, v7
    v_mfma_f32_16x16x32_bf16 v[104:107], v[156:159], a[92:95], v[104:107]
    v_mul_f32 v10, v10, v112
    v_exp_f32 v10, v10
    v_mfma_f32_16x16x32_bf16 v[100:103], v[156:159], a[88:91], v[100:103]
    buffer_load_dwordx4 v[228:231], v3, s[20:23], s58 offen offset:2048
    v_mfma_f32_16x16x32_bf16 v[96:99], v[156:159], a[84:87], v[96:99]
    v_mul_f32 v128, v128, v112
    v_mul_f32 v127, v127, v11
    v_mfma_f32_16x16x32_bf16 v[92:95], v[156:159], a[80:83], v[92:95]
    s_waitcnt vmcnt(17)
    v_add_f32 v10, 1.0, v10
    v_cvt_pk_bf16_f32 v141, v126, v127
    v_mfma_f32_16x16x32_bf16 v[76:79], v[160:163], a[96:99], v[76:79]
    s_add_u32 s32, s58, s57
    ds_read_b128 a[64:67], v5 offset:24576
    v_rcp_f32 v10, v10
    v_mfma_f32_16x16x32_bf16 v[80:83], v[160:163], a[100:103], v[80:83]
    buffer_load_dwordx4 v[232:235], v3, s[20:23], s32 offen offset:0
    v_mfma_f32_16x16x32_bf16 v[84:87], v[160:163], a[104:107], v[84:87]
    ds_read_b128 a[68:71], v5 offset:25600
    v_mul_f32 v11, v113, v113
    v_mfma_f32_16x16x32_bf16 v[88:91], v[160:163], a[108:111], v[88:91]
    s_waitcnt vmcnt(17)
    ds_read_b128 a[72:75], v5 offset:26624
    v_fma_f32 v11, v11, s35, v7
    v_mfma_f32_16x16x32_bf16 v[104:107], v[164:167], a[108:111], v[104:107]
    s_add_u32 s58, s32, 12288
    ds_read_b128 a[76:79], v5 offset:27648
    v_mul_f32 v11, v11, v113
    v_mfma_f32_16x16x32_bf16 v[100:103], v[164:167], a[104:107], v[100:103]
    buffer_load_dwordx4 v[236:239], v3, s[20:23], s58 offen offset:0
    v_mfma_f32_16x16x32_bf16 v[96:99], v[164:167], a[100:103], v[96:99]
    ds_read_b128 a[80:83], v5 offset:28672
    v_exp_f32 v11, v11
    v_mfma_f32_16x16x32_bf16 v[92:95], v[164:167], a[96:99], v[92:95]
    s_waitcnt vmcnt(17)
    ds_read_b128 a[84:87], v5 offset:29696
    v_mul_f32 v129, v129, v113
    v_mul_f32 v128, v128, v10
    v_mfma_f32_16x16x32_bf16 v[76:79], v[168:171], a[112:115], v[76:79]
    ds_read_b128 a[88:91], v5 offset:30720
    v_add_f32 v11, 1.0, v11
    v_mfma_f32_16x16x32_bf16 v[80:83], v[168:171], a[116:119], v[80:83]
    buffer_load_dwordx4 v[240:243], v3, s[20:23], s32 offen offset:1024
    v_mfma_f32_16x16x32_bf16 v[84:87], v[168:171], a[120:123], v[84:87]
    ds_read_b128 a[92:95], v5 offset:31744
    v_mfma_f32_16x16x32_bf16 v[88:91], v[168:171], a[124:127], v[88:91]
    s_waitcnt vmcnt(17)
    ds_write_b64 v4, v[140:141] offset:57344
    v_rcp_f32 v11, v11
    v_mfma_f32_16x16x32_bf16 v[104:107], v[172:175], a[124:127], v[104:107]
    v_mul_f32 v10, v114, v114
    v_fma_f32 v10, v10, s35, v7
    v_mfma_f32_16x16x32_bf16 v[100:103], v[172:175], a[120:123], v[100:103]
    buffer_load_dwordx4 v[244:247], v3, s[20:23], s58 offen offset:1024
    v_mfma_f32_16x16x32_bf16 v[96:99], v[172:175], a[116:119], v[96:99]
    v_mul_f32 v10, v10, v114
    v_exp_f32 v10, v10
    v_mfma_f32_16x16x32_bf16 v[92:95], v[172:175], a[112:115], v[92:95]
    s_waitcnt vmcnt(17)
    v_mul_f32 v130, v130, v114
    v_mul_f32 v129, v129, v11
    v_mfma_f32_16x16x32_bf16 v[76:79], v[176:179], a[128:131], v[76:79]
    ds_read_b128 a[96:99], v5 offset:32768
    v_add_f32 v10, 1.0, v10
    v_mfma_f32_16x16x32_bf16 v[80:83], v[176:179], a[132:135], v[80:83]
    buffer_load_dwordx4 v[248:251], v3, s[20:23], s32 offen offset:2048
    v_mfma_f32_16x16x32_bf16 v[84:87], v[176:179], a[136:139], v[84:87]
    ds_read_b128 a[100:103], v5 offset:33792
    v_cvt_pk_bf16_f32 v142, v128, v129
    v_mfma_f32_16x16x32_bf16 v[88:91], v[176:179], a[140:143], v[88:91]
    s_waitcnt vmcnt(17)
    ds_read_b128 a[104:107], v5 offset:34816
    v_rcp_f32 v10, v10
    v_mfma_f32_16x16x32_bf16 v[104:107], v[180:183], a[140:143], v[104:107]
    ds_read_b128 a[108:111], v5 offset:35840
    v_mul_f32 v11, v115, v115
    v_mfma_f32_16x16x32_bf16 v[100:103], v[180:183], a[136:139], v[100:103]
    buffer_load_dwordx4 v[252:255], v3, s[20:23], s58 offen offset:2048
    v_fma_f32 v11, v11, s35, v7
    v_mfma_f32_16x16x32_bf16 v[96:99], v[180:183], a[132:135], v[96:99]
    ds_read_b128 a[112:115], v5 offset:36864
    v_mul_f32 v11, v11, v115
    v_mfma_f32_16x16x32_bf16 v[92:95], v[180:183], a[128:131], v[92:95]
    s_waitcnt vmcnt(17)
    ds_read_b128 a[116:119], v5 offset:37888
    v_mfma_f32_16x16x32_bf16 v[76:79], v[184:187], a[144:147], v[76:79]
    ds_read_b128 a[120:123], v5 offset:38912
    v_mfma_f32_16x16x32_bf16 v[80:83], v[184:187], a[148:151], v[80:83]
    buffer_load_dwordx4 v[148:151], v3, s[20:23], s38 offen offset:0
    v_mfma_f32_16x16x32_bf16 v[84:87], v[184:187], a[152:155], v[84:87]
    ds_read_b128 a[124:127], v5 offset:39936
    v_exp_f32 v11, v11
    v_mfma_f32_16x16x32_bf16 v[88:91], v[184:187], a[156:159], v[88:91]
    s_waitcnt vmcnt(17)
    v_mul_f32 v131, v131, v115
    v_mul_f32 v130, v130, v10
    v_mfma_f32_16x16x32_bf16 v[104:107], v[188:191], a[156:159], v[104:107]
    v_add_f32 v11, 1.0, v11
    v_mfma_f32_16x16x32_bf16 v[100:103], v[188:191], a[152:155], v[100:103]
    buffer_load_dwordx4 v[152:155], v3, s[20:23], s38 offen offset:1024
    v_mfma_f32_16x16x32_bf16 v[96:99], v[188:191], a[148:151], v[96:99]
    v_rcp_f32 v11, v11
    v_mul_f32 v10, v116, v116
    v_mfma_f32_16x16x32_bf16 v[92:95], v[188:191], a[144:147], v[92:95]
    s_waitcnt vmcnt(17)
    v_fma_f32 v10, v10, s35, v7
    v_mul_f32 v10, v10, v116
    v_mfma_f32_16x16x32_bf16 v[76:79], v[192:195], a[160:163], v[76:79]
    ds_read_b128 a[128:131], v5 offset:40960
    v_exp_f32 v10, v10
    v_mfma_f32_16x16x32_bf16 v[80:83], v[192:195], a[164:167], v[80:83]
    buffer_load_dwordx4 v[156:159], v3, s[20:23], s38 offen offset:2048
    v_mfma_f32_16x16x32_bf16 v[84:87], v[192:195], a[168:171], v[84:87]
    ds_read_b128 a[132:135], v5 offset:41984
    v_mul_f32 v132, v132, v116
    v_mfma_f32_16x16x32_bf16 v[88:91], v[192:195], a[172:175], v[88:91]
    s_waitcnt vmcnt(17)
    ds_read_b128 a[136:139], v5 offset:43008
    v_mul_f32 v131, v131, v11
    v_mfma_f32_16x16x32_bf16 v[104:107], v[196:199], a[172:175], v[104:107]
    s_add_u32 s38, s38, 12288
    ds_read_b128 a[140:143], v5 offset:44032
    v_add_f32 v10, 1.0, v10
    v_cvt_pk_bf16_f32 v143, v130, v131
    v_mfma_f32_16x16x32_bf16 v[100:103], v[196:199], a[168:171], v[100:103]
    buffer_load_dwordx4 v[160:163], v3, s[20:23], s38 offen offset:0
    v_mfma_f32_16x16x32_bf16 v[96:99], v[196:199], a[164:167], v[96:99]
    ds_read_b128 a[144:147], v5 offset:45056
    v_mfma_f32_16x16x32_bf16 v[92:95], v[196:199], a[160:163], v[92:95]
    s_waitcnt vmcnt(17)
    ds_read_b128 a[148:151], v5 offset:46080
    v_rcp_f32 v10, v10
    v_mfma_f32_16x16x32_bf16 v[76:79], v[200:203], a[176:179], v[76:79]
    ds_read_b128 a[152:155], v5 offset:47104
    v_mul_f32 v11, v117, v117
    v_mfma_f32_16x16x32_bf16 v[80:83], v[200:203], a[180:183], v[80:83]
    buffer_load_dwordx4 v[164:167], v3, s[20:23], s38 offen offset:1024
    v_mfma_f32_16x16x32_bf16 v[84:87], v[200:203], a[184:187], v[84:87]
    ds_read_b128 a[156:159], v5 offset:48128
    v_fma_f32 v11, v11, s35, v7
    v_mfma_f32_16x16x32_bf16 v[88:91], v[200:203], a[188:191], v[88:91]
    s_waitcnt vmcnt(17)
    v_mul_f32 v11, v11, v117
    v_exp_f32 v11, v11
    v_mfma_f32_16x16x32_bf16 v[104:107], v[204:207], a[188:191], v[104:107]
    v_mul_f32 v133, v133, v117
    v_mul_f32 v132, v132, v10
    v_mfma_f32_16x16x32_bf16 v[100:103], v[204:207], a[184:187], v[100:103]
    buffer_load_dwordx4 v[168:171], v3, s[20:23], s38 offen offset:2048
    v_mfma_f32_16x16x32_bf16 v[96:99], v[204:207], a[180:183], v[96:99]
    v_add_f32 v11, 1.0, v11
    v_rcp_f32 v11, v11
    v_mfma_f32_16x16x32_bf16 v[92:95], v[204:207], a[176:179], v[92:95]
    s_waitcnt vmcnt(17)
    ds_write_b64 v4, v[142:143] offset:58368
    v_mul_f32 v10, v118, v118
    v_mfma_f32_16x16x32_bf16 v[76:79], v[208:211], a[192:195], v[76:79]
    s_add_u32 s38, s38, 12288
    ds_read_b128 a[160:163], v5 offset:49152
    v_fma_f32 v10, v10, s35, v7
    v_mfma_f32_16x16x32_bf16 v[80:83], v[208:211], a[196:199], v[80:83]
    buffer_load_dwordx4 v[172:175], v3, s[20:23], s38 offen offset:0
    v_mfma_f32_16x16x32_bf16 v[84:87], v[208:211], a[200:203], v[84:87]
    ds_read_b128 a[164:167], v5 offset:50176
    v_mul_f32 v10, v10, v118
    v_mfma_f32_16x16x32_bf16 v[88:91], v[208:211], a[204:207], v[88:91]
    s_waitcnt vmcnt(17)
    ds_read_b128 a[168:171], v5 offset:51200
    v_exp_f32 v10, v10
    v_mfma_f32_16x16x32_bf16 v[104:107], v[212:215], a[204:207], v[104:107]
    ds_read_b128 a[172:175], v5 offset:52224
    v_mul_f32 v134, v134, v118
    v_mfma_f32_16x16x32_bf16 v[100:103], v[212:215], a[200:203], v[100:103]
    buffer_load_dwordx4 v[176:179], v3, s[20:23], s38 offen offset:1024
    v_mfma_f32_16x16x32_bf16 v[96:99], v[212:215], a[196:199], v[96:99]
    ds_read_b128 a[176:179], v5 offset:53248
    v_mul_f32 v133, v133, v11
    v_add_f32 v10, 1.0, v10
    v_mfma_f32_16x16x32_bf16 v[92:95], v[212:215], a[192:195], v[92:95]
    s_waitcnt vmcnt(17)
    ds_read_b128 a[180:183], v5 offset:54272
    v_cvt_pk_bf16_f32 v144, v132, v133
    v_mfma_f32_16x16x32_bf16 v[76:79], v[216:219], a[208:211], v[76:79]
    ds_read_b128 a[184:187], v5 offset:55296
    v_mfma_f32_16x16x32_bf16 v[80:83], v[216:219], a[212:215], v[80:83]
    buffer_load_dwordx4 v[180:183], v3, s[20:23], s38 offen offset:2048
    v_mfma_f32_16x16x32_bf16 v[84:87], v[216:219], a[216:219], v[84:87]
    ds_read_b128 a[188:191], v5 offset:56320
    v_rcp_f32 v10, v10
    v_mfma_f32_16x16x32_bf16 v[88:91], v[216:219], a[220:223], v[88:91]
    s_waitcnt vmcnt(17)
    v_mul_f32 v11, v119, v119
    v_fma_f32 v11, v11, s35, v7
    v_mfma_f32_16x16x32_bf16 v[104:107], v[220:223], a[220:223], v[104:107]
    s_add_u32 s38, s38, 12288
    v_mul_f32 v11, v11, v119
    v_mfma_f32_16x16x32_bf16 v[100:103], v[220:223], a[216:219], v[100:103]
    buffer_load_dwordx4 v[184:187], v3, s[20:23], s38 offen offset:0
    v_mfma_f32_16x16x32_bf16 v[96:99], v[220:223], a[212:215], v[96:99]
    v_exp_f32 v11, v11
    v_mul_f32 v135, v135, v119
    v_mfma_f32_16x16x32_bf16 v[92:95], v[220:223], a[208:211], v[92:95]
    s_waitcnt vmcnt(17)
    v_mul_f32 v134, v134, v10
    v_add_f32 v11, 1.0, v11
    v_mfma_f32_16x16x32_bf16 v[76:79], v[224:227], a[224:227], v[76:79]
    v_rcp_f32 v11, v11
    v_mul_f32 v10, v120, v120
    v_mfma_f32_16x16x32_bf16 v[80:83], v[224:227], a[228:231], v[80:83]
    buffer_load_dwordx4 v[188:191], v3, s[20:23], s38 offen offset:1024
    v_mfma_f32_16x16x32_bf16 v[84:87], v[224:227], a[232:235], v[84:87]
    v_fma_f32 v10, v10, s35, v7
    v_mul_f32 v10, v10, v120
    v_mfma_f32_16x16x32_bf16 v[88:91], v[224:227], a[236:239], v[88:91]
    s_waitcnt vmcnt(17)
    v_exp_f32 v10, v10
    v_mfma_f32_16x16x32_bf16 v[104:107], v[228:231], a[236:239], v[104:107]
    v_mul_f32 v136, v136, v120
    v_mul_f32 v135, v135, v11
    v_add_f32 v10, 1.0, v10
    v_mfma_f32_16x16x32_bf16 v[100:103], v[228:231], a[232:235], v[100:103]
    buffer_load_dwordx4 v[192:195], v3, s[20:23], s38 offen offset:2048
    v_mfma_f32_16x16x32_bf16 v[96:99], v[228:231], a[228:231], v[96:99]
    v_cvt_pk_bf16_f32 v145, v134, v135
    v_mfma_f32_16x16x32_bf16 v[92:95], v[228:231], a[224:227], v[92:95]
    s_waitcnt vmcnt(17)
    v_rcp_f32 v10, v10
    v_mul_f32 v11, v121, v121
    v_mfma_f32_16x16x32_bf16 v[76:79], v[232:235], a[240:243], v[76:79]
    s_add_u32 s38, s38, 12288
    v_fma_f32 v11, v11, s35, v7
    v_mul_f32 v11, v11, v121
    v_mfma_f32_16x16x32_bf16 v[80:83], v[232:235], a[244:247], v[80:83]
    buffer_load_dwordx4 v[196:199], v3, s[20:23], s38 offen offset:0
    v_mfma_f32_16x16x32_bf16 v[84:87], v[232:235], a[248:251], v[84:87]
    v_exp_f32 v11, v11
    v_mfma_f32_16x16x32_bf16 v[88:91], v[232:235], a[252:255], v[88:91]
    s_waitcnt vmcnt(17)
    v_mul_f32 v137, v137, v121
    v_mul_f32 v136, v136, v10
    v_add_f32 v11, 1.0, v11
    v_mfma_f32_16x16x32_bf16 v[104:107], v[236:239], a[252:255], v[104:107]
    v_rcp_f32 v11, v11
    v_mfma_f32_16x16x32_bf16 v[100:103], v[236:239], a[248:251], v[100:103]
    buffer_load_dwordx4 v[200:203], v3, s[20:23], s38 offen offset:1024
    v_mfma_f32_16x16x32_bf16 v[96:99], v[236:239], a[244:247], v[96:99]
    ds_write_b64 v4, v[144:145] offset:59392
    v_mul_f32 v10, v122, v122
    v_fma_f32 v10, v10, s35, v7
    v_mfma_f32_16x16x32_bf16 v[92:95], v[236:239], a[240:243], v[92:95]
    s_waitcnt vmcnt(17)
    v_mul_f32 v10, v10, v122
    v_mfma_f32_16x16x32_bf16 v[76:79], v[240:243], v[12:15], v[76:79]
    v_exp_f32 v10, v10
    v_mfma_f32_16x16x32_bf16 v[80:83], v[240:243], v[16:19], v[80:83]
    buffer_load_dwordx4 v[204:207], v3, s[20:23], s38 offen offset:2048
    v_mfma_f32_16x16x32_bf16 v[84:87], v[240:243], v[20:23], v[84:87]
    v_mul_f32 v138, v138, v122
    v_mul_f32 v137, v137, v11
    v_add_f32 v10, 1.0, v10
    v_mfma_f32_16x16x32_bf16 v[88:91], v[240:243], v[24:27], v[88:91]
    s_waitcnt vmcnt(17)
    v_cvt_pk_bf16_f32 v146, v136, v137
    v_mfma_f32_16x16x32_bf16 v[104:107], v[244:247], v[24:27], v[104:107]
    s_add_u32 s38, s38, 12288
    v_rcp_f32 v10, v10
    v_mfma_f32_16x16x32_bf16 v[100:103], v[244:247], v[20:23], v[100:103]
    buffer_load_dwordx4 v[208:211], v3, s[20:23], s38 offen offset:0
    v_mfma_f32_16x16x32_bf16 v[96:99], v[244:247], v[16:19], v[96:99]
    v_mul_f32 v11, v123, v123
    v_fma_f32 v11, v11, s35, v7
    v_mul_f32 v11, v11, v123
    v_mfma_f32_16x16x32_bf16 v[92:95], v[244:247], v[12:15], v[92:95]
    s_waitcnt vmcnt(17)
    v_exp_f32 v11, v11
    v_mfma_f32_16x16x32_bf16 v[76:79], v[248:251], v[28:31], v[76:79]
    s_add_u32 s32, s38, s8
    v_mul_f32 v139, v139, v123
    v_mul_f32 v138, v138, v10
    v_mfma_f32_16x16x32_bf16 v[80:83], v[248:251], v[32:35], v[80:83]
    buffer_load_dwordx4 v[212:215], v3, s[20:23], s32 offen offset:0
    v_add_f32 v11, 1.0, v11
    v_mfma_f32_16x16x32_bf16 v[84:87], v[248:251], v[36:39], v[84:87]
    v_rcp_f32 v11, v11
    v_mfma_f32_16x16x32_bf16 v[88:91], v[248:251], v[40:43], v[88:91]
    s_waitcnt vmcnt(17)
    v_nop
    v_mul_f32 v139, v139, v11
    v_mfma_f32_16x16x32_bf16 v[104:107], v[252:255], v[40:43], v[104:107]
    v_cvt_pk_bf16_f32 v147, v138, v139
    v_nop
    v_mfma_f32_16x16x32_bf16 v[100:103], v[252:255], v[36:39], v[100:103]
    buffer_load_dwordx4 v[216:219], v3, s[20:23], s32 offen offset:1024
    ds_write_b64 v4, v[146:147] offset:60416
    v_mfma_f32_16x16x32_bf16 v[96:99], v[252:255], v[32:35], v[96:99]
    v_mfma_f32_16x16x32_bf16 v[92:95], v[252:255], v[28:31], v[92:95]
    s_waitcnt vmcnt(17) lgkmcnt(15)
    v_mfma_f32_16x16x32_bf16 v[108:111], v[148:151], v[44:47], 0
    v_mfma_f32_16x16x32_bf16 v[112:115], v[148:151], v[48:51], 0
    buffer_load_dwordx4 v[220:223], v3, s[20:23], s32 offen offset:2048
    v_mfma_f32_16x16x32_bf16 v[116:119], v[148:151], v[52:55], 0
    v_mfma_f32_16x16x32_bf16 v[120:123], v[148:151], v[56:59], 0
    s_waitcnt vmcnt(17)
    v_mul_f32 v10, v76, v76
    v_fma_f32 v10, v10, s35, v7
    v_mfma_f32_16x16x32_bf16 v[108:111], v[152:155], v[60:63], v[108:111]
    s_add_u32 s32, s32, 12288
    v_mul_f32 v10, v10, v76
    v_exp_f32 v10, v10
    v_mfma_f32_16x16x32_bf16 v[112:115], v[152:155], v[64:67], v[112:115]
    buffer_load_dwordx4 v[224:227], v3, s[20:23], s32 offen offset:0
    v_mfma_f32_16x16x32_bf16 v[116:119], v[152:155], v[68:71], v[116:119]
    s_waitcnt vmcnt(17) lgkmcnt(0)
    v_mul_f32 v92, v92, v76
    v_add_f32 v10, 1.0, v10
    v_mfma_f32_16x16x32_bf16 v[120:123], v[152:155], v[72:75], v[120:123]
    s_barrier
    v_rcp_f32 v10, v10
    v_mul_f32 v11, v77, v77
    v_mfma_f32_16x16x32_bf16 v[108:111], v[156:159], a[0:3], v[108:111]
    ds_read_b128 a[192:195], v5 offset:57344
    v_fma_f32 v11, v11, s35, v7
    v_mfma_f32_16x16x32_bf16 v[112:115], v[156:159], a[4:7], v[112:115]
    buffer_load_dwordx4 v[228:231], v3, s[20:23], s32 offen offset:1024
    v_mfma_f32_16x16x32_bf16 v[116:119], v[156:159], a[8:11], v[116:119]
    ds_read_b128 a[196:199], v5 offset:58368
    v_mul_f32 v11, v11, v77
    v_mfma_f32_16x16x32_bf16 v[120:123], v[156:159], a[12:15], v[120:123]
    s_waitcnt vmcnt(17)
    ds_read_b128 a[200:203], v5 offset:59392
    v_exp_f32 v11, v11
    v_mfma_f32_16x16x32_bf16 v[108:111], v[160:163], a[16:19], v[108:111]
    ds_read_b128 a[204:207], v5 offset:60416
    v_mul_f32 v93, v93, v77
    v_mfma_f32_16x16x32_bf16 v[112:115], v[160:163], a[20:23], v[112:115]
    buffer_load_dwordx4 v[232:235], v3, s[20:23], s32 offen offset:2048
    v_mul_f32 v92, v92, v10
    v_mfma_f32_16x16x32_bf16 v[116:119], v[160:163], a[24:27], v[116:119]
    ds_read_b128 a[208:211], v5 offset:61440
    v_add_f32 v11, 1.0, v11
    v_mfma_f32_16x16x32_bf16 v[120:123], v[160:163], a[28:31], v[120:123]
    s_waitcnt vmcnt(17)
    ds_read_b128 a[212:215], v5 offset:62464
    v_mfma_f32_16x16x32_bf16 v[108:111], v[164:167], a[32:35], v[108:111]
    s_add_u32 s32, s32, 12288
    ds_read_b128 a[216:219], v5 offset:63488
    v_rcp_f32 v11, v11
    v_mfma_f32_16x16x32_bf16 v[112:115], v[164:167], a[36:39], v[112:115]
    buffer_load_dwordx4 v[236:239], v3, s[20:23], s32 offen offset:0
    v_mfma_f32_16x16x32_bf16 v[116:119], v[164:167], a[40:43], v[116:119]
    ds_read_b128 a[220:223], v5 offset:64512
    v_mul_f32 v10, v78, v78
    v_mfma_f32_16x16x32_bf16 v[120:123], v[164:167], a[44:47], v[120:123]
    s_waitcnt vmcnt(17)
    v_fma_f32 v10, v10, s35, v7
    v_mul_f32 v10, v10, v78
    v_mfma_f32_16x16x32_bf16 v[108:111], v[168:171], a[48:51], v[108:111]
    v_exp_f32 v10, v10
    v_mul_f32 v94, v94, v78
    v_mfma_f32_16x16x32_bf16 v[112:115], v[168:171], a[52:55], v[112:115]
    buffer_load_dwordx4 v[240:243], v3, s[20:23], s32 offen offset:1024
    v_mfma_f32_16x16x32_bf16 v[116:119], v[168:171], a[56:59], v[116:119]
    v_mul_f32 v93, v93, v11
    v_add_f32 v10, 1.0, v10
    v_cvt_pk_bf16_f32 v140, v92, v93
    v_mfma_f32_16x16x32_bf16 v[120:123], v[168:171], a[60:63], v[120:123]
    s_waitcnt vmcnt(17)
    v_rcp_f32 v10, v10
    v_mfma_f32_16x16x32_bf16 v[108:111], v[172:175], a[64:67], v[108:111]
    v_mul_f32 v11, v79, v79
    v_fma_f32 v11, v11, s35, v7
    v_mfma_f32_16x16x32_bf16 v[112:115], v[172:175], a[68:71], v[112:115]
    buffer_load_dwordx4 v[244:247], v3, s[20:23], s32 offen offset:2048
    v_mul_f32 v11, v11, v79
    v_mfma_f32_16x16x32_bf16 v[116:119], v[172:175], a[72:75], v[116:119]
    v_exp_f32 v11, v11
    v_mfma_f32_16x16x32_bf16 v[120:123], v[172:175], a[76:79], v[120:123]
    s_waitcnt vmcnt(17)
    v_mul_f32 v95, v95, v79
    v_mul_f32 v94, v94, v10
    v_mfma_f32_16x16x32_bf16 v[108:111], v[176:179], a[80:83], v[108:111]
    s_add_u32 s32, s32, 12288
    v_add_f32 v11, 1.0, v11
    v_rcp_f32 v11, v11
    v_mfma_f32_16x16x32_bf16 v[112:115], v[176:179], a[84:87], v[112:115]
    buffer_load_dwordx4 v[248:251], v3, s[20:23], s32 offen offset:0
    v_mfma_f32_16x16x32_bf16 v[116:119], v[176:179], a[88:91], v[116:119]
    v_mul_f32 v10, v80, v80
    v_fma_f32 v10, v10, s35, v7
    v_mfma_f32_16x16x32_bf16 v[120:123], v[176:179], a[92:95], v[120:123]
    s_waitcnt vmcnt(17)
    v_mul_f32 v10, v10, v80
    v_exp_f32 v10, v10
    v_mfma_f32_16x16x32_bf16 v[108:111], v[180:183], a[96:99], v[108:111]
    v_mul_f32 v96, v96, v80
    v_mul_f32 v95, v95, v11
    v_mfma_f32_16x16x32_bf16 v[112:115], v[180:183], a[100:103], v[112:115]
    buffer_load_dwordx4 v[252:255], v3, s[20:23], s32 offen offset:1024
    v_mfma_f32_16x16x32_bf16 v[116:119], v[180:183], a[104:107], v[116:119]
    v_add_f32 v10, 1.0, v10
    v_cvt_pk_bf16_f32 v141, v94, v95
    v_mfma_f32_16x16x32_bf16 v[120:123], v[180:183], a[108:111], v[120:123]
    s_waitcnt vmcnt(17)
    v_rcp_f32 v10, v10
    v_mul_f32 v11, v81, v81
    v_mfma_f32_16x16x32_bf16 v[108:111], v[184:187], a[112:115], v[108:111]
    v_fma_f32 v11, v11, s35, v7
    v_mul_f32 v11, v11, v81
    v_mfma_f32_16x16x32_bf16 v[112:115], v[184:187], a[116:119], v[112:115]
    buffer_load_dwordx4 v[148:151], v3, s[20:23], s32 offen offset:2048
    v_mfma_f32_16x16x32_bf16 v[116:119], v[184:187], a[120:123], v[116:119]
    v_exp_f32 v11, v11
    v_mul_f32 v97, v97, v81
    v_mfma_f32_16x16x32_bf16 v[120:123], v[184:187], a[124:127], v[120:123]
    s_waitcnt vmcnt(17)
    v_mul_f32 v96, v96, v10
    v_add_f32 v11, 1.0, v11
    v_mfma_f32_16x16x32_bf16 v[108:111], v[188:191], a[128:131], v[108:111]
    s_add_u32 s32, s32, 12288
    ds_write_b64 v4, v[140:141] offset:0
    v_rcp_f32 v11, v11
    v_mfma_f32_16x16x32_bf16 v[112:115], v[188:191], a[132:135], v[112:115]
    buffer_load_dwordx4 v[152:155], v3, s[20:23], s32 offen offset:0
    v_mfma_f32_16x16x32_bf16 v[116:119], v[188:191], a[136:139], v[116:119]
    v_mul_f32 v10, v82, v82
    v_fma_f32 v10, v10, s35, v7
    v_mfma_f32_16x16x32_bf16 v[120:123], v[188:191], a[140:143], v[120:123]
    s_waitcnt vmcnt(17)
    v_mul_f32 v10, v10, v82
    v_exp_f32 v10, v10
    v_mfma_f32_16x16x32_bf16 v[108:111], v[192:195], a[144:147], v[108:111]
    v_mul_f32 v98, v98, v82
    v_mul_f32 v97, v97, v11
    v_mfma_f32_16x16x32_bf16 v[112:115], v[192:195], a[148:151], v[112:115]
    buffer_load_dwordx4 v[156:159], v3, s[20:23], s32 offen offset:1024
    v_mfma_f32_16x16x32_bf16 v[116:119], v[192:195], a[152:155], v[116:119]
    v_add_f32 v10, 1.0, v10
    v_cvt_pk_bf16_f32 v142, v96, v97
    v_mfma_f32_16x16x32_bf16 v[120:123], v[192:195], a[156:159], v[120:123]
    s_waitcnt vmcnt(17)
    v_rcp_f32 v10, v10
    v_mul_f32 v11, v83, v83
    v_mfma_f32_16x16x32_bf16 v[108:111], v[196:199], a[160:163], v[108:111]
    v_fma_f32 v11, v11, s35, v7
    v_mul_f32 v11, v11, v83
    v_mfma_f32_16x16x32_bf16 v[112:115], v[196:199], a[164:167], v[112:115]
    buffer_load_dwordx4 v[160:163], v3, s[20:23], s32 offen offset:2048
    v_mfma_f32_16x16x32_bf16 v[116:119], v[196:199], a[168:171], v[116:119]
    v_exp_f32 v11, v11
    v_mul_f32 v99, v99, v83
    v_mfma_f32_16x16x32_bf16 v[120:123], v[196:199], a[172:175], v[120:123]
    s_waitcnt vmcnt(17)
    v_mul_f32 v98, v98, v10
    v_add_f32 v11, 1.0, v11
    v_mfma_f32_16x16x32_bf16 v[108:111], v[200:203], a[176:179], v[108:111]
    s_add_u32 s32, s32, 12288
    v_rcp_f32 v11, v11
    v_mul_f32 v10, v84, v84
    v_mfma_f32_16x16x32_bf16 v[112:115], v[200:203], a[180:183], v[112:115]
    buffer_load_dwordx4 v[164:167], v3, s[20:23], s32 offen offset:0
    v_mfma_f32_16x16x32_bf16 v[116:119], v[200:203], a[184:187], v[116:119]
    v_fma_f32 v10, v10, s35, v7
    v_mul_f32 v10, v10, v84
    v_mfma_f32_16x16x32_bf16 v[120:123], v[200:203], a[188:191], v[120:123]
    s_waitcnt vmcnt(17) lgkmcnt(1)
    v_exp_f32 v10, v10
    v_mfma_f32_16x16x32_bf16 v[108:111], v[204:207], a[192:195], v[108:111]
    v_mul_f32 v100, v100, v84
    v_mul_f32 v99, v99, v11
    v_add_f32 v10, 1.0, v10
    v_mfma_f32_16x16x32_bf16 v[112:115], v[204:207], a[196:199], v[112:115]
    buffer_load_dwordx4 v[168:171], v3, s[20:23], s38 offen offset:1024
    v_mfma_f32_16x16x32_bf16 v[116:119], v[204:207], a[200:203], v[116:119]
    v_cvt_pk_bf16_f32 v143, v98, v99
    v_mfma_f32_16x16x32_bf16 v[120:123], v[204:207], a[204:207], v[120:123]
    s_waitcnt vmcnt(17)
    v_rcp_f32 v10, v10
    v_mul_f32 v11, v85, v85
    v_mfma_f32_16x16x32_bf16 v[108:111], v[208:211], a[208:211], v[108:111]
    v_fma_f32 v11, v11, s35, v7
    v_mul_f32 v11, v11, v85
    v_mfma_f32_16x16x32_bf16 v[112:115], v[208:211], a[212:215], v[112:115]
    buffer_load_dwordx4 v[172:175], v3, s[20:23], s38 offen offset:2048
    v_mfma_f32_16x16x32_bf16 v[116:119], v[208:211], a[216:219], v[116:119]
    v_exp_f32 v11, v11
    v_mul_f32 v101, v101, v85
    v_mfma_f32_16x16x32_bf16 v[120:123], v[208:211], a[220:223], v[120:123]
    s_waitcnt vmcnt(17)
    v_mul_f32 v100, v100, v10
    v_add_f32 v11, 1.0, v11
    v_mfma_f32_16x16x32_bf16 v[124:127], v[212:215], v[44:47], 0
    v_rcp_f32 v11, v11
    v_mfma_f32_16x16x32_bf16 v[128:131], v[212:215], v[48:51], 0
    buffer_load_dwordx4 v[176:179], v3, s[20:23], s32 offen offset:1024
    ds_write_b64 v4, v[142:143] offset:1024
    v_mfma_f32_16x16x32_bf16 v[132:135], v[212:215], v[52:55], 0
    v_mul_f32 v10, v86, v86
    v_fma_f32 v10, v10, s35, v7
    v_mfma_f32_16x16x32_bf16 v[136:139], v[212:215], v[56:59], 0
    s_waitcnt vmcnt(17)
    v_mul_f32 v10, v10, v86
    v_mfma_f32_16x16x32_bf16 v[124:127], v[216:219], v[60:63], v[124:127]
    v_exp_f32 v10, v10
    v_mul_f32 v102, v102, v86
    v_mfma_f32_16x16x32_bf16 v[128:131], v[216:219], v[64:67], v[128:131]
    buffer_load_dwordx4 v[180:183], v3, s[20:23], s32 offen offset:2048
    v_mfma_f32_16x16x32_bf16 v[132:135], v[216:219], v[68:71], v[132:135]
    v_mul_f32 v101, v101, v11
    v_add_f32 v10, 1.0, v10
    v_mfma_f32_16x16x32_bf16 v[136:139], v[216:219], v[72:75], v[136:139]
    s_waitcnt vmcnt(17)
    v_cvt_pk_bf16_f32 v144, v100, v101
    v_rcp_f32 v10, v10
    v_mfma_f32_16x16x32_bf16 v[124:127], v[220:223], a[0:3], v[124:127]
    s_add_u32 s32, s32, s9
    v_mul_f32 v11, v87, v87
    v_fma_f32 v11, v11, s35, v7
    v_mfma_f32_16x16x32_bf16 v[128:131], v[220:223], a[4:7], v[128:131]
    buffer_load_dwordx4 v[184:187], v3, s[20:23], s32 offen offset:0
    v_mfma_f32_16x16x32_bf16 v[132:135], v[220:223], a[8:11], v[132:135]
    v_mul_f32 v11, v11, v87
    v_exp_f32 v11, v11
    v_mfma_f32_16x16x32_bf16 v[136:139], v[220:223], a[12:15], v[136:139]
    s_waitcnt vmcnt(17)
    v_mul_f32 v103, v103, v87
    v_mul_f32 v102, v102, v10
    v_mfma_f32_16x16x32_bf16 v[124:127], v[224:227], a[16:19], v[124:127]
    v_add_f32 v11, 1.0, v11
    v_mfma_f32_16x16x32_bf16 v[128:131], v[224:227], a[20:23], v[128:131]
    buffer_load_dwordx4 v[188:191], v3, s[20:23], s32 offen offset:1024
    v_mfma_f32_16x16x32_bf16 v[132:135], v[224:227], a[24:27], v[132:135]
    v_rcp_f32 v11, v11
    v_mul_f32 v10, v88, v88
    v_mfma_f32_16x16x32_bf16 v[136:139], v[224:227], a[28:31], v[136:139]
    s_waitcnt vmcnt(17)
    v_fma_f32 v10, v10, s35, v7
    v_mul_f32 v10, v10, v88
    v_mfma_f32_16x16x32_bf16 v[124:127], v[228:231], a[32:35], v[124:127]
    v_exp_f32 v10, v10
    v_mul_f32 v104, v104, v88
    v_mfma_f32_16x16x32_bf16 v[128:131], v[228:231], a[36:39], v[128:131]
    buffer_load_dwordx4 v[192:195], v3, s[20:23], s32 offen offset:2048
    v_mfma_f32_16x16x32_bf16 v[132:135], v[228:231], a[40:43], v[132:135]
    v_mul_f32 v103, v103, v11
    v_add_f32 v10, 1.0, v10
    v_mfma_f32_16x16x32_bf16 v[136:139], v[228:231], a[44:47], v[136:139]
    s_waitcnt vmcnt(17)
    v_cvt_pk_bf16_f32 v145, v102, v103
    v_rcp_f32 v10, v10
    v_mfma_f32_16x16x32_bf16 v[124:127], v[232:235], a[48:51], v[124:127]
    s_add_u32 s32, s32, 12288
    v_mul_f32 v11, v89, v89
    v_fma_f32 v11, v11, s35, v7
    v_mfma_f32_16x16x32_bf16 v[128:131], v[232:235], a[52:55], v[128:131]
    buffer_load_dwordx4 v[196:199], v3, s[20:23], s32 offen offset:0
    v_mfma_f32_16x16x32_bf16 v[132:135], v[232:235], a[56:59], v[132:135]
    v_mul_f32 v11, v11, v89
    v_exp_f32 v11, v11
    v_mfma_f32_16x16x32_bf16 v[136:139], v[232:235], a[60:63], v[136:139]
    s_waitcnt vmcnt(17)
    v_mul_f32 v105, v105, v89
    v_mul_f32 v104, v104, v10
    v_mfma_f32_16x16x32_bf16 v[124:127], v[236:239], a[64:67], v[124:127]
    v_add_f32 v11, 1.0, v11
    v_mfma_f32_16x16x32_bf16 v[128:131], v[236:239], a[68:71], v[128:131]
    buffer_load_dwordx4 v[200:203], v3, s[20:23], s32 offen offset:1024
    v_mfma_f32_16x16x32_bf16 v[132:135], v[236:239], a[72:75], v[132:135]
    ds_write_b64 v4, v[144:145] offset:2048
    v_rcp_f32 v11, v11
    v_mfma_f32_16x16x32_bf16 v[136:139], v[236:239], a[76:79], v[136:139]
    s_waitcnt vmcnt(17)
    v_mul_f32 v10, v90, v90
    v_fma_f32 v10, v10, s35, v7
    v_mfma_f32_16x16x32_bf16 v[124:127], v[240:243], a[80:83], v[124:127]
    v_mul_f32 v10, v10, v90
    v_exp_f32 v10, v10
    v_mfma_f32_16x16x32_bf16 v[128:131], v[240:243], a[84:87], v[128:131]
    buffer_load_dwordx4 v[204:207], v3, s[20:23], s32 offen offset:2048
    v_mfma_f32_16x16x32_bf16 v[132:135], v[240:243], a[88:91], v[132:135]
    v_mul_f32 v106, v106, v90
    v_mul_f32 v105, v105, v11
    v_mfma_f32_16x16x32_bf16 v[136:139], v[240:243], a[92:95], v[136:139]
    s_waitcnt vmcnt(17)
    v_add_f32 v10, 1.0, v10
    v_cvt_pk_bf16_f32 v146, v104, v105
    v_mfma_f32_16x16x32_bf16 v[124:127], v[244:247], a[96:99], v[124:127]
    s_add_u32 s32, s32, 12288
    v_rcp_f32 v10, v10
    v_mul_f32 v11, v91, v91
    v_mfma_f32_16x16x32_bf16 v[128:131], v[244:247], a[100:103], v[128:131]
    buffer_load_dwordx4 v[208:211], v3, s[20:23], s32 offen offset:0
    v_mfma_f32_16x16x32_bf16 v[132:135], v[244:247], a[104:107], v[132:135]
    v_fma_f32 v11, v11, s35, v7
    v_mul_f32 v11, v11, v91
    v_mfma_f32_16x16x32_bf16 v[136:139], v[244:247], a[108:111], v[136:139]
    s_waitcnt vmcnt(17)
    v_exp_f32 v11, v11
    v_mul_f32 v107, v107, v91
    v_mfma_f32_16x16x32_bf16 v[124:127], v[248:251], a[112:115], v[124:127]
    v_mul_f32 v106, v106, v10
    v_add_f32 v11, 1.0, v11
    v_mfma_f32_16x16x32_bf16 v[128:131], v[248:251], a[116:119], v[128:131]
    buffer_load_dwordx4 v[212:215], v3, s[20:23], s32 offen offset:1024
    v_mfma_f32_16x16x32_bf16 v[132:135], v[248:251], a[120:123], v[132:135]
    v_rcp_f32 v11, v11
    v_nop
    v_mfma_f32_16x16x32_bf16 v[136:139], v[248:251], a[124:127], v[136:139]
    s_waitcnt vmcnt(17)
    v_mul_f32 v107, v107, v11
    v_cvt_pk_bf16_f32 v147, v106, v107
    v_mfma_f32_16x16x32_bf16 v[124:127], v[252:255], a[128:131], v[124:127]
    ds_write_b64 v4, v[146:147] offset:3072
    v_nop
    v_mfma_f32_16x16x32_bf16 v[128:131], v[252:255], a[132:135], v[128:131]
    buffer_load_dwordx4 v[216:219], v3, s[20:23], s32 offen offset:2048
    v_mfma_f32_16x16x32_bf16 v[132:135], v[252:255], a[136:139], v[132:135]
    s_waitcnt vmcnt(17) lgkmcnt(0)
    v_mfma_f32_16x16x32_bf16 v[136:139], v[252:255], a[140:143], v[136:139]
    s_barrier
    v_mfma_f32_16x16x32_bf16 v[124:127], v[148:151], a[144:147], v[124:127]
    s_add_u32 s32, s32, 12288
    ds_read_b128 a[224:227], v5 offset:0
    ds_read_b128 a[228:231], v5 offset:1024
    v_mfma_f32_16x16x32_bf16 v[128:131], v[148:151], a[148:151], v[128:131]
    buffer_load_dwordx4 v[220:223], v3, s[20:23], s32 offen offset:0
    v_mfma_f32_16x16x32_bf16 v[132:135], v[148:151], a[152:155], v[132:135]
    ds_read_b128 a[232:235], v5 offset:2048
    ds_read_b128 a[236:239], v5 offset:3072
    v_mfma_f32_16x16x32_bf16 v[136:139], v[148:151], a[156:159], v[136:139]
    s_waitcnt vmcnt(17)
    ds_read_b128 a[240:243], v5 offset:4096
    ds_read_b128 a[244:247], v5 offset:5120
    v_mfma_f32_16x16x32_bf16 v[124:127], v[152:155], a[160:163], v[124:127]
    ds_read_b128 a[248:251], v5 offset:6144
    ds_read_b128 a[252:255], v5 offset:7168
    v_mfma_f32_16x16x32_bf16 v[128:131], v[152:155], a[164:167], v[128:131]
    buffer_load_dwordx4 v[224:227], v3, s[20:23], s32 offen offset:1024
    v_mfma_f32_16x16x32_bf16 v[132:135], v[152:155], a[168:171], v[132:135]
    v_mfma_f32_16x16x32_bf16 v[136:139], v[152:155], a[172:175], v[136:139]
    s_waitcnt vmcnt(17)
    v_mfma_f32_16x16x32_bf16 v[124:127], v[156:159], a[176:179], v[124:127]
    v_mfma_f32_16x16x32_bf16 v[128:131], v[156:159], a[180:183], v[128:131]
    buffer_load_dwordx4 v[228:231], v3, s[20:23], s32 offen offset:2048
    v_mfma_f32_16x16x32_bf16 v[132:135], v[156:159], a[184:187], v[132:135]
    v_mfma_f32_16x16x32_bf16 v[136:139], v[156:159], a[188:191], v[136:139]
    s_waitcnt vmcnt(17)
    v_mfma_f32_16x16x32_bf16 v[124:127], v[160:163], a[192:195], v[124:127]
    s_add_u32 s32, s32, 12288
    v_mfma_f32_16x16x32_bf16 v[128:131], v[160:163], a[196:199], v[128:131]
    buffer_load_dwordx4 v[232:235], v3, s[20:23], s32 offen offset:0
    v_mfma_f32_16x16x32_bf16 v[132:135], v[160:163], a[200:203], v[132:135]
    v_mfma_f32_16x16x32_bf16 v[136:139], v[160:163], a[204:207], v[136:139]
    s_waitcnt vmcnt(17)
    v_mfma_f32_16x16x32_bf16 v[124:127], v[164:167], a[208:211], v[124:127]
    v_mfma_f32_16x16x32_bf16 v[128:131], v[164:167], a[212:215], v[128:131]
    buffer_load_dwordx4 v[236:239], v3, s[20:23], s32 offen offset:1024
    v_mfma_f32_16x16x32_bf16 v[132:135], v[164:167], a[216:219], v[132:135]
    v_mfma_f32_16x16x32_bf16 v[136:139], v[164:167], a[220:223], v[136:139]
    s_waitcnt vmcnt(17) lgkmcnt(0)
    v_mfma_f32_16x16x32_bf16 v[108:111], v[168:171], a[224:227], v[108:111]
    v_mfma_f32_16x16x32_bf16 v[112:115], v[168:171], a[228:231], v[112:115]
    buffer_load_dwordx4 v[240:243], v3, s[20:23], s32 offen offset:2048
    v_mfma_f32_16x16x32_bf16 v[116:119], v[168:171], a[232:235], v[116:119]
    v_mfma_f32_16x16x32_bf16 v[120:123], v[168:171], a[236:239], v[120:123]
    s_waitcnt vmcnt(17)
    v_mfma_f32_16x16x32_bf16 v[108:111], v[172:175], a[240:243], v[108:111]
    s_add_u32 s32, s32, 12288
    v_mfma_f32_16x16x32_bf16 v[112:115], v[172:175], a[244:247], v[112:115]
    buffer_load_dwordx4 v[244:247], v3, s[20:23], s32 offen offset:0
    v_mfma_f32_16x16x32_bf16 v[116:119], v[172:175], a[248:251], v[116:119]
    v_mfma_f32_16x16x32_bf16 v[120:123], v[172:175], a[252:255], v[120:123]
    s_waitcnt vmcnt(17)
    v_mfma_f32_16x16x32_bf16 v[124:127], v[176:179], a[224:227], v[124:127]
    v_mfma_f32_16x16x32_bf16 v[128:131], v[176:179], a[228:231], v[128:131]
    buffer_load_dwordx4 v[248:251], v3, s[20:23], s32 offen offset:1024
    v_mfma_f32_16x16x32_bf16 v[132:135], v[176:179], a[232:235], v[132:135]
    v_mfma_f32_16x16x32_bf16 v[136:139], v[176:179], a[236:239], v[136:139]
    s_waitcnt vmcnt(17)
    v_cvt_pk_bf16_f32 v12, v108, v109
    v_mfma_f32_16x16x32_bf16 v[124:127], v[180:183], a[240:243], v[124:127]
    v_cvt_pk_bf16_f32 v13, v110, v111
    v_mfma_f32_16x16x32_bf16 v[128:131], v[180:183], a[244:247], v[128:131]
    buffer_load_dwordx4 v[252:255], v3, s[20:23], s32 offen offset:2048
    v_mfma_f32_16x16x32_bf16 v[132:135], v[180:183], a[248:251], v[132:135]
    v_cvt_pk_bf16_f32 v14, v112, v113
    v_mfma_f32_16x16x32_bf16 v[136:139], v[180:183], a[252:255], v[136:139]
    s_waitcnt vmcnt(17)
    v_mfma_f32_16x16x32_bf16 v[76:79], v[184:187], v[44:47], 0
    s_add_u32 s32, s32, s10
    v_cvt_pk_bf16_f32 v15, v114, v115
    v_mfma_f32_16x16x32_bf16 v[80:83], v[184:187], v[48:51], 0
    buffer_load_dwordx4 v[148:151], v3, s[20:23], s32 offen offset:0
    v_mfma_f32_16x16x32_bf16 v[84:87], v[184:187], v[52:55], 0
    v_cvt_pk_bf16_f32 v16, v116, v117
    v_mfma_f32_16x16x32_bf16 v[88:91], v[184:187], v[56:59], 0
    s_waitcnt vmcnt(17)
    v_cvt_pk_bf16_f32 v17, v118, v119
    v_mfma_f32_16x16x32_bf16 v[76:79], v[188:191], v[60:63], v[76:79]
    v_cvt_pk_bf16_f32 v18, v120, v121
    v_mfma_f32_16x16x32_bf16 v[80:83], v[188:191], v[64:67], v[80:83]
    buffer_load_dwordx4 v[152:155], v3, s[20:23], s32 offen offset:1024
    v_mfma_f32_16x16x32_bf16 v[84:87], v[188:191], v[68:71], v[84:87]
    v_cvt_pk_bf16_f32 v19, v122, v123
    v_mfma_f32_16x16x32_bf16 v[88:91], v[188:191], v[72:75], v[88:91]
    s_waitcnt vmcnt(17)
    v_permlane16_swap_b32 v12, v14
    v_mfma_f32_16x16x32_bf16 v[76:79], v[192:195], a[0:3], v[76:79]
    v_mfma_f32_16x16x32_bf16 v[80:83], v[192:195], a[4:7], v[80:83]
    buffer_load_dwordx4 v[156:159], v3, s[20:23], s32 offen offset:2048
    v_mfma_f32_16x16x32_bf16 v[84:87], v[192:195], a[8:11], v[84:87]
    v_permlane16_swap_b32 v13, v15
    v_mfma_f32_16x16x32_bf16 v[88:91], v[192:195], a[12:15], v[88:91]
    s_waitcnt vmcnt(17)
    v_permlane16_swap_b32 v16, v18
    v_mfma_f32_16x16x32_bf16 v[76:79], v[196:199], a[16:19], v[76:79]
    s_add_u32 s32, s32, 12288
    v_permlane16_swap_b32 v17, v19
    v_mfma_f32_16x16x32_bf16 v[80:83], v[196:199], a[20:23], v[80:83]
    buffer_load_dwordx4 v[160:163], v3, s[20:23], s32 offen offset:0
    v_mfma_f32_16x16x32_bf16 v[84:87], v[196:199], a[24:27], v[84:87]
    v_mfma_f32_16x16x32_bf16 v[88:91], v[196:199], a[28:31], v[88:91]
    s_waitcnt vmcnt(17)
    buffer_store_dwordx4 v[12:15], v6, s[20:23], s36 offen sc1
    v_mfma_f32_16x16x32_bf16 v[76:79], v[200:203], a[32:35], v[76:79]
    v_cvt_pk_bf16_f32 v20, v124, v125
    v_mfma_f32_16x16x32_bf16 v[80:83], v[200:203], a[36:39], v[80:83]
    buffer_load_dwordx4 v[164:167], v3, s[20:23], s32 offen offset:1024
    v_mfma_f32_16x16x32_bf16 v[84:87], v[200:203], a[40:43], v[84:87]
    v_cvt_pk_bf16_f32 v21, v126, v127
    v_mfma_f32_16x16x32_bf16 v[88:91], v[200:203], a[44:47], v[88:91]
    s_waitcnt vmcnt(18)
    v_cvt_pk_bf16_f32 v22, v128, v129
    v_mfma_f32_16x16x32_bf16 v[76:79], v[204:207], a[48:51], v[76:79]
    v_cvt_pk_bf16_f32 v23, v130, v131
    v_mfma_f32_16x16x32_bf16 v[80:83], v[204:207], a[52:55], v[80:83]
    buffer_load_dwordx4 v[168:171], v3, s[20:23], s32 offen offset:2048
    v_mfma_f32_16x16x32_bf16 v[84:87], v[204:207], a[56:59], v[84:87]
    v_cvt_pk_bf16_f32 v24, v132, v133
    v_mfma_f32_16x16x32_bf16 v[88:91], v[204:207], a[60:63], v[88:91]
    s_waitcnt vmcnt(18)
    v_cvt_pk_bf16_f32 v25, v134, v135
    v_mfma_f32_16x16x32_bf16 v[76:79], v[208:211], a[64:67], v[76:79]
    s_add_u32 s32, s32, 12288
    v_mfma_f32_16x16x32_bf16 v[80:83], v[208:211], a[68:71], v[80:83]
    buffer_load_dwordx4 v[172:175], v3, s[20:23], s32 offen offset:0
    v_mfma_f32_16x16x32_bf16 v[84:87], v[208:211], a[72:75], v[84:87]
    v_cvt_pk_bf16_f32 v26, v136, v137
    v_mfma_f32_16x16x32_bf16 v[88:91], v[208:211], a[76:79], v[88:91]
    s_waitcnt vmcnt(18)
    v_cvt_pk_bf16_f32 v27, v138, v139
    v_mfma_f32_16x16x32_bf16 v[76:79], v[212:215], a[80:83], v[76:79]
    v_permlane16_swap_b32 v20, v22
    v_mfma_f32_16x16x32_bf16 v[80:83], v[212:215], a[84:87], v[80:83]
    buffer_load_dwordx4 v[176:179], v3, s[20:23], s32 offen offset:1024
    v_mfma_f32_16x16x32_bf16 v[84:87], v[212:215], a[88:91], v[84:87]
    v_permlane16_swap_b32 v21, v23
    v_mfma_f32_16x16x32_bf16 v[88:91], v[212:215], a[92:95], v[88:91]
    s_waitcnt vmcnt(18)
    v_permlane16_swap_b32 v24, v26
    v_mfma_f32_16x16x32_bf16 v[76:79], v[216:219], a[96:99], v[76:79]
    v_permlane16_swap_b32 v25, v27
    v_mfma_f32_16x16x32_bf16 v[80:83], v[216:219], a[100:103], v[80:83]
    buffer_load_dwordx4 v[180:183], v3, s[20:23], s32 offen offset:2048
    v_mfma_f32_16x16x32_bf16 v[84:87], v[216:219], a[104:107], v[84:87]
    v_mfma_f32_16x16x32_bf16 v[88:91], v[216:219], a[108:111], v[88:91]
    s_waitcnt vmcnt(18)
    v_mfma_f32_16x16x32_bf16 v[76:79], v[220:223], a[112:115], v[76:79]
    s_add_u32 s32, s32, 12288
    v_mfma_f32_16x16x32_bf16 v[80:83], v[220:223], a[116:119], v[80:83]
    buffer_load_dwordx4 v[184:187], v3, s[20:23], s32 offen offset:0
    v_mfma_f32_16x16x32_bf16 v[84:87], v[220:223], a[120:123], v[84:87]
    v_mfma_f32_16x16x32_bf16 v[88:91], v[220:223], a[124:127], v[88:91]
    s_waitcnt vmcnt(18)
    v_mfma_f32_16x16x32_bf16 v[76:79], v[224:227], a[128:131], v[76:79]
    v_mfma_f32_16x16x32_bf16 v[80:83], v[224:227], a[132:135], v[80:83]
    buffer_load_dwordx4 v[188:191], v3, s[20:23], s32 offen offset:1024
    v_mfma_f32_16x16x32_bf16 v[84:87], v[224:227], a[136:139], v[84:87]
    v_mfma_f32_16x16x32_bf16 v[88:91], v[224:227], a[140:143], v[88:91]
    s_waitcnt vmcnt(18)
    buffer_store_dwordx4 v[16:19], v6, s[20:23], s37 offen sc1
    v_mfma_f32_16x16x32_bf16 v[76:79], v[228:231], a[144:147], v[76:79]
    v_mfma_f32_16x16x32_bf16 v[80:83], v[228:231], a[148:151], v[80:83]
    buffer_load_dwordx4 v[192:195], v3, s[20:23], s32 offen offset:2048
    v_mfma_f32_16x16x32_bf16 v[84:87], v[228:231], a[152:155], v[84:87]
    v_mfma_f32_16x16x32_bf16 v[88:91], v[228:231], a[156:159], v[88:91]
    s_waitcnt vmcnt(19)
    v_mfma_f32_16x16x32_bf16 v[76:79], v[232:235], a[160:163], v[76:79]
    s_add_u32 s32, s32, 12288
    v_mfma_f32_16x16x32_bf16 v[80:83], v[232:235], a[164:167], v[80:83]
    buffer_load_dwordx4 v[196:199], v3, s[20:23], s32 offen offset:0
    v_mfma_f32_16x16x32_bf16 v[84:87], v[232:235], a[168:171], v[84:87]
    v_mfma_f32_16x16x32_bf16 v[88:91], v[232:235], a[172:175], v[88:91]
    s_waitcnt vmcnt(19)
    v_mfma_f32_16x16x32_bf16 v[76:79], v[236:239], a[176:179], v[76:79]
    v_mfma_f32_16x16x32_bf16 v[80:83], v[236:239], a[180:183], v[80:83]
    buffer_load_dwordx4 v[200:203], v3, s[20:23], s32 offen offset:1024
    v_mfma_f32_16x16x32_bf16 v[84:87], v[236:239], a[184:187], v[84:87]
    v_mfma_f32_16x16x32_bf16 v[88:91], v[236:239], a[188:191], v[88:91]
    s_waitcnt vmcnt(19)
    v_mfma_f32_16x16x32_bf16 v[76:79], v[240:243], a[192:195], v[76:79]
    v_mfma_f32_16x16x32_bf16 v[80:83], v[240:243], a[196:199], v[80:83]
    buffer_load_dwordx4 v[204:207], v3, s[20:23], s32 offen offset:2048
    v_mfma_f32_16x16x32_bf16 v[84:87], v[240:243], a[200:203], v[84:87]
    v_mfma_f32_16x16x32_bf16 v[88:91], v[240:243], a[204:207], v[88:91]
    s_waitcnt vmcnt(19)
    v_mfma_f32_16x16x32_bf16 v[76:79], v[244:247], a[208:211], v[76:79]
    s_add_u32 s32, s32, 12288
    v_mfma_f32_16x16x32_bf16 v[80:83], v[244:247], a[212:215], v[80:83]
    buffer_load_dwordx4 v[208:211], v3, s[20:23], s32 offen offset:0
    v_mfma_f32_16x16x32_bf16 v[84:87], v[244:247], a[216:219], v[84:87]
    v_mfma_f32_16x16x32_bf16 v[88:91], v[244:247], a[220:223], v[88:91]
    s_waitcnt vmcnt(19)
    v_mfma_f32_16x16x32_bf16 v[76:79], v[248:251], a[224:227], v[76:79]
    v_mfma_f32_16x16x32_bf16 v[80:83], v[248:251], a[228:231], v[80:83]
    buffer_load_dwordx4 v[212:215], v3, s[20:23], s32 offen offset:1024
    v_mfma_f32_16x16x32_bf16 v[84:87], v[248:251], a[232:235], v[84:87]
    v_mfma_f32_16x16x32_bf16 v[88:91], v[248:251], a[236:239], v[88:91]
    s_waitcnt vmcnt(19)
    v_mfma_f32_16x16x32_bf16 v[76:79], v[252:255], a[240:243], v[76:79]
    v_mfma_f32_16x16x32_bf16 v[80:83], v[252:255], a[244:247], v[80:83]
    buffer_load_dwordx4 v[216:219], v3, s[20:23], s32 offen offset:2048
    v_mfma_f32_16x16x32_bf16 v[84:87], v[252:255], a[248:251], v[84:87]
    s_add_u32 s36, s36, s40
    v_mfma_f32_16x16x32_bf16 v[88:91], v[252:255], a[252:255], v[88:91]
    s_waitcnt vmcnt(19)
    buffer_store_dwordx4 v[20:23], v6, s[20:23], s36 offen sc1
    v_mfma_f32_16x16x32_bf16 v[92:95], v[148:151], v[44:47], 0
    s_add_u32 s32, s32, s11
    v_mfma_f32_16x16x32_bf16 v[96:99], v[148:151], v[48:51], 0
    buffer_load_dwordx4 v[220:223], v3, s[20:23], s32 offen offset:0
    v_mfma_f32_16x16x32_bf16 v[100:103], v[148:151], v[52:55], 0
    v_mfma_f32_16x16x32_bf16 v[104:107], v[148:151], v[56:59], 0
    s_waitcnt vmcnt(20)
    v_cvt_pk_bf16_f32 v28, v76, v77
    v_mfma_f32_16x16x32_bf16 v[92:95], v[152:155], v[60:63], v[92:95]
    v_cvt_pk_bf16_f32 v29, v78, v79
    v_mfma_f32_16x16x32_bf16 v[96:99], v[152:155], v[64:67], v[96:99]
    buffer_load_dwordx4 v[224:227], v3, s[20:23], s32 offen offset:1024
    v_mfma_f32_16x16x32_bf16 v[100:103], v[152:155], v[68:71], v[100:103]
    v_cvt_pk_bf16_f32 v30, v80, v81
    v_mfma_f32_16x16x32_bf16 v[104:107], v[152:155], v[72:75], v[104:107]
    s_waitcnt vmcnt(20)
    v_mfma_f32_16x16x32_bf16 v[92:95], v[156:159], a[0:3], v[92:95]
    v_cvt_pk_bf16_f32 v31, v82, v83
    v_mfma_f32_16x16x32_bf16 v[96:99], v[156:159], a[4:7], v[96:99]
    buffer_load_dwordx4 v[228:231], v3, s[20:23], s32 offen offset:2048
    v_mfma_f32_16x16x32_bf16 v[100:103], v[156:159], a[8:11], v[100:103]
    v_cvt_pk_bf16_f32 v32, v84, v85
    v_mfma_f32_16x16x32_bf16 v[104:107], v[156:159], a[12:15], v[104:107]
    s_waitcnt vmcnt(20)
    v_cvt_pk_bf16_f32 v33, v86, v87
    v_mfma_f32_16x16x32_bf16 v[92:95], v[160:163], a[16:19], v[92:95]
    s_add_u32 s32, s32, 12288
    v_cvt_pk_bf16_f32 v34, v88, v89
    v_mfma_f32_16x16x32_bf16 v[96:99], v[160:163], a[20:23], v[96:99]
    buffer_load_dwordx4 v[232:235], v3, s[20:23], s32 offen offset:0
    v_mfma_f32_16x16x32_bf16 v[100:103], v[160:163], a[24:27], v[100:103]
    v_cvt_pk_bf16_f32 v35, v90, v91
    v_mfma_f32_16x16x32_bf16 v[104:107], v[160:163], a[28:31], v[104:107]
    s_waitcnt vmcnt(19)
    v_permlane16_swap_b32 v28, v30
    v_mfma_f32_16x16x32_bf16 v[92:95], v[164:167], a[32:35], v[92:95]
    v_mfma_f32_16x16x32_bf16 v[96:99], v[164:167], a[36:39], v[96:99]
    buffer_load_dwordx4 v[236:239], v3, s[20:23], s32 offen offset:1024
    v_mfma_f32_16x16x32_bf16 v[100:103], v[164:167], a[40:43], v[100:103]
    v_permlane16_swap_b32 v29, v31
    v_mfma_f32_16x16x32_bf16 v[104:107], v[164:167], a[44:47], v[104:107]
    s_waitcnt vmcnt(19)
    v_permlane16_swap_b32 v32, v34
    v_mfma_f32_16x16x32_bf16 v[92:95], v[168:171], a[48:51], v[92:95]
    v_permlane16_swap_b32 v33, v35
    v_mfma_f32_16x16x32_bf16 v[96:99], v[168:171], a[52:55], v[96:99]
    buffer_load_dwordx4 v[240:243], v3, s[20:23], s32 offen offset:2048
    v_mfma_f32_16x16x32_bf16 v[100:103], v[168:171], a[56:59], v[100:103]
    v_mfma_f32_16x16x32_bf16 v[104:107], v[168:171], a[60:63], v[104:107]
    s_waitcnt vmcnt(19)
    v_mfma_f32_16x16x32_bf16 v[92:95], v[172:175], a[64:67], v[92:95]
    s_add_u32 s32, s32, 12288
    v_mfma_f32_16x16x32_bf16 v[96:99], v[172:175], a[68:71], v[96:99]
    buffer_load_dwordx4 v[244:247], v3, s[20:23], s32 offen offset:0
    v_mfma_f32_16x16x32_bf16 v[100:103], v[172:175], a[72:75], v[100:103]
    s_add_u32 s37, s37, s40
    v_mfma_f32_16x16x32_bf16 v[104:107], v[172:175], a[76:79], v[104:107]
    s_waitcnt vmcnt(19)
    buffer_store_dwordx4 v[24:27], v6, s[20:23], s37 offen sc1
    v_mfma_f32_16x16x32_bf16 v[92:95], v[176:179], a[80:83], v[92:95]
    v_mfma_f32_16x16x32_bf16 v[96:99], v[176:179], a[84:87], v[96:99]
    buffer_load_dwordx4 v[248:251], v3, s[20:23], s32 offen offset:1024
    v_mfma_f32_16x16x32_bf16 v[100:103], v[176:179], a[88:91], v[100:103]
    v_mfma_f32_16x16x32_bf16 v[104:107], v[176:179], a[92:95], v[104:107]
    s_waitcnt vmcnt(20)
    v_mfma_f32_16x16x32_bf16 v[92:95], v[180:183], a[96:99], v[92:95]
    v_mfma_f32_16x16x32_bf16 v[96:99], v[180:183], a[100:103], v[96:99]
    buffer_load_dwordx4 v[252:255], v3, s[20:23], s32 offen offset:2048
    v_mfma_f32_16x16x32_bf16 v[100:103], v[180:183], a[104:107], v[100:103]
    v_mfma_f32_16x16x32_bf16 v[104:107], v[180:183], a[108:111], v[104:107]
    s_waitcnt vmcnt(20)
    v_mfma_f32_16x16x32_bf16 v[92:95], v[184:187], a[112:115], v[92:95]
    s_add_u32 s32, s32, 12288
    v_mfma_f32_16x16x32_bf16 v[96:99], v[184:187], a[116:119], v[96:99]
    buffer_load_dwordx4 v[148:151], v3, s[20:23], s32 offen offset:0
    v_mfma_f32_16x16x32_bf16 v[100:103], v[184:187], a[120:123], v[100:103]
    v_mfma_f32_16x16x32_bf16 v[104:107], v[184:187], a[124:127], v[104:107]
    s_waitcnt vmcnt(20)
    v_mfma_f32_16x16x32_bf16 v[92:95], v[188:191], a[128:131], v[92:95]
    v_mfma_f32_16x16x32_bf16 v[96:99], v[188:191], a[132:135], v[96:99]
    buffer_load_dwordx4 v[152:155], v3, s[20:23], s32 offen offset:1024
    v_mfma_f32_16x16x32_bf16 v[100:103], v[188:191], a[136:139], v[100:103]
    v_mfma_f32_16x16x32_bf16 v[104:107], v[188:191], a[140:143], v[104:107]
    s_waitcnt vmcnt(19)
    v_mfma_f32_16x16x32_bf16 v[92:95], v[192:195], a[144:147], v[92:95]
    v_mfma_f32_16x16x32_bf16 v[96:99], v[192:195], a[148:151], v[96:99]
    buffer_load_dwordx4 v[156:159], v3, s[20:23], s32 offen offset:2048
    v_mfma_f32_16x16x32_bf16 v[100:103], v[192:195], a[152:155], v[100:103]
    v_mfma_f32_16x16x32_bf16 v[104:107], v[192:195], a[156:159], v[104:107]
    s_waitcnt vmcnt(19)
    v_mfma_f32_16x16x32_bf16 v[92:95], v[196:199], a[160:163], v[92:95]
    s_add_u32 s32, s32, 12288
    v_mfma_f32_16x16x32_bf16 v[96:99], v[196:199], a[164:167], v[96:99]
    buffer_load_dwordx4 v[160:163], v3, s[20:23], s32 offen offset:0
    v_mfma_f32_16x16x32_bf16 v[100:103], v[196:199], a[168:171], v[100:103]
    v_mfma_f32_16x16x32_bf16 v[104:107], v[196:199], a[172:175], v[104:107]
    s_waitcnt vmcnt(19)
    v_mfma_f32_16x16x32_bf16 v[92:95], v[200:203], a[176:179], v[92:95]
    v_mfma_f32_16x16x32_bf16 v[96:99], v[200:203], a[180:183], v[96:99]
    buffer_load_dwordx4 v[164:167], v3, s[20:23], s32 offen offset:1024
    v_mfma_f32_16x16x32_bf16 v[100:103], v[200:203], a[184:187], v[100:103]
    s_add_u32 s36, s36, s41
    v_mfma_f32_16x16x32_bf16 v[104:107], v[200:203], a[188:191], v[104:107]
    s_waitcnt vmcnt(19)
    buffer_store_dwordx4 v[28:31], v6, s[20:23], s36 offen sc1
    v_mfma_f32_16x16x32_bf16 v[92:95], v[204:207], a[192:195], v[92:95]
    v_mfma_f32_16x16x32_bf16 v[96:99], v[204:207], a[196:199], v[96:99]
    buffer_load_dwordx4 v[168:171], v3, s[20:23], s32 offen offset:2048
    v_mfma_f32_16x16x32_bf16 v[100:103], v[204:207], a[200:203], v[100:103]
    v_mfma_f32_16x16x32_bf16 v[104:107], v[204:207], a[204:207], v[104:107]
    s_waitcnt vmcnt(20)
    v_mfma_f32_16x16x32_bf16 v[92:95], v[208:211], a[208:211], v[92:95]
    s_add_u32 s32, s32, 12288
    v_mfma_f32_16x16x32_bf16 v[96:99], v[208:211], a[212:215], v[96:99]
    buffer_load_dwordx4 v[172:175], v3, s[20:23], s32 offen offset:0
    v_mfma_f32_16x16x32_bf16 v[100:103], v[208:211], a[216:219], v[100:103]
    v_mfma_f32_16x16x32_bf16 v[104:107], v[208:211], a[220:223], v[104:107]
    s_waitcnt vmcnt(20)
    v_mfma_f32_16x16x32_bf16 v[92:95], v[212:215], a[224:227], v[92:95]
    v_mfma_f32_16x16x32_bf16 v[96:99], v[212:215], a[228:231], v[96:99]
    buffer_load_dwordx4 v[176:179], v3, s[20:23], s32 offen offset:1024
    v_mfma_f32_16x16x32_bf16 v[100:103], v[212:215], a[232:235], v[100:103]
    v_mfma_f32_16x16x32_bf16 v[104:107], v[212:215], a[236:239], v[104:107]
    s_waitcnt vmcnt(20)
    v_mfma_f32_16x16x32_bf16 v[92:95], v[216:219], a[240:243], v[92:95]
    v_mfma_f32_16x16x32_bf16 v[96:99], v[216:219], a[244:247], v[96:99]
    buffer_load_dwordx4 v[180:183], v3, s[20:23], s32 offen offset:2048
    v_mfma_f32_16x16x32_bf16 v[100:103], v[216:219], a[248:251], v[100:103]
    v_mfma_f32_16x16x32_bf16 v[104:107], v[216:219], a[252:255], v[104:107]
    s_waitcnt vmcnt(19)
    v_mfma_f32_16x16x32_bf16 v[108:111], v[220:223], v[44:47], 0
    s_add_u32 s32, s32, s12
    v_mfma_f32_16x16x32_bf16 v[112:115], v[220:223], v[48:51], 0
    buffer_load_dwordx4 v[184:187], v3, s[20:23], s32 offen offset:0
    v_mfma_f32_16x16x32_bf16 v[116:119], v[220:223], v[52:55], 0
    v_mfma_f32_16x16x32_bf16 v[120:123], v[220:223], v[56:59], 0
    s_waitcnt vmcnt(19)
    v_cvt_pk_bf16_f32 v36, v92, v93
    v_mfma_f32_16x16x32_bf16 v[108:111], v[224:227], v[60:63], v[108:111]
    v_cvt_pk_bf16_f32 v37, v94, v95
    v_mfma_f32_16x16x32_bf16 v[112:115], v[224:227], v[64:67], v[112:115]
    buffer_load_dwordx4 v[188:191], v3, s[20:23], s32 offen offset:1024
    v_mfma_f32_16x16x32_bf16 v[116:119], v[224:227], v[68:71], v[116:119]
    v_cvt_pk_bf16_f32 v38, v96, v97
    v_mfma_f32_16x16x32_bf16 v[120:123], v[224:227], v[72:75], v[120:123]
    s_waitcnt vmcnt(19)
    v_cvt_pk_bf16_f32 v39, v98, v99
    v_mfma_f32_16x16x32_bf16 v[108:111], v[228:231], a[0:3], v[108:111]
    v_cvt_pk_bf16_f32 v40, v100, v101
    v_mfma_f32_16x16x32_bf16 v[112:115], v[228:231], a[4:7], v[112:115]
    buffer_load_dwordx4 v[192:195], v3, s[20:23], s32 offen offset:2048
    v_mfma_f32_16x16x32_bf16 v[116:119], v[228:231], a[8:11], v[116:119]
    s_add_u32 s37, s37, s41
    v_cvt_pk_bf16_f32 v41, v102, v103
    v_mfma_f32_16x16x32_bf16 v[120:123], v[228:231], a[12:15], v[120:123]
    s_waitcnt vmcnt(19)
    buffer_store_dwordx4 v[32:35], v6, s[20:23], s37 offen sc1
    v_mfma_f32_16x16x32_bf16 v[108:111], v[232:235], a[16:19], v[108:111]
    s_add_u32 s32, s32, 12288
    v_mfma_f32_16x16x32_bf16 v[112:115], v[232:235], a[20:23], v[112:115]
    buffer_load_dwordx4 v[196:199], v3, s[20:23], s32 offen offset:0
    v_mfma_f32_16x16x32_bf16 v[116:119], v[232:235], a[24:27], v[116:119]
    v_cvt_pk_bf16_f32 v42, v104, v105
    v_mfma_f32_16x16x32_bf16 v[120:123], v[232:235], a[28:31], v[120:123]
    s_waitcnt vmcnt(20)
    v_cvt_pk_bf16_f32 v43, v106, v107
    v_mfma_f32_16x16x32_bf16 v[108:111], v[236:239], a[32:35], v[108:111]
    v_permlane16_swap_b32 v36, v38
    v_mfma_f32_16x16x32_bf16 v[112:115], v[236:239], a[36:39], v[112:115]
    buffer_load_dwordx4 v[200:203], v3, s[20:23], s32 offen offset:1024
    v_mfma_f32_16x16x32_bf16 v[116:119], v[236:239], a[40:43], v[116:119]
    v_permlane16_swap_b32 v37, v39
    v_mfma_f32_16x16x32_bf16 v[120:123], v[236:239], a[44:47], v[120:123]
    s_waitcnt vmcnt(20)
    v_permlane16_swap_b32 v40, v42
    v_mfma_f32_16x16x32_bf16 v[108:111], v[240:243], a[48:51], v[108:111]
    v_permlane16_swap_b32 v41, v43
    v_mfma_f32_16x16x32_bf16 v[112:115], v[240:243], a[52:55], v[112:115]
    buffer_load_dwordx4 v[204:207], v3, s[20:23], s32 offen offset:2048
    v_mfma_f32_16x16x32_bf16 v[116:119], v[240:243], a[56:59], v[116:119]
    v_mfma_f32_16x16x32_bf16 v[120:123], v[240:243], a[60:63], v[120:123]
    s_waitcnt vmcnt(20)
    v_mfma_f32_16x16x32_bf16 v[108:111], v[244:247], a[64:67], v[108:111]
    s_add_u32 s32, s32, 12288
    v_mfma_f32_16x16x32_bf16 v[112:115], v[244:247], a[68:71], v[112:115]
    buffer_load_dwordx4 v[208:211], v3, s[20:23], s32 offen offset:0
    v_mfma_f32_16x16x32_bf16 v[116:119], v[244:247], a[72:75], v[116:119]
    v_mfma_f32_16x16x32_bf16 v[120:123], v[244:247], a[76:79], v[120:123]
    s_waitcnt vmcnt(19)
    v_mfma_f32_16x16x32_bf16 v[108:111], v[248:251], a[80:83], v[108:111]
    v_mfma_f32_16x16x32_bf16 v[112:115], v[248:251], a[84:87], v[112:115]
    buffer_load_dwordx4 v[212:215], v3, s[20:23], s32 offen offset:1024
    v_mfma_f32_16x16x32_bf16 v[116:119], v[248:251], a[88:91], v[116:119]
    v_mfma_f32_16x16x32_bf16 v[120:123], v[248:251], a[92:95], v[120:123]
    s_waitcnt vmcnt(19)
    v_mfma_f32_16x16x32_bf16 v[108:111], v[252:255], a[96:99], v[108:111]
    v_mfma_f32_16x16x32_bf16 v[112:115], v[252:255], a[100:103], v[112:115]
    buffer_load_dwordx4 v[216:219], v3, s[20:23], s32 offen offset:2048
    v_mfma_f32_16x16x32_bf16 v[116:119], v[252:255], a[104:107], v[116:119]
    v_mfma_f32_16x16x32_bf16 v[120:123], v[252:255], a[108:111], v[120:123]
    s_waitcnt vmcnt(19)
    v_mfma_f32_16x16x32_bf16 v[108:111], v[148:151], a[112:115], v[108:111]
    s_add_u32 s32, s32, 12288
    v_mfma_f32_16x16x32_bf16 v[112:115], v[148:151], a[116:119], v[112:115]
    buffer_load_dwordx4 v[220:223], v3, s[20:23], s32 offen offset:0
    v_mfma_f32_16x16x32_bf16 v[116:119], v[148:151], a[120:123], v[116:119]
    s_add_u32 s36, s36, s42
    v_mfma_f32_16x16x32_bf16 v[120:123], v[148:151], a[124:127], v[120:123]
    s_waitcnt vmcnt(19)
    buffer_store_dwordx4 v[36:39], v6, s[20:23], s36 offen sc1
    v_mfma_f32_16x16x32_bf16 v[108:111], v[152:155], a[128:131], v[108:111]
    v_mfma_f32_16x16x32_bf16 v[112:115], v[152:155], a[132:135], v[112:115]
    buffer_load_dwordx4 v[224:227], v3, s[20:23], s32 offen offset:1024
    v_mfma_f32_16x16x32_bf16 v[116:119], v[152:155], a[136:139], v[116:119]
    v_mfma_f32_16x16x32_bf16 v[120:123], v[152:155], a[140:143], v[120:123]
    s_waitcnt vmcnt(20)
    v_mfma_f32_16x16x32_bf16 v[108:111], v[156:159], a[144:147], v[108:111]
    v_mfma_f32_16x16x32_bf16 v[112:115], v[156:159], a[148:151], v[112:115]
    buffer_load_dwordx4 v[228:231], v3, s[20:23], s32 offen offset:2048
    v_mfma_f32_16x16x32_bf16 v[116:119], v[156:159], a[152:155], v[116:119]
    v_mfma_f32_16x16x32_bf16 v[120:123], v[156:159], a[156:159], v[120:123]
    s_waitcnt vmcnt(20)
    v_mfma_f32_16x16x32_bf16 v[108:111], v[160:163], a[160:163], v[108:111]
    s_add_u32 s32, s32, 12288
    v_mfma_f32_16x16x32_bf16 v[112:115], v[160:163], a[164:167], v[112:115]
    buffer_load_dwordx4 v[232:235], v3, s[20:23], s32 offen offset:0
    v_mfma_f32_16x16x32_bf16 v[116:119], v[160:163], a[168:171], v[116:119]
    v_mfma_f32_16x16x32_bf16 v[120:123], v[160:163], a[172:175], v[120:123]
    s_waitcnt vmcnt(20)
    v_mfma_f32_16x16x32_bf16 v[108:111], v[164:167], a[176:179], v[108:111]
    v_mfma_f32_16x16x32_bf16 v[112:115], v[164:167], a[180:183], v[112:115]
    buffer_load_dwordx4 v[236:239], v3, s[20:23], s32 offen offset:1024
    v_mfma_f32_16x16x32_bf16 v[116:119], v[164:167], a[184:187], v[116:119]
    v_mfma_f32_16x16x32_bf16 v[120:123], v[164:167], a[188:191], v[120:123]
    s_waitcnt vmcnt(19)
    v_mfma_f32_16x16x32_bf16 v[108:111], v[168:171], a[192:195], v[108:111]
    v_mfma_f32_16x16x32_bf16 v[112:115], v[168:171], a[196:199], v[112:115]
    buffer_load_dwordx4 v[240:243], v3, s[20:23], s32 offen offset:2048
    v_mfma_f32_16x16x32_bf16 v[116:119], v[168:171], a[200:203], v[116:119]
    v_mfma_f32_16x16x32_bf16 v[120:123], v[168:171], a[204:207], v[120:123]
    s_waitcnt vmcnt(19)
    v_mfma_f32_16x16x32_bf16 v[108:111], v[172:175], a[208:211], v[108:111]
    s_add_u32 s32, s32, 12288
    v_mfma_f32_16x16x32_bf16 v[112:115], v[172:175], a[212:215], v[112:115]
    buffer_load_dwordx4 v[244:247], v3, s[20:23], s32 offen offset:0
    v_mfma_f32_16x16x32_bf16 v[116:119], v[172:175], a[216:219], v[116:119]
    v_mfma_f32_16x16x32_bf16 v[120:123], v[172:175], a[220:223], v[120:123]
    s_waitcnt vmcnt(19)
    v_mfma_f32_16x16x32_bf16 v[108:111], v[176:179], a[224:227], v[108:111]
    v_mfma_f32_16x16x32_bf16 v[112:115], v[176:179], a[228:231], v[112:115]
    buffer_load_dwordx4 v[248:251], v3, s[20:23], s32 offen offset:1024
    v_mfma_f32_16x16x32_bf16 v[116:119], v[176:179], a[232:235], v[116:119]
    s_add_u32 s37, s37, s42
    v_mfma_f32_16x16x32_bf16 v[120:123], v[176:179], a[236:239], v[120:123]
    s_waitcnt vmcnt(19)
    buffer_store_dwordx4 v[40:43], v6, s[20:23], s37 offen sc1
    v_mfma_f32_16x16x32_bf16 v[108:111], v[180:183], a[240:243], v[108:111]
    v_mfma_f32_16x16x32_bf16 v[112:115], v[180:183], a[244:247], v[112:115]
    buffer_load_dwordx4 v[252:255], v3, s[20:23], s32 offen offset:2048
    v_mfma_f32_16x16x32_bf16 v[116:119], v[180:183], a[248:251], v[116:119]
    v_mfma_f32_16x16x32_bf16 v[120:123], v[180:183], a[252:255], v[120:123]
    s_waitcnt vmcnt(20)
    v_mfma_f32_16x16x32_bf16 v[124:127], v[184:187], v[44:47], 0
    s_add_u32 s32, s32, s13
    v_mfma_f32_16x16x32_bf16 v[128:131], v[184:187], v[48:51], 0
    buffer_load_dwordx4 v[148:151], v3, s[20:23], s32 offen offset:0
    v_mfma_f32_16x16x32_bf16 v[132:135], v[184:187], v[52:55], 0
    v_mfma_f32_16x16x32_bf16 v[136:139], v[184:187], v[56:59], 0
    s_waitcnt vmcnt(20)
    v_cvt_pk_bf16_f32 v12, v108, v109
    v_mfma_f32_16x16x32_bf16 v[124:127], v[188:191], v[60:63], v[124:127]
    v_cvt_pk_bf16_f32 v13, v110, v111
    v_mfma_f32_16x16x32_bf16 v[128:131], v[188:191], v[64:67], v[128:131]
    buffer_load_dwordx4 v[152:155], v3, s[20:23], s32 offen offset:1024
    v_mfma_f32_16x16x32_bf16 v[132:135], v[188:191], v[68:71], v[132:135]
    v_cvt_pk_bf16_f32 v14, v112, v113
    v_mfma_f32_16x16x32_bf16 v[136:139], v[188:191], v[72:75], v[136:139]
    s_waitcnt vmcnt(20)
    v_mfma_f32_16x16x32_bf16 v[124:127], v[192:195], a[0:3], v[124:127]
    v_cvt_pk_bf16_f32 v15, v114, v115
    v_mfma_f32_16x16x32_bf16 v[128:131], v[192:195], a[4:7], v[128:131]
    buffer_load_dwordx4 v[156:159], v3, s[20:23], s32 offen offset:2048
    v_mfma_f32_16x16x32_bf16 v[132:135], v[192:195], a[8:11], v[132:135]
    v_cvt_pk_bf16_f32 v16, v116, v117
    v_mfma_f32_16x16x32_bf16 v[136:139], v[192:195], a[12:15], v[136:139]
    s_waitcnt vmcnt(19)
    v_cvt_pk_bf16_f32 v17, v118, v119
    v_mfma_f32_16x16x32_bf16 v[124:127], v[196:199], a[16:19], v[124:127]
    s_add_u32 s32, s32, 12288
    v_cvt_pk_bf16_f32 v18, v120, v121
    v_mfma_f32_16x16x32_bf16 v[128:131], v[196:199], a[20:23], v[128:131]
    buffer_load_dwordx4 v[160:163], v3, s[20:23], s32 offen offset:0
    v_mfma_f32_16x16x32_bf16 v[132:135], v[196:199], a[24:27], v[132:135]
    v_cvt_pk_bf16_f32 v19, v122, v123
    v_mfma_f32_16x16x32_bf16 v[136:139], v[196:199], a[28:31], v[136:139]
    s_waitcnt vmcnt(19)
    v_permlane16_swap_b32 v12, v14
    v_mfma_f32_16x16x32_bf16 v[124:127], v[200:203], a[32:35], v[124:127]
    v_mfma_f32_16x16x32_bf16 v[128:131], v[200:203], a[36:39], v[128:131]
    buffer_load_dwordx4 v[164:167], v3, s[20:23], s32 offen offset:1024
    v_mfma_f32_16x16x32_bf16 v[132:135], v[200:203], a[40:43], v[132:135]
    v_permlane16_swap_b32 v13, v15
    v_mfma_f32_16x16x32_bf16 v[136:139], v[200:203], a[44:47], v[136:139]
    s_waitcnt vmcnt(19)
    v_permlane16_swap_b32 v16, v18
    v_mfma_f32_16x16x32_bf16 v[124:127], v[204:207], a[48:51], v[124:127]
    v_permlane16_swap_b32 v17, v19
    v_mfma_f32_16x16x32_bf16 v[128:131], v[204:207], a[52:55], v[128:131]
    buffer_load_dwordx4 v[168:171], v3, s[20:23], s32 offen offset:2048
    v_mfma_f32_16x16x32_bf16 v[132:135], v[204:207], a[56:59], v[132:135]
    s_add_u32 s36, s36, s43
    v_mfma_f32_16x16x32_bf16 v[136:139], v[204:207], a[60:63], v[136:139]
    s_waitcnt vmcnt(19)
    buffer_store_dwordx4 v[12:15], v6, s[20:23], s36 offen sc1
    v_mfma_f32_16x16x32_bf16 v[124:127], v[208:211], a[64:67], v[124:127]
    s_add_u32 s32, s32, 12288
    v_mfma_f32_16x16x32_bf16 v[128:131], v[208:211], a[68:71], v[128:131]
    buffer_load_dwordx4 v[172:175], v3, s[20:23], s32 offen offset:0
    v_mfma_f32_16x16x32_bf16 v[132:135], v[208:211], a[72:75], v[132:135]
    v_mfma_f32_16x16x32_bf16 v[136:139], v[208:211], a[76:79], v[136:139]
    s_waitcnt vmcnt(20)
    v_mfma_f32_16x16x32_bf16 v[124:127], v[212:215], a[80:83], v[124:127]
    v_mfma_f32_16x16x32_bf16 v[128:131], v[212:215], a[84:87], v[128:131]
    buffer_load_dwordx4 v[176:179], v3, s[20:23], s32 offen offset:1024
    v_mfma_f32_16x16x32_bf16 v[132:135], v[212:215], a[88:91], v[132:135]
    v_mfma_f32_16x16x32_bf16 v[136:139], v[212:215], a[92:95], v[136:139]
    s_waitcnt vmcnt(20)
    v_mfma_f32_16x16x32_bf16 v[124:127], v[216:219], a[96:99], v[124:127]
    v_mfma_f32_16x16x32_bf16 v[128:131], v[216:219], a[100:103], v[128:131]
    buffer_load_dwordx4 v[180:183], v3, s[20:23], s32 offen offset:2048
    v_mfma_f32_16x16x32_bf16 v[132:135], v[216:219], a[104:107], v[132:135]
    v_mfma_f32_16x16x32_bf16 v[136:139], v[216:219], a[108:111], v[136:139]
    s_waitcnt vmcnt(20)
    v_mfma_f32_16x16x32_bf16 v[124:127], v[220:223], a[112:115], v[124:127]
    s_add_u32 s32, s32, 12288
    v_mfma_f32_16x16x32_bf16 v[128:131], v[220:223], a[116:119], v[128:131]
    buffer_load_dwordx4 v[184:187], v3, s[20:23], s32 offen offset:0
    v_mfma_f32_16x16x32_bf16 v[132:135], v[220:223], a[120:123], v[132:135]
    v_mfma_f32_16x16x32_bf16 v[136:139], v[220:223], a[124:127], v[136:139]
    s_waitcnt vmcnt(19)
    v_mfma_f32_16x16x32_bf16 v[124:127], v[224:227], a[128:131], v[124:127]
    v_mfma_f32_16x16x32_bf16 v[128:131], v[224:227], a[132:135], v[128:131]
    buffer_load_dwordx4 v[188:191], v3, s[20:23], s32 offen offset:1024
    v_mfma_f32_16x16x32_bf16 v[132:135], v[224:227], a[136:139], v[132:135]
    v_mfma_f32_16x16x32_bf16 v[136:139], v[224:227], a[140:143], v[136:139]
    s_waitcnt vmcnt(19)
    v_mfma_f32_16x16x32_bf16 v[124:127], v[228:231], a[144:147], v[124:127]
    v_mfma_f32_16x16x32_bf16 v[128:131], v[228:231], a[148:151], v[128:131]
    buffer_load_dwordx4 v[192:195], v3, s[20:23], s32 offen offset:2048
    v_mfma_f32_16x16x32_bf16 v[132:135], v[228:231], a[152:155], v[132:135]
    v_mfma_f32_16x16x32_bf16 v[136:139], v[228:231], a[156:159], v[136:139]
    s_waitcnt vmcnt(19)
    v_mfma_f32_16x16x32_bf16 v[124:127], v[232:235], a[160:163], v[124:127]
    s_add_u32 s32, s32, 12288
    v_mfma_f32_16x16x32_bf16 v[128:131], v[232:235], a[164:167], v[128:131]
    buffer_load_dwordx4 v[196:199], v3, s[20:23], s32 offen offset:0
    v_mfma_f32_16x16x32_bf16 v[132:135], v[232:235], a[168:171], v[132:135]
    s_add_u32 s37, s37, s43
    v_mfma_f32_16x16x32_bf16 v[136:139], v[232:235], a[172:175], v[136:139]
    s_waitcnt vmcnt(19)
    buffer_store_dwordx4 v[16:19], v6, s[20:23], s37 offen sc1
    v_mfma_f32_16x16x32_bf16 v[124:127], v[236:239], a[176:179], v[124:127]
    v_mfma_f32_16x16x32_bf16 v[128:131], v[236:239], a[180:183], v[128:131]
    buffer_load_dwordx4 v[200:203], v3, s[20:23], s32 offen offset:1024
    v_mfma_f32_16x16x32_bf16 v[132:135], v[236:239], a[184:187], v[132:135]
    v_mfma_f32_16x16x32_bf16 v[136:139], v[236:239], a[188:191], v[136:139]
    s_waitcnt vmcnt(20)
    v_mfma_f32_16x16x32_bf16 v[124:127], v[240:243], a[192:195], v[124:127]
    v_mfma_f32_16x16x32_bf16 v[128:131], v[240:243], a[196:199], v[128:131]
    buffer_load_dwordx4 v[204:207], v3, s[20:23], s32 offen offset:2048
    v_mfma_f32_16x16x32_bf16 v[132:135], v[240:243], a[200:203], v[132:135]
    v_mfma_f32_16x16x32_bf16 v[136:139], v[240:243], a[204:207], v[136:139]
    s_waitcnt vmcnt(20)
    v_mfma_f32_16x16x32_bf16 v[124:127], v[244:247], a[208:211], v[124:127]
    s_add_u32 s32, s32, 12288
    v_mfma_f32_16x16x32_bf16 v[128:131], v[244:247], a[212:215], v[128:131]
    buffer_load_dwordx4 v[208:211], v3, s[20:23], s32 offen offset:0
    v_mfma_f32_16x16x32_bf16 v[132:135], v[244:247], a[216:219], v[132:135]
    v_mfma_f32_16x16x32_bf16 v[136:139], v[244:247], a[220:223], v[136:139]
    s_waitcnt vmcnt(20)
    v_mfma_f32_16x16x32_bf16 v[124:127], v[248:251], a[224:227], v[124:127]
    v_mfma_f32_16x16x32_bf16 v[128:131], v[248:251], a[228:231], v[128:131]
    buffer_load_dwordx4 v[212:215], v3, s[20:23], s32 offen offset:1024
    v_mfma_f32_16x16x32_bf16 v[132:135], v[248:251], a[232:235], v[132:135]
    v_mfma_f32_16x16x32_bf16 v[136:139], v[248:251], a[236:239], v[136:139]
    s_waitcnt vmcnt(19)
    v_mfma_f32_16x16x32_bf16 v[124:127], v[252:255], a[240:243], v[124:127]
    v_mfma_f32_16x16x32_bf16 v[128:131], v[252:255], a[244:247], v[128:131]
    buffer_load_dwordx4 v[216:219], v3, s[20:23], s32 offen offset:2048
    v_mfma_f32_16x16x32_bf16 v[132:135], v[252:255], a[248:251], v[132:135]
    v_mfma_f32_16x16x32_bf16 v[136:139], v[252:255], a[252:255], v[136:139]
    s_waitcnt vmcnt(19)
    v_mfma_f32_16x16x32_bf16 v[76:79], v[148:151], v[44:47], 0
    s_add_u32 s32, s32, s14
    v_mfma_f32_16x16x32_bf16 v[80:83], v[148:151], v[48:51], 0
    buffer_load_dwordx4 v[220:223], v3, s[20:23], s32 offen offset:0
    v_mfma_f32_16x16x32_bf16 v[84:87], v[148:151], v[52:55], 0
    v_mfma_f32_16x16x32_bf16 v[88:91], v[148:151], v[56:59], 0
    s_waitcnt vmcnt(19)
    v_cvt_pk_bf16_f32 v20, v124, v125
    v_mfma_f32_16x16x32_bf16 v[76:79], v[152:155], v[60:63], v[76:79]
    v_cvt_pk_bf16_f32 v21, v126, v127
    v_mfma_f32_16x16x32_bf16 v[80:83], v[152:155], v[64:67], v[80:83]
    buffer_load_dwordx4 v[224:227], v3, s[20:23], s32 offen offset:1024
    v_mfma_f32_16x16x32_bf16 v[84:87], v[152:155], v[68:71], v[84:87]
    v_cvt_pk_bf16_f32 v22, v128, v129
    v_mfma_f32_16x16x32_bf16 v[88:91], v[152:155], v[72:75], v[88:91]
    s_waitcnt vmcnt(19)
    v_mfma_f32_16x16x32_bf16 v[76:79], v[156:159], a[0:3], v[76:79]
    v_cvt_pk_bf16_f32 v23, v130, v131
    v_mfma_f32_16x16x32_bf16 v[80:83], v[156:159], a[4:7], v[80:83]
    buffer_load_dwordx4 v[228:231], v3, s[20:23], s32 offen offset:2048
    v_mfma_f32_16x16x32_bf16 v[84:87], v[156:159], a[8:11], v[84:87]
    v_cvt_pk_bf16_f32 v24, v132, v133
    v_mfma_f32_16x16x32_bf16 v[88:91], v[156:159], a[12:15], v[88:91]
    s_waitcnt vmcnt(19)
    v_cvt_pk_bf16_f32 v25, v134, v135
    v_mfma_f32_16x16x32_bf16 v[76:79], v[160:163], a[16:19], v[76:79]
    s_add_u32 s32, s32, 12288
    v_cvt_pk_bf16_f32 v26, v136, v137
    v_mfma_f32_16x16x32_bf16 v[80:83], v[160:163], a[20:23], v[80:83]
    buffer_load_dwordx4 v[232:235], v3, s[20:23], s32 offen offset:0
    v_mfma_f32_16x16x32_bf16 v[84:87], v[160:163], a[24:27], v[84:87]
    v_cvt_pk_bf16_f32 v27, v138, v139
    v_mfma_f32_16x16x32_bf16 v[88:91], v[160:163], a[28:31], v[88:91]
    s_waitcnt vmcnt(19)
    v_permlane16_swap_b32 v20, v22
    v_mfma_f32_16x16x32_bf16 v[76:79], v[164:167], a[32:35], v[76:79]
    v_mfma_f32_16x16x32_bf16 v[80:83], v[164:167], a[36:39], v[80:83]
    buffer_load_dwordx4 v[236:239], v3, s[20:23], s32 offen offset:1024
    v_mfma_f32_16x16x32_bf16 v[84:87], v[164:167], a[40:43], v[84:87]
    v_permlane16_swap_b32 v21, v23
    v_mfma_f32_16x16x32_bf16 v[88:91], v[164:167], a[44:47], v[88:91]
    s_waitcnt vmcnt(19)
    v_permlane16_swap_b32 v24, v26
    v_mfma_f32_16x16x32_bf16 v[76:79], v[168:171], a[48:51], v[76:79]
    v_permlane16_swap_b32 v25, v27
    v_mfma_f32_16x16x32_bf16 v[80:83], v[168:171], a[52:55], v[80:83]
    buffer_load_dwordx4 v[240:243], v3, s[20:23], s32 offen offset:2048
    v_mfma_f32_16x16x32_bf16 v[84:87], v[168:171], a[56:59], v[84:87]
    s_add_u32 s36, s36, s44
    v_mfma_f32_16x16x32_bf16 v[88:91], v[168:171], a[60:63], v[88:91]
    s_waitcnt vmcnt(18)
    buffer_store_dwordx4 v[20:23], v6, s[20:23], s36 offen sc1
    v_mfma_f32_16x16x32_bf16 v[76:79], v[172:175], a[64:67], v[76:79]
    s_add_u32 s32, s32, 12288
    v_mfma_f32_16x16x32_bf16 v[80:83], v[172:175], a[68:71], v[80:83]
    buffer_load_dwordx4 v[244:247], v3, s[20:23], s32 offen offset:0
    v_mfma_f32_16x16x32_bf16 v[84:87], v[172:175], a[72:75], v[84:87]
    v_mfma_f32_16x16x32_bf16 v[88:91], v[172:175], a[76:79], v[88:91]
    s_waitcnt vmcnt(19)
    v_mfma_f32_16x16x32_bf16 v[76:79], v[176:179], a[80:83], v[76:79]
    v_mfma_f32_16x16x32_bf16 v[80:83], v[176:179], a[84:87], v[80:83]
    buffer_load_dwordx4 v[248:251], v3, s[20:23], s32 offen offset:1024
    v_mfma_f32_16x16x32_bf16 v[84:87], v[176:179], a[88:91], v[84:87]
    v_mfma_f32_16x16x32_bf16 v[88:91], v[176:179], a[92:95], v[88:91]
    s_waitcnt vmcnt(19)
    v_mfma_f32_16x16x32_bf16 v[76:79], v[180:183], a[96:99], v[76:79]
    v_mfma_f32_16x16x32_bf16 v[80:83], v[180:183], a[100:103], v[80:83]
    buffer_load_dwordx4 v[252:255], v3, s[20:23], s32 offen offset:2048
    v_mfma_f32_16x16x32_bf16 v[84:87], v[180:183], a[104:107], v[84:87]
    v_mfma_f32_16x16x32_bf16 v[88:91], v[180:183], a[108:111], v[88:91]
    s_waitcnt vmcnt(19)
    v_mfma_f32_16x16x32_bf16 v[76:79], v[184:187], a[112:115], v[76:79]
    s_add_u32 s32, s32, 12288
    v_mfma_f32_16x16x32_bf16 v[80:83], v[184:187], a[116:119], v[80:83]
    buffer_load_dwordx4 v[148:151], v3, s[20:23], s32 offen offset:0
    v_mfma_f32_16x16x32_bf16 v[84:87], v[184:187], a[120:123], v[84:87]
    v_mfma_f32_16x16x32_bf16 v[88:91], v[184:187], a[124:127], v[88:91]
    s_waitcnt vmcnt(19)
    v_mfma_f32_16x16x32_bf16 v[76:79], v[188:191], a[128:131], v[76:79]
    v_mfma_f32_16x16x32_bf16 v[80:83], v[188:191], a[132:135], v[80:83]
    buffer_load_dwordx4 v[152:155], v3, s[20:23], s32 offen offset:1024
    v_mfma_f32_16x16x32_bf16 v[84:87], v[188:191], a[136:139], v[84:87]
    v_mfma_f32_16x16x32_bf16 v[88:91], v[188:191], a[140:143], v[88:91]
    s_waitcnt vmcnt(19)
    v_mfma_f32_16x16x32_bf16 v[76:79], v[192:195], a[144:147], v[76:79]
    v_mfma_f32_16x16x32_bf16 v[80:83], v[192:195], a[148:151], v[80:83]
    buffer_load_dwordx4 v[156:159], v3, s[20:23], s32 offen offset:2048
    v_mfma_f32_16x16x32_bf16 v[84:87], v[192:195], a[152:155], v[84:87]
    v_mfma_f32_16x16x32_bf16 v[88:91], v[192:195], a[156:159], v[88:91]
    s_waitcnt vmcnt(19)
    v_mfma_f32_16x16x32_bf16 v[76:79], v[196:199], a[160:163], v[76:79]
    s_add_u32 s32, s32, 12288
    v_mfma_f32_16x16x32_bf16 v[80:83], v[196:199], a[164:167], v[80:83]
    buffer_load_dwordx4 v[160:163], v3, s[20:23], s32 offen offset:0
    v_mfma_f32_16x16x32_bf16 v[84:87], v[196:199], a[168:171], v[84:87]
    s_add_u32 s37, s37, s44
    v_mfma_f32_16x16x32_bf16 v[88:91], v[196:199], a[172:175], v[88:91]
    s_waitcnt vmcnt(18)
    buffer_store_dwordx4 v[24:27], v6, s[20:23], s37 offen sc1
    v_mfma_f32_16x16x32_bf16 v[76:79], v[200:203], a[176:179], v[76:79]
    v_mfma_f32_16x16x32_bf16 v[80:83], v[200:203], a[180:183], v[80:83]
    buffer_load_dwordx4 v[164:167], v3, s[20:23], s32 offen offset:1024
    v_mfma_f32_16x16x32_bf16 v[84:87], v[200:203], a[184:187], v[84:87]
    v_mfma_f32_16x16x32_bf16 v[88:91], v[200:203], a[188:191], v[88:91]
    s_waitcnt vmcnt(19)
    v_mfma_f32_16x16x32_bf16 v[76:79], v[204:207], a[192:195], v[76:79]
    v_mfma_f32_16x16x32_bf16 v[80:83], v[204:207], a[196:199], v[80:83]
    buffer_load_dwordx4 v[168:171], v3, s[20:23], s32 offen offset:2048
    v_mfma_f32_16x16x32_bf16 v[84:87], v[204:207], a[200:203], v[84:87]
    v_mfma_f32_16x16x32_bf16 v[88:91], v[204:207], a[204:207], v[88:91]
    s_waitcnt vmcnt(19)
    v_mfma_f32_16x16x32_bf16 v[76:79], v[208:211], a[208:211], v[76:79]
    s_add_u32 s32, s32, 12288
    v_mfma_f32_16x16x32_bf16 v[80:83], v[208:211], a[212:215], v[80:83]
    buffer_load_dwordx4 v[172:175], v3, s[20:23], s32 offen offset:0
    v_mfma_f32_16x16x32_bf16 v[84:87], v[208:211], a[216:219], v[84:87]
    v_mfma_f32_16x16x32_bf16 v[88:91], v[208:211], a[220:223], v[88:91]
    s_waitcnt vmcnt(19)
    v_mfma_f32_16x16x32_bf16 v[76:79], v[212:215], a[224:227], v[76:79]
    v_mfma_f32_16x16x32_bf16 v[80:83], v[212:215], a[228:231], v[80:83]
    buffer_load_dwordx4 v[176:179], v3, s[20:23], s32 offen offset:1024
    v_mfma_f32_16x16x32_bf16 v[84:87], v[212:215], a[232:235], v[84:87]
    v_mfma_f32_16x16x32_bf16 v[88:91], v[212:215], a[236:239], v[88:91]
    s_waitcnt vmcnt(19)
    v_mfma_f32_16x16x32_bf16 v[76:79], v[216:219], a[240:243], v[76:79]
    v_mfma_f32_16x16x32_bf16 v[80:83], v[216:219], a[244:247], v[80:83]
    buffer_load_dwordx4 v[180:183], v3, s[20:23], s32 offen offset:2048
    v_mfma_f32_16x16x32_bf16 v[84:87], v[216:219], a[248:251], v[84:87]
    v_mfma_f32_16x16x32_bf16 v[88:91], v[216:219], a[252:255], v[88:91]
    s_waitcnt vmcnt(19)
    v_mfma_f32_16x16x32_bf16 v[92:95], v[220:223], v[44:47], 0
    s_add_u32 s32, s32, s15
    v_mfma_f32_16x16x32_bf16 v[96:99], v[220:223], v[48:51], 0
    buffer_load_dwordx4 v[184:187], v3, s[20:23], s32 offen offset:0
    v_mfma_f32_16x16x32_bf16 v[100:103], v[220:223], v[52:55], 0
    v_mfma_f32_16x16x32_bf16 v[104:107], v[220:223], v[56:59], 0
    s_waitcnt vmcnt(19)
    v_cvt_pk_bf16_f32 v28, v76, v77
    v_mfma_f32_16x16x32_bf16 v[92:95], v[224:227], v[60:63], v[92:95]
    v_cvt_pk_bf16_f32 v29, v78, v79
    v_mfma_f32_16x16x32_bf16 v[96:99], v[224:227], v[64:67], v[96:99]
    buffer_load_dwordx4 v[188:191], v3, s[20:23], s32 offen offset:1024
    v_mfma_f32_16x16x32_bf16 v[100:103], v[224:227], v[68:71], v[100:103]
    v_cvt_pk_bf16_f32 v30, v80, v81
    v_mfma_f32_16x16x32_bf16 v[104:107], v[224:227], v[72:75], v[104:107]
    s_waitcnt vmcnt(19)
    v_mfma_f32_16x16x32_bf16 v[92:95], v[228:231], a[0:3], v[92:95]
    v_cvt_pk_bf16_f32 v31, v82, v83
    v_mfma_f32_16x16x32_bf16 v[96:99], v[228:231], a[4:7], v[96:99]
    buffer_load_dwordx4 v[192:195], v3, s[20:23], s32 offen offset:2048
    v_mfma_f32_16x16x32_bf16 v[100:103], v[228:231], a[8:11], v[100:103]
    v_cvt_pk_bf16_f32 v32, v84, v85
    v_mfma_f32_16x16x32_bf16 v[104:107], v[228:231], a[12:15], v[104:107]
    s_waitcnt vmcnt(19)
    v_cvt_pk_bf16_f32 v33, v86, v87
    v_mfma_f32_16x16x32_bf16 v[92:95], v[232:235], a[16:19], v[92:95]
    s_add_u32 s32, s32, 12288
    v_cvt_pk_bf16_f32 v34, v88, v89
    v_mfma_f32_16x16x32_bf16 v[96:99], v[232:235], a[20:23], v[96:99]
    buffer_load_dwordx4 v[196:199], v3, s[20:23], s32 offen offset:0
    v_mfma_f32_16x16x32_bf16 v[100:103], v[232:235], a[24:27], v[100:103]
    v_cvt_pk_bf16_f32 v35, v90, v91
    v_mfma_f32_16x16x32_bf16 v[104:107], v[232:235], a[28:31], v[104:107]
    s_waitcnt vmcnt(19)
    v_permlane16_swap_b32 v28, v30
    v_mfma_f32_16x16x32_bf16 v[92:95], v[236:239], a[32:35], v[92:95]
    v_mfma_f32_16x16x32_bf16 v[96:99], v[236:239], a[36:39], v[96:99]
    buffer_load_dwordx4 v[200:203], v3, s[20:23], s32 offen offset:1024
    v_mfma_f32_16x16x32_bf16 v[100:103], v[236:239], a[40:43], v[100:103]
    v_permlane16_swap_b32 v29, v31
    v_mfma_f32_16x16x32_bf16 v[104:107], v[236:239], a[44:47], v[104:107]
    s_waitcnt vmcnt(19)
    v_permlane16_swap_b32 v32, v34
    v_mfma_f32_16x16x32_bf16 v[92:95], v[240:243], a[48:51], v[92:95]
    v_permlane16_swap_b32 v33, v35
    v_mfma_f32_16x16x32_bf16 v[96:99], v[240:243], a[52:55], v[96:99]
    buffer_load_dwordx4 v[204:207], v3, s[20:23], s32 offen offset:2048
    v_mfma_f32_16x16x32_bf16 v[100:103], v[240:243], a[56:59], v[100:103]
    s_add_u32 s36, s36, s45
    v_mfma_f32_16x16x32_bf16 v[104:107], v[240:243], a[60:63], v[104:107]
    s_waitcnt vmcnt(18)
    buffer_store_dwordx4 v[28:31], v6, s[20:23], s36 offen sc1
    v_mfma_f32_16x16x32_bf16 v[92:95], v[244:247], a[64:67], v[92:95]
    s_add_u32 s32, s32, 12288
    v_mfma_f32_16x16x32_bf16 v[96:99], v[244:247], a[68:71], v[96:99]
    buffer_load_dwordx4 v[208:211], v3, s[20:23], s32 offen offset:0
    v_mfma_f32_16x16x32_bf16 v[100:103], v[244:247], a[72:75], v[100:103]
    v_mfma_f32_16x16x32_bf16 v[104:107], v[244:247], a[76:79], v[104:107]
    s_waitcnt vmcnt(19)
    v_mfma_f32_16x16x32_bf16 v[92:95], v[248:251], a[80:83], v[92:95]
    v_mfma_f32_16x16x32_bf16 v[96:99], v[248:251], a[84:87], v[96:99]
    buffer_load_dwordx4 v[212:215], v3, s[20:23], s32 offen offset:1024
    v_mfma_f32_16x16x32_bf16 v[100:103], v[248:251], a[88:91], v[100:103]
    v_mfma_f32_16x16x32_bf16 v[104:107], v[248:251], a[92:95], v[104:107]
    s_waitcnt vmcnt(19)
    v_mfma_f32_16x16x32_bf16 v[92:95], v[252:255], a[96:99], v[92:95]
    v_mfma_f32_16x16x32_bf16 v[96:99], v[252:255], a[100:103], v[96:99]
    buffer_load_dwordx4 v[216:219], v3, s[20:23], s32 offen offset:2048
    v_mfma_f32_16x16x32_bf16 v[100:103], v[252:255], a[104:107], v[100:103]
    v_mfma_f32_16x16x32_bf16 v[104:107], v[252:255], a[108:111], v[104:107]
    s_waitcnt vmcnt(19)
    v_mfma_f32_16x16x32_bf16 v[92:95], v[148:151], a[112:115], v[92:95]
    s_add_u32 s32, s32, 12288
    v_mfma_f32_16x16x32_bf16 v[96:99], v[148:151], a[116:119], v[96:99]
    buffer_load_dwordx4 v[220:223], v3, s[20:23], s32 offen offset:0
    v_mfma_f32_16x16x32_bf16 v[100:103], v[148:151], a[120:123], v[100:103]
    v_mfma_f32_16x16x32_bf16 v[104:107], v[148:151], a[124:127], v[104:107]
    s_waitcnt vmcnt(19)
    v_mfma_f32_16x16x32_bf16 v[92:95], v[152:155], a[128:131], v[92:95]
    v_mfma_f32_16x16x32_bf16 v[96:99], v[152:155], a[132:135], v[96:99]
    buffer_load_dwordx4 v[224:227], v3, s[20:23], s32 offen offset:1024
    v_mfma_f32_16x16x32_bf16 v[100:103], v[152:155], a[136:139], v[100:103]
    v_mfma_f32_16x16x32_bf16 v[104:107], v[152:155], a[140:143], v[104:107]
    s_waitcnt vmcnt(19)
    v_mfma_f32_16x16x32_bf16 v[92:95], v[156:159], a[144:147], v[92:95]
    v_mfma_f32_16x16x32_bf16 v[96:99], v[156:159], a[148:151], v[96:99]
    buffer_load_dwordx4 v[228:231], v3, s[20:23], s32 offen offset:2048
    v_mfma_f32_16x16x32_bf16 v[100:103], v[156:159], a[152:155], v[100:103]
    v_mfma_f32_16x16x32_bf16 v[104:107], v[156:159], a[156:159], v[104:107]
    s_waitcnt vmcnt(19)
    v_mfma_f32_16x16x32_bf16 v[92:95], v[160:163], a[160:163], v[92:95]
    s_add_u32 s32, s32, 12288
    v_mfma_f32_16x16x32_bf16 v[96:99], v[160:163], a[164:167], v[96:99]
    buffer_load_dwordx4 v[232:235], v3, s[20:23], s32 offen offset:0
    v_mfma_f32_16x16x32_bf16 v[100:103], v[160:163], a[168:171], v[100:103]
    s_add_u32 s37, s37, s45
    v_mfma_f32_16x16x32_bf16 v[104:107], v[160:163], a[172:175], v[104:107]
    s_waitcnt vmcnt(18)
    buffer_store_dwordx4 v[32:35], v6, s[20:23], s37 offen sc1
    v_mfma_f32_16x16x32_bf16 v[92:95], v[164:167], a[176:179], v[92:95]
    v_mfma_f32_16x16x32_bf16 v[96:99], v[164:167], a[180:183], v[96:99]
    buffer_load_dwordx4 v[236:239], v3, s[20:23], s32 offen offset:1024
    v_mfma_f32_16x16x32_bf16 v[100:103], v[164:167], a[184:187], v[100:103]
    v_mfma_f32_16x16x32_bf16 v[104:107], v[164:167], a[188:191], v[104:107]
    s_waitcnt vmcnt(19)
    v_mfma_f32_16x16x32_bf16 v[92:95], v[168:171], a[192:195], v[92:95]
    v_mfma_f32_16x16x32_bf16 v[96:99], v[168:171], a[196:199], v[96:99]
    buffer_load_dwordx4 v[240:243], v3, s[20:23], s32 offen offset:2048
    v_mfma_f32_16x16x32_bf16 v[100:103], v[168:171], a[200:203], v[100:103]
    v_mfma_f32_16x16x32_bf16 v[104:107], v[168:171], a[204:207], v[104:107]
    s_waitcnt vmcnt(19)
    v_mfma_f32_16x16x32_bf16 v[92:95], v[172:175], a[208:211], v[92:95]
    s_add_u32 s32, s32, 12288
    v_mfma_f32_16x16x32_bf16 v[96:99], v[172:175], a[212:215], v[96:99]
    buffer_load_dwordx4 v[244:247], v3, s[20:23], s32 offen offset:0
    v_mfma_f32_16x16x32_bf16 v[100:103], v[172:175], a[216:219], v[100:103]
    v_mfma_f32_16x16x32_bf16 v[104:107], v[172:175], a[220:223], v[104:107]
    s_waitcnt vmcnt(19)
    v_mfma_f32_16x16x32_bf16 v[92:95], v[176:179], a[224:227], v[92:95]
    v_mfma_f32_16x16x32_bf16 v[96:99], v[176:179], a[228:231], v[96:99]
    buffer_load_dwordx4 v[248:251], v3, s[20:23], s32 offen offset:1024
    v_mfma_f32_16x16x32_bf16 v[100:103], v[176:179], a[232:235], v[100:103]
    v_mfma_f32_16x16x32_bf16 v[104:107], v[176:179], a[236:239], v[104:107]
    s_waitcnt vmcnt(19)
    v_mfma_f32_16x16x32_bf16 v[92:95], v[180:183], a[240:243], v[92:95]
    v_mfma_f32_16x16x32_bf16 v[96:99], v[180:183], a[244:247], v[96:99]
    buffer_load_dwordx4 v[252:255], v3, s[20:23], s32 offen offset:2048
    v_mfma_f32_16x16x32_bf16 v[100:103], v[180:183], a[248:251], v[100:103]
    v_mfma_f32_16x16x32_bf16 v[104:107], v[180:183], a[252:255], v[104:107]
    s_waitcnt vmcnt(19)
    v_mfma_f32_16x16x32_bf16 v[108:111], v[184:187], v[44:47], 0
    v_mfma_f32_16x16x32_bf16 v[112:115], v[184:187], v[48:51], 0
    v_mfma_f32_16x16x32_bf16 v[116:119], v[184:187], v[52:55], 0
    v_mfma_f32_16x16x32_bf16 v[120:123], v[184:187], v[56:59], 0
    s_waitcnt vmcnt(18)
    v_cvt_pk_bf16_f32 v36, v92, v93
    v_mfma_f32_16x16x32_bf16 v[108:111], v[188:191], v[60:63], v[108:111]
    v_mfma_f32_16x16x32_bf16 v[112:115], v[188:191], v[64:67], v[112:115]
    v_cvt_pk_bf16_f32 v37, v94, v95
    v_mfma_f32_16x16x32_bf16 v[116:119], v[188:191], v[68:71], v[116:119]
    v_cvt_pk_bf16_f32 v38, v96, v97
    v_mfma_f32_16x16x32_bf16 v[120:123], v[188:191], v[72:75], v[120:123]
    s_waitcnt vmcnt(17)
    v_mfma_f32_16x16x32_bf16 v[108:111], v[192:195], a[0:3], v[108:111]
    v_cvt_pk_bf16_f32 v39, v98, v99
    v_mfma_f32_16x16x32_bf16 v[112:115], v[192:195], a[4:7], v[112:115]
    v_cvt_pk_bf16_f32 v40, v100, v101
    v_mfma_f32_16x16x32_bf16 v[116:119], v[192:195], a[8:11], v[116:119]
    v_mfma_f32_16x16x32_bf16 v[120:123], v[192:195], a[12:15], v[120:123]
    s_waitcnt vmcnt(16)
    v_cvt_pk_bf16_f32 v41, v102, v103
    v_mfma_f32_16x16x32_bf16 v[108:111], v[196:199], a[16:19], v[108:111]
    v_cvt_pk_bf16_f32 v42, v104, v105
    v_mfma_f32_16x16x32_bf16 v[112:115], v[196:199], a[20:23], v[112:115]
    v_mfma_f32_16x16x32_bf16 v[116:119], v[196:199], a[24:27], v[116:119]
    v_cvt_pk_bf16_f32 v43, v106, v107
    v_mfma_f32_16x16x32_bf16 v[120:123], v[196:199], a[28:31], v[120:123]
    s_waitcnt vmcnt(15)
    v_permlane16_swap_b32 v36, v38
    v_mfma_f32_16x16x32_bf16 v[108:111], v[200:203], a[32:35], v[108:111]
    v_mfma_f32_16x16x32_bf16 v[112:115], v[200:203], a[36:39], v[112:115]
    v_permlane16_swap_b32 v37, v39
    v_mfma_f32_16x16x32_bf16 v[116:119], v[200:203], a[40:43], v[116:119]
    v_permlane16_swap_b32 v40, v42
    v_mfma_f32_16x16x32_bf16 v[120:123], v[200:203], a[44:47], v[120:123]
    s_waitcnt vmcnt(14)
    v_mfma_f32_16x16x32_bf16 v[108:111], v[204:207], a[48:51], v[108:111]
    v_permlane16_swap_b32 v41, v43
    v_mfma_f32_16x16x32_bf16 v[112:115], v[204:207], a[52:55], v[112:115]
    v_mfma_f32_16x16x32_bf16 v[116:119], v[204:207], a[56:59], v[116:119]
    s_add_u32 s36, s36, s46
    v_mfma_f32_16x16x32_bf16 v[120:123], v[204:207], a[60:63], v[120:123]
    s_waitcnt vmcnt(12)
    buffer_store_dwordx4 v[36:39], v6, s[20:23], s36 offen sc1
    v_mfma_f32_16x16x32_bf16 v[108:111], v[208:211], a[64:67], v[108:111]
    v_mfma_f32_16x16x32_bf16 v[112:115], v[208:211], a[68:71], v[112:115]
    v_mfma_f32_16x16x32_bf16 v[116:119], v[208:211], a[72:75], v[116:119]
    v_mfma_f32_16x16x32_bf16 v[120:123], v[208:211], a[76:79], v[120:123]
    s_waitcnt vmcnt(12)
    v_mfma_f32_16x16x32_bf16 v[108:111], v[212:215], a[80:83], v[108:111]
    v_mfma_f32_16x16x32_bf16 v[112:115], v[212:215], a[84:87], v[112:115]
    v_mfma_f32_16x16x32_bf16 v[116:119], v[212:215], a[88:91], v[116:119]
    v_mfma_f32_16x16x32_bf16 v[120:123], v[212:215], a[92:95], v[120:123]
    s_waitcnt vmcnt(11)
    v_mfma_f32_16x16x32_bf16 v[108:111], v[216:219], a[96:99], v[108:111]
    v_mfma_f32_16x16x32_bf16 v[112:115], v[216:219], a[100:103], v[112:115]
    v_mfma_f32_16x16x32_bf16 v[116:119], v[216:219], a[104:107], v[116:119]
    v_mfma_f32_16x16x32_bf16 v[120:123], v[216:219], a[108:111], v[120:123]
    s_waitcnt vmcnt(10)
    v_mfma_f32_16x16x32_bf16 v[108:111], v[220:223], a[112:115], v[108:111]
    v_mfma_f32_16x16x32_bf16 v[112:115], v[220:223], a[116:119], v[112:115]
    v_mfma_f32_16x16x32_bf16 v[116:119], v[220:223], a[120:123], v[116:119]
    v_mfma_f32_16x16x32_bf16 v[120:123], v[220:223], a[124:127], v[120:123]
    s_waitcnt vmcnt(9)
    v_mfma_f32_16x16x32_bf16 v[108:111], v[224:227], a[128:131], v[108:111]
    v_mfma_f32_16x16x32_bf16 v[112:115], v[224:227], a[132:135], v[112:115]
    v_mfma_f32_16x16x32_bf16 v[116:119], v[224:227], a[136:139], v[116:119]
    v_mfma_f32_16x16x32_bf16 v[120:123], v[224:227], a[140:143], v[120:123]
    s_waitcnt vmcnt(8)
    v_mfma_f32_16x16x32_bf16 v[108:111], v[228:231], a[144:147], v[108:111]
    v_mfma_f32_16x16x32_bf16 v[112:115], v[228:231], a[148:151], v[112:115]
    v_mfma_f32_16x16x32_bf16 v[116:119], v[228:231], a[152:155], v[116:119]
    v_mfma_f32_16x16x32_bf16 v[120:123], v[228:231], a[156:159], v[120:123]
    s_waitcnt vmcnt(7)
    v_mfma_f32_16x16x32_bf16 v[108:111], v[232:235], a[160:163], v[108:111]
    v_mfma_f32_16x16x32_bf16 v[112:115], v[232:235], a[164:167], v[112:115]
    v_mfma_f32_16x16x32_bf16 v[116:119], v[232:235], a[168:171], v[116:119]
    s_add_u32 s37, s37, s46
    v_mfma_f32_16x16x32_bf16 v[120:123], v[232:235], a[172:175], v[120:123]
    s_waitcnt vmcnt(5)
    buffer_store_dwordx4 v[40:43], v6, s[20:23], s37 offen sc1
    v_mfma_f32_16x16x32_bf16 v[108:111], v[236:239], a[176:179], v[108:111]
    v_mfma_f32_16x16x32_bf16 v[112:115], v[236:239], a[180:183], v[112:115]
    v_mfma_f32_16x16x32_bf16 v[116:119], v[236:239], a[184:187], v[116:119]
    v_mfma_f32_16x16x32_bf16 v[120:123], v[236:239], a[188:191], v[120:123]
    s_waitcnt vmcnt(5)
    v_mfma_f32_16x16x32_bf16 v[108:111], v[240:243], a[192:195], v[108:111]
    v_mfma_f32_16x16x32_bf16 v[112:115], v[240:243], a[196:199], v[112:115]
    v_mfma_f32_16x16x32_bf16 v[116:119], v[240:243], a[200:203], v[116:119]
    v_mfma_f32_16x16x32_bf16 v[120:123], v[240:243], a[204:207], v[120:123]
    s_waitcnt vmcnt(4)
    v_mfma_f32_16x16x32_bf16 v[108:111], v[244:247], a[208:211], v[108:111]
    v_mfma_f32_16x16x32_bf16 v[112:115], v[244:247], a[212:215], v[112:115]
    v_mfma_f32_16x16x32_bf16 v[116:119], v[244:247], a[216:219], v[116:119]
    v_mfma_f32_16x16x32_bf16 v[120:123], v[244:247], a[220:223], v[120:123]
    s_waitcnt vmcnt(3)
    v_mfma_f32_16x16x32_bf16 v[108:111], v[248:251], a[224:227], v[108:111]
    v_mfma_f32_16x16x32_bf16 v[112:115], v[248:251], a[228:231], v[112:115]
    v_mfma_f32_16x16x32_bf16 v[116:119], v[248:251], a[232:235], v[116:119]
    v_mfma_f32_16x16x32_bf16 v[120:123], v[248:251], a[236:239], v[120:123]
    s_waitcnt vmcnt(2)
    v_mfma_f32_16x16x32_bf16 v[108:111], v[252:255], a[240:243], v[108:111]
    v_mfma_f32_16x16x32_bf16 v[112:115], v[252:255], a[244:247], v[112:115]
    v_mfma_f32_16x16x32_bf16 v[116:119], v[252:255], a[248:251], v[116:119]
    v_mfma_f32_16x16x32_bf16 v[120:123], v[252:255], a[252:255], v[120:123]
    s_nop 4
    s_load_dwordx2 s[96:97], s[0:1], 88
    s_lshl_b32 s12, s30, 8
    s_add_u32 s12, s12, 3145728
    buffer_load_dword v146, off, s[20:23], s12 sc1
    v_cvt_pk_bf16_f32 v12, v108, v109
    v_cvt_pk_bf16_f32 v13, v110, v111
    v_cvt_pk_bf16_f32 v14, v112, v113
    v_cvt_pk_bf16_f32 v15, v114, v115
    v_cvt_pk_bf16_f32 v16, v116, v117
    v_cvt_pk_bf16_f32 v17, v118, v119
    v_cvt_pk_bf16_f32 v18, v120, v121
    v_cvt_pk_bf16_f32 v19, v122, v123
    s_nop 0
    v_permlane16_swap_b32 v12, v14
    v_permlane16_swap_b32 v13, v15
    v_permlane16_swap_b32 v16, v18
    v_permlane16_swap_b32 v17, v19
    s_add_u32 s36, s36, s47
    buffer_store_dwordx4 v[12:15], v6, s[20:23], s36 offen sc1
    s_add_u32 s37, s37, s47
    buffer_store_dwordx4 v[16:19], v6, s[20:23], s37 offen sc1
    s_mov_b32 s13, s29
    s_mov_b32 s84, 0
    v_mov_b32 v1, 0
    v_mov_b32 v144, 0
    v_mov_b32 v145, 0
    ds_write_b64 v1, v[144:145]
    s_waitcnt vmcnt(0) lgkmcnt(0)
    s_barrier
    v_readfirstlane_b32 s16, v146
    v_mov_b32 v10, 0
    s_lshl_b32 s87, 1, s29
    s_cmp_lg_u32 s28, 3
    s_cbranch_scc1 WORK_k45_kernel
    s_mov_b64 exec, 1
    v_mov_b32 v12, s87
    v_mov_b32 v13, 0
    buffer_atomic_add v12, off, s[20:23], s12 sc0 sc1
    s_waitcnt vmcnt(0)
    v_readfirstlane_b32 s16, v12
    s_or_b32 s16, s16, s87
    s_and_b32 s88, s16, 255
    s_cmp_eq_u32 s88, 255
    s_cbranch_scc1 TELL_k45_kernel
POLL_k45_kernel:
    buffer_load_dword v14, off, s[20:23], s12 sc1
    v_mov_b32 v12, s88
    s_add_u32 s84, s84, 1
    ds_write_b32 v10, v12
    s_waitcnt vmcnt(0) lgkmcnt(0)
    v_readfirstlane_b32 s88, v14
    s_and_b32 s88, s88, 255
    s_mov_b32 s16, s88
    s_cmp_eq_u32 s88, 255
    s_cbranch_scc1 TELL_k45_kernel
    s_cmp_lt_u32 s84, 16384
    s_cbranch_scc1 POLL_k45_kernel
    s_lshl_b32 s87, s87, 16
    v_mov_b32 v12, s87
    buffer_atomic_add v12, off, s[20:23], s12 sc0 sc1
    s_waitcnt vmcnt(0)
    v_readfirstlane_b32 s16, v12
    s_and_b32 s16, s16, 255
    s_cmp_lg_u32 s16, 255
    s_cselect_b32 s87, 1, 0
    v_mov_b32 v13, s87
TELL_k45_kernel:
    v_mov_b32 v12, s16
    ds_write_b64 v10, v[12:13]
    s_mov_b64 exec, -1
    s_waitcnt lgkmcnt(0)
    s_branch FIN_k45_kernel
WORK_k45_kernel:
    s_or_b32 s16, s16, s87
    s_mul_i32 s87, s28, 3072
    v_and_b32 v1, 7, v0
    v_lshlrev_b32 v6, 4, v0
    v_add_u32 v5, s87, v6
    v_lshrrev_b32 v2, 3, v0
    v_and_b32 v6, 0xffffff80, v5
    s_mul_i32 s87, s28, 384
    v_mul_u32_u24 v4, 1152, v1
    v_lshl_add_u32 v4, v2, 4, v4
    v_add_u32 v4, s87, v4
    s_mov_b32 s8, s96
    s_and_b32 s9, s97, 0xffff
    s_mov_b32 s10, 2359296
    s_mov_b32 s11, 0x00020000
PIECE_k45_kernel:
    s_mul_i32 s95, s30, 8
    s_add_u32 s95, s95, s13
    s_mul_i32 s19, s95, 9216
    s_mul_i32 s17, s19, 8
    s_add_u32 s17, s17, 109051904
    s_add_u32 s18, s19, 20971520
    s_or_b32 s89, s13, 1
    s_add_u32 s89, s89, 1
    s_mov_b32 s15, 0
    s_mov_b32 s94, 16
    s_mov_b32 s85, 0x3f80
    s_mov_b32 s86, 0x3f800000
    s_mov_b32 s88, 2424928
    buffer_load_dwordx4 v[160:163], v6, s[20:23], s88 offen offset:0
    buffer_load_dwordx4 v[164:167], v6, s[20:23], s88 offen offset:16
    buffer_load_dwordx4 v[168:171], v6, s[20:23], s88 offen offset:1024
    buffer_load_dwordx4 v[172:175], v6, s[20:23], s88 offen offset:1040
    buffer_load_dwordx4 v[176:179], v6, s[20:23], s88 offen offset:2048
    buffer_load_dwordx4 v[180:183], v6, s[20:23], s88 offen offset:2064
    buffer_load_dwordx4 v[40:43], v5, s[20:23], s18 offen offset:0
    buffer_load_dwordx4 v[44:47], v5, s[20:23], s18 offen offset:1024
    buffer_load_dwordx4 v[48:51], v5, s[20:23], s18 offen offset:2048
    s_branch LOOK_k45_kernel
SPIN_k45_kernel:
    ds_read_b64 v[12:13], v10
    s_waitcnt lgkmcnt(0)
    v_readfirstlane_b32 s87, v13
    v_readfirstlane_b32 s16, v12
    s_cmp_lg_u32 s87, 0
    s_cbranch_scc1 QUIT_k45_kernel
LOOK_k45_kernel:
    s_and_b32 s16, s16, 255
    s_bcnt1_i32_b32 s87, s16
    s_cmp_lt_u32 s87, 8
    s_cbranch_scc1 SPIN_k45_kernel
    s_mul_i32 s16, s16, 257
    s_lshr_b32 s16, s16, s89
    s_and_b32 s16, s16, 255
    s_cmp_eq_u32 s16, 255
    s_cselect_b32 s88, 0, -1
    s_andn2_b32 s16, s16, s15
    s_cbranch_scc0 SPIN_k45_kernel
    s_or_b32 s88, s15, s16
    s_ff0_i32_b32 s87, s88
    s_lshr_b32 s88, s88, s87
    s_cselect_b32 s87, s87, 16
    s_min_u32 s94, s94, s87
    s_bitcmp1_b32 s16, 0
    s_cbranch_scc0 SK0_k45_kernel
    s_add_u32 s87, s89, 0
    s_and_b32 s87, s87, 7
    s_mul_i32 s87, s87, 9216
    s_add_u32 s87, s87, s17
    buffer_load_dwordx4 v[64:67], v5, s[20:23], s87 offen offset:0 sc1
    buffer_load_dwordx4 v[68:71], v5, s[20:23], s87 offen offset:1024 sc1
    buffer_load_dwordx4 v[72:75], v5, s[20:23], s87 offen offset:2048 sc1
SK0_k45_kernel:
    s_bitcmp1_b32 s16, 1
    s_cbranch_scc0 SK1_k45_kernel
    s_add_u32 s87, s89, 1
    s_and_b32 s87, s87, 7
    s_mul_i32 s87, s87, 9216
    s_add_u32 s87, s87, s17
    buffer_load_dwordx4 v[76:79], v5, s[20:23], s87 offen offset:0 sc1
    buffer_load_dwordx4 v[80:83], v5, s[20:23], s87 offen offset:1024 sc1
    buffer_load_dwordx4 v[84:87], v5, s[20:23], s87 offen offset:2048 sc1
SK1_k45_kernel:
    s_bitcmp1_b32 s16, 2
    s_cbranch_scc0 SK2_k45_kernel
    s_add_u32 s87, s89, 2
    s_and_b32 s87, s87, 7
    s_mul_i32 s87, s87, 9216
    s_add_u32 s87, s87, s17
    buffer_load_dwordx4 v[88:91], v5, s[20:23], s87 offen offset:0 sc1
    buffer_load_dwordx4 v[92:95], v5, s[20:23], s87 offen offset:1024 sc1
    buffer_load_dwordx4 v[96:99], v5, s[20:23], s87 offen offset:2048 sc1
SK2_k45_kernel:
    s_bitcmp1_b32 s16, 3
    s_cbranch_scc0 SK3_k45_kernel
    s_add_u32 s87, s89, 3
    s_and_b32 s87, s87, 7
    s_mul_i32 s87, s87, 9216
    s_add_u32 s87, s87, s17
    buffer_load_dwordx4 v[100:103], v5, s[20:23], s87 offen offset:0 sc1
    buffer_load_dwordx4 v[104:107], v5, s[20:23], s87 offen offset:1024 sc1
    buffer_load_dwordx4 v[108:111], v5, s[20:23], s87 offen offset:2048 sc1
SK3_k45_kernel:
    s_bitcmp1_b32 s16, 4
    s_cbranch_scc0 SK4_k45_kernel
    s_add_u32 s87, s89, 4
    s_and_b32 s87, s87, 7
    s_mul_i32 s87, s87, 9216
    s_add_u32 s87, s87, s17
    buffer_load_dwordx4 v[112:115], v5, s[20:23], s87 offen offset:0 sc1
    buffer_load_dwordx4 v[116:119], v5, s[20:23], s87 offen offset:1024 sc1
    buffer_load_dwordx4 v[120:123], v5, s[20:23], s87 offen offset:2048 sc1
SK4_k45_kernel:
    s_bitcmp1_b32 s16, 5
    s_cbranch_scc0 SK5_k45_kernel
    s_add_u32 s87, s89, 5
    s_and_b32 s87, s87, 7
    s_mul_i32 s87, s87, 9216
    s_add_u32 s87, s87, s17
    buffer_load_dwordx4 v[124:127], v5, s[20:23], s87 offen offset:0 sc1
    buffer_load_dwordx4 v[128:131], v5, s[20:23], s87 offen offset:1024 sc1
    buffer_load_dwordx4 v[132:135], v5, s[20:23], s87 offen offset:2048 sc1
SK5_k45_kernel:
    s_bitcmp1_b32 s16, 6
    s_cbranch_scc0 SK6_k45_kernel
    s_add_u32 s87, s89, 6
    s_and_b32 s87, s87, 7
    s_mul_i32 s87, s87, 9216
    s_add_u32 s87, s87, s17
    buffer_load_dwordx4 v[136:139], v5, s[20:23], s87 offen offset:0 sc1
    buffer_load_dwordx4 v[140:143], v5, s[20:23], s87 offen offset:1024 sc1
    buffer_load_dwordx4 v[144:147], v5, s[20:23], s87 offen offset:2048 sc1
SK6_k45_kernel:
    s_bitcmp1_b32 s16, 7
    s_cbranch_scc0 SK7_k45_kernel
    s_add_u32 s87, s89, 7
    s_and_b32 s87, s87, 7
    s_mul_i32 s87, s87, 9216
    s_add_u32 s87, s87, s17
    buffer_load_dwordx4 v[148:151], v5, s[20:23], s87 offen offset:0 sc1
    buffer_load_dwordx4 v[152:155], v5, s[20:23], s87 offen offset:1024 sc1
    buffer_load_dwordx4 v[156:159], v5, s[20:23], s87 offen offset:2048 sc1
SK7_k45_kernel:
    s_or_b32 s15, s15, s16
    s_cmp_lg_u32 s15, 255
    s_cbranch_scc1 SPIN_k45_kernel
    s_waitcnt vmcnt(21)
    s_cmp_lg_u32 s94, 0
    s_cbranch_scc1 NW0_k45_kernel
    s_waitcnt vmcnt(0)
NW0_k45_kernel:
    v_lshlrev_b32 v16, 16, v64
    v_and_b32 v17, 0xffff0000, v64
    v_lshlrev_b32 v18, 16, v65
    v_and_b32 v19, 0xffff0000, v65
    v_lshlrev_b32 v20, 16, v66
    v_and_b32 v21, 0xffff0000, v66
    v_lshlrev_b32 v22, 16, v67
    v_and_b32 v23, 0xffff0000, v67
    v_lshlrev_b32 v24, 16, v68
    v_and_b32 v25, 0xffff0000, v68
    v_lshlrev_b32 v26, 16, v69
    v_and_b32 v27, 0xffff0000, v69
    v_lshlrev_b32 v28, 16, v70
    v_and_b32 v29, 0xffff0000, v70
    v_lshlrev_b32 v30, 16, v71
    v_and_b32 v31, 0xffff0000, v71
    v_lshlrev_b32 v32, 16, v72
    v_and_b32 v33, 0xffff0000, v72
    v_lshlrev_b32 v34, 16, v73
    v_and_b32 v35, 0xffff0000, v73
    v_lshlrev_b32 v36, 16, v74
    v_and_b32 v37, 0xffff0000, v74
    v_lshlrev_b32 v38, 16, v75
    v_and_b32 v39, 0xffff0000, v75
    v_lshlrev_b32 v184, 16, v40
    v_and_b32 v185, 0xffff0000, v40
    v_lshlrev_b32 v186, 16, v41
    v_and_b32 v187, 0xffff0000, v41
    v_lshlrev_b32 v188, 16, v42
    v_and_b32 v189, 0xffff0000, v42
    v_lshlrev_b32 v190, 16, v43
    v_and_b32 v191, 0xffff0000, v43
    v_lshlrev_b32 v192, 16, v44
    v_and_b32 v193, 0xffff0000, v44
    v_lshlrev_b32 v194, 16, v45
    v_and_b32 v195, 0xffff0000, v45
    v_lshlrev_b32 v196, 16, v46
    v_and_b32 v197, 0xffff0000, v46
    v_lshlrev_b32 v198, 16, v47
    v_and_b32 v199, 0xffff0000, v47
    v_lshlrev_b32 v200, 16, v48
    v_and_b32 v201, 0xffff0000, v48
    v_lshlrev_b32 v202, 16, v49
    v_and_b32 v203, 0xffff0000, v49
    v_lshlrev_b32 v204, 16, v50
    v_and_b32 v205, 0xffff0000, v50
    v_lshlrev_b32 v206, 16, v51
    v_and_b32 v207, 0xffff0000, v51
    s_waitcnt vmcnt(18)
    s_cmp_lg_u32 s94, 1
    s_cbranch_scc1 NW1_k45_kernel
    s_waitcnt vmcnt(0)
NW1_k45_kernel:
    v_dot2c_f32_bf16 v16, s85, v76
    v_dot2c_f32_bf16 v17, s86, v76
    v_dot2c_f32_bf16 v18, s85, v77
    v_dot2c_f32_bf16 v19, s86, v77
    v_dot2c_f32_bf16 v20, s85, v78
    v_dot2c_f32_bf16 v21, s86, v78
    v_dot2c_f32_bf16 v22, s85, v79
    v_dot2c_f32_bf16 v23, s86, v79
    v_dot2c_f32_bf16 v24, s85, v80
    v_dot2c_f32_bf16 v25, s86, v80
    v_dot2c_f32_bf16 v26, s85, v81
    v_dot2c_f32_bf16 v27, s86, v81
    v_dot2c_f32_bf16 v28, s85, v82
    v_dot2c_f32_bf16 v29, s86, v82
    v_dot2c_f32_bf16 v30, s85, v83
    v_dot2c_f32_bf16 v31, s86, v83
    v_dot2c_f32_bf16 v32, s85, v84
    v_dot2c_f32_bf16 v33, s86, v84
    v_dot2c_f32_bf16 v34, s85, v85
    v_dot2c_f32_bf16 v35, s86, v85
    v_dot2c_f32_bf16 v36, s85, v86
    v_dot2c_f32_bf16 v37, s86, v86
    v_dot2c_f32_bf16 v38, s85, v87
    v_dot2c_f32_bf16 v39, s86, v87
    s_waitcnt vmcnt(15)
    s_cmp_lg_u32 s94, 2
    s_cbranch_scc1 NW2_k45_kernel
    s_waitcnt vmcnt(0)
NW2_k45_kernel:
    v_dot2c_f32_bf16 v16, s85, v88
    v_dot2c_f32_bf16 v17, s86, v88
    v_dot2c_f32_bf16 v18, s85, v89
    v_dot2c_f32_bf16 v19, s86, v89
    v_dot2c_f32_bf16 v20, s85, v90
    v_dot2c_f32_bf16 v21, s86, v90
    v_dot2c_f32_bf16 v22, s85, v91
    v_dot2c_f32_bf16 v23, s86, v91
    v_dot2c_f32_bf16 v24, s85, v92
    v_dot2c_f32_bf16 v25, s86, v92
    v_dot2c_f32_bf16 v26, s85, v93
    v_dot2c_f32_bf16 v27, s86, v93
    v_dot2c_f32_bf16 v28, s85, v94
    v_dot2c_f32_bf16 v29, s86, v94
    v_dot2c_f32_bf16 v30, s85, v95
    v_dot2c_f32_bf16 v31, s86, v95
    v_dot2c_f32_bf16 v32, s85, v96
    v_dot2c_f32_bf16 v33, s86, v96
    v_dot2c_f32_bf16 v34, s85, v97
    v_dot2c_f32_bf16 v35, s86, v97
    v_dot2c_f32_bf16 v36, s85, v98
    v_dot2c_f32_bf16 v37, s86, v98
    v_dot2c_f32_bf16 v38, s85, v99
    v_dot2c_f32_bf16 v39, s86, v99
    s_waitcnt vmcnt(12)
    s_cmp_lg_u32 s94, 3
    s_cbranch_scc1 NW3_k45_kernel
    s_waitcnt vmcnt(0)
NW3_k45_kernel:
    v_dot2c_f32_bf16 v16, s85, v100
    v_dot2c_f32_bf16 v17, s86, v100
    v_dot2c_f32_bf16 v18, s85, v101
    v_dot2c_f32_bf16 v19, s86, v101
    v_dot2c_f32_bf16 v20, s85, v102
    v_dot2c_f32_bf16 v21, s86, v102
    v_dot2c_f32_bf16 v22, s85, v103
    v_dot2c_f32_bf16 v23, s86, v103
    v_dot2c_f32_bf16 v24, s85, v104
    v_dot2c_f32_bf16 v25, s86, v104
    v_dot2c_f32_bf16 v26, s85, v105
    v_dot2c_f32_bf16 v27, s86, v105
    v_dot2c_f32_bf16 v28, s85, v106
    v_dot2c_f32_bf16 v29, s86, v106
    v_dot2c_f32_bf16 v30, s85, v107
    v_dot2c_f32_bf16 v31, s86, v107
    v_dot2c_f32_bf16 v32, s85, v108
    v_dot2c_f32_bf16 v33, s86, v108
    v_dot2c_f32_bf16 v34, s85, v109
    v_dot2c_f32_bf16 v35, s86, v109
    v_dot2c_f32_bf16 v36, s85, v110
    v_dot2c_f32_bf16 v37, s86, v110
    v_dot2c_f32_bf16 v38, s85, v111
    v_dot2c_f32_bf16 v39, s86, v111
    s_waitcnt vmcnt(9)
    s_cmp_lg_u32 s94, 4
    s_cbranch_scc1 NW4_k45_kernel
    s_waitcnt vmcnt(0)
NW4_k45_kernel:
    v_dot2c_f32_bf16 v16, s85, v112
    v_dot2c_f32_bf16 v17, s86, v112
    v_dot2c_f32_bf16 v18, s85, v113
    v_dot2c_f32_bf16 v19, s86, v113
    v_dot2c_f32_bf16 v20, s85, v114
    v_dot2c_f32_bf16 v21, s86, v114
    v_dot2c_f32_bf16 v22, s85, v115
    v_dot2c_f32_bf16 v23, s86, v115
    v_dot2c_f32_bf16 v24, s85, v116
    v_dot2c_f32_bf16 v25, s86, v116
    v_dot2c_f32_bf16 v26, s85, v117
    v_dot2c_f32_bf16 v27, s86, v117
    v_dot2c_f32_bf16 v28, s85, v118
    v_dot2c_f32_bf16 v29, s86, v118
    v_dot2c_f32_bf16 v30, s85, v119
    v_dot2c_f32_bf16 v31, s86, v119
    v_dot2c_f32_bf16 v32, s85, v120
    v_dot2c_f32_bf16 v33, s86, v120
    v_dot2c_f32_bf16 v34, s85, v121
    v_dot2c_f32_bf16 v35, s86, v121
    v_dot2c_f32_bf16 v36, s85, v122
    v_dot2c_f32_bf16 v37, s86, v122
    v_dot2c_f32_bf16 v38, s85, v123
    v_dot2c_f32_bf16 v39, s86, v123
    s_waitcnt vmcnt(6)
    s_cmp_lg_u32 s94, 5
    s_cbranch_scc1 NW5_k45_kernel
    s_waitcnt vmcnt(0)
NW5_k45_kernel:
    v_dot2c_f32_bf16 v16, s85, v124
    v_dot2c_f32_bf16 v17, s86, v124
    v_dot2c_f32_bf16 v18, s85, v125
    v_dot2c_f32_bf16 v19, s86, v125
    v_dot2c_f32_bf16 v20, s85, v126
    v_dot2c_f32_bf16 v21, s86, v126
    v_dot2c_f32_bf16 v22, s85, v127
    v_dot2c_f32_bf16 v23, s86, v127
    v_dot2c_f32_bf16 v24, s85, v128
    v_dot2c_f32_bf16 v25, s86, v128
    v_dot2c_f32_bf16 v26, s85, v129
    v_dot2c_f32_bf16 v27, s86, v129
    v_dot2c_f32_bf16 v28, s85, v130
    v_dot2c_f32_bf16 v29, s86, v130
    v_dot2c_f32_bf16 v30, s85, v131
    v_dot2c_f32_bf16 v31, s86, v131
    v_dot2c_f32_bf16 v32, s85, v132
    v_dot2c_f32_bf16 v33, s86, v132
    v_dot2c_f32_bf16 v34, s85, v133
    v_dot2c_f32_bf16 v35, s86, v133
    v_dot2c_f32_bf16 v36, s85, v134
    v_dot2c_f32_bf16 v37, s86, v134
    v_dot2c_f32_bf16 v38, s85, v135
    v_dot2c_f32_bf16 v39, s86, v135
    s_waitcnt vmcnt(3)
    s_cmp_lg_u32 s94, 6
    s_cbranch_scc1 NW6_k45_kernel
    s_waitcnt vmcnt(0)
NW6_k45_kernel:
    v_dot2c_f32_bf16 v16, s85, v136
    v_dot2c_f32_bf16 v17, s86, v136
    v_dot2c_f32_bf16 v18, s85, v137
    v_dot2c_f32_bf16 v19, s86, v137
    v_dot2c_f32_bf16 v20, s85, v138
    v_dot2c_f32_bf16 v21, s86, v138
    v_dot2c_f32_bf16 v22, s85, v139
    v_dot2c_f32_bf16 v23, s86, v139
    v_dot2c_f32_bf16 v24, s85, v140
    v_dot2c_f32_bf16 v25, s86, v140
    v_dot2c_f32_bf16 v26, s85, v141
    v_dot2c_f32_bf16 v27, s86, v141
    v_dot2c_f32_bf16 v28, s85, v142
    v_dot2c_f32_bf16 v29, s86, v142
    v_dot2c_f32_bf16 v30, s85, v143
    v_dot2c_f32_bf16 v31, s86, v143
    v_dot2c_f32_bf16 v32, s85, v144
    v_dot2c_f32_bf16 v33, s86, v144
    v_dot2c_f32_bf16 v34, s85, v145
    v_dot2c_f32_bf16 v35, s86, v145
    v_dot2c_f32_bf16 v36, s85, v146
    v_dot2c_f32_bf16 v37, s86, v146
    v_dot2c_f32_bf16 v38, s85, v147
    v_dot2c_f32_bf16 v39, s86, v147
    s_waitcnt vmcnt(0)
    s_cmp_lg_u32 s94, 7
    s_cbranch_scc1 NW7_k45_kernel
    s_waitcnt vmcnt(0)
NW7_k45_kernel:
    v_dot2c_f32_bf16 v16, s85, v148
    v_dot2c_f32_bf16 v17, s86, v148
    v_dot2c_f32_bf16 v18, s85, v149
    v_dot2c_f32_bf16 v19, s86, v149
    v_dot2c_f32_bf16 v20, s85, v150
    v_dot2c_f32_bf16 v21, s86, v150
    v_dot2c_f32_bf16 v22, s85, v151
    v_dot2c_f32_bf16 v23, s86, v151
    v_dot2c_f32_bf16 v24, s85, v152
    v_dot2c_f32_bf16 v25, s86, v152
    v_dot2c_f32_bf16 v26, s85, v153
    v_dot2c_f32_bf16 v27, s86, v153
    v_dot2c_f32_bf16 v28, s85, v154
    v_dot2c_f32_bf16 v29, s86, v154
    v_dot2c_f32_bf16 v30, s85, v155
    v_dot2c_f32_bf16 v31, s86, v155
    v_dot2c_f32_bf16 v32, s85, v156
    v_dot2c_f32_bf16 v33, s86, v156
    v_dot2c_f32_bf16 v34, s85, v157
    v_dot2c_f32_bf16 v35, s86, v157
    v_dot2c_f32_bf16 v36, s85, v158
    v_dot2c_f32_bf16 v37, s86, v158
    v_dot2c_f32_bf16 v38, s85, v159
    v_dot2c_f32_bf16 v39, s86, v159
    s_nop 1
    v_fma_f32 v184, v160, v16, v184
    v_fma_f32 v185, v161, v17, v185
    v_fma_f32 v186, v162, v18, v186
    v_fma_f32 v187, v163, v19, v187
    v_fma_f32 v188, v164, v20, v188
    v_fma_f32 v189, v165, v21, v189
    v_fma_f32 v190, v166, v22, v190
    v_fma_f32 v191, v167, v23, v191
    v_cvt_pk_bf16_f32 v40, v184, v185
    v_cvt_pk_bf16_f32 v41, v186, v187
    v_cvt_pk_bf16_f32 v42, v188, v189
    v_cvt_pk_bf16_f32 v43, v190, v191
    buffer_store_dwordx4 v[40:43], v4, s[8:11], s19 offen offset:0
    v_fma_f32 v192, v168, v24, v192
    v_fma_f32 v193, v169, v25, v193
    v_fma_f32 v194, v170, v26, v194
    v_fma_f32 v195, v171, v27, v195
    v_fma_f32 v196, v172, v28, v196
    v_fma_f32 v197, v173, v29, v197
    v_fma_f32 v198, v174, v30, v198
    v_fma_f32 v199, v175, v31, v199
    v_cvt_pk_bf16_f32 v44, v192, v193
    v_cvt_pk_bf16_f32 v45, v194, v195
    v_cvt_pk_bf16_f32 v46, v196, v197
    v_cvt_pk_bf16_f32 v47, v198, v199
    buffer_store_dwordx4 v[44:47], v4, s[8:11], s19 offen offset:128
    v_fma_f32 v200, v176, v32, v200
    v_fma_f32 v201, v177, v33, v201
    v_fma_f32 v202, v178, v34, v202
    v_fma_f32 v203, v179, v35, v203
    v_fma_f32 v204, v180, v36, v204
    v_fma_f32 v205, v181, v37, v205
    v_fma_f32 v206, v182, v38, v206
    v_fma_f32 v207, v183, v39, v207
    v_cvt_pk_bf16_f32 v48, v200, v201
    v_cvt_pk_bf16_f32 v49, v202, v203
    v_cvt_pk_bf16_f32 v50, v204, v205
    v_cvt_pk_bf16_f32 v51, v206, v207
    buffer_store_dwordx4 v[48:51], v4, s[8:11], s19 offen offset:256
    s_cmp_lg_u32 s84, 0
    s_cbranch_scc1 TODO_k45_kernel
LAST_k45_kernel:
    ds_read_b32 v12, v10
    s_waitcnt lgkmcnt(0)
    v_readfirstlane_b32 s14, v12
    s_and_b32 s87, s14, 255
    s_cmp_lg_u32 s87, 255
    s_cbranch_scc1 LAST_k45_kernel
    s_lshr_b32 s14, s14, 16
TODO_k45_kernel:
    s_cmp_eq_u32 s14, 0
    s_cbranch_scc1 FIN_k45_kernel
    s_ff1_i32_b32 s13, s14
    s_bitset0_b32 s14, s13
    s_mov_b32 s16, 255
    s_mov_b32 s84, 1
    s_waitcnt vmcnt(0)
    s_barrier
    s_branch PIECE_k45_kernel
QUIT_k45_kernel:
    s_waitcnt vmcnt(0)
FIN_k45_kernel:
END_k45_kernel:
    s_endpgm

.section .rodata,"a"
.p2align 6
.amdhsa_kernel k1_kernel
  .amdhsa_next_free_vgpr 128
  .amdhsa_next_free_sgpr 102
  .amdhsa_accum_offset 128
  .amdhsa_group_segment_fixed_size 0
  .amdhsa_kernarg_size 112
  .amdhsa_user_sgpr_count 2
  .amdhsa_user_sgpr_kernarg_segment_ptr 1
  .amdhsa_system_sgpr_workgroup_id_x 1
  .amdhsa_float_denorm_mode_32 3
  .amdhsa_float_denorm_mode_16_64 3
.end_amdhsa_kernel

.p2align 6
.amdhsa_kernel adaLN_cond__gqa_block_cached__glu_gated_geglu__prompt_kernel
  .amdhsa_next_free_vgpr 512
  .amdhsa_next_free_sgpr 102
  .amdhsa_accum_offset 256
  .amdhsa_group_segment_fixed_size 0
  .amdhsa_kernarg_size 112
  .amdhsa_user_sgpr_count 2
  .amdhsa_user_sgpr_kernarg_segment_ptr 1
  .amdhsa_system_sgpr_workgroup_id_x 1
  .amdhsa_float_denorm_mode_32 3
  .amdhsa_float_denorm_mode_16_64 3
.end_amdhsa_kernel

.p2align 6
.amdhsa_kernel k45_kernel
  .amdhsa_next_free_vgpr 512
  .amdhsa_next_free_sgpr 102
  .amdhsa_accum_offset 256
  .amdhsa_group_segment_fixed_size 0
  .amdhsa_kernarg_size 112
  .amdhsa_user_sgpr_count 2
  .amdhsa_user_sgpr_kernarg_segment_ptr 1
  .amdhsa_system_sgpr_workgroup_id_x 1
  .amdhsa_float_denorm_mode_32 3
  .amdhsa_float_denorm_mode_16_64 3
.end_amdhsa_kernel
```
